```python
import torch

def _softmax(x, axis=-1):
    return torch.softmax(x, dim=axis)

def _gelu(x):
    return torch.nn.functional.gelu(x, approximate='tanh')

def _silu(x):
    return torch.nn.functional.silu(x)

def _sigmoid(x):
    return torch.sigmoid(x)

def _layernorm(x, axis=-1, eps=1e-05):
    m = x.mean(dim=axis, keepdim=True)
    v = x.var(dim=axis, keepdim=True, unbiased=False)
    return (x - m) / torch.sqrt(v + eps)

def _scatter_add(tgt, idx, src, axis=0):
    return tgt.clone().index_add_(axis, idx, src)

def _segment_sum(src, seg, n):
    out = torch.zeros((n,) + src.shape[1:], dtype=src.dtype)
    return out.index_add_(0, seg, src)

def _pad(x, pw):
    flat = tuple((v for pair in reversed(pw) for v in pair))
    return torch.nn.functional.pad(x, flat)
kernel_name = 'standalone__conformer_family_branchformer__speech'

def setup_inputs():

    _w = lambda a: (lambda t: t.to(torch.bfloat16) if t.is_floating_point() else t)(torch.as_tensor(a))
    B, T, D, K = (2, 4000, 512, 5)
    s = float(D) ** (-0.5)
    return {'x': _w((lambda *s: torch.randn(*s, dtype=torch.bfloat16) * 0.05)(B, T, D)), 'w_q': _w((lambda *s: torch.randn(*s, dtype=torch.bfloat16) * 1.6)(D, D) * s), 'w_k': _w((lambda *s: torch.randn(*s, dtype=torch.bfloat16) * 1.6)(D, D) * s), 'w_v': _w((lambda *s: torch.randn(*s, dtype=torch.bfloat16) * 0.4)(D, D) * s), 'w_ao': _w((lambda *s: torch.randn(*s, dtype=torch.bfloat16) * 0.4)(D, D) * s), 'w_up': _w((lambda *s: torch.randn(*s, dtype=torch.bfloat16) * 0.8)(D, 2 * D) * s), 'dw': _w((lambda *s: torch.randn(*s, dtype=torch.bfloat16) * 0.8)(K, D) * (1.0 / K)), 'w_dn': _w((lambda *s: torch.randn(*s, dtype=torch.bfloat16) * 0.4)(D, D) * s), 'w_merge': _w((lambda *s: torch.randn(*s, dtype=torch.bfloat16) * 0.4)(2 * D, D) * s)}

def reference(x, w_q, w_k, w_v, w_ao, w_up, dw, w_dn, w_merge):
    B, T, D = x.shape
    K = dw.shape[0]
    xa = _layernorm(x, axis=-1)
    q = torch.einsum('btd,de->bte', xa, w_q)
    k = torch.einsum('btd,de->bte', xa, w_k)
    v = torch.einsum('btd,de->bte', xa, w_v)
    logits = torch.einsum('btd,bsd->bts', q, k) * float(D) ** (-0.5)
    attn = _softmax(logits, axis=-1)
    ya = torch.einsum('bts,bsd->btd', attn, v)
    ya = torch.einsum('btd,de->bte', ya, w_ao)
    xc = _layernorm(x, axis=-1)
    h = _gelu(torch.einsum('btd,de->bte', xc, w_up))
    u = h[..., :D].clone()
    g = _layernorm(h[..., D:], axis=-1)
    pad = K // 2
    gp = _pad(g, ((0, 0), (pad, pad), (0, 0)))
    conv = torch.zeros_like(g)
    for i in range(K):
        conv = conv + gp[:, i:i + T, :] * dw[i][None, None, :]
    yc = torch.einsum('btd,de->bte', u * conv, w_dn)
    merged = torch.concatenate([ya, yc], axis=-1)
    out = torch.einsum('btf,fd->btd', merged, w_merge)
    return x + out
```

```asm
; @launch grid=(256,1,1) block=(256,1,1) lds=163840
.amdgcn_target "amdgcn-amd-amdhsa--gfx950"
.text
.globl standalone__conformer_family_branchformer__speech_kernel
.p2align 8
.type standalone__conformer_family_branchformer__speech_kernel,@function
standalone__conformer_family_branchformer__speech_kernel:
s_cmp_lt_u32 s2, 256
s_cbranch_scc1 L_k2_go
s_endpgm
L_k2_go:
s_load_dwordx16 s[36:51], s[0:1], 0
s_load_dwordx8 s[52:59], s[0:1], 64
v_lshrrev_b32 v1, 6, v0
v_and_b32 v0, 63, v0
v_readfirstlane_b32 s20, v1
v_lshlrev_b32 v1, 4, v0
s_getpc_b64 s[72:73]
L_pc0:
s_lshr_b32 s21, s2, 3
s_lshl_b32 s21, s21, 2
s_add_u32 s21, s21, s20
s_lshl_b32 s21, s21, 10
v_add_u32 v8, s21, v1
v_min_u32 v8, L_code_end-L_pc0, v8
v_mov_b32 v9, s73
v_add_co_u32 v8, vcc, s72, v8
s_nop 1
v_addc_co_u32 v9, vcc, 0, v9, vcc
global_load_dword v7, v[8:9], off
s_lshr_b32 s21, s2, 3
s_and_b32 s22, s2, 1
s_lshl_b32 s23, s22, 1
s_sub_u32 s23, 26, s23
s_bfe_u32 s24, s2, 0x10001
s_mul_i32 s24, s24, 25
s_mul_i32 s25, s22, 13
s_add_u32 s24, s24, s25
s_lshl_b32 s24, s24, 1
s_add_u32 s24, s24, s21
s_lshl_b32 s24, s24, 1
s_bfe_u32 s25, s2, 0x10002
s_or_b32 s24, s24, s25
s_bfe_u32 s25, s2, 0x20001
s_mul_i32 s25, s25, 14
s_mul_i32 s26, s22, 6
s_add_u32 s25, s25, s26
s_add_u32 s25, s25, s21
s_sub_u32 s25, s25, s23
s_add_u32 s25, s25, 200
s_cmp_lt_u32 s21, s23
s_cselect_b32 s3, s24, s25
s_cmp_eq_u32 s3, 253
s_cselect_b32 s24, 213, s3
s_cmp_eq_u32 s3, 213
s_cselect_b32 s3, 253, s24
s_cmp_eq_u32 s3, 254
s_cselect_b32 s24, 227, s3
s_cmp_eq_u32 s3, 227
s_cselect_b32 s3, 254, s24
s_cmp_eq_u32 s3, 255
s_cselect_b32 s24, 241, s3
s_cmp_eq_u32 s3, 241
s_cselect_b32 s3, 255, s24
v_lshrrev_b32 v2, 4, v0
v_sub_u32 v4, 0, v2
v_xor_b32 v4, v4, v0
v_and_b32 v4, 3, v4
v_lshlrev_b32 v4, 4, v4
v_lshl_add_u32 v4, v2, 13, v4
v_bfe_u32 v5, v0, 2, 2
v_lshl_add_u32 v4, v5, 10, v4
s_and_b32 s23, s2, 3
s_lshl_b32 s23, s23, 2
s_bfe_u32 s21, s2, 0x20003
s_add_u32 s23, s23, s21
s_bfe_u32 s22, s2, 0x10002
s_lshl_b32 s22, s22, 3
s_lshr_b32 s21, s2, 5
s_add_u32 s22, s22, s21
s_lshl_b32 s21, s20, 8
s_lshl_b32 s24, s23, 15
s_add_u32 s24, s24, s21
s_add_u32 s25, s24, 4096
s_lshl_b32 s26, s22, 15
s_add_u32 s26, s26, s21
s_add_u32 s27, s26, 4096
s_sub_u32 s21, s3, 200
s_cmp_lt_u32 s21, 53
s_cselect_b32 s33, 0x18000, 0
s_mov_b32 s31, 147456
s_cselect_b32 s31, 81920, s31
s_lshl_b32 s32, s20, 14
s_add_u32 s32, s32, s33
s_lshl_b32 s21, s20, 11
s_add_u32 s31, s31, s21
s_waitcnt lgkmcnt(0)
s_mov_b32 s60, s38
s_and_b32 s61, s39, 0xffff
s_mov_b32 s62, 0x80000
s_mov_b32 s63, 0x20000
s_mov_b32 s64, s40
s_and_b32 s65, s41, 0xffff
s_mov_b32 s66, 0x80000
s_mov_b32 s67, 0x20000
s_add_u32 m0, s32, 0
s_nop 0
buffer_load_dwordx4 v4, s[60:63], s24 offen offset:0 lds
s_add_u32 m0, s32, 4032
s_nop 0
buffer_load_dwordx4 v4, s[60:63], s24 offen offset:64 lds
s_add_u32 m0, s32, 1024
s_nop 0
buffer_load_dwordx4 v4, s[60:63], s25 offen offset:0 lds
s_add_u32 m0, s32, 5056
s_nop 0
buffer_load_dwordx4 v4, s[60:63], s25 offen offset:64 lds
s_add_u32 m0, s32, 2048
s_nop 0
buffer_load_dwordx4 v4, s[64:67], s26 offen offset:0 lds
s_add_u32 m0, s32, 6080
s_nop 0
buffer_load_dwordx4 v4, s[64:67], s26 offen offset:64 lds
s_add_u32 m0, s32, 3072
s_nop 0
buffer_load_dwordx4 v4, s[64:67], s27 offen offset:0 lds
s_add_u32 m0, s32, 7104
s_nop 0
buffer_load_dwordx4 v4, s[64:67], s27 offen offset:64 lds
s_add_u32 m0, s32, 8064
s_nop 0
buffer_load_dwordx4 v4, s[60:63], s24 offen offset:128 lds
s_add_u32 m0, s32, 12096
s_nop 0
buffer_load_dwordx4 v4, s[60:63], s24 offen offset:192 lds
s_add_u32 m0, s32, 9088
s_nop 0
buffer_load_dwordx4 v4, s[60:63], s25 offen offset:128 lds
s_add_u32 m0, s32, 13120
s_nop 0
buffer_load_dwordx4 v4, s[60:63], s25 offen offset:192 lds
s_add_u32 m0, s32, 10112
s_nop 0
buffer_load_dwordx4 v4, s[64:67], s26 offen offset:128 lds
s_add_u32 m0, s32, 14144
s_nop 0
buffer_load_dwordx4 v4, s[64:67], s26 offen offset:192 lds
s_add_u32 m0, s32, 11136
s_nop 0
buffer_load_dwordx4 v4, s[64:67], s27 offen offset:128 lds
s_add_u32 m0, s32, 15168
s_nop 0
buffer_load_dwordx4 v4, s[64:67], s27 offen offset:192 lds
s_add_u32 s4, s58, 0x3420000
s_addc_u32 s5, s59, 0
s_load_dword s7, s[4:5], 0
s_mov_b32 s8, s58
s_and_b32 s9, s59, 0xffff
s_mov_b32 s10, 0x10000000
s_mov_b32 s11, 0x20000
s_mov_b32 s72, s36
s_and_b32 s73, s37, 0xffff
s_mov_b32 s74, 0x7d0000
s_mov_b32 s75, 0x20000
s_lshl_b32 s30, s22, 4
s_add_u32 s30, s30, s23
s_lshr_b32 s24, s30, 6
s_bfe_u32 s25, s30, 0x10004
s_lshl_b32 s25, s25, 3
s_bfe_u32 s26, s30, 0x10003
s_add_u32 s25, s25, s26
s_lshl_b32 s26, s24, 1
s_add_u32 s25, s25, s26
s_and_b32 s26, s30, 7
s_bfe_u32 s27, s30, 0x20003
s_lshl_b32 s24, s24, 2
s_add_u32 s27, s27, s24
s_bitcmp0_b32 s30, 5
s_cselect_b32 s34, s25, s26
s_cselect_b32 s35, s26, s27
s_cselect_b32 s68, s46, s52
s_cselect_b32 s69, s47, s53
s_cselect_b32 s28, 11, 10
s_mov_b32 s29, 0x3300000
s_cselect_b32 s29, 0x3200000, s29
s_mov_b32 s70, 0x100000
s_cselect_b32 s70, 0x100000, s70
s_and_b32 s69, s69, 0xffff
s_mov_b32 s71, 0x20000
s_lshl_b32 s34, s34, 1
s_and_b32 s21, s20, 1
s_add_u32 s34, s34, s21
s_lshl_b32 s35, s35, 1
s_lshr_b32 s21, s20, 1
s_add_u32 s35, s35, s21
v_lshrrev_b32 v5, 2, v0
v_lshlrev_b32 v5, s28, v5
v_and_b32 v6, 3, v0
v_lshl_add_u32 v5, v6, 4, v5
s_add_u32 s21, s28, 5
s_lshl_b32 s24, s35, s21
s_lshl_b32 s21, s34, 6
s_add_u32 s24, s24, s21
s_lshl_b32 s21, 16, s28
s_add_u32 s25, s24, s21
s_add_u32 m0, s31, 0
s_nop 0
buffer_load_dwordx4 v5, s[68:71], s24 offen lds
s_add_u32 m0, s31, 1024
s_nop 0
buffer_load_dwordx4 v5, s[68:71], s25 offen lds
s_lshr_b32 s24, s3, 2
s_mul_i32 s24, s24, 80
s_and_b32 s25, s3, 1
s_mul_i32 s25, s25, 4000
s_add_u32 s24, s24, s25
s_sub_u32 s25, s3, 200
s_mul_i32 s25, s25, 76
s_sub_u32 s25, s25, 2
s_cmp_lt_u32 s3, 253
s_cselect_b32 s25, s25, 0x4000
s_bfe_u32 s14, s3, 0x10001
s_lshl_b32 s12, s24, 10
s_cmp_lt_u32 s3, 200
s_cselect_b32 s24, s24, s25
s_cselect_b32 s26, 1, 5
s_mov_b32 s27, 1024
s_cselect_b32 s27, 0x4000, s27
s_cselect_b32 s14, s14, 0
s_cselect_b32 s12, s12, 0x10000000
s_cselect_b32 s13, 0x10000, 0
s_mov_b32 s6, 0x3280000
s_cselect_b32 s6, 0x3000000, s6
s_sub_u32 s101, 0, s20
v_xor_b32 v13, s101, v0
v_and_b32 v13, 3, v13
v_lshlrev_b32 v13, 4, v13
v_lshrrev_b32 v12, 4, v0
v_lshl_add_u32 v13, v12, 6, v13
s_lshl_b32 s101, s20, 2
v_bfe_u32 v12, v0, 2, 2
v_add_u32 v12, s101, v12
v_mul_u32_u24 v12, s26, v12
v_lshl_add_u32 v12, v12, 10, v13
s_lshl_b32 s24, s24, 10
v_add_u32 v12, s24, v12
s_lshl_b32 s16, s14, 9
s_xor_b32 s17, s16, 512
v_add_u32 v13, s27, v12
v_add_u32 v14, s27, v13
v_add_u32 v15, s27, v14
v_add_u32 v16, s27, v15
v_bfe_u32 v3, v0, 2, 2
v_sub_u32 v3, 0, v3
v_lshrrev_b32 v2, 4, v0
v_xor_b32 v3, v3, v2
v_and_b32 v3, 3, v3
v_and_b32 v2, 15, v0
v_lshl_add_u32 v2, v2, 2, v3
v_lshlrev_b32 v2, 4, v2
v_add_u32 v2, s32, v2
v_and_b32 v6, 15, v0
v_lshlrev_b32 v6, 4, v6
v_lshrrev_b32 v3, 4, v0
v_lshl_add_u32 v6, v3, 9, v6
v_add_u32 v6, s31, v6
s_waitcnt vmcnt(11)
ds_read_b128 v[128:131], v2 offset:0
ds_read_b128 v[132:135], v2 offset:1024
ds_read_b128 v[136:139], v2 offset:2048
ds_read_b128 v[140:143], v2 offset:3072
s_waitcnt vmcnt(10)
ds_read_b128 v[144:147], v2 offset:4096
ds_read_b128 v[148:151], v2 offset:5120
ds_read_b128 v[152:155], v2 offset:6144
ds_read_b128 v[156:159], v2 offset:7168
s_waitcnt vmcnt(3)
ds_read_b128 v[160:163], v2 offset:8192
ds_read_b128 v[164:167], v2 offset:9216
ds_read_b128 v[168:171], v2 offset:10240
ds_read_b128 v[172:175], v2 offset:11264
s_waitcnt vmcnt(2)
ds_read_b128 v[176:179], v2 offset:12288
ds_read_b128 v[180:183], v2 offset:13312
ds_read_b128 v[184:187], v2 offset:14336
ds_read_b128 v[188:191], v2 offset:15360
buffer_load_dwordx4 v[192:195], v12, s[72:75], s16 offen offset:0
buffer_load_dwordx4 v[196:199], v12, s[72:75], s16 offen offset:256
buffer_load_dwordx4 v[200:203], v12, s[72:75], s17 offen offset:0
buffer_load_dwordx4 v[204:207], v12, s[72:75], s17 offen offset:256
s_waitcnt lgkmcnt(12)
v_mfma_f32_16x16x32_bf16 v[76:79], v[128:131], v[136:139], 0
v_mfma_f32_16x16x32_bf16 v[80:83], v[132:135], v[136:139], 0
v_mfma_f32_16x16x32_bf16 v[84:87], v[128:131], v[140:143], 0
v_mfma_f32_16x16x32_bf16 v[88:91], v[132:135], v[140:143], 0
buffer_load_dwordx4 v[208:211], v13, s[72:75], s16 offen offset:0
buffer_load_dwordx4 v[212:215], v13, s[72:75], s16 offen offset:256
buffer_load_dwordx4 v[216:219], v13, s[72:75], s17 offen offset:0
buffer_load_dwordx4 v[220:223], v13, s[72:75], s17 offen offset:256
s_waitcnt lgkmcnt(8)
v_mfma_f32_16x16x32_bf16 v[76:79], v[144:147], v[152:155], v[76:79]
v_mfma_f32_16x16x32_bf16 v[80:83], v[148:151], v[152:155], v[80:83]
v_mfma_f32_16x16x32_bf16 v[84:87], v[144:147], v[156:159], v[84:87]
v_mfma_f32_16x16x32_bf16 v[88:91], v[148:151], v[156:159], v[88:91]
s_waitcnt lgkmcnt(4)
v_mfma_f32_16x16x32_bf16 v[76:79], v[160:163], v[168:171], v[76:79]
v_mfma_f32_16x16x32_bf16 v[80:83], v[164:167], v[168:171], v[80:83]
v_mfma_f32_16x16x32_bf16 v[84:87], v[160:163], v[172:175], v[84:87]
v_mfma_f32_16x16x32_bf16 v[88:91], v[164:167], v[172:175], v[88:91]
s_waitcnt lgkmcnt(0)
v_mfma_f32_16x16x32_bf16 v[76:79], v[176:179], v[184:187], v[76:79]
v_mfma_f32_16x16x32_bf16 v[80:83], v[180:183], v[184:187], v[80:83]
v_mfma_f32_16x16x32_bf16 v[84:87], v[176:179], v[188:191], v[84:87]
v_mfma_f32_16x16x32_bf16 v[88:91], v[180:183], v[188:191], v[88:91]
s_waitcnt vmcnt(8)
ds_read_b64_tr_b16 v[92:93], v6 offset:0
ds_read_b64_tr_b16 v[94:95], v6 offset:256
ds_read_b64_tr_b16 v[96:97], v6 offset:8
ds_read_b64_tr_b16 v[98:99], v6 offset:264
v_add_u32 v22, s32, v1
s_and_b32 s21, s20, 1
s_lshl_b32 s24, s21, 11
s_add_u32 s24, s24, s33
v_add_u32 v23, s24, v1
s_lshl_b32 s22, s22, 1
s_add_u32 s22, s22, s21
s_lshl_b32 s22, s22, 14
s_lshl_b32 s23, s23, 10
s_add_u32 s22, s22, s23
s_add_u32 s22, s22, 0x3000000
s_cmp_lt_u32 s20, 2
s_cselect_b32 s22, s22, 0x10000000
ds_write_b128 v22, v[76:79] offset:0
ds_write_b128 v22, v[80:83] offset:1024
ds_write_b128 v22, v[84:87] offset:2048
ds_write_b128 v22, v[88:91] offset:3072
s_lshr_b32 s21, s35, 4
s_lshl_b32 s21, s21, 19
s_add_u32 s29, s29, s21
s_and_b32 s21, s35, 15
s_lshl_b32 s21, s21, 10
s_add_u32 s29, s29, s21
s_lshl_b32 s21, s34, 15
s_add_u32 s24, s29, s21
s_add_u32 s25, s24, 16384
s_waitcnt lgkmcnt(0)
s_barrier
ds_read_b128 v[128:131], v23 offset:0
ds_read_b128 v[132:135], v23 offset:1024
ds_read_b128 v[136:139], v23 offset:16384
ds_read_b128 v[140:143], v23 offset:17408
ds_read_b128 v[144:147], v23 offset:32768
ds_read_b128 v[148:151], v23 offset:33792
ds_read_b128 v[152:155], v23 offset:49152
ds_read_b128 v[156:159], v23 offset:50176
buffer_store_dwordx4 v[92:95], v1, s[8:11], s24 offen sc1
buffer_store_dwordx4 v[96:99], v1, s[8:11], s25 offen sc1
v_mov_b32 v60, 0x3d8293ee
s_add_u32 s7, s7, 0x9e3779b9
v_min_u32 v20, 1, v0
v_lshlrev_b32 v20, 30, v20
v_mov_b32 v21, s7
s_lshl_b32 s30, s30, 7
s_add_u32 s30, s30, 0x3418000
s_cmp_eq_u32 s20, 0
s_cselect_b32 s30, s30, 0x10000000
s_lshl_b32 s21, s20, 13
s_add_u32 s21, s21, 0x3418000
v_lshl_add_u32 v18, v0, 7, s21
s_waitcnt lgkmcnt(4)
v_pk_add_f32 v[128:129], v[128:129], v[136:137]
v_pk_add_f32 v[130:131], v[130:131], v[138:139]
v_pk_add_f32 v[132:133], v[132:133], v[140:141]
v_pk_add_f32 v[134:135], v[134:135], v[142:143]
s_waitcnt lgkmcnt(2)
v_pk_add_f32 v[128:129], v[128:129], v[144:145]
v_pk_add_f32 v[130:131], v[130:131], v[146:147]
v_pk_add_f32 v[132:133], v[132:133], v[148:149]
v_pk_add_f32 v[134:135], v[134:135], v[150:151]
s_waitcnt lgkmcnt(0)
v_pk_add_f32 v[128:129], v[128:129], v[152:153]
v_pk_add_f32 v[130:131], v[130:131], v[154:155]
v_pk_add_f32 v[132:133], v[132:133], v[156:157]
v_pk_add_f32 v[134:135], v[134:135], v[158:159]
v_pk_mul_f32 v[128:129], v[128:129], v[60:61] op_sel_hi:[1,0]
v_pk_mul_f32 v[130:131], v[130:131], v[60:61] op_sel_hi:[1,0]
v_pk_mul_f32 v[132:133], v[132:133], v[60:61] op_sel_hi:[1,0]
v_pk_mul_f32 v[134:135], v[134:135], v[60:61] op_sel_hi:[1,0]
v_cvt_pk_bf16_f32 v128, v128, v129
v_cvt_pk_bf16_f32 v129, v130, v131
v_cvt_pk_bf16_f32 v130, v132, v133
v_cvt_pk_bf16_f32 v131, v134, v135
buffer_store_dwordx4 v[128:131], v1, s[8:11], s22 offen sc1
s_cmp_lt_u32 s3, 253
s_cbranch_scc0 L_k2_spare
v_and_b32 v3, 15, v0
s_lshl_b32 s101, s20, 8
v_lshl_add_u32 v3, v3, 4, s101
v_lshrrev_b32 v17, 4, v0
v_lshl_add_u32 v17, v17, 10, v3
s_lshl_b32 s21, s14, 13
v_add_u32 v17, s21, v17
v_add_u32 v8, s13, v17
v_xor_b32 v9, 0x2000, v8
v_add_u32 v10, 0x10000, v8
v_add_u32 v11, 0x10000, v9
s_mov_b32 s15, 0xffff0000
s_lshl_b32 s21, s20, 17
s_add_u32 s6, s6, s21
v_mov_b32 v66, 0x3f803f80
s_mul_i32 s21, s14, 98304
s_add_u32 s6, s6, s21
v_mov_b32 v60, 0
v_mov_b32 v61, 0
s_waitcnt vmcnt(10)
v_dot2c_f32_bf16 v60, v192, v66
v_dot2c_f32_bf16 v61, v192, v192
v_dot2c_f32_bf16 v60, v193, v66
v_dot2c_f32_bf16 v61, v193, v193
v_dot2c_f32_bf16 v60, v194, v66
v_dot2c_f32_bf16 v61, v194, v194
v_dot2c_f32_bf16 v60, v195, v66
v_dot2c_f32_bf16 v61, v195, v195
s_waitcnt vmcnt(9)
v_dot2c_f32_bf16 v60, v196, v66
v_dot2c_f32_bf16 v61, v196, v196
v_dot2c_f32_bf16 v60, v197, v66
v_dot2c_f32_bf16 v61, v197, v197
buffer_load_dwordx4 v[224:227], v14, s[72:75], s16 offen offset:0
v_dot2c_f32_bf16 v60, v198, v66
v_dot2c_f32_bf16 v61, v198, v198
v_dot2c_f32_bf16 v60, v199, v66
v_dot2c_f32_bf16 v61, v199, v199
s_waitcnt vmcnt(9)
v_dot2c_f32_bf16 v60, v200, v66
v_dot2c_f32_bf16 v61, v200, v200
v_dot2c_f32_bf16 v60, v201, v66
v_dot2c_f32_bf16 v61, v201, v201
v_dot2c_f32_bf16 v60, v202, v66
v_dot2c_f32_bf16 v61, v202, v202
v_dot2c_f32_bf16 v60, v203, v66
v_dot2c_f32_bf16 v61, v203, v203
s_waitcnt vmcnt(8)
v_dot2c_f32_bf16 v60, v204, v66
v_dot2c_f32_bf16 v61, v204, v204
buffer_load_dwordx4 v[228:231], v14, s[72:75], s16 offen offset:256
v_dot2c_f32_bf16 v60, v205, v66
v_dot2c_f32_bf16 v61, v205, v205
v_dot2c_f32_bf16 v60, v206, v66
v_dot2c_f32_bf16 v61, v206, v206
v_dot2c_f32_bf16 v60, v207, v66
v_dot2c_f32_bf16 v61, v207, v207
v_lshlrev_b32 v76, 16, v192
v_and_b32 v77, s15, v192
v_lshlrev_b32 v78, 16, v193
v_and_b32 v79, s15, v193
v_add_f32_dpp v60, v60, v60 quad_perm:[1,0,3,2] row_mask:0xf bank_mask:0xf
v_add_f32_dpp v61, v61, v61 quad_perm:[1,0,3,2] row_mask:0xf bank_mask:0xf
v_lshlrev_b32 v80, 16, v194
v_and_b32 v81, s15, v194
buffer_load_dwordx4 v[232:235], v14, s[72:75], s17 offen offset:0
v_lshlrev_b32 v82, 16, v195
v_and_b32 v83, s15, v195
v_add_f32_dpp v60, v60, v60 quad_perm:[2,3,0,1] row_mask:0xf bank_mask:0xf
v_add_f32_dpp v61, v61, v61 quad_perm:[2,3,0,1] row_mask:0xf bank_mask:0xf
v_mov_b32 v62, v60
v_mov_b32 v63, v61
v_lshlrev_b32 v84, 16, v196
v_and_b32 v85, s15, v196
v_lshlrev_b32 v86, 16, v197
v_and_b32 v87, s15, v197
v_permlane16_swap_b32 v62, v60
v_permlane16_swap_b32 v63, v61
v_add_f32 v60, v60, v62
v_add_f32 v61, v61, v63
buffer_load_dwordx4 v[236:239], v14, s[72:75], s17 offen offset:256
v_mov_b32 v62, v60
v_mov_b32 v63, v61
v_lshlrev_b32 v88, 16, v198
v_and_b32 v89, s15, v198
v_lshlrev_b32 v90, 16, v199
v_and_b32 v91, s15, v199
v_permlane32_swap_b32 v62, v60
v_permlane32_swap_b32 v63, v61
v_add_f32 v60, v60, v62
v_add_f32 v61, v61, v63
v_mul_f32 v60, 0xbb000000, v60
v_mul_f32 v61, 0x3b000000, v61
v_fma_f32 v61, -v60, v60, v61
v_max_f32 v61, 0, v61
buffer_load_dwordx4 v[240:243], v15, s[72:75], s16 offen offset:0
v_add_f32 v61, 0x3727c5ac, v61
v_rsq_f32 v62, v61
v_lshlrev_b32 v92, 16, v200
v_and_b32 v93, s15, v200
v_lshlrev_b32 v94, 16, v201
v_and_b32 v95, s15, v201
v_mul_f32 v64, v60, v62
v_lshlrev_b32 v96, 16, v202
v_and_b32 v97, s15, v202
v_lshlrev_b32 v98, 16, v203
s_waitcnt vmcnt(5)
s_barrier
buffer_store_dword v21, v20, s[8:11], s30 offen sc1
v_and_b32 v99, s15, v203
v_lshlrev_b32 v100, 16, v204
v_and_b32 v101, s15, v204
v_lshlrev_b32 v102, 16, v205
buffer_load_dwordx4 v[244:247], v15, s[72:75], s16 offen offset:256
v_and_b32 v103, s15, v205
v_lshlrev_b32 v104, 16, v206
v_and_b32 v105, s15, v206
v_lshlrev_b32 v106, 16, v207
v_and_b32 v107, s15, v207
v_pk_fma_f32 v[76:77], v[76:77], v[62:63], v[64:65] op_sel_hi:[1,0,0]
v_pk_fma_f32 v[78:79], v[78:79], v[62:63], v[64:65] op_sel_hi:[1,0,0]
v_pk_fma_f32 v[80:81], v[80:81], v[62:63], v[64:65] op_sel_hi:[1,0,0]
v_pk_fma_f32 v[82:83], v[82:83], v[62:63], v[64:65] op_sel_hi:[1,0,0]
v_cvt_pk_bf16_f32 v192, v76, v77
v_cvt_pk_bf16_f32 v193, v78, v79
v_cvt_pk_bf16_f32 v194, v80, v81
v_cvt_pk_bf16_f32 v195, v82, v83
ds_write_b128 v8, v[192:195] offset:0
buffer_load_dwordx4 v[248:251], v15, s[72:75], s17 offen offset:0
s_add_u32 s24, s12, 0
buffer_store_dwordx4 v[192:195], v17, s[8:11], s24 offen sc1
v_pk_fma_f32 v[84:85], v[84:85], v[62:63], v[64:65] op_sel_hi:[1,0,0]
v_pk_fma_f32 v[86:87], v[86:87], v[62:63], v[64:65] op_sel_hi:[1,0,0]
v_pk_fma_f32 v[88:89], v[88:89], v[62:63], v[64:65] op_sel_hi:[1,0,0]
v_pk_fma_f32 v[90:91], v[90:91], v[62:63], v[64:65] op_sel_hi:[1,0,0]
v_cvt_pk_bf16_f32 v196, v84, v85
v_cvt_pk_bf16_f32 v197, v86, v87
v_cvt_pk_bf16_f32 v198, v88, v89
v_cvt_pk_bf16_f32 v199, v90, v91
ds_write_b128 v8, v[196:199] offset:4096
s_add_u32 s24, s12, 4096
buffer_store_dwordx4 v[196:199], v17, s[8:11], s24 offen sc1
v_pk_fma_f32 v[92:93], v[92:93], v[62:63], v[64:65] op_sel_hi:[1,0,0]
buffer_load_dwordx4 v[252:255], v15, s[72:75], s17 offen offset:256
v_pk_fma_f32 v[94:95], v[94:95], v[62:63], v[64:65] op_sel_hi:[1,0,0]
v_pk_fma_f32 v[96:97], v[96:97], v[62:63], v[64:65] op_sel_hi:[1,0,0]
v_pk_fma_f32 v[98:99], v[98:99], v[62:63], v[64:65] op_sel_hi:[1,0,0]
v_cvt_pk_bf16_f32 v200, v92, v93
v_cvt_pk_bf16_f32 v201, v94, v95
v_cvt_pk_bf16_f32 v202, v96, v97
v_cvt_pk_bf16_f32 v203, v98, v99
ds_write_b128 v9, v[200:203] offset:0
v_pk_fma_f32 v[100:101], v[100:101], v[62:63], v[64:65] op_sel_hi:[1,0,0]
v_pk_fma_f32 v[102:103], v[102:103], v[62:63], v[64:65] op_sel_hi:[1,0,0]
v_pk_fma_f32 v[104:105], v[104:105], v[62:63], v[64:65] op_sel_hi:[1,0,0]
v_pk_fma_f32 v[106:107], v[106:107], v[62:63], v[64:65] op_sel_hi:[1,0,0]
v_cvt_pk_bf16_f32 v204, v100, v101
v_cvt_pk_bf16_f32 v205, v102, v103
v_cvt_pk_bf16_f32 v206, v104, v105
v_cvt_pk_bf16_f32 v207, v106, v107
ds_write_b128 v9, v[204:207] offset:4096
v_mov_b32 v60, 0
v_mov_b32 v61, 0
v_dot2c_f32_bf16 v60, v208, v66
v_dot2c_f32_bf16 v61, v208, v208
v_dot2c_f32_bf16 v60, v209, v66
v_dot2c_f32_bf16 v61, v209, v209
v_dot2c_f32_bf16 v60, v210, v66
v_dot2c_f32_bf16 v61, v210, v210
v_dot2c_f32_bf16 v60, v211, v66
v_dot2c_f32_bf16 v61, v211, v211
v_dot2c_f32_bf16 v60, v212, v66
v_dot2c_f32_bf16 v61, v212, v212
v_dot2c_f32_bf16 v60, v213, v66
v_dot2c_f32_bf16 v61, v213, v213
v_dot2c_f32_bf16 v60, v214, v66
v_dot2c_f32_bf16 v61, v214, v214
v_dot2c_f32_bf16 v60, v215, v66
v_dot2c_f32_bf16 v61, v215, v215
v_dot2c_f32_bf16 v60, v216, v66
v_dot2c_f32_bf16 v61, v216, v216
v_dot2c_f32_bf16 v60, v217, v66
v_dot2c_f32_bf16 v61, v217, v217
v_dot2c_f32_bf16 v60, v218, v66
v_dot2c_f32_bf16 v61, v218, v218
v_dot2c_f32_bf16 v60, v219, v66
buffer_load_dwordx4 v[112:115], v16, s[72:75], s16 offen offset:0
v_dot2c_f32_bf16 v61, v219, v219
v_dot2c_f32_bf16 v60, v220, v66
v_dot2c_f32_bf16 v61, v220, v220
v_dot2c_f32_bf16 v60, v221, v66
v_dot2c_f32_bf16 v61, v221, v221
v_dot2c_f32_bf16 v60, v222, v66
v_dot2c_f32_bf16 v61, v222, v222
v_dot2c_f32_bf16 v60, v223, v66
v_dot2c_f32_bf16 v61, v223, v223
v_lshlrev_b32 v76, 16, v208
v_and_b32 v77, s15, v208
v_lshlrev_b32 v78, 16, v209
v_and_b32 v79, s15, v209
v_add_f32_dpp v60, v60, v60 quad_perm:[1,0,3,2] row_mask:0xf bank_mask:0xf
v_add_f32_dpp v61, v61, v61 quad_perm:[1,0,3,2] row_mask:0xf bank_mask:0xf
v_lshlrev_b32 v80, 16, v210
v_and_b32 v81, s15, v210
v_lshlrev_b32 v82, 16, v211
v_and_b32 v83, s15, v211
v_add_f32_dpp v60, v60, v60 quad_perm:[2,3,0,1] row_mask:0xf bank_mask:0xf
v_add_f32_dpp v61, v61, v61 quad_perm:[2,3,0,1] row_mask:0xf bank_mask:0xf
v_mov_b32 v62, v60
v_mov_b32 v63, v61
v_lshlrev_b32 v84, 16, v212
v_and_b32 v85, s15, v212
buffer_load_dwordx4 v[116:119], v16, s[72:75], s16 offen offset:256
v_lshlrev_b32 v86, 16, v213
v_and_b32 v87, s15, v213
v_permlane16_swap_b32 v62, v60
v_permlane16_swap_b32 v63, v61
v_add_f32 v60, v60, v62
v_add_f32 v61, v61, v63
v_mov_b32 v62, v60
v_mov_b32 v63, v61
v_lshlrev_b32 v88, 16, v214
v_and_b32 v89, s15, v214
v_lshlrev_b32 v90, 16, v215
v_and_b32 v91, s15, v215
v_permlane32_swap_b32 v62, v60
v_permlane32_swap_b32 v63, v61
v_add_f32 v60, v60, v62
v_add_f32 v61, v61, v63
v_mul_f32 v60, 0xbb000000, v60
v_mul_f32 v61, 0x3b000000, v61
v_fma_f32 v61, -v60, v60, v61
v_max_f32 v61, 0, v61
v_add_f32 v61, 0x3727c5ac, v61
v_rsq_f32 v62, v61
v_lshlrev_b32 v92, 16, v216
v_and_b32 v93, s15, v216
v_lshlrev_b32 v94, 16, v217
buffer_load_dwordx4 v[120:123], v16, s[72:75], s17 offen offset:0
v_and_b32 v95, s15, v217
v_mul_f32 v64, v60, v62
v_lshlrev_b32 v96, 16, v218
v_and_b32 v97, s15, v218
v_lshlrev_b32 v98, 16, v219
v_and_b32 v99, s15, v219
v_lshlrev_b32 v100, 16, v220
v_and_b32 v101, s15, v220
v_lshlrev_b32 v102, 16, v221
v_and_b32 v103, s15, v221
v_lshlrev_b32 v104, 16, v222
v_and_b32 v105, s15, v222
v_lshlrev_b32 v106, 16, v223
v_and_b32 v107, s15, v223
v_pk_fma_f32 v[76:77], v[76:77], v[62:63], v[64:65] op_sel_hi:[1,0,0]
v_pk_fma_f32 v[78:79], v[78:79], v[62:63], v[64:65] op_sel_hi:[1,0,0]
v_pk_fma_f32 v[80:81], v[80:81], v[62:63], v[64:65] op_sel_hi:[1,0,0]
v_pk_fma_f32 v[82:83], v[82:83], v[62:63], v[64:65] op_sel_hi:[1,0,0]
v_cvt_pk_bf16_f32 v208, v76, v77
v_cvt_pk_bf16_f32 v209, v78, v79
v_cvt_pk_bf16_f32 v210, v80, v81
v_cvt_pk_bf16_f32 v211, v82, v83
ds_write_b128 v8, v[208:211] offset:16384
s_add_u32 s24, s12, 16384
buffer_store_dwordx4 v[208:211], v17, s[8:11], s24 offen sc1
buffer_load_dwordx4 v[124:127], v16, s[72:75], s17 offen offset:256
v_pk_fma_f32 v[84:85], v[84:85], v[62:63], v[64:65] op_sel_hi:[1,0,0]
v_pk_fma_f32 v[86:87], v[86:87], v[62:63], v[64:65] op_sel_hi:[1,0,0]
v_pk_fma_f32 v[88:89], v[88:89], v[62:63], v[64:65] op_sel_hi:[1,0,0]
v_pk_fma_f32 v[90:91], v[90:91], v[62:63], v[64:65] op_sel_hi:[1,0,0]
v_cvt_pk_bf16_f32 v212, v84, v85
v_cvt_pk_bf16_f32 v213, v86, v87
v_cvt_pk_bf16_f32 v214, v88, v89
v_cvt_pk_bf16_f32 v215, v90, v91
ds_write_b128 v8, v[212:215] offset:20480
s_add_u32 s24, s12, 20480
buffer_store_dwordx4 v[212:215], v17, s[8:11], s24 offen sc1
v_pk_fma_f32 v[92:93], v[92:93], v[62:63], v[64:65] op_sel_hi:[1,0,0]
v_pk_fma_f32 v[94:95], v[94:95], v[62:63], v[64:65] op_sel_hi:[1,0,0]
v_pk_fma_f32 v[96:97], v[96:97], v[62:63], v[64:65] op_sel_hi:[1,0,0]
v_pk_fma_f32 v[98:99], v[98:99], v[62:63], v[64:65] op_sel_hi:[1,0,0]
v_cvt_pk_bf16_f32 v216, v92, v93
v_cvt_pk_bf16_f32 v217, v94, v95
v_cvt_pk_bf16_f32 v218, v96, v97
v_cvt_pk_bf16_f32 v219, v98, v99
ds_write_b128 v9, v[216:219] offset:16384
v_pk_fma_f32 v[100:101], v[100:101], v[62:63], v[64:65] op_sel_hi:[1,0,0]
v_pk_fma_f32 v[102:103], v[102:103], v[62:63], v[64:65] op_sel_hi:[1,0,0]
v_pk_fma_f32 v[104:105], v[104:105], v[62:63], v[64:65] op_sel_hi:[1,0,0]
v_pk_fma_f32 v[106:107], v[106:107], v[62:63], v[64:65] op_sel_hi:[1,0,0]
v_cvt_pk_bf16_f32 v220, v100, v101
v_cvt_pk_bf16_f32 v221, v102, v103
v_cvt_pk_bf16_f32 v222, v104, v105
v_cvt_pk_bf16_f32 v223, v106, v107
ds_write_b128 v9, v[220:223] offset:20480
v_mov_b32 v60, 0
v_mov_b32 v61, 0
s_waitcnt vmcnt(16)
v_dot2c_f32_bf16 v60, v224, v66
v_dot2c_f32_bf16 v61, v224, v224
v_dot2c_f32_bf16 v60, v225, v66
v_dot2c_f32_bf16 v61, v225, v225
v_dot2c_f32_bf16 v60, v226, v66
v_dot2c_f32_bf16 v61, v226, v226
v_dot2c_f32_bf16 v60, v227, v66
v_dot2c_f32_bf16 v61, v227, v227
s_waitcnt vmcnt(15)
v_dot2c_f32_bf16 v60, v228, v66
v_dot2c_f32_bf16 v61, v228, v228
v_dot2c_f32_bf16 v60, v229, v66
v_dot2c_f32_bf16 v61, v229, v229
v_dot2c_f32_bf16 v60, v230, v66
v_dot2c_f32_bf16 v61, v230, v230
v_dot2c_f32_bf16 v60, v231, v66
v_dot2c_f32_bf16 v61, v231, v231
s_waitcnt vmcnt(14)
v_dot2c_f32_bf16 v60, v232, v66
v_dot2c_f32_bf16 v61, v232, v232
v_dot2c_f32_bf16 v60, v233, v66
v_dot2c_f32_bf16 v61, v233, v233
v_dot2c_f32_bf16 v60, v234, v66
v_dot2c_f32_bf16 v61, v234, v234
v_dot2c_f32_bf16 v60, v235, v66
v_dot2c_f32_bf16 v61, v235, v235
s_waitcnt vmcnt(13)
v_dot2c_f32_bf16 v60, v236, v66
v_dot2c_f32_bf16 v61, v236, v236
v_dot2c_f32_bf16 v60, v237, v66
v_dot2c_f32_bf16 v61, v237, v237
v_dot2c_f32_bf16 v60, v238, v66
v_dot2c_f32_bf16 v61, v238, v238
v_dot2c_f32_bf16 v60, v239, v66
v_dot2c_f32_bf16 v61, v239, v239
v_lshlrev_b32 v76, 16, v224
v_and_b32 v77, s15, v224
v_lshlrev_b32 v78, 16, v225
v_and_b32 v79, s15, v225
v_add_f32_dpp v60, v60, v60 quad_perm:[1,0,3,2] row_mask:0xf bank_mask:0xf
v_add_f32_dpp v61, v61, v61 quad_perm:[1,0,3,2] row_mask:0xf bank_mask:0xf
v_lshlrev_b32 v80, 16, v226
v_and_b32 v81, s15, v226
v_lshlrev_b32 v82, 16, v227
v_and_b32 v83, s15, v227
v_add_f32_dpp v60, v60, v60 quad_perm:[2,3,0,1] row_mask:0xf bank_mask:0xf
v_add_f32_dpp v61, v61, v61 quad_perm:[2,3,0,1] row_mask:0xf bank_mask:0xf
v_mov_b32 v62, v60
v_mov_b32 v63, v61
v_lshlrev_b32 v84, 16, v228
v_and_b32 v85, s15, v228
v_lshlrev_b32 v86, 16, v229
v_and_b32 v87, s15, v229
v_permlane16_swap_b32 v62, v60
v_permlane16_swap_b32 v63, v61
v_add_f32 v60, v60, v62
v_add_f32 v61, v61, v63
v_mov_b32 v62, v60
v_mov_b32 v63, v61
v_lshlrev_b32 v88, 16, v230
v_and_b32 v89, s15, v230
v_lshlrev_b32 v90, 16, v231
v_and_b32 v91, s15, v231
v_permlane32_swap_b32 v62, v60
v_permlane32_swap_b32 v63, v61
v_add_f32 v60, v60, v62
v_add_f32 v61, v61, v63
v_mul_f32 v60, 0xbb000000, v60
v_mul_f32 v61, 0x3b000000, v61
v_fma_f32 v61, -v60, v60, v61
v_max_f32 v61, 0, v61
v_add_f32 v61, 0x3727c5ac, v61
v_rsq_f32 v62, v61
v_lshlrev_b32 v92, 16, v232
v_and_b32 v93, s15, v232
v_lshlrev_b32 v94, 16, v233
v_and_b32 v95, s15, v233
v_mul_f32 v64, v60, v62
v_lshlrev_b32 v96, 16, v234
v_and_b32 v97, s15, v234
v_lshlrev_b32 v98, 16, v235
v_and_b32 v99, s15, v235
v_lshlrev_b32 v100, 16, v236
v_and_b32 v101, s15, v236
v_lshlrev_b32 v102, 16, v237
v_and_b32 v103, s15, v237
v_lshlrev_b32 v104, 16, v238
v_and_b32 v105, s15, v238
v_lshlrev_b32 v106, 16, v239
v_and_b32 v107, s15, v239
v_pk_fma_f32 v[76:77], v[76:77], v[62:63], v[64:65] op_sel_hi:[1,0,0]
v_pk_fma_f32 v[78:79], v[78:79], v[62:63], v[64:65] op_sel_hi:[1,0,0]
v_pk_fma_f32 v[80:81], v[80:81], v[62:63], v[64:65] op_sel_hi:[1,0,0]
v_pk_fma_f32 v[82:83], v[82:83], v[62:63], v[64:65] op_sel_hi:[1,0,0]
v_cvt_pk_bf16_f32 v224, v76, v77
v_cvt_pk_bf16_f32 v225, v78, v79
v_cvt_pk_bf16_f32 v226, v80, v81
v_cvt_pk_bf16_f32 v227, v82, v83
ds_write_b128 v8, v[224:227] offset:32768
s_add_u32 s24, s12, 32768
buffer_store_dwordx4 v[224:227], v17, s[8:11], s24 offen sc1
v_pk_fma_f32 v[84:85], v[84:85], v[62:63], v[64:65] op_sel_hi:[1,0,0]
v_pk_fma_f32 v[86:87], v[86:87], v[62:63], v[64:65] op_sel_hi:[1,0,0]
v_pk_fma_f32 v[88:89], v[88:89], v[62:63], v[64:65] op_sel_hi:[1,0,0]
v_pk_fma_f32 v[90:91], v[90:91], v[62:63], v[64:65] op_sel_hi:[1,0,0]
v_cvt_pk_bf16_f32 v228, v84, v85
v_cvt_pk_bf16_f32 v229, v86, v87
v_cvt_pk_bf16_f32 v230, v88, v89
v_cvt_pk_bf16_f32 v231, v90, v91
ds_write_b128 v8, v[228:231] offset:36864
s_add_u32 s24, s12, 36864
buffer_store_dwordx4 v[228:231], v17, s[8:11], s24 offen sc1
v_pk_fma_f32 v[92:93], v[92:93], v[62:63], v[64:65] op_sel_hi:[1,0,0]
v_pk_fma_f32 v[94:95], v[94:95], v[62:63], v[64:65] op_sel_hi:[1,0,0]
v_pk_fma_f32 v[96:97], v[96:97], v[62:63], v[64:65] op_sel_hi:[1,0,0]
v_pk_fma_f32 v[98:99], v[98:99], v[62:63], v[64:65] op_sel_hi:[1,0,0]
v_cvt_pk_bf16_f32 v232, v92, v93
v_cvt_pk_bf16_f32 v233, v94, v95
v_cvt_pk_bf16_f32 v234, v96, v97
v_cvt_pk_bf16_f32 v235, v98, v99
ds_write_b128 v9, v[232:235] offset:32768
v_pk_fma_f32 v[100:101], v[100:101], v[62:63], v[64:65] op_sel_hi:[1,0,0]
v_pk_fma_f32 v[102:103], v[102:103], v[62:63], v[64:65] op_sel_hi:[1,0,0]
v_pk_fma_f32 v[104:105], v[104:105], v[62:63], v[64:65] op_sel_hi:[1,0,0]
v_pk_fma_f32 v[106:107], v[106:107], v[62:63], v[64:65] op_sel_hi:[1,0,0]
v_cvt_pk_bf16_f32 v236, v100, v101
v_cvt_pk_bf16_f32 v237, v102, v103
v_cvt_pk_bf16_f32 v238, v104, v105
v_cvt_pk_bf16_f32 v239, v106, v107
ds_write_b128 v9, v[236:239] offset:36864
buffer_load_dword v19, v18, s[8:11], 0 offen sc1
v_mov_b32 v60, 0
v_mov_b32 v61, 0
s_waitcnt vmcnt(15)
v_dot2c_f32_bf16 v60, v240, v66
v_dot2c_f32_bf16 v61, v240, v240
v_dot2c_f32_bf16 v60, v241, v66
v_dot2c_f32_bf16 v61, v241, v241
v_dot2c_f32_bf16 v60, v242, v66
v_dot2c_f32_bf16 v61, v242, v242
v_dot2c_f32_bf16 v60, v243, v66
v_dot2c_f32_bf16 v61, v243, v243
s_waitcnt vmcnt(13)
v_dot2c_f32_bf16 v60, v244, v66
v_dot2c_f32_bf16 v61, v244, v244
v_dot2c_f32_bf16 v60, v245, v66
v_dot2c_f32_bf16 v61, v245, v245
v_dot2c_f32_bf16 v60, v246, v66
v_dot2c_f32_bf16 v61, v246, v246
v_dot2c_f32_bf16 v60, v247, v66
v_dot2c_f32_bf16 v61, v247, v247
s_waitcnt vmcnt(12)
v_dot2c_f32_bf16 v60, v248, v66
v_dot2c_f32_bf16 v61, v248, v248
v_dot2c_f32_bf16 v60, v249, v66
v_dot2c_f32_bf16 v61, v249, v249
v_dot2c_f32_bf16 v60, v250, v66
v_dot2c_f32_bf16 v61, v250, v250
v_dot2c_f32_bf16 v60, v251, v66
v_dot2c_f32_bf16 v61, v251, v251
s_waitcnt vmcnt(9)
v_dot2c_f32_bf16 v60, v252, v66
v_dot2c_f32_bf16 v61, v252, v252
v_dot2c_f32_bf16 v60, v253, v66
v_dot2c_f32_bf16 v61, v253, v253
v_dot2c_f32_bf16 v60, v254, v66
v_dot2c_f32_bf16 v61, v254, v254
v_dot2c_f32_bf16 v60, v255, v66
v_dot2c_f32_bf16 v61, v255, v255
v_lshlrev_b32 v76, 16, v240
v_and_b32 v77, s15, v240
v_lshlrev_b32 v78, 16, v241
v_and_b32 v79, s15, v241
v_add_f32_dpp v60, v60, v60 quad_perm:[1,0,3,2] row_mask:0xf bank_mask:0xf
v_add_f32_dpp v61, v61, v61 quad_perm:[1,0,3,2] row_mask:0xf bank_mask:0xf
v_lshlrev_b32 v80, 16, v242
v_and_b32 v81, s15, v242
v_lshlrev_b32 v82, 16, v243
v_and_b32 v83, s15, v243
v_add_f32_dpp v60, v60, v60 quad_perm:[2,3,0,1] row_mask:0xf bank_mask:0xf
v_add_f32_dpp v61, v61, v61 quad_perm:[2,3,0,1] row_mask:0xf bank_mask:0xf
v_mov_b32 v62, v60
v_mov_b32 v63, v61
v_lshlrev_b32 v84, 16, v244
v_and_b32 v85, s15, v244
v_lshlrev_b32 v86, 16, v245
v_and_b32 v87, s15, v245
v_permlane16_swap_b32 v62, v60
v_permlane16_swap_b32 v63, v61
v_add_f32 v60, v60, v62
v_add_f32 v61, v61, v63
v_mov_b32 v62, v60
v_mov_b32 v63, v61
v_lshlrev_b32 v88, 16, v246
v_and_b32 v89, s15, v246
v_lshlrev_b32 v90, 16, v247
v_and_b32 v91, s15, v247
v_permlane32_swap_b32 v62, v60
v_permlane32_swap_b32 v63, v61
v_add_f32 v60, v60, v62
v_add_f32 v61, v61, v63
v_mul_f32 v60, 0xbb000000, v60
v_mul_f32 v61, 0x3b000000, v61
v_fma_f32 v61, -v60, v60, v61
v_max_f32 v61, 0, v61
v_add_f32 v61, 0x3727c5ac, v61
v_rsq_f32 v62, v61
v_lshlrev_b32 v92, 16, v248
v_and_b32 v93, s15, v248
v_lshlrev_b32 v94, 16, v249
v_and_b32 v95, s15, v249
v_mul_f32 v64, v60, v62
v_lshlrev_b32 v96, 16, v250
v_and_b32 v97, s15, v250
v_lshlrev_b32 v98, 16, v251
v_and_b32 v99, s15, v251
v_lshlrev_b32 v100, 16, v252
v_and_b32 v101, s15, v252
v_lshlrev_b32 v102, 16, v253
v_and_b32 v103, s15, v253
v_lshlrev_b32 v104, 16, v254
v_and_b32 v105, s15, v254
v_lshlrev_b32 v106, 16, v255
v_and_b32 v107, s15, v255
v_pk_fma_f32 v[76:77], v[76:77], v[62:63], v[64:65] op_sel_hi:[1,0,0]
v_pk_fma_f32 v[78:79], v[78:79], v[62:63], v[64:65] op_sel_hi:[1,0,0]
v_pk_fma_f32 v[80:81], v[80:81], v[62:63], v[64:65] op_sel_hi:[1,0,0]
v_pk_fma_f32 v[82:83], v[82:83], v[62:63], v[64:65] op_sel_hi:[1,0,0]
v_cvt_pk_bf16_f32 v240, v76, v77
v_cvt_pk_bf16_f32 v241, v78, v79
v_cvt_pk_bf16_f32 v242, v80, v81
v_cvt_pk_bf16_f32 v243, v82, v83
ds_write_b128 v8, v[240:243] offset:49152
s_add_u32 s24, s12, 49152
buffer_store_dwordx4 v[240:243], v17, s[8:11], s24 offen sc1
v_pk_fma_f32 v[84:85], v[84:85], v[62:63], v[64:65] op_sel_hi:[1,0,0]
v_pk_fma_f32 v[86:87], v[86:87], v[62:63], v[64:65] op_sel_hi:[1,0,0]
v_pk_fma_f32 v[88:89], v[88:89], v[62:63], v[64:65] op_sel_hi:[1,0,0]
v_pk_fma_f32 v[90:91], v[90:91], v[62:63], v[64:65] op_sel_hi:[1,0,0]
v_cvt_pk_bf16_f32 v244, v84, v85
v_cvt_pk_bf16_f32 v245, v86, v87
v_cvt_pk_bf16_f32 v246, v88, v89
v_cvt_pk_bf16_f32 v247, v90, v91
ds_write_b128 v8, v[244:247] offset:53248
s_add_u32 s24, s12, 53248
buffer_store_dwordx4 v[244:247], v17, s[8:11], s24 offen sc1
v_pk_fma_f32 v[92:93], v[92:93], v[62:63], v[64:65] op_sel_hi:[1,0,0]
v_pk_fma_f32 v[94:95], v[94:95], v[62:63], v[64:65] op_sel_hi:[1,0,0]
v_pk_fma_f32 v[96:97], v[96:97], v[62:63], v[64:65] op_sel_hi:[1,0,0]
v_pk_fma_f32 v[98:99], v[98:99], v[62:63], v[64:65] op_sel_hi:[1,0,0]
v_cvt_pk_bf16_f32 v248, v92, v93
v_cvt_pk_bf16_f32 v249, v94, v95
v_cvt_pk_bf16_f32 v250, v96, v97
v_cvt_pk_bf16_f32 v251, v98, v99
ds_write_b128 v9, v[248:251] offset:49152
v_pk_fma_f32 v[100:101], v[100:101], v[62:63], v[64:65] op_sel_hi:[1,0,0]
v_pk_fma_f32 v[102:103], v[102:103], v[62:63], v[64:65] op_sel_hi:[1,0,0]
v_pk_fma_f32 v[104:105], v[104:105], v[62:63], v[64:65] op_sel_hi:[1,0,0]
v_pk_fma_f32 v[106:107], v[106:107], v[62:63], v[64:65] op_sel_hi:[1,0,0]
v_cvt_pk_bf16_f32 v252, v100, v101
v_cvt_pk_bf16_f32 v253, v102, v103
v_cvt_pk_bf16_f32 v254, v104, v105
v_cvt_pk_bf16_f32 v255, v106, v107
ds_write_b128 v9, v[252:255] offset:53248
s_waitcnt vmcnt(2)
v_cmp_ne_u32 vcc, s7, v19
s_cbranch_vccnz L_spin0
L_ok0:
v_mov_b32 v60, 0
v_mov_b32 v61, 0
v_dot2c_f32_bf16 v60, v112, v66
v_dot2c_f32_bf16 v61, v112, v112
v_dot2c_f32_bf16 v60, v113, v66
v_dot2c_f32_bf16 v61, v113, v113
v_dot2c_f32_bf16 v60, v114, v66
v_dot2c_f32_bf16 v61, v114, v114
buffer_load_dwordx4 v[128:131], v1, s[8:11], s6 offen offset:0 sc1
v_dot2c_f32_bf16 v60, v115, v66
v_dot2c_f32_bf16 v61, v115, v115
v_dot2c_f32_bf16 v60, v116, v66
v_dot2c_f32_bf16 v61, v116, v116
v_dot2c_f32_bf16 v60, v117, v66
v_dot2c_f32_bf16 v61, v117, v117
v_dot2c_f32_bf16 v60, v118, v66
v_dot2c_f32_bf16 v61, v118, v118
buffer_load_dwordx4 v[132:135], v1, s[8:11], s6 offen offset:1024 sc1
v_dot2c_f32_bf16 v60, v119, v66
v_dot2c_f32_bf16 v61, v119, v119
v_dot2c_f32_bf16 v60, v120, v66
v_dot2c_f32_bf16 v61, v120, v120
v_dot2c_f32_bf16 v60, v121, v66
v_dot2c_f32_bf16 v61, v121, v121
v_dot2c_f32_bf16 v60, v122, v66
v_dot2c_f32_bf16 v61, v122, v122
buffer_load_dwordx4 v[136:139], v1, s[8:11], s6 offen offset:2048 sc1
v_dot2c_f32_bf16 v60, v123, v66
v_dot2c_f32_bf16 v61, v123, v123
v_dot2c_f32_bf16 v60, v124, v66
v_dot2c_f32_bf16 v61, v124, v124
v_dot2c_f32_bf16 v60, v125, v66
v_dot2c_f32_bf16 v61, v125, v125
v_dot2c_f32_bf16 v60, v126, v66
v_dot2c_f32_bf16 v61, v126, v126
buffer_load_dwordx4 v[140:143], v1, s[8:11], s6 offen offset:3072 sc1
s_add_u32 s6, s6, 4096
v_dot2c_f32_bf16 v60, v127, v66
v_dot2c_f32_bf16 v61, v127, v127
v_lshlrev_b32 v76, 16, v112
v_and_b32 v77, s15, v112
v_lshlrev_b32 v78, 16, v113
v_and_b32 v79, s15, v113
v_add_f32_dpp v60, v60, v60 quad_perm:[1,0,3,2] row_mask:0xf bank_mask:0xf
v_add_f32_dpp v61, v61, v61 quad_perm:[1,0,3,2] row_mask:0xf bank_mask:0xf
buffer_load_dwordx4 v[144:147], v1, s[8:11], s6 offen offset:0 sc1
v_lshlrev_b32 v80, 16, v114
v_and_b32 v81, s15, v114
v_lshlrev_b32 v82, 16, v115
v_and_b32 v83, s15, v115
v_add_f32_dpp v60, v60, v60 quad_perm:[2,3,0,1] row_mask:0xf bank_mask:0xf
v_add_f32_dpp v61, v61, v61 quad_perm:[2,3,0,1] row_mask:0xf bank_mask:0xf
v_mov_b32 v62, v60
v_mov_b32 v63, v61
buffer_load_dwordx4 v[148:151], v1, s[8:11], s6 offen offset:1024 sc1
v_lshlrev_b32 v84, 16, v116
v_and_b32 v85, s15, v116
v_lshlrev_b32 v86, 16, v117
v_and_b32 v87, s15, v117
v_permlane16_swap_b32 v62, v60
v_permlane16_swap_b32 v63, v61
v_add_f32 v60, v60, v62
v_add_f32 v61, v61, v63
buffer_load_dwordx4 v[152:155], v1, s[8:11], s6 offen offset:2048 sc1
v_mov_b32 v62, v60
v_mov_b32 v63, v61
v_lshlrev_b32 v88, 16, v118
v_and_b32 v89, s15, v118
v_lshlrev_b32 v90, 16, v119
v_and_b32 v91, s15, v119
v_permlane32_swap_b32 v62, v60
v_permlane32_swap_b32 v63, v61
buffer_load_dwordx4 v[156:159], v1, s[8:11], s6 offen offset:3072 sc1
s_add_u32 s6, s6, 4096
v_add_f32 v60, v60, v62
v_add_f32 v61, v61, v63
v_mul_f32 v60, 0xbb000000, v60
v_mul_f32 v61, 0x3b000000, v61
v_fma_f32 v61, -v60, v60, v61
v_max_f32 v61, 0, v61
v_add_f32 v61, 0x3727c5ac, v61
v_rsq_f32 v62, v61
buffer_load_dwordx4 v[160:163], v1, s[8:11], s6 offen offset:0 sc1
v_lshlrev_b32 v92, 16, v120
v_and_b32 v93, s15, v120
v_lshlrev_b32 v94, 16, v121
v_and_b32 v95, s15, v121
v_mul_f32 v64, v60, v62
v_lshlrev_b32 v96, 16, v122
v_and_b32 v97, s15, v122
v_lshlrev_b32 v98, 16, v123
buffer_load_dwordx4 v[164:167], v1, s[8:11], s6 offen offset:1024 sc1
v_and_b32 v99, s15, v123
v_lshlrev_b32 v100, 16, v124
v_and_b32 v101, s15, v124
v_lshlrev_b32 v102, 16, v125
v_and_b32 v103, s15, v125
v_lshlrev_b32 v104, 16, v126
v_and_b32 v105, s15, v126
v_lshlrev_b32 v106, 16, v127
buffer_load_dwordx4 v[168:171], v1, s[8:11], s6 offen offset:2048 sc1
v_and_b32 v107, s15, v127
v_pk_fma_f32 v[76:77], v[76:77], v[62:63], v[64:65] op_sel_hi:[1,0,0]
v_pk_fma_f32 v[78:79], v[78:79], v[62:63], v[64:65] op_sel_hi:[1,0,0]
v_pk_fma_f32 v[80:81], v[80:81], v[62:63], v[64:65] op_sel_hi:[1,0,0]
v_pk_fma_f32 v[82:83], v[82:83], v[62:63], v[64:65] op_sel_hi:[1,0,0]
v_cvt_pk_bf16_f32 v112, v76, v77
v_cvt_pk_bf16_f32 v113, v78, v79
v_cvt_pk_bf16_f32 v114, v80, v81
buffer_load_dwordx4 v[172:175], v1, s[8:11], s6 offen offset:3072 sc1
s_add_u32 s6, s6, 4096
v_cvt_pk_bf16_f32 v115, v82, v83
ds_write_b128 v10, v[112:115] offset:0
s_add_u32 s24, s12, 65536
buffer_store_dwordx4 v[112:115], v17, s[8:11], s24 offen sc1
v_pk_fma_f32 v[84:85], v[84:85], v[62:63], v[64:65] op_sel_hi:[1,0,0]
v_pk_fma_f32 v[86:87], v[86:87], v[62:63], v[64:65] op_sel_hi:[1,0,0]
v_pk_fma_f32 v[88:89], v[88:89], v[62:63], v[64:65] op_sel_hi:[1,0,0]
v_pk_fma_f32 v[90:91], v[90:91], v[62:63], v[64:65] op_sel_hi:[1,0,0]
buffer_load_dwordx4 v[176:179], v1, s[8:11], s6 offen offset:0 sc1
v_cvt_pk_bf16_f32 v116, v84, v85
v_cvt_pk_bf16_f32 v117, v86, v87
v_cvt_pk_bf16_f32 v118, v88, v89
v_cvt_pk_bf16_f32 v119, v90, v91
ds_write_b128 v10, v[116:119] offset:4096
s_add_u32 s24, s12, 69632
buffer_store_dwordx4 v[116:119], v17, s[8:11], s24 offen sc1
v_pk_fma_f32 v[92:93], v[92:93], v[62:63], v[64:65] op_sel_hi:[1,0,0]
buffer_load_dwordx4 v[180:183], v1, s[8:11], s6 offen offset:1024 sc1
v_pk_fma_f32 v[94:95], v[94:95], v[62:63], v[64:65] op_sel_hi:[1,0,0]
v_pk_fma_f32 v[96:97], v[96:97], v[62:63], v[64:65] op_sel_hi:[1,0,0]
v_pk_fma_f32 v[98:99], v[98:99], v[62:63], v[64:65] op_sel_hi:[1,0,0]
v_cvt_pk_bf16_f32 v120, v92, v93
v_cvt_pk_bf16_f32 v121, v94, v95
v_cvt_pk_bf16_f32 v122, v96, v97
v_cvt_pk_bf16_f32 v123, v98, v99
ds_write_b128 v11, v[120:123] offset:0
v_pk_fma_f32 v[100:101], v[100:101], v[62:63], v[64:65] op_sel_hi:[1,0,0]
v_pk_fma_f32 v[102:103], v[102:103], v[62:63], v[64:65] op_sel_hi:[1,0,0]
v_pk_fma_f32 v[104:105], v[104:105], v[62:63], v[64:65] op_sel_hi:[1,0,0]
v_pk_fma_f32 v[106:107], v[106:107], v[62:63], v[64:65] op_sel_hi:[1,0,0]
v_cvt_pk_bf16_f32 v124, v100, v101
v_cvt_pk_bf16_f32 v125, v102, v103
v_cvt_pk_bf16_f32 v126, v104, v105
v_cvt_pk_bf16_f32 v127, v106, v107
ds_write_b128 v11, v[124:127] offset:4096
s_cmp_lt_u32 s3, 200
s_cbranch_scc0 L_k2_conv
s_mov_b32 s16, s54
s_and_b32 s17, s55, 0xffff
s_mov_b32 s18, 0x7d0000
s_mov_b32 s19, 0x20000
s_and_b32 s23, s3, 1
s_bfe_u32 s24, s3, 0x10001
s_lshr_b32 s25, s3, 2
s_mul_i32 s39, s25, 5
s_sub_u32 s42, 249, s39
s_mul_i32 s34, s23, 250
s_add_u32 s39, s39, s34
s_mul_i32 s35, s24, 63
s_sub_u32 s26, 125, s35
s_min_u32 s26, s26, 63
s_mul_i32 s34, s23, 125
s_add_u32 s35, s35, s34
s_and_b32 s21, s20, 1
s_lshl_b32 s28, s35, 15
s_add_u32 s35, s35, s26
s_lshl_b32 s30, s35, 15
s_mov_b32 s41, 0x40004000
v_mov_b32 v6, 159744
s_lshl_b32 s36, s21, 2
s_add_u32 s36, s36, 147456
v_lshl_add_u32 v4, v0, 3, s36
s_mov_b32 s37, s6
buffer_load_dwordx4 v[184:187], v1, s[8:11], s37 offen offset:2048 sc1
buffer_load_dwordx4 v[188:191], v1, s[8:11], s37 offen offset:3072 sc1
s_add_u32 s37, s37, 4096
v_bfe_u32 v7, v0, 2, 2
v_sub_u32 v7, 0, v7
v_lshrrev_b32 v2, 4, v0
v_xor_b32 v7, v7, v2
v_and_b32 v7, 3, v7
v_and_b32 v2, 15, v0
v_lshl_add_u32 v2, v2, 2, v7
v_lshlrev_b32 v2, 4, v2
v_add_u32 v2, 65536, v2
v_add_u32 v3, 0x10000, v2
s_waitcnt lgkmcnt(0)
s_barrier
ds_read_b128 a[16:19], v3 offset:0
ds_read_b128 a[36:39], v3 offset:1024
ds_read_b128 a[32:35], v2 offset:50176
ds_read_b128 a[12:15], v2 offset:49152
ds_read_b128 a[8:11], v2 offset:32768
ds_read_b128 a[28:31], v2 offset:33792
ds_read_b128 a[24:27], v2 offset:17408
ds_read_b128 a[4:7], v2 offset:16384
ds_read_b128 a[0:3], v2 offset:0
ds_read_b128 a[20:23], v2 offset:1024
s_waitcnt vmcnt(17) lgkmcnt(8)
v_mfma_f32_16x16x32_bf16 v[32:35], v[128:131], a[16:19], 0
ds_read_b128 a[40:43], v2 offset:2048
buffer_load_dwordx4 v[84:87], v1, s[8:11], s37 offen offset:0 sc1
s_waitcnt vmcnt(17)
v_mfma_f32_16x16x32_bf16 v[32:35], v[132:135], a[36:39], v[32:35]
ds_read_b128 a[60:63], v2 offset:3072
s_lshl_b32 s34, s24, 2
s_waitcnt lgkmcnt(8)
v_mfma_f32_16x16x32_bf16 v[28:31], v[132:135], a[32:35], 0
ds_read_b128 a[64:67], v2 offset:19456
s_add_u32 s34, s34, s20
v_mfma_f32_16x16x32_bf16 v[28:31], v[128:131], a[12:15], v[28:31]
ds_read_b128 a[44:47], v2 offset:18432
s_lshl_b32 s48, s34, 16
s_waitcnt lgkmcnt(8)
v_mfma_f32_16x16x32_bf16 v[24:27], v[128:131], a[8:11], 0
ds_read_b128 a[48:51], v2 offset:34816
s_add_u32 s48, s48, 0x3180000
v_mfma_f32_16x16x32_bf16 v[24:27], v[132:135], a[28:31], v[24:27]
ds_read_b128 a[68:71], v2 offset:35840
buffer_load_dwordx4 v[88:91], v1, s[8:11], s37 offen offset:1024 sc1
s_waitcnt lgkmcnt(8)
v_mfma_f32_16x16x32_bf16 v[20:23], v[132:135], a[24:27], 0
ds_read_b128 a[72:75], v2 offset:52224
s_lshr_b32 s48, s34, 1
v_mfma_f32_16x16x32_bf16 v[20:23], v[128:131], a[4:7], v[20:23]
ds_read_b128 a[52:55], v2 offset:51200
s_lshl_b32 s48, s48, 17
s_waitcnt lgkmcnt(8)
v_mfma_f32_16x16x32_bf16 v[16:19], v[128:131], a[0:3], 0
ds_read_b128 a[56:59], v3 offset:2048
s_waitcnt vmcnt(16)
v_mfma_f32_16x16x32_bf16 v[16:19], v[132:135], a[20:23], v[16:19]
ds_read_b128 a[76:79], v3 offset:3072
s_lshl_b32 s46, s21, 14
s_waitcnt lgkmcnt(8)
v_mfma_f32_16x16x32_bf16 v[16:19], v[136:139], a[40:43], v[16:19]
ds_read_b128 a[96:99], v3 offset:4096
buffer_load_dwordx4 v[92:95], v1, s[8:11], s37 offen offset:2048 sc1
v_mfma_f32_16x16x32_bf16 v[16:19], v[140:143], a[60:63], v[16:19]
ds_read_b128 a[116:119], v3 offset:5120
s_add_u32 s30, s30, s46
s_waitcnt lgkmcnt(8)
v_mfma_f32_16x16x32_bf16 v[20:23], v[140:143], a[64:67], v[20:23]
ds_read_b128 a[112:115], v2 offset:54272
s_add_u32 s48, s48, s46
v_mfma_f32_16x16x32_bf16 v[20:23], v[136:139], a[44:47], v[20:23]
ds_read_b128 a[92:95], v2 offset:53248
s_add_u32 s48, s48, 0x3180000
s_waitcnt lgkmcnt(8)
v_mfma_f32_16x16x32_bf16 v[24:27], v[136:139], a[48:51], v[24:27]
ds_read_b128 a[88:91], v2 offset:36864
s_or_b32 s46, s48, 0x20000
v_mfma_f32_16x16x32_bf16 v[24:27], v[140:143], a[68:71], v[24:27]
ds_read_b128 a[108:111], v2 offset:37888
buffer_load_dwordx4 v[96:99], v1, s[8:11], s37 offen offset:3072 sc1
s_waitcnt lgkmcnt(8)
v_mfma_f32_16x16x32_bf16 v[28:31], v[140:143], a[72:75], v[28:31]
ds_read_b128 a[104:107], v2 offset:21504
s_add_u32 s37, s37, 4096
v_mfma_f32_16x16x32_bf16 v[28:31], v[136:139], a[52:55], v[28:31]
ds_read_b128 a[84:87], v2 offset:20480
s_lshl_b32 s35, s39, 14
s_waitcnt lgkmcnt(8)
v_mfma_f32_16x16x32_bf16 v[32:35], v[136:139], a[56:59], v[32:35]
ds_read_b128 a[80:83], v2 offset:4096
s_waitcnt vmcnt(16)
v_mfma_f32_16x16x32_bf16 v[32:35], v[140:143], a[76:79], v[32:35]
ds_read_b128 a[100:103], v2 offset:5120
s_lshl_b32 s56, s34, 7
s_waitcnt lgkmcnt(8)
v_mfma_f32_16x16x32_bf16 v[32:35], v[144:147], a[96:99], v[32:35]
ds_read_b128 a[120:123], v2 offset:6144
buffer_load_dwordx4 v[100:103], v1, s[8:11], s37 offen offset:0 sc1
v_mfma_f32_16x16x32_bf16 v[32:35], v[148:151], a[116:119], v[32:35]
ds_read_b128 a[140:143], v2 offset:7168
s_add_u32 s56, s56, s35
s_waitcnt lgkmcnt(8)
v_mfma_f32_16x16x32_bf16 v[28:31], v[148:151], a[112:115], v[28:31]
ds_read_b128 a[144:147], v2 offset:23552
s_mul_i32 s35, s23, 4341760
v_mfma_f32_16x16x32_bf16 v[28:31], v[144:147], a[92:95], v[28:31]
ds_read_b128 a[124:127], v2 offset:22528
s_lshl_b32 s55, s34, 11
s_waitcnt lgkmcnt(8)
v_mfma_f32_16x16x32_bf16 v[24:27], v[144:147], a[88:91], v[24:27]
ds_read_b128 a[128:131], v2 offset:38912
s_add_u32 s55, s55, s35
v_mfma_f32_16x16x32_bf16 v[24:27], v[148:151], a[108:111], v[24:27]
ds_read_b128 a[148:151], v2 offset:39936
buffer_load_dwordx4 v[104:107], v1, s[8:11], s37 offen offset:1024 sc1
s_waitcnt lgkmcnt(8)
v_mfma_f32_16x16x32_bf16 v[20:23], v[148:151], a[104:107], v[20:23]
ds_read_b128 a[152:155], v2 offset:56320
s_add_u32 s55, s55, 0x3800000
v_mfma_f32_16x16x32_bf16 v[20:23], v[144:147], a[84:87], v[20:23]
ds_read_b128 a[132:135], v2 offset:55296
s_xor_b32 s34, s24, 1
s_waitcnt lgkmcnt(8)
v_mfma_f32_16x16x32_bf16 v[16:19], v[144:147], a[80:83], v[16:19]
ds_read_b128 a[136:139], v3 offset:6144
s_waitcnt vmcnt(16)
v_mfma_f32_16x16x32_bf16 v[16:19], v[148:151], a[100:103], v[16:19]
ds_read_b128 a[156:159], v3 offset:7168
s_mul_i32 s34, s34, 500
s_waitcnt lgkmcnt(8)
v_mfma_f32_16x16x32_bf16 v[16:19], v[152:155], a[120:123], v[16:19]
ds_read_b128 a[176:179], v3 offset:8192
buffer_load_dwordx4 v[108:111], v1, s[8:11], s37 offen offset:2048 sc1
v_mfma_f32_16x16x32_bf16 v[16:19], v[156:159], a[140:143], v[16:19]
ds_read_b128 a[196:199], v3 offset:9216
s_add_u32 s34, s34, s39
s_waitcnt lgkmcnt(8)
v_mfma_f32_16x16x32_bf16 v[20:23], v[156:159], a[144:147], v[20:23]
ds_read_b128 a[192:195], v2 offset:58368
s_lshl_b32 s54, s34, 7
v_mfma_f32_16x16x32_bf16 v[20:23], v[152:155], a[124:127], v[20:23]
ds_read_b128 a[172:175], v2 offset:57344
s_add_u32 s54, s54, 0x2800000
s_waitcnt lgkmcnt(8)
v_mfma_f32_16x16x32_bf16 v[24:27], v[152:155], a[128:131], v[24:27]
ds_read_b128 a[168:171], v2 offset:40960
s_lshl_b32 s58, s20, 12
v_mfma_f32_16x16x32_bf16 v[24:27], v[156:159], a[148:151], v[24:27]
ds_read_b128 a[188:191], v2 offset:41984
buffer_load_dwordx4 v[112:115], v1, s[8:11], s37 offen offset:3072 sc1
s_waitcnt lgkmcnt(8)
v_mfma_f32_16x16x32_bf16 v[28:31], v[156:159], a[152:155], v[28:31]
ds_read_b128 a[184:187], v2 offset:25600
s_add_u32 s37, s37, 4096
v_mfma_f32_16x16x32_bf16 v[28:31], v[152:155], a[132:135], v[28:31]
ds_read_b128 a[164:167], v2 offset:24576
s_lshl_b32 s53, s34, 14
s_waitcnt lgkmcnt(8)
v_mfma_f32_16x16x32_bf16 v[32:35], v[152:155], a[136:139], v[32:35]
ds_read_b128 a[160:163], v2 offset:8192
s_waitcnt vmcnt(16)
v_mfma_f32_16x16x32_bf16 v[32:35], v[156:159], a[156:159], v[32:35]
ds_read_b128 a[180:183], v2 offset:9216
s_add_u32 s53, s53, 0x1000000
s_waitcnt lgkmcnt(8)
v_mfma_f32_16x16x32_bf16 v[32:35], v[160:163], a[176:179], v[32:35]
ds_read_b128 a[200:203], v2 offset:10240
buffer_load_dwordx4 v[116:119], v1, s[8:11], s37 offen offset:0 sc1
v_mfma_f32_16x16x32_bf16 v[32:35], v[164:167], a[196:199], v[32:35]
ds_read_b128 a[220:223], v2 offset:11264
s_mov_b32 s45, s53
s_waitcnt lgkmcnt(8)
v_mfma_f32_16x16x32_bf16 v[28:31], v[164:167], a[192:195], v[28:31]
ds_read_b128 a[224:227], v2 offset:27648
s_lshl_b32 s52, s3, 1
v_mfma_f32_16x16x32_bf16 v[28:31], v[160:163], a[172:175], v[28:31]
ds_read_b128 a[204:207], v2 offset:26624
s_add_u32 s52, s52, s21
s_waitcnt lgkmcnt(8)
v_mfma_f32_16x16x32_bf16 v[24:27], v[160:163], a[168:171], v[24:27]
ds_read_b128 a[208:211], v2 offset:43008
s_lshl_b32 s52, s52, 7
v_mfma_f32_16x16x32_bf16 v[24:27], v[164:167], a[188:191], v[24:27]
ds_read_b128 a[228:231], v2 offset:44032
buffer_load_dwordx4 v[120:123], v1, s[8:11], s37 offen offset:1024 sc1
s_waitcnt lgkmcnt(8)
v_mfma_f32_16x16x32_bf16 v[20:23], v[164:167], a[184:187], v[20:23]
ds_read_b128 a[232:235], v2 offset:60416
s_add_u32 s52, s52, 0x3400000
v_mfma_f32_16x16x32_bf16 v[20:23], v[160:163], a[164:167], v[20:23]
ds_read_b128 a[212:215], v2 offset:59392
s_mov_b32 s59, 0xffff0000
s_waitcnt lgkmcnt(8)
v_mfma_f32_16x16x32_bf16 v[16:19], v[160:163], a[160:163], v[16:19]
ds_read_b128 a[216:219], v3 offset:10240
s_waitcnt vmcnt(16)
v_mfma_f32_16x16x32_bf16 v[16:19], v[164:167], a[180:183], v[16:19]
ds_read_b128 a[236:239], v3 offset:11264
s_lshl_b32 s44, s20, 17
s_waitcnt lgkmcnt(8)
v_mfma_f32_16x16x32_bf16 v[16:19], v[168:171], a[200:203], v[16:19]
ds_read_b128 v[192:195], v3 offset:12288
buffer_load_dwordx4 v[124:127], v1, s[8:11], s37 offen offset:2048 sc1
v_mfma_f32_16x16x32_bf16 v[16:19], v[172:175], a[220:223], v[16:19]
ds_read_b128 v[212:215], v3 offset:13312
s_add_u32 s44, s44, 0x3008000
s_waitcnt lgkmcnt(8)
v_mfma_f32_16x16x32_bf16 v[20:23], v[172:175], a[224:227], v[20:23]
ds_read_b128 v[208:211], v2 offset:62464
s_lshl_b32 s36, s20, 12
v_mfma_f32_16x16x32_bf16 v[20:23], v[168:171], a[204:207], v[20:23]
ds_read_b128 a[252:255], v2 offset:61440
s_add_u32 s36, s36, 65536
v_add_u32 v56, s36, v1
v_add_u32 v57, 0x10000, v56
s_waitcnt lgkmcnt(8)
v_mfma_f32_16x16x32_bf16 v[24:27], v[168:171], a[208:211], v[24:27]
ds_read_b128 a[248:251], v2 offset:45056
s_mul_i32 s34, s24, 3072
v_add_u32 v8, s34, v56
v_add_u32 v9, s34, v57
v_mfma_f32_16x16x32_bf16 v[24:27], v[172:175], a[228:231], v[24:27]
ds_read_b128 v[204:207], v2 offset:46080
buffer_load_dwordx4 v[128:131], v1, s[8:11], s37 offen offset:3072 sc1
s_waitcnt lgkmcnt(8)
v_mfma_f32_16x16x32_bf16 v[28:31], v[172:175], a[232:235], v[28:31]
ds_read_b128 v[200:203], v2 offset:29696
s_add_u32 s37, s37, 4096
v_mfma_f32_16x16x32_bf16 v[28:31], v[168:171], a[212:215], v[28:31]
ds_read_b128 a[244:247], v2 offset:28672
s_sub_u32 s62, s36, s34
s_waitcnt lgkmcnt(8)
v_mfma_f32_16x16x32_bf16 v[32:35], v[168:171], a[216:219], v[32:35]
ds_read_b128 a[240:243], v2 offset:12288
s_waitcnt vmcnt(14)
v_mfma_f32_16x16x32_bf16 v[32:35], v[172:175], a[236:239], v[32:35]
ds_read_b128 v[196:199], v2 offset:13312
s_add_u32 s62, s62, 3072
s_waitcnt lgkmcnt(8)
v_mfma_f32_16x16x32_bf16 v[32:35], v[176:179], v[192:195], v[32:35]
ds_read_b128 v[216:219], v2 offset:14336
buffer_load_dwordx4 v[132:135], v1, s[8:11], s37 offen offset:0 sc1
v_mfma_f32_16x16x32_bf16 v[32:35], v[180:183], v[212:215], v[32:35]
ds_read_b128 v[236:239], v2 offset:15360
s_lshl_b32 s34, s3, 2
s_waitcnt lgkmcnt(8)
v_mfma_f32_16x16x32_bf16 v[28:31], v[180:183], v[208:211], v[28:31]
ds_read_b128 v[240:243], v2 offset:31744
s_add_u32 s34, s34, s20
v_mfma_f32_16x16x32_bf16 v[28:31], v[176:179], a[252:255], v[28:31]
ds_read_b128 v[220:223], v2 offset:30720
s_mul_i32 s60, s34, 5120
s_waitcnt lgkmcnt(8)
v_mfma_f32_16x16x32_bf16 v[24:27], v[176:179], a[248:251], v[24:27]
ds_read_b128 v[224:227], v2 offset:47104
s_add_u32 s60, s60, 0x800000
v_mfma_f32_16x16x32_bf16 v[24:27], v[180:183], v[204:207], v[24:27]
ds_read_b128 v[244:247], v2 offset:48128
buffer_load_dwordx4 v[136:139], v1, s[8:11], s37 offen offset:1024 sc1
s_waitcnt lgkmcnt(8)
v_mfma_f32_16x16x32_bf16 v[20:23], v[180:183], v[200:203], v[20:23]
ds_read_b128 v[248:251], v2 offset:64512
s_xor_b32 s34, s34, 8
v_mfma_f32_16x16x32_bf16 v[20:23], v[176:179], a[244:247], v[20:23]
ds_read_b128 v[228:231], v2 offset:63488
s_mul_i32 s61, s34, 5120
s_waitcnt lgkmcnt(8)
v_mfma_f32_16x16x32_bf16 v[16:19], v[176:179], a[240:243], v[16:19]
ds_read_b128 v[232:235], v3 offset:14336
s_waitcnt vmcnt(14)
v_mfma_f32_16x16x32_bf16 v[16:19], v[180:183], v[196:199], v[16:19]
ds_read_b128 v[252:255], v3 offset:15360
s_add_u32 s61, s61, 0x800000
s_waitcnt lgkmcnt(8)
v_mfma_f32_16x16x32_bf16 v[16:19], v[184:187], v[216:219], v[16:19]
buffer_load_dwordx4 v[140:143], v1, s[8:11], s37 offen offset:2048 sc1
v_mfma_f32_16x16x32_bf16 v[16:19], v[188:191], v[236:239], v[16:19]
s_lshl_b32 s38, s3, 7
s_add_u32 s63, s38, 0x3420400
s_waitcnt lgkmcnt(6)
v_mfma_f32_16x16x32_bf16 v[20:23], v[188:191], v[240:243], v[20:23]
s_add_u32 s38, s38, 0x3410000
s_xor_b32 s34, s63, 256
v_mov_b32 v59, s34
v_mfma_f32_16x16x32_bf16 v[20:23], v[184:187], v[220:223], v[20:23]
s_mul_i32 s34, s24, 50
v_min_u32 v58, 51, v0
v_add_u32 v58, s34, v58
v_min_u32 v58, 0x63, v58
v_lshl_add_u32 v58, v58, 1, s23
s_waitcnt lgkmcnt(4)
v_mfma_f32_16x16x32_bf16 v[24:27], v[184:187], v[224:227], v[24:27]
v_lshlrev_b32 v58, 7, v58
v_add_u32 v58, 0x3410000, v58
v_mfma_f32_16x16x32_bf16 v[24:27], v[188:191], v[244:247], v[24:27]
buffer_load_dwordx4 v[144:147], v1, s[8:11], s37 offen offset:3072 sc1
s_waitcnt lgkmcnt(2)
v_mfma_f32_16x16x32_bf16 v[28:31], v[188:191], v[248:251], v[28:31]
s_mov_b32 s37, s44
v_or_b32 v60, s20, v0
v_min_u32 v60, 1, v60
v_mfma_f32_16x16x32_bf16 v[28:31], v[184:187], v[228:231], v[28:31]
v_lshlrev_b32 v60, 30, v60
v_mov_b32 v61, s7
s_waitcnt lgkmcnt(0)
v_mfma_f32_16x16x32_bf16 v[32:35], v[184:187], v[232:235], v[32:35]
s_waitcnt vmcnt(14)
v_mov_b32 v62, -1
v_mfma_f32_16x16x32_bf16 v[32:35], v[188:191], v[252:255], v[32:35]
s_lshl_b32 s36, s20, 13
s_add_u32 s35, s28, s36
v_mfma_f32_16x16x32_bf16 v[52:55], v[84:87], a[16:19], 0
buffer_load_dwordx4 v[148:151], v1, s[8:11], s37 offen offset:0 sc1
v_mfma_f32_16x16x32_bf16 v[52:55], v[88:91], a[36:39], v[52:55]
v_mfma_f32_16x16x32_bf16 v[48:51], v[88:91], a[32:35], 0
s_barrier
v_mfma_f32_16x16x32_bf16 v[48:51], v[84:87], a[12:15], v[48:51]
ds_write_b32 v6, v62
v_mfma_f32_16x16x32_bf16 v[44:47], v[84:87], a[8:11], 0
v_cvt_pk_bf16_f32 v64, v16, v17
v_cvt_pk_bf16_f32 v65, v18, v19
v_mfma_f32_16x16x32_bf16 v[44:47], v[88:91], a[28:31], v[44:47]
buffer_load_dwordx4 v[152:155], v1, s[8:11], s37 offen offset:1024 sc1
v_mfma_f32_16x16x32_bf16 v[40:43], v[88:91], a[24:27], 0
ds_write_b64 v8, v[64:65] offset:0
v_mfma_f32_16x16x32_bf16 v[40:43], v[84:87], a[4:7], v[40:43]
v_cvt_pk_bf16_f32 v68, v20, v21
v_cvt_pk_bf16_f32 v69, v22, v23
v_mfma_f32_16x16x32_bf16 v[36:39], v[84:87], a[0:3], 0
s_waitcnt vmcnt(14)
ds_write_b64 v8, v[68:69] offset:16384
v_mfma_f32_16x16x32_bf16 v[36:39], v[88:91], a[20:23], v[36:39]
v_cvt_pk_bf16_f32 v72, v24, v25
v_cvt_pk_bf16_f32 v73, v26, v27
v_mfma_f32_16x16x32_bf16 v[36:39], v[92:95], a[40:43], v[36:39]
buffer_load_dwordx4 v[156:159], v1, s[8:11], s37 offen offset:2048 sc1
v_mfma_f32_16x16x32_bf16 v[36:39], v[96:99], a[60:63], v[36:39]
ds_write_b64 v8, v[72:73] offset:32768
v_mfma_f32_16x16x32_bf16 v[40:43], v[96:99], a[64:67], v[40:43]
v_cvt_pk_bf16_f32 v76, v28, v29
v_cvt_pk_bf16_f32 v77, v30, v31
v_mfma_f32_16x16x32_bf16 v[40:43], v[92:95], a[44:47], v[40:43]
ds_write_b64 v8, v[76:77] offset:49152
v_mfma_f32_16x16x32_bf16 v[44:47], v[92:95], a[48:51], v[44:47]
v_cvt_pk_bf16_f32 v80, v32, v33
v_cvt_pk_bf16_f32 v81, v34, v35
v_mfma_f32_16x16x32_bf16 v[44:47], v[96:99], a[68:71], v[44:47]
buffer_load_dwordx4 v[160:163], v1, s[8:11], s37 offen offset:3072 sc1
v_mfma_f32_16x16x32_bf16 v[48:51], v[96:99], a[72:75], v[48:51]
s_add_u32 s37, s37, 4096
ds_write_b64 v9, v[80:81] offset:0
v_mfma_f32_16x16x32_bf16 v[48:51], v[92:95], a[52:55], v[48:51]
v_mfma_f32_16x16x32_bf16 v[52:55], v[92:95], a[56:59], v[52:55]
s_waitcnt vmcnt(14)
v_mfma_f32_16x16x32_bf16 v[52:55], v[96:99], a[76:79], v[52:55]
v_mfma_f32_16x16x32_bf16 v[52:55], v[100:103], a[96:99], v[52:55]
buffer_load_dwordx4 v[164:167], v1, s[8:11], s37 offen offset:0 sc1
v_mfma_f32_16x16x32_bf16 v[52:55], v[104:107], a[116:119], v[52:55]
v_mfma_f32_16x16x32_bf16 v[48:51], v[104:107], a[112:115], v[48:51]
v_mfma_f32_16x16x32_bf16 v[48:51], v[100:103], a[92:95], v[48:51]
v_mfma_f32_16x16x32_bf16 v[44:47], v[100:103], a[88:91], v[44:47]
v_mfma_f32_16x16x32_bf16 v[44:47], v[104:107], a[108:111], v[44:47]
buffer_load_dwordx4 v[168:171], v1, s[8:11], s37 offen offset:1024 sc1
v_mfma_f32_16x16x32_bf16 v[40:43], v[104:107], a[104:107], v[40:43]
v_mfma_f32_16x16x32_bf16 v[40:43], v[100:103], a[84:87], v[40:43]
v_mfma_f32_16x16x32_bf16 v[36:39], v[100:103], a[80:83], v[36:39]
s_waitcnt vmcnt(14)
v_mfma_f32_16x16x32_bf16 v[36:39], v[104:107], a[100:103], v[36:39]
v_mfma_f32_16x16x32_bf16 v[36:39], v[108:111], a[120:123], v[36:39]
buffer_load_dwordx4 v[172:175], v1, s[8:11], s37 offen offset:2048 sc1
v_mfma_f32_16x16x32_bf16 v[36:39], v[112:115], a[140:143], v[36:39]
v_mfma_f32_16x16x32_bf16 v[40:43], v[112:115], a[144:147], v[40:43]
v_mfma_f32_16x16x32_bf16 v[40:43], v[108:111], a[124:127], v[40:43]
v_mfma_f32_16x16x32_bf16 v[44:47], v[108:111], a[128:131], v[44:47]
v_mfma_f32_16x16x32_bf16 v[44:47], v[112:115], a[148:151], v[44:47]
buffer_load_dwordx4 v[176:179], v1, s[8:11], s37 offen offset:3072 sc1
v_mfma_f32_16x16x32_bf16 v[48:51], v[112:115], a[152:155], v[48:51]
s_add_u32 s37, s37, 4096
v_mfma_f32_16x16x32_bf16 v[48:51], v[108:111], a[132:135], v[48:51]
v_mfma_f32_16x16x32_bf16 v[52:55], v[108:111], a[136:139], v[52:55]
s_waitcnt vmcnt(14)
v_mfma_f32_16x16x32_bf16 v[52:55], v[112:115], a[156:159], v[52:55]
v_mfma_f32_16x16x32_bf16 v[52:55], v[116:119], a[176:179], v[52:55]
buffer_load_dwordx4 v[180:183], v1, s[8:11], s37 offen offset:0 sc1
v_mfma_f32_16x16x32_bf16 v[52:55], v[120:123], a[196:199], v[52:55]
v_mfma_f32_16x16x32_bf16 v[48:51], v[120:123], a[192:195], v[48:51]
v_mfma_f32_16x16x32_bf16 v[48:51], v[116:119], a[172:175], v[48:51]
v_mfma_f32_16x16x32_bf16 v[44:47], v[116:119], a[168:171], v[44:47]
v_mfma_f32_16x16x32_bf16 v[44:47], v[120:123], a[188:191], v[44:47]
buffer_load_dwordx4 v[184:187], v1, s[8:11], s37 offen offset:1024 sc1
v_mfma_f32_16x16x32_bf16 v[40:43], v[120:123], a[184:187], v[40:43]
v_mfma_f32_16x16x32_bf16 v[40:43], v[116:119], a[164:167], v[40:43]
v_mfma_f32_16x16x32_bf16 v[36:39], v[116:119], a[160:163], v[36:39]
s_waitcnt vmcnt(14)
v_mfma_f32_16x16x32_bf16 v[36:39], v[120:123], a[180:183], v[36:39]
v_mfma_f32_16x16x32_bf16 v[36:39], v[124:127], a[200:203], v[36:39]
buffer_load_dwordx4 v[188:191], v1, s[8:11], s37 offen offset:2048 sc1
v_mfma_f32_16x16x32_bf16 v[36:39], v[128:131], a[220:223], v[36:39]
v_mfma_f32_16x16x32_bf16 v[40:43], v[128:131], a[224:227], v[40:43]
v_mfma_f32_16x16x32_bf16 v[40:43], v[124:127], a[204:207], v[40:43]
v_mfma_f32_16x16x32_bf16 v[44:47], v[124:127], a[208:211], v[44:47]
v_mfma_f32_16x16x32_bf16 v[44:47], v[128:131], a[228:231], v[44:47]
buffer_load_dwordx4 v[84:87], v1, s[8:11], s37 offen offset:3072 sc1
v_mfma_f32_16x16x32_bf16 v[48:51], v[128:131], a[232:235], v[48:51]
s_add_u32 s37, s37, 4096
v_mfma_f32_16x16x32_bf16 v[48:51], v[124:127], a[212:215], v[48:51]
v_mfma_f32_16x16x32_bf16 v[52:55], v[124:127], a[216:219], v[52:55]
s_waitcnt vmcnt(14)
v_mfma_f32_16x16x32_bf16 v[52:55], v[128:131], a[236:239], v[52:55]
v_mfma_f32_16x16x32_bf16 v[52:55], v[132:135], v[192:195], v[52:55]
buffer_load_dwordx4 v[88:91], v1, s[8:11], s37 offen offset:0 sc1
v_mfma_f32_16x16x32_bf16 v[52:55], v[136:139], v[212:215], v[52:55]
v_mfma_f32_16x16x32_bf16 v[48:51], v[136:139], v[208:211], v[48:51]
v_mfma_f32_16x16x32_bf16 v[48:51], v[132:135], a[252:255], v[48:51]
v_mfma_f32_16x16x32_bf16 v[44:47], v[132:135], a[248:251], v[44:47]
v_mfma_f32_16x16x32_bf16 v[44:47], v[136:139], v[204:207], v[44:47]
buffer_load_dwordx4 v[92:95], v1, s[8:11], s37 offen offset:1024 sc1
v_mfma_f32_16x16x32_bf16 v[40:43], v[136:139], v[200:203], v[40:43]
v_mfma_f32_16x16x32_bf16 v[40:43], v[132:135], a[244:247], v[40:43]
v_mfma_f32_16x16x32_bf16 v[36:39], v[132:135], a[240:243], v[36:39]
s_waitcnt vmcnt(14)
v_mfma_f32_16x16x32_bf16 v[36:39], v[136:139], v[196:199], v[36:39]
v_mfma_f32_16x16x32_bf16 v[36:39], v[140:143], v[216:219], v[36:39]
buffer_load_dwordx4 v[96:99], v1, s[8:11], s37 offen offset:2048 sc1
v_mfma_f32_16x16x32_bf16 v[36:39], v[144:147], v[236:239], v[36:39]
v_mfma_f32_16x16x32_bf16 v[40:43], v[144:147], v[240:243], v[40:43]
s_barrier
v_mfma_f32_16x16x32_bf16 v[40:43], v[140:143], v[220:223], v[40:43]
buffer_store_dword v61, v60, s[8:11], s38 offen sc1
v_mfma_f32_16x16x32_bf16 v[44:47], v[140:143], v[224:227], v[44:47]
v_mfma_f32_16x16x32_bf16 v[44:47], v[144:147], v[244:247], v[44:47]
buffer_load_dwordx4 v[100:103], v1, s[8:11], s37 offen offset:3072 sc1
v_mfma_f32_16x16x32_bf16 v[48:51], v[144:147], v[248:251], v[48:51]
s_add_u32 s37, s37, 4096
v_mfma_f32_16x16x32_bf16 v[48:51], v[140:143], v[228:231], v[48:51]
v_mfma_f32_16x16x32_bf16 v[52:55], v[140:143], v[232:235], v[52:55]
s_waitcnt vmcnt(15)
v_mfma_f32_16x16x32_bf16 v[52:55], v[144:147], v[252:255], v[52:55]
v_mfma_f32_16x16x32_bf16 v[32:35], v[148:151], a[16:19], 0
buffer_load_dwordx4 v[104:107], v1, s[8:11], s37 offen offset:0 sc1
v_mfma_f32_16x16x32_bf16 v[32:35], v[152:155], a[36:39], v[32:35]
v_mfma_f32_16x16x32_bf16 v[28:31], v[152:155], a[32:35], 0
v_mfma_f32_16x16x32_bf16 v[28:31], v[148:151], a[12:15], v[28:31]
v_mfma_f32_16x16x32_bf16 v[24:27], v[148:151], a[8:11], 0
v_cvt_pk_bf16_f32 v66, v36, v37
v_cvt_pk_bf16_f32 v67, v38, v39
v_mfma_f32_16x16x32_bf16 v[24:27], v[152:155], a[28:31], v[24:27]
buffer_load_dwordx4 v[108:111], v1, s[8:11], s37 offen offset:1024 sc1
v_mfma_f32_16x16x32_bf16 v[20:23], v[152:155], a[24:27], 0
ds_write_b64 v8, v[66:67] offset:8
v_mfma_f32_16x16x32_bf16 v[20:23], v[148:151], a[4:7], v[20:23]
buffer_store_dwordx4 v[64:67], v1, s[8:11], s60 offen offset:0 sc1
v_mfma_f32_16x16x32_bf16 v[16:19], v[148:151], a[0:3], 0
s_waitcnt vmcnt(16)
v_cvt_pk_bf16_f32 v70, v40, v41
v_cvt_pk_bf16_f32 v71, v42, v43
v_mfma_f32_16x16x32_bf16 v[16:19], v[152:155], a[20:23], v[16:19]
ds_write_b64 v8, v[70:71] offset:16392
v_mfma_f32_16x16x32_bf16 v[16:19], v[156:159], a[40:43], v[16:19]
buffer_load_dwordx4 v[112:115], v1, s[8:11], s37 offen offset:2048 sc1
v_mfma_f32_16x16x32_bf16 v[16:19], v[160:163], a[60:63], v[16:19]
buffer_store_dwordx4 v[68:71], v1, s[8:11], s60 offen offset:1024 sc1
v_mfma_f32_16x16x32_bf16 v[20:23], v[160:163], a[64:67], v[20:23]
v_cvt_pk_bf16_f32 v74, v44, v45
v_cvt_pk_bf16_f32 v75, v46, v47
v_mfma_f32_16x16x32_bf16 v[20:23], v[156:159], a[44:47], v[20:23]
ds_write_b64 v8, v[74:75] offset:32776
v_mfma_f32_16x16x32_bf16 v[24:27], v[156:159], a[48:51], v[24:27]
buffer_store_dwordx4 v[72:75], v1, s[8:11], s60 offen offset:2048 sc1
v_mfma_f32_16x16x32_bf16 v[24:27], v[160:163], a[68:71], v[24:27]
buffer_load_dwordx4 v[116:119], v1, s[8:11], s37 offen offset:3072 sc1
v_mfma_f32_16x16x32_bf16 v[28:31], v[160:163], a[72:75], v[28:31]
s_add_u32 s37, s37, 4096
v_cvt_pk_bf16_f32 v78, v48, v49
v_cvt_pk_bf16_f32 v79, v50, v51
v_mfma_f32_16x16x32_bf16 v[28:31], v[156:159], a[52:55], v[28:31]
ds_write_b64 v8, v[78:79] offset:49160
v_mfma_f32_16x16x32_bf16 v[32:35], v[156:159], a[56:59], v[32:35]
s_waitcnt vmcnt(18)
buffer_store_dwordx4 v[76:79], v1, s[8:11], s60 offen offset:3072 sc1
v_mfma_f32_16x16x32_bf16 v[32:35], v[160:163], a[76:79], v[32:35]
v_cvt_pk_bf16_f32 v82, v52, v53
v_cvt_pk_bf16_f32 v83, v54, v55
v_mfma_f32_16x16x32_bf16 v[32:35], v[164:167], a[96:99], v[32:35]
buffer_load_dwordx4 v[120:123], v1, s[8:11], s37 offen offset:0 sc1
v_mfma_f32_16x16x32_bf16 v[32:35], v[168:171], a[116:119], v[32:35]
ds_write_b64 v9, v[82:83] offset:8
s_add_u32 s60, s60, 4096
v_mfma_f32_16x16x32_bf16 v[28:31], v[168:171], a[112:115], v[28:31]
buffer_store_dwordx4 v[80:83], v1, s[8:11], s60 offen offset:0 sc1
v_mfma_f32_16x16x32_bf16 v[28:31], v[164:167], a[92:95], v[28:31]
v_mfma_f32_16x16x32_bf16 v[24:27], v[164:167], a[88:91], v[24:27]
v_mfma_f32_16x16x32_bf16 v[24:27], v[168:171], a[108:111], v[24:27]
buffer_load_dwordx4 v[124:127], v1, s[8:11], s37 offen offset:1024 sc1
v_mfma_f32_16x16x32_bf16 v[20:23], v[168:171], a[104:107], v[20:23]
v_mfma_f32_16x16x32_bf16 v[20:23], v[164:167], a[84:87], v[20:23]
v_mfma_f32_16x16x32_bf16 v[16:19], v[164:167], a[80:83], v[16:19]
s_waitcnt vmcnt(20)
v_mfma_f32_16x16x32_bf16 v[16:19], v[168:171], a[100:103], v[16:19]
v_mfma_f32_16x16x32_bf16 v[16:19], v[172:175], a[120:123], v[16:19]
buffer_load_dwordx4 v[128:131], v1, s[8:11], s37 offen offset:2048 sc1
v_mfma_f32_16x16x32_bf16 v[16:19], v[176:179], a[140:143], v[16:19]
v_mfma_f32_16x16x32_bf16 v[20:23], v[176:179], a[144:147], v[20:23]
v_mfma_f32_16x16x32_bf16 v[20:23], v[172:175], a[124:127], v[20:23]
v_mfma_f32_16x16x32_bf16 v[24:27], v[172:175], a[128:131], v[24:27]
v_mfma_f32_16x16x32_bf16 v[24:27], v[176:179], a[148:151], v[24:27]
buffer_load_dwordx4 v[132:135], v1, s[8:11], s37 offen offset:3072 sc1
v_mfma_f32_16x16x32_bf16 v[28:31], v[176:179], a[152:155], v[28:31]
s_add_u32 s37, s37, 4096
v_mfma_f32_16x16x32_bf16 v[28:31], v[172:175], a[132:135], v[28:31]
v_mfma_f32_16x16x32_bf16 v[32:35], v[172:175], a[136:139], v[32:35]
s_waitcnt vmcnt(20)
v_mfma_f32_16x16x32_bf16 v[32:35], v[176:179], a[156:159], v[32:35]
v_mfma_f32_16x16x32_bf16 v[32:35], v[180:183], a[176:179], v[32:35]
buffer_load_dwordx4 v[136:139], v1, s[8:11], s37 offen offset:0 sc1
v_mfma_f32_16x16x32_bf16 v[32:35], v[184:187], a[196:199], v[32:35]
v_mfma_f32_16x16x32_bf16 v[28:31], v[184:187], a[192:195], v[28:31]
v_mfma_f32_16x16x32_bf16 v[28:31], v[180:183], a[172:175], v[28:31]
v_mfma_f32_16x16x32_bf16 v[24:27], v[180:183], a[168:171], v[24:27]
v_mfma_f32_16x16x32_bf16 v[24:27], v[184:187], a[188:191], v[24:27]
buffer_load_dwordx4 v[140:143], v1, s[8:11], s37 offen offset:1024 sc1
v_mfma_f32_16x16x32_bf16 v[20:23], v[184:187], a[184:187], v[20:23]
v_mfma_f32_16x16x32_bf16 v[20:23], v[180:183], a[164:167], v[20:23]
v_mfma_f32_16x16x32_bf16 v[16:19], v[180:183], a[160:163], v[16:19]
s_waitcnt vmcnt(20)
v_mfma_f32_16x16x32_bf16 v[16:19], v[184:187], a[180:183], v[16:19]
v_mfma_f32_16x16x32_bf16 v[16:19], v[188:191], a[200:203], v[16:19]
buffer_load_dwordx4 v[144:147], v1, s[8:11], s37 offen offset:2048 sc1
v_mfma_f32_16x16x32_bf16 v[16:19], v[84:87], a[220:223], v[16:19]
v_mfma_f32_16x16x32_bf16 v[20:23], v[84:87], a[224:227], v[20:23]
v_mfma_f32_16x16x32_bf16 v[20:23], v[188:191], a[204:207], v[20:23]
v_mfma_f32_16x16x32_bf16 v[24:27], v[188:191], a[208:211], v[24:27]
v_mfma_f32_16x16x32_bf16 v[24:27], v[84:87], a[228:231], v[24:27]
buffer_load_dwordx4 v[148:151], v1, s[8:11], s37 offen offset:3072 sc1
v_mfma_f32_16x16x32_bf16 v[28:31], v[84:87], a[232:235], v[28:31]
s_add_u32 s37, s37, 4096
v_mfma_f32_16x16x32_bf16 v[28:31], v[188:191], a[212:215], v[28:31]
v_mfma_f32_16x16x32_bf16 v[32:35], v[188:191], a[216:219], v[32:35]
s_waitcnt vmcnt(20)
v_mfma_f32_16x16x32_bf16 v[32:35], v[84:87], a[236:239], v[32:35]
v_mfma_f32_16x16x32_bf16 v[32:35], v[88:91], v[192:195], v[32:35]
buffer_load_dwordx4 v[152:155], v1, s[8:11], s37 offen offset:0 sc1
v_mfma_f32_16x16x32_bf16 v[32:35], v[92:95], v[212:215], v[32:35]
v_mfma_f32_16x16x32_bf16 v[28:31], v[92:95], v[208:211], v[28:31]
v_mfma_f32_16x16x32_bf16 v[28:31], v[88:91], a[252:255], v[28:31]
v_mfma_f32_16x16x32_bf16 v[24:27], v[88:91], a[248:251], v[24:27]
v_mfma_f32_16x16x32_bf16 v[24:27], v[92:95], v[204:207], v[24:27]
buffer_load_dwordx4 v[156:159], v1, s[8:11], s37 offen offset:1024 sc1
v_mfma_f32_16x16x32_bf16 v[20:23], v[92:95], v[200:203], v[20:23]
v_mfma_f32_16x16x32_bf16 v[20:23], v[88:91], a[244:247], v[20:23]
v_mfma_f32_16x16x32_bf16 v[16:19], v[88:91], a[240:243], v[16:19]
s_waitcnt vmcnt(19)
v_mfma_f32_16x16x32_bf16 v[16:19], v[92:95], v[196:199], v[16:19]
v_mfma_f32_16x16x32_bf16 v[16:19], v[96:99], v[216:219], v[16:19]
buffer_load_dwordx4 v[160:163], v1, s[8:11], s37 offen offset:2048 sc1
v_mfma_f32_16x16x32_bf16 v[16:19], v[100:103], v[236:239], v[16:19]
v_mfma_f32_16x16x32_bf16 v[20:23], v[100:103], v[240:243], v[20:23]
v_mfma_f32_16x16x32_bf16 v[20:23], v[96:99], v[220:223], v[20:23]
v_mfma_f32_16x16x32_bf16 v[24:27], v[96:99], v[224:227], v[24:27]
v_mfma_f32_16x16x32_bf16 v[24:27], v[100:103], v[244:247], v[24:27]
buffer_load_dwordx4 v[164:167], v1, s[8:11], s37 offen offset:3072 sc1
v_mfma_f32_16x16x32_bf16 v[28:31], v[100:103], v[248:251], v[28:31]
s_add_u32 s37, s37, 4096
v_mfma_f32_16x16x32_bf16 v[28:31], v[96:99], v[228:231], v[28:31]
v_mfma_f32_16x16x32_bf16 v[32:35], v[96:99], v[232:235], v[32:35]
s_waitcnt vmcnt(19)
v_mfma_f32_16x16x32_bf16 v[32:35], v[100:103], v[252:255], v[32:35]
v_mfma_f32_16x16x32_bf16 v[52:55], v[104:107], a[16:19], 0
buffer_load_dwordx4 v[168:171], v1, s[8:11], s37 offen offset:0 sc1
v_mfma_f32_16x16x32_bf16 v[52:55], v[108:111], a[36:39], v[52:55]
v_mfma_f32_16x16x32_bf16 v[48:51], v[108:111], a[32:35], 0
v_mfma_f32_16x16x32_bf16 v[48:51], v[104:107], a[12:15], v[48:51]
v_mfma_f32_16x16x32_bf16 v[44:47], v[104:107], a[8:11], 0
v_cvt_pk_bf16_f32 v10, v16, v17
v_cvt_pk_bf16_f32 v11, v18, v19
v_mfma_f32_16x16x32_bf16 v[44:47], v[108:111], a[28:31], v[44:47]
buffer_load_dwordx4 v[172:175], v1, s[8:11], s37 offen offset:1024 sc1
v_mfma_f32_16x16x32_bf16 v[40:43], v[108:111], a[24:27], 0
ds_write_b64 v56, v[10:11] offset:1024
v_mfma_f32_16x16x32_bf16 v[40:43], v[104:107], a[4:7], v[40:43]
v_cvt_pk_bf16_f32 v12, v20, v21
v_cvt_pk_bf16_f32 v13, v22, v23
v_mfma_f32_16x16x32_bf16 v[36:39], v[104:107], a[0:3], 0
s_waitcnt vmcnt(16)
ds_write_b64 v56, v[12:13] offset:17408
v_mfma_f32_16x16x32_bf16 v[36:39], v[108:111], a[20:23], v[36:39]
v_cvt_pk_bf16_f32 v14, v24, v25
v_cvt_pk_bf16_f32 v15, v26, v27
v_mfma_f32_16x16x32_bf16 v[36:39], v[112:115], a[40:43], v[36:39]
buffer_load_dwordx4 v[176:179], v1, s[8:11], s37 offen offset:2048 sc1
v_mfma_f32_16x16x32_bf16 v[36:39], v[116:119], a[60:63], v[36:39]
ds_write_b64 v56, v[14:15] offset:33792
v_mfma_f32_16x16x32_bf16 v[40:43], v[116:119], a[64:67], v[40:43]
v_cvt_pk_bf16_f32 v10, v28, v29
v_cvt_pk_bf16_f32 v11, v30, v31
v_mfma_f32_16x16x32_bf16 v[40:43], v[112:115], a[44:47], v[40:43]
ds_write_b64 v56, v[10:11] offset:50176
v_mfma_f32_16x16x32_bf16 v[44:47], v[112:115], a[48:51], v[44:47]
v_cvt_pk_bf16_f32 v12, v32, v33
v_cvt_pk_bf16_f32 v13, v34, v35
v_mfma_f32_16x16x32_bf16 v[44:47], v[116:119], a[68:71], v[44:47]
buffer_load_dwordx4 v[180:183], v1, s[8:11], s37 offen offset:3072 sc1
v_mfma_f32_16x16x32_bf16 v[48:51], v[116:119], a[72:75], v[48:51]
s_add_u32 s37, s37, 4096
ds_write_b64 v57, v[12:13] offset:1024
v_mfma_f32_16x16x32_bf16 v[48:51], v[112:115], a[52:55], v[48:51]
v_mfma_f32_16x16x32_bf16 v[52:55], v[112:115], a[56:59], v[52:55]
s_waitcnt vmcnt(14)
v_mfma_f32_16x16x32_bf16 v[52:55], v[116:119], a[76:79], v[52:55]
v_mfma_f32_16x16x32_bf16 v[52:55], v[120:123], a[96:99], v[52:55]
buffer_load_dwordx4 v[184:187], v1, s[8:11], s37 offen offset:0 sc1
v_mfma_f32_16x16x32_bf16 v[52:55], v[124:127], a[116:119], v[52:55]
v_mfma_f32_16x16x32_bf16 v[48:51], v[124:127], a[112:115], v[48:51]
s_barrier
v_mfma_f32_16x16x32_bf16 v[48:51], v[120:123], a[92:95], v[48:51]
buffer_store_dword v61, v60, s[8:11], s63 offen sc1
v_mfma_f32_16x16x32_bf16 v[44:47], v[120:123], a[88:91], v[44:47]
v_mfma_f32_16x16x32_bf16 v[44:47], v[124:127], a[108:111], v[44:47]
buffer_load_dwordx4 v[188:191], v1, s[8:11], s37 offen offset:1024 sc1
v_mfma_f32_16x16x32_bf16 v[40:43], v[124:127], a[104:107], v[40:43]
v_mfma_f32_16x16x32_bf16 v[40:43], v[120:123], a[84:87], v[40:43]
v_mfma_f32_16x16x32_bf16 v[36:39], v[120:123], a[80:83], v[36:39]
s_waitcnt vmcnt(15)
v_mfma_f32_16x16x32_bf16 v[36:39], v[124:127], a[100:103], v[36:39]
v_mfma_f32_16x16x32_bf16 v[36:39], v[128:131], a[120:123], v[36:39]
buffer_load_dwordx4 v[84:87], v1, s[8:11], s37 offen offset:2048 sc1
v_mfma_f32_16x16x32_bf16 v[36:39], v[132:135], a[140:143], v[36:39]
v_mfma_f32_16x16x32_bf16 v[40:43], v[132:135], a[144:147], v[40:43]
v_mfma_f32_16x16x32_bf16 v[40:43], v[128:131], a[124:127], v[40:43]
v_mfma_f32_16x16x32_bf16 v[44:47], v[128:131], a[128:131], v[44:47]
v_mfma_f32_16x16x32_bf16 v[44:47], v[132:135], a[148:151], v[44:47]
buffer_load_dwordx4 v[88:91], v1, s[8:11], s37 offen offset:3072 sc1
v_mfma_f32_16x16x32_bf16 v[48:51], v[132:135], a[152:155], v[48:51]
s_add_u32 s37, s37, 4096
v_mfma_f32_16x16x32_bf16 v[48:51], v[128:131], a[132:135], v[48:51]
v_mfma_f32_16x16x32_bf16 v[52:55], v[128:131], a[136:139], v[52:55]
s_waitcnt vmcnt(15)
v_mfma_f32_16x16x32_bf16 v[52:55], v[132:135], a[156:159], v[52:55]
v_mfma_f32_16x16x32_bf16 v[52:55], v[136:139], a[176:179], v[52:55]
buffer_load_dwordx4 v[92:95], v1, s[8:11], s37 offen offset:0 sc1
v_mfma_f32_16x16x32_bf16 v[52:55], v[140:143], a[196:199], v[52:55]
v_mfma_f32_16x16x32_bf16 v[48:51], v[140:143], a[192:195], v[48:51]
v_mfma_f32_16x16x32_bf16 v[48:51], v[136:139], a[172:175], v[48:51]
buffer_load_dword v5, v58, s[8:11], 0 offen sc1
v_mfma_f32_16x16x32_bf16 v[44:47], v[136:139], a[168:171], v[44:47]
v_mfma_f32_16x16x32_bf16 v[44:47], v[140:143], a[188:191], v[44:47]
buffer_load_dwordx4 v[96:99], v1, s[8:11], s37 offen offset:1024 sc1
v_mfma_f32_16x16x32_bf16 v[40:43], v[140:143], a[184:187], v[40:43]
v_mfma_f32_16x16x32_bf16 v[40:43], v[136:139], a[164:167], v[40:43]
v_mfma_f32_16x16x32_bf16 v[36:39], v[136:139], a[160:163], v[36:39]
s_waitcnt vmcnt(16)
v_mfma_f32_16x16x32_bf16 v[36:39], v[140:143], a[180:183], v[36:39]
v_mfma_f32_16x16x32_bf16 v[36:39], v[144:147], a[200:203], v[36:39]
buffer_load_dwordx4 v[100:103], v1, s[8:11], s37 offen offset:2048 sc1
v_mfma_f32_16x16x32_bf16 v[36:39], v[148:151], a[220:223], v[36:39]
v_mfma_f32_16x16x32_bf16 v[40:43], v[148:151], a[224:227], v[40:43]
v_mfma_f32_16x16x32_bf16 v[40:43], v[144:147], a[204:207], v[40:43]
v_mfma_f32_16x16x32_bf16 v[44:47], v[144:147], a[208:211], v[44:47]
v_mfma_f32_16x16x32_bf16 v[44:47], v[148:151], a[228:231], v[44:47]
buffer_load_dwordx4 v[104:107], v1, s[8:11], s37 offen offset:3072 sc1
v_mfma_f32_16x16x32_bf16 v[48:51], v[148:151], a[232:235], v[48:51]
s_add_u32 s37, s37, 4096
v_mfma_f32_16x16x32_bf16 v[48:51], v[144:147], a[212:215], v[48:51]
v_mfma_f32_16x16x32_bf16 v[52:55], v[144:147], a[216:219], v[52:55]
s_waitcnt vmcnt(16)
v_mfma_f32_16x16x32_bf16 v[52:55], v[148:151], a[236:239], v[52:55]
v_mfma_f32_16x16x32_bf16 v[52:55], v[152:155], v[192:195], v[52:55]
buffer_load_dwordx4 v[108:111], v1, s[8:11], s37 offen offset:0 sc1
v_mfma_f32_16x16x32_bf16 v[52:55], v[156:159], v[212:215], v[52:55]
v_mfma_f32_16x16x32_bf16 v[48:51], v[156:159], v[208:211], v[48:51]
v_mfma_f32_16x16x32_bf16 v[48:51], v[152:155], a[252:255], v[48:51]
v_mfma_f32_16x16x32_bf16 v[44:47], v[152:155], a[248:251], v[44:47]
v_mfma_f32_16x16x32_bf16 v[44:47], v[156:159], v[204:207], v[44:47]
buffer_load_dwordx4 v[112:115], v1, s[8:11], s37 offen offset:1024 sc1
v_mfma_f32_16x16x32_bf16 v[40:43], v[156:159], v[200:203], v[40:43]
v_mfma_f32_16x16x32_bf16 v[40:43], v[152:155], a[244:247], v[40:43]
v_mfma_f32_16x16x32_bf16 v[36:39], v[152:155], a[240:243], v[36:39]
s_waitcnt vmcnt(16)
v_mfma_f32_16x16x32_bf16 v[36:39], v[156:159], v[196:199], v[36:39]
v_mfma_f32_16x16x32_bf16 v[36:39], v[160:163], v[216:219], v[36:39]
buffer_load_dwordx4 v[116:119], v1, s[8:11], s37 offen offset:2048 sc1
v_mfma_f32_16x16x32_bf16 v[36:39], v[164:167], v[236:239], v[36:39]
v_mfma_f32_16x16x32_bf16 v[40:43], v[164:167], v[240:243], v[40:43]
v_mfma_f32_16x16x32_bf16 v[40:43], v[160:163], v[220:223], v[40:43]
v_mfma_f32_16x16x32_bf16 v[44:47], v[160:163], v[224:227], v[44:47]
v_mfma_f32_16x16x32_bf16 v[44:47], v[164:167], v[244:247], v[44:47]
buffer_load_dwordx4 v[120:123], v1, s[8:11], s37 offen offset:3072 sc1
v_mfma_f32_16x16x32_bf16 v[48:51], v[164:167], v[248:251], v[48:51]
s_add_u32 s37, s37, 4096
v_mfma_f32_16x16x32_bf16 v[48:51], v[160:163], v[228:231], v[48:51]
v_mfma_f32_16x16x32_bf16 v[52:55], v[160:163], v[232:235], v[52:55]
s_waitcnt vmcnt(16)
v_mfma_f32_16x16x32_bf16 v[52:55], v[164:167], v[252:255], v[52:55]
v_mfma_f32_16x16x32_bf16 v[32:35], v[168:171], a[16:19], 0
buffer_load_dwordx4 v[124:127], v1, s[8:11], s37 offen offset:0 sc1
v_mfma_f32_16x16x32_bf16 v[32:35], v[172:175], a[36:39], v[32:35]
s_waitcnt vmcnt(8)
v_cmp_ne_u32 vcc, s7, v5
v_mfma_f32_16x16x32_bf16 v[28:31], v[172:175], a[32:35], 0
v_mfma_f32_16x16x32_bf16 v[28:31], v[168:171], a[12:15], v[28:31]
s_cbranch_vccnz L_spinX
L_okX:
v_mfma_f32_16x16x32_bf16 v[24:27], v[168:171], a[8:11], 0
v_cvt_pk_bf16_f32 v10, v36, v37
v_cvt_pk_bf16_f32 v11, v38, v39
v_mfma_f32_16x16x32_bf16 v[24:27], v[172:175], a[28:31], v[24:27]
buffer_load_dwordx4 v[128:131], v1, s[8:11], s37 offen offset:1024 sc1
v_mfma_f32_16x16x32_bf16 v[20:23], v[172:175], a[24:27], 0
ds_write_b64 v56, v[10:11] offset:1032
v_mfma_f32_16x16x32_bf16 v[20:23], v[168:171], a[4:7], v[20:23]
v_cvt_pk_bf16_f32 v12, v40, v41
v_cvt_pk_bf16_f32 v13, v42, v43
v_mfma_f32_16x16x32_bf16 v[16:19], v[168:171], a[0:3], 0
ds_write_b64 v56, v[12:13] offset:17416
v_mfma_f32_16x16x32_bf16 v[16:19], v[172:175], a[20:23], v[16:19]
v_cvt_pk_bf16_f32 v14, v44, v45
v_cvt_pk_bf16_f32 v15, v46, v47
v_mfma_f32_16x16x32_bf16 v[16:19], v[176:179], a[40:43], v[16:19]
buffer_load_dwordx4 v[132:135], v1, s[8:11], s37 offen offset:2048 sc1
v_mfma_f32_16x16x32_bf16 v[16:19], v[180:183], a[60:63], v[16:19]
ds_write_b64 v56, v[14:15] offset:33800
v_mfma_f32_16x16x32_bf16 v[20:23], v[180:183], a[64:67], v[20:23]
v_cvt_pk_bf16_f32 v10, v48, v49
v_cvt_pk_bf16_f32 v11, v50, v51
v_mfma_f32_16x16x32_bf16 v[20:23], v[176:179], a[44:47], v[20:23]
ds_write_b64 v56, v[10:11] offset:50184
v_mfma_f32_16x16x32_bf16 v[24:27], v[176:179], a[48:51], v[24:27]
v_cvt_pk_bf16_f32 v12, v52, v53
v_cvt_pk_bf16_f32 v13, v54, v55
v_mfma_f32_16x16x32_bf16 v[24:27], v[180:183], a[68:71], v[24:27]
buffer_load_dwordx4 v[136:139], v1, s[8:11], s37 offen offset:3072 sc1
v_mfma_f32_16x16x32_bf16 v[28:31], v[180:183], a[72:75], v[28:31]
s_add_u32 s37, s37, 4096
ds_write_b64 v57, v[12:13] offset:1032
v_mfma_f32_16x16x32_bf16 v[28:31], v[176:179], a[52:55], v[28:31]
v_mfma_f32_16x16x32_bf16 v[32:35], v[176:179], a[56:59], v[32:35]
v_mfma_f32_16x16x32_bf16 v[32:35], v[180:183], a[76:79], v[32:35]
v_mfma_f32_16x16x32_bf16 v[32:35], v[184:187], a[96:99], v[32:35]
buffer_load_dwordx4 v[140:143], v1, s[8:11], s37 offen offset:0 sc1
v_mfma_f32_16x16x32_bf16 v[32:35], v[188:191], a[116:119], v[32:35]
v_mfma_f32_16x16x32_bf16 v[28:31], v[188:191], a[112:115], v[28:31]
v_mfma_f32_16x16x32_bf16 v[28:31], v[184:187], a[92:95], v[28:31]
v_mfma_f32_16x16x32_bf16 v[24:27], v[184:187], a[88:91], v[24:27]
v_mfma_f32_16x16x32_bf16 v[24:27], v[188:191], a[108:111], v[24:27]
buffer_load_dwordx4 v[144:147], v1, s[8:11], s37 offen offset:1024 sc1
v_mfma_f32_16x16x32_bf16 v[20:23], v[188:191], a[104:107], v[20:23]
v_mfma_f32_16x16x32_bf16 v[20:23], v[184:187], a[84:87], v[20:23]
v_mfma_f32_16x16x32_bf16 v[16:19], v[184:187], a[80:83], v[16:19]
v_mfma_f32_16x16x32_bf16 v[16:19], v[188:191], a[100:103], v[16:19]
v_mfma_f32_16x16x32_bf16 v[16:19], v[84:87], a[120:123], v[16:19]
buffer_load_dwordx4 v[148:151], v1, s[8:11], s37 offen offset:2048 sc1
v_mfma_f32_16x16x32_bf16 v[16:19], v[88:91], a[140:143], v[16:19]
v_mfma_f32_16x16x32_bf16 v[20:23], v[88:91], a[144:147], v[20:23]
v_mfma_f32_16x16x32_bf16 v[20:23], v[84:87], a[124:127], v[20:23]
buffer_load_dword v5, v59, s[8:11], 0 offen sc1
v_mfma_f32_16x16x32_bf16 v[24:27], v[84:87], a[128:131], v[24:27]
v_mfma_f32_16x16x32_bf16 v[24:27], v[88:91], a[148:151], v[24:27]
buffer_load_dwordx4 v[152:155], v1, s[8:11], s37 offen offset:3072 sc1
v_mfma_f32_16x16x32_bf16 v[28:31], v[88:91], a[152:155], v[28:31]
s_add_u32 s37, s37, 4096
v_mfma_f32_16x16x32_bf16 v[28:31], v[84:87], a[132:135], v[28:31]
v_mfma_f32_16x16x32_bf16 v[32:35], v[84:87], a[136:139], v[32:35]
s_waitcnt vmcnt(15)
v_mfma_f32_16x16x32_bf16 v[32:35], v[88:91], a[156:159], v[32:35]
v_mfma_f32_16x16x32_bf16 v[32:35], v[92:95], a[176:179], v[32:35]
buffer_load_dwordx4 v[156:159], v1, s[8:11], s37 offen offset:0 sc1
v_mfma_f32_16x16x32_bf16 v[32:35], v[96:99], a[196:199], v[32:35]
v_mfma_f32_16x16x32_bf16 v[28:31], v[96:99], a[192:195], v[28:31]
v_mfma_f32_16x16x32_bf16 v[28:31], v[92:95], a[172:175], v[28:31]
v_mfma_f32_16x16x32_bf16 v[24:27], v[92:95], a[168:171], v[24:27]
v_mfma_f32_16x16x32_bf16 v[24:27], v[96:99], a[188:191], v[24:27]
buffer_load_dwordx4 v[160:163], v1, s[8:11], s37 offen offset:1024 sc1
v_mfma_f32_16x16x32_bf16 v[20:23], v[96:99], a[184:187], v[20:23]
v_mfma_f32_16x16x32_bf16 v[20:23], v[92:95], a[164:167], v[20:23]
v_mfma_f32_16x16x32_bf16 v[16:19], v[92:95], a[160:163], v[16:19]
s_waitcnt vmcnt(15)
v_mfma_f32_16x16x32_bf16 v[16:19], v[96:99], a[180:183], v[16:19]
v_mfma_f32_16x16x32_bf16 v[16:19], v[100:103], a[200:203], v[16:19]
buffer_load_dwordx4 v[164:167], v1, s[8:11], s37 offen offset:2048 sc1
v_mfma_f32_16x16x32_bf16 v[16:19], v[104:107], a[220:223], v[16:19]
v_mfma_f32_16x16x32_bf16 v[20:23], v[104:107], a[224:227], v[20:23]
v_mfma_f32_16x16x32_bf16 v[20:23], v[100:103], a[204:207], v[20:23]
v_mfma_f32_16x16x32_bf16 v[24:27], v[100:103], a[208:211], v[24:27]
v_mfma_f32_16x16x32_bf16 v[24:27], v[104:107], a[228:231], v[24:27]
buffer_load_dwordx4 v[168:171], v1, s[8:11], s37 offen offset:3072 sc1
v_mfma_f32_16x16x32_bf16 v[28:31], v[104:107], a[232:235], v[28:31]
s_add_u32 s37, s37, 4096
v_mfma_f32_16x16x32_bf16 v[28:31], v[100:103], a[212:215], v[28:31]
v_mfma_f32_16x16x32_bf16 v[32:35], v[100:103], a[216:219], v[32:35]
s_waitcnt vmcnt(15)
v_mfma_f32_16x16x32_bf16 v[32:35], v[104:107], a[236:239], v[32:35]
v_mfma_f32_16x16x32_bf16 v[32:35], v[108:111], v[192:195], v[32:35]
buffer_load_dwordx4 v[172:175], v1, s[8:11], s37 offen offset:0 sc1
v_mfma_f32_16x16x32_bf16 v[32:35], v[112:115], v[212:215], v[32:35]
s_add_u32 m0, s36, 0
s_add_u32 s34, s35, 0
v_mfma_f32_16x16x32_bf16 v[28:31], v[112:115], v[208:211], v[28:31]
buffer_load_dwordx4 v1, s[8:11], s34 offen offset:0 sc1 lds
v_mfma_f32_16x16x32_bf16 v[28:31], v[108:111], a[252:255], v[28:31]
v_mfma_f32_16x16x32_bf16 v[24:27], v[108:111], a[248:251], v[24:27]
v_mfma_f32_16x16x32_bf16 v[24:27], v[112:115], v[204:207], v[24:27]
buffer_load_dwordx4 v[176:179], v1, s[8:11], s37 offen offset:1024 sc1
v_mfma_f32_16x16x32_bf16 v[20:23], v[112:115], v[200:203], v[20:23]
v_mfma_f32_16x16x32_bf16 v[20:23], v[108:111], a[244:247], v[20:23]
buffer_load_dwordx4 v1, s[8:11], s34 offen offset:1024 sc1 lds
v_mfma_f32_16x16x32_bf16 v[16:19], v[108:111], a[240:243], v[16:19]
s_waitcnt vmcnt(17)
v_mfma_f32_16x16x32_bf16 v[16:19], v[112:115], v[196:199], v[16:19]
v_mfma_f32_16x16x32_bf16 v[16:19], v[116:119], v[216:219], v[16:19]
buffer_load_dwordx4 v[180:183], v1, s[8:11], s37 offen offset:2048 sc1
v_mfma_f32_16x16x32_bf16 v[16:19], v[120:123], v[236:239], v[16:19]
v_mfma_f32_16x16x32_bf16 v[20:23], v[120:123], v[240:243], v[20:23]
buffer_load_dwordx4 v1, s[8:11], s34 offen offset:2048 sc1 lds
v_mfma_f32_16x16x32_bf16 v[20:23], v[116:119], v[220:223], v[20:23]
v_mfma_f32_16x16x32_bf16 v[24:27], v[116:119], v[224:227], v[24:27]
v_mfma_f32_16x16x32_bf16 v[24:27], v[120:123], v[244:247], v[24:27]
buffer_load_dwordx4 v[184:187], v1, s[8:11], s37 offen offset:3072 sc1
v_mfma_f32_16x16x32_bf16 v[28:31], v[120:123], v[248:251], v[28:31]
s_add_u32 s37, s37, 4096
v_mfma_f32_16x16x32_bf16 v[28:31], v[116:119], v[228:231], v[28:31]
buffer_load_dwordx4 v1, s[8:11], s34 offen offset:3072 sc1 lds
v_mfma_f32_16x16x32_bf16 v[32:35], v[116:119], v[232:235], v[32:35]
s_waitcnt vmcnt(19)
v_mfma_f32_16x16x32_bf16 v[32:35], v[120:123], v[252:255], v[32:35]
v_mfma_f32_16x16x32_bf16 v[52:55], v[124:127], a[16:19], 0
v_mfma_f32_16x16x32_bf16 v[52:55], v[128:131], a[36:39], v[52:55]
s_add_u32 m0, s36, 4096
s_add_u32 s34, s35, 4096
s_waitcnt vmcnt(13)
v_cmp_ne_u32 vcc, s7, v5
v_mfma_f32_16x16x32_bf16 v[48:51], v[128:131], a[32:35], 0
buffer_load_dwordx4 v1, s[8:11], s34 offen offset:0 sc1 lds
v_mfma_f32_16x16x32_bf16 v[48:51], v[124:127], a[12:15], v[48:51]
s_cbranch_vccnz L_spinQ
L_okQ:
v_mfma_f32_16x16x32_bf16 v[44:47], v[124:127], a[8:11], 0
v_cvt_pk_bf16_f32 v10, v16, v17
v_cvt_pk_bf16_f32 v11, v18, v19
v_mfma_f32_16x16x32_bf16 v[44:47], v[128:131], a[28:31], v[44:47]
ds_write_b64 v56, v[10:11] offset:2048
v_mfma_f32_16x16x32_bf16 v[40:43], v[128:131], a[24:27], 0
v_cvt_pk_bf16_f32 v12, v20, v21
v_cvt_pk_bf16_f32 v13, v22, v23
v_mfma_f32_16x16x32_bf16 v[40:43], v[124:127], a[4:7], v[40:43]
buffer_load_dwordx4 v1, s[8:11], s34 offen offset:1024 sc1 lds
v_mfma_f32_16x16x32_bf16 v[36:39], v[124:127], a[0:3], 0
ds_write_b64 v56, v[12:13] offset:18432
v_mfma_f32_16x16x32_bf16 v[36:39], v[128:131], a[20:23], v[36:39]
v_cvt_pk_bf16_f32 v14, v24, v25
v_cvt_pk_bf16_f32 v15, v26, v27
v_mfma_f32_16x16x32_bf16 v[36:39], v[132:135], a[40:43], v[36:39]
ds_write_b64 v56, v[14:15] offset:34816
v_mfma_f32_16x16x32_bf16 v[36:39], v[136:139], a[60:63], v[36:39]
v_cvt_pk_bf16_f32 v10, v28, v29
v_cvt_pk_bf16_f32 v11, v30, v31
v_mfma_f32_16x16x32_bf16 v[40:43], v[136:139], a[64:67], v[40:43]
buffer_load_dwordx4 v1, s[8:11], s34 offen offset:2048 sc1 lds
v_mfma_f32_16x16x32_bf16 v[40:43], v[132:135], a[44:47], v[40:43]
ds_write_b64 v56, v[10:11] offset:51200
v_mfma_f32_16x16x32_bf16 v[44:47], v[132:135], a[48:51], v[44:47]
v_cvt_pk_bf16_f32 v12, v32, v33
v_cvt_pk_bf16_f32 v13, v34, v35
v_mfma_f32_16x16x32_bf16 v[44:47], v[136:139], a[68:71], v[44:47]
ds_write_b64 v57, v[12:13] offset:2048
v_mfma_f32_16x16x32_bf16 v[48:51], v[136:139], a[72:75], v[48:51]
v_mfma_f32_16x16x32_bf16 v[48:51], v[132:135], a[52:55], v[48:51]
buffer_load_dwordx4 v1, s[8:11], s34 offen offset:3072 sc1 lds
v_mfma_f32_16x16x32_bf16 v[52:55], v[132:135], a[56:59], v[52:55]
v_mfma_f32_16x16x32_bf16 v[52:55], v[136:139], a[76:79], v[52:55]
s_add_u32 m0, s62, 0
s_add_u32 s34, s61, 0
v_mfma_f32_16x16x32_bf16 v[52:55], v[140:143], a[96:99], v[52:55]
buffer_load_dwordx4 v1, s[8:11], s34 offen sc1 lds
v_mfma_f32_16x16x32_bf16 v[52:55], v[144:147], a[116:119], v[52:55]
v_mfma_f32_16x16x32_bf16 v[48:51], v[144:147], a[112:115], v[48:51]
v_mfma_f32_16x16x32_bf16 v[48:51], v[140:143], a[92:95], v[48:51]
v_mfma_f32_16x16x32_bf16 v[44:47], v[140:143], a[88:91], v[44:47]
s_add_u32 m0, s62, 16384
s_add_u32 s34, s61, 1024
v_mfma_f32_16x16x32_bf16 v[44:47], v[144:147], a[108:111], v[44:47]
buffer_load_dwordx4 v1, s[8:11], s34 offen sc1 lds
v_mfma_f32_16x16x32_bf16 v[40:43], v[144:147], a[104:107], v[40:43]
v_mfma_f32_16x16x32_bf16 v[40:43], v[140:143], a[84:87], v[40:43]
v_mfma_f32_16x16x32_bf16 v[36:39], v[140:143], a[80:83], v[36:39]
s_waitcnt vmcnt(18)
v_mfma_f32_16x16x32_bf16 v[36:39], v[144:147], a[100:103], v[36:39]
s_add_u32 m0, s62, 32768
s_add_u32 s34, s61, 2048
v_mfma_f32_16x16x32_bf16 v[36:39], v[148:151], a[120:123], v[36:39]
buffer_load_dwordx4 v1, s[8:11], s34 offen sc1 lds
v_mfma_f32_16x16x32_bf16 v[36:39], v[152:155], a[140:143], v[36:39]
v_mfma_f32_16x16x32_bf16 v[40:43], v[152:155], a[144:147], v[40:43]
v_mfma_f32_16x16x32_bf16 v[40:43], v[148:151], a[124:127], v[40:43]
v_mfma_f32_16x16x32_bf16 v[44:47], v[148:151], a[128:131], v[44:47]
s_add_u32 m0, s62, 49152
s_add_u32 s34, s61, 3072
v_mfma_f32_16x16x32_bf16 v[44:47], v[152:155], a[148:151], v[44:47]
buffer_load_dwordx4 v1, s[8:11], s34 offen sc1 lds
v_mfma_f32_16x16x32_bf16 v[48:51], v[152:155], a[152:155], v[48:51]
v_mfma_f32_16x16x32_bf16 v[48:51], v[148:151], a[132:135], v[48:51]
v_mfma_f32_16x16x32_bf16 v[52:55], v[148:151], a[136:139], v[52:55]
s_waitcnt vmcnt(18)
v_mfma_f32_16x16x32_bf16 v[52:55], v[152:155], a[156:159], v[52:55]
s_add_u32 m0, s62, 65536
s_add_u32 s34, s61, 4096
v_mfma_f32_16x16x32_bf16 v[52:55], v[156:159], a[176:179], v[52:55]
buffer_load_dwordx4 v1, s[8:11], s34 offen sc1 lds
v_mfma_f32_16x16x32_bf16 v[52:55], v[160:163], a[196:199], v[52:55]
v_mfma_f32_16x16x32_bf16 v[48:51], v[160:163], a[192:195], v[48:51]
v_mfma_f32_16x16x32_bf16 v[48:51], v[156:159], a[172:175], v[48:51]
v_mfma_f32_16x16x32_bf16 v[44:47], v[156:159], a[168:171], v[44:47]
v_mfma_f32_16x16x32_bf16 v[44:47], v[160:163], a[188:191], v[44:47]
v_mfma_f32_16x16x32_bf16 v[40:43], v[160:163], a[184:187], v[40:43]
v_mfma_f32_16x16x32_bf16 v[40:43], v[156:159], a[164:167], v[40:43]
v_mfma_f32_16x16x32_bf16 v[36:39], v[156:159], a[160:163], v[36:39]
s_waitcnt vmcnt(17)
v_mfma_f32_16x16x32_bf16 v[36:39], v[160:163], a[180:183], v[36:39]
v_mfma_f32_16x16x32_bf16 v[36:39], v[164:167], a[200:203], v[36:39]
v_mfma_f32_16x16x32_bf16 v[36:39], v[168:171], a[220:223], v[36:39]
v_mfma_f32_16x16x32_bf16 v[40:43], v[168:171], a[224:227], v[40:43]
v_mfma_f32_16x16x32_bf16 v[40:43], v[164:167], a[204:207], v[40:43]
v_mfma_f32_16x16x32_bf16 v[44:47], v[164:167], a[208:211], v[44:47]
v_mfma_f32_16x16x32_bf16 v[44:47], v[168:171], a[228:231], v[44:47]
v_mfma_f32_16x16x32_bf16 v[48:51], v[168:171], a[232:235], v[48:51]
v_mfma_f32_16x16x32_bf16 v[48:51], v[164:167], a[212:215], v[48:51]
v_mfma_f32_16x16x32_bf16 v[52:55], v[164:167], a[216:219], v[52:55]
s_waitcnt vmcnt(14)
v_mfma_f32_16x16x32_bf16 v[52:55], v[168:171], a[236:239], v[52:55]
v_mfma_f32_16x16x32_bf16 v[52:55], v[172:175], v[192:195], v[52:55]
v_mfma_f32_16x16x32_bf16 v[52:55], v[176:179], v[212:215], v[52:55]
v_mfma_f32_16x16x32_bf16 v[48:51], v[176:179], v[208:211], v[48:51]
v_mfma_f32_16x16x32_bf16 v[48:51], v[172:175], a[252:255], v[48:51]
v_mfma_f32_16x16x32_bf16 v[44:47], v[172:175], a[248:251], v[44:47]
v_mfma_f32_16x16x32_bf16 v[44:47], v[176:179], v[204:207], v[44:47]
v_mfma_f32_16x16x32_bf16 v[40:43], v[176:179], v[200:203], v[40:43]
v_mfma_f32_16x16x32_bf16 v[40:43], v[172:175], a[244:247], v[40:43]
v_mfma_f32_16x16x32_bf16 v[36:39], v[172:175], a[240:243], v[36:39]
s_waitcnt vmcnt(10)
v_mfma_f32_16x16x32_bf16 v[36:39], v[176:179], v[196:199], v[36:39]
v_mfma_f32_16x16x32_bf16 v[36:39], v[180:183], v[216:219], v[36:39]
v_mfma_f32_16x16x32_bf16 v[36:39], v[184:187], v[236:239], v[36:39]
v_mfma_f32_16x16x32_bf16 v[40:43], v[184:187], v[240:243], v[40:43]
v_mfma_f32_16x16x32_bf16 v[40:43], v[180:183], v[220:223], v[40:43]
v_mfma_f32_16x16x32_bf16 v[44:47], v[180:183], v[224:227], v[44:47]
v_mfma_f32_16x16x32_bf16 v[44:47], v[184:187], v[244:247], v[44:47]
v_mfma_f32_16x16x32_bf16 v[48:51], v[184:187], v[248:251], v[48:51]
v_mfma_f32_16x16x32_bf16 v[48:51], v[180:183], v[228:231], v[48:51]
v_mfma_f32_16x16x32_bf16 v[52:55], v[180:183], v[232:235], v[52:55]
v_mfma_f32_16x16x32_bf16 v[52:55], v[184:187], v[252:255], v[52:55]
v_cvt_pk_bf16_f32 v10, v36, v37
v_cvt_pk_bf16_f32 v11, v38, v39
ds_write_b64 v56, v[10:11] offset:2056
v_cvt_pk_bf16_f32 v12, v40, v41
v_cvt_pk_bf16_f32 v13, v42, v43
ds_write_b64 v56, v[12:13] offset:18440
v_cvt_pk_bf16_f32 v14, v44, v45
v_cvt_pk_bf16_f32 v15, v46, v47
ds_write_b64 v56, v[14:15] offset:34824
v_cvt_pk_bf16_f32 v10, v48, v49
v_cvt_pk_bf16_f32 v11, v50, v51
ds_write_b64 v56, v[10:11] offset:51208
v_cvt_pk_bf16_f32 v12, v52, v53
v_cvt_pk_bf16_f32 v13, v54, v55
ds_write_b64 v57, v[12:13] offset:2056
s_waitcnt vmcnt(0) lgkmcnt(0)
s_barrier
s_lshl_b32 s29, s21, 14
s_add_u32 s29, s29, 32768
s_add_u32 s28, s28, s29
s_mov_b32 s31, s28
s_bitcmp1_b32 s20, 1
s_cbranch_scc1 L_pv
s_add_u32 s28, s28, 65536
s_add_u32 s29, s29, 65536
s_mov_b32 s31, s28
v_bfe_u32 v7, v0, 2, 2
v_sub_u32 v7, 0, v7
v_lshrrev_b32 v2, 4, v0
v_xor_b32 v7, v7, v2
v_and_b32 v7, 3, v7
v_and_b32 v2, 15, v0
v_lshl_add_u32 v2, v2, 2, v7
v_lshlrev_b32 v2, 4, v2
s_lshl_b32 s36, s21, 14
v_add_u32 v2, s36, v2
v_add_u32 v8, 65536, v1
v_add_u32 v9, 131072, v1
ds_read_b128 v[80:83], v2 offset:0
ds_read_b128 v[84:87], v2 offset:1024
ds_read_b128 a[16:19], v9 offset:0
ds_read_b128 a[36:39], v9 offset:1024
ds_read_b128 a[32:35], v8 offset:50176
ds_read_b128 a[12:15], v8 offset:49152
ds_read_b128 a[8:11], v8 offset:32768
ds_read_b128 a[28:31], v8 offset:33792
ds_read_b128 a[24:27], v8 offset:17408
ds_read_b128 a[4:7], v8 offset:16384
ds_read_b128 a[0:3], v8 offset:0
ds_read_b128 a[20:23], v8 offset:1024
s_lshl_b32 s36, s21, 9
s_add_u32 s36, s36, 131072
v_lshl_add_u32 v3, v0, 2, s36
v_mov_b32 v112, 0
v_mov_b32 v113, 0
v_mov_b32 v114, 0
v_mov_b32 v115, 0
v_mov_b32 v116, 0
s_and_b32 s36, s25, 7
s_lshl_b32 s36, s36, 11
s_add_u32 s36, s36, 0
v_lshl_add_u32 v122, v0, 5, s36
v_lshrrev_b32 v122, 4, v0
v_min_u32 v122, 2, v122
v_lshlrev_b32 v122, 7, v122
v_add_u32 v122, 0x340fd00, v122
s_waitcnt lgkmcnt(8)
v_mfma_f32_16x16x32_bf16 v[56:59], v[80:83], a[16:19], 0
ds_read_b128 a[40:43], v8 offset:2048
ds_read_b128 v[88:91], v2 offset:2048
v_mfma_f32_16x16x32_bf16 v[56:59], v[84:87], a[36:39], v[56:59]
ds_read_b128 a[60:63], v8 offset:3072
ds_read_b128 v[92:95], v2 offset:3072
s_waitcnt lgkmcnt(10)
v_mfma_f32_16x16x32_bf16 v[52:55], v[84:87], a[32:35], 0
ds_read_b128 a[64:67], v8 offset:19456
v_mfma_f32_16x16x32_bf16 v[52:55], v[80:83], a[12:15], v[52:55]
ds_read_b128 a[44:47], v8 offset:18432
s_waitcnt lgkmcnt(10)
v_mfma_f32_16x16x32_bf16 v[48:51], v[80:83], a[8:11], 0
ds_read_b128 a[48:51], v8 offset:34816
v_mfma_f32_16x16x32_bf16 v[48:51], v[84:87], a[28:31], v[48:51]
ds_read_b128 a[68:71], v8 offset:35840
s_waitcnt lgkmcnt(10)
v_mfma_f32_16x16x32_bf16 v[44:47], v[84:87], a[24:27], 0
ds_read_b128 a[72:75], v8 offset:52224
v_mfma_f32_16x16x32_bf16 v[44:47], v[80:83], a[4:7], v[44:47]
ds_read_b128 a[52:55], v8 offset:51200
s_waitcnt lgkmcnt(10)
v_mfma_f32_16x16x32_bf16 v[40:43], v[80:83], a[0:3], 0
ds_read_b128 a[56:59], v9 offset:2048
v_mfma_f32_16x16x32_bf16 v[40:43], v[84:87], a[20:23], v[40:43]
ds_read_b128 a[76:79], v9 offset:3072
s_waitcnt lgkmcnt(8)
v_mfma_f32_16x16x32_bf16 v[40:43], v[88:91], a[40:43], v[40:43]
ds_read_b128 a[96:99], v9 offset:4096
ds_read_b128 v[96:99], v2 offset:4096
v_mfma_f32_16x16x32_bf16 v[40:43], v[92:95], a[60:63], v[40:43]
ds_read_b128 a[116:119], v9 offset:5120
ds_read_b128 v[100:103], v2 offset:5120
s_waitcnt lgkmcnt(10)
v_mfma_f32_16x16x32_bf16 v[44:47], v[92:95], a[64:67], v[44:47]
ds_read_b128 a[112:115], v8 offset:54272
v_mfma_f32_16x16x32_bf16 v[44:47], v[88:91], a[44:47], v[44:47]
ds_read_b128 a[92:95], v8 offset:53248
s_waitcnt lgkmcnt(10)
v_mfma_f32_16x16x32_bf16 v[48:51], v[88:91], a[48:51], v[48:51]
ds_read_b128 a[88:91], v8 offset:36864
v_mfma_f32_16x16x32_bf16 v[48:51], v[92:95], a[68:71], v[48:51]
ds_read_b128 a[108:111], v8 offset:37888
s_waitcnt lgkmcnt(10)
v_mfma_f32_16x16x32_bf16 v[52:55], v[92:95], a[72:75], v[52:55]
ds_read_b128 a[104:107], v8 offset:21504
v_mfma_f32_16x16x32_bf16 v[52:55], v[88:91], a[52:55], v[52:55]
ds_read_b128 a[84:87], v8 offset:20480
s_waitcnt lgkmcnt(10)
v_mfma_f32_16x16x32_bf16 v[56:59], v[88:91], a[56:59], v[56:59]
ds_read_b128 a[80:83], v8 offset:4096
v_mfma_f32_16x16x32_bf16 v[56:59], v[92:95], a[76:79], v[56:59]
ds_read_b128 a[100:103], v8 offset:5120
s_waitcnt lgkmcnt(8)
v_mfma_f32_16x16x32_bf16 v[56:59], v[96:99], a[96:99], v[56:59]
ds_read_b128 a[120:123], v8 offset:6144
ds_read_b128 v[104:107], v2 offset:6144
v_mfma_f32_16x16x32_bf16 v[56:59], v[100:103], a[116:119], v[56:59]
ds_read_b128 a[140:143], v8 offset:7168
ds_read_b128 v[108:111], v2 offset:7168
s_waitcnt lgkmcnt(10)
v_mfma_f32_16x16x32_bf16 v[52:55], v[100:103], a[112:115], v[52:55]
ds_read_b128 a[144:147], v8 offset:23552
v_mfma_f32_16x16x32_bf16 v[52:55], v[96:99], a[92:95], v[52:55]
ds_read_b128 a[124:127], v8 offset:22528
s_waitcnt lgkmcnt(10)
v_mfma_f32_16x16x32_bf16 v[48:51], v[96:99], a[88:91], v[48:51]
ds_read_b128 a[128:131], v8 offset:38912
v_mfma_f32_16x16x32_bf16 v[48:51], v[100:103], a[108:111], v[48:51]
ds_read_b128 a[148:151], v8 offset:39936
s_waitcnt lgkmcnt(10)
v_mfma_f32_16x16x32_bf16 v[44:47], v[100:103], a[104:107], v[44:47]
ds_read_b128 a[152:155], v8 offset:56320
v_mfma_f32_16x16x32_bf16 v[44:47], v[96:99], a[84:87], v[44:47]
ds_read_b128 a[132:135], v8 offset:55296
s_waitcnt lgkmcnt(10)
v_mfma_f32_16x16x32_bf16 v[40:43], v[96:99], a[80:83], v[40:43]
ds_read_b128 a[136:139], v9 offset:6144
v_mfma_f32_16x16x32_bf16 v[40:43], v[100:103], a[100:103], v[40:43]
ds_read_b128 a[156:159], v9 offset:7168
s_waitcnt lgkmcnt(8)
v_mfma_f32_16x16x32_bf16 v[40:43], v[104:107], a[120:123], v[40:43]
ds_read_b128 a[176:179], v9 offset:8192
ds_read_b128 v[80:83], v2 offset:8192
v_mfma_f32_16x16x32_bf16 v[40:43], v[108:111], a[140:143], v[40:43]
ds_read_b128 a[196:199], v9 offset:9216
ds_read_b128 v[84:87], v2 offset:9216
s_waitcnt lgkmcnt(10)
v_mfma_f32_16x16x32_bf16 v[44:47], v[108:111], a[144:147], v[44:47]
ds_read_b128 a[192:195], v8 offset:58368
v_mfma_f32_16x16x32_bf16 v[44:47], v[104:107], a[124:127], v[44:47]
ds_read_b128 a[172:175], v8 offset:57344
s_waitcnt lgkmcnt(10)
v_mfma_f32_16x16x32_bf16 v[48:51], v[104:107], a[128:131], v[48:51]
ds_read_b128 a[168:171], v8 offset:40960
v_mfma_f32_16x16x32_bf16 v[48:51], v[108:111], a[148:151], v[48:51]
ds_read_b128 a[188:191], v8 offset:41984
s_waitcnt lgkmcnt(10)
v_mfma_f32_16x16x32_bf16 v[52:55], v[108:111], a[152:155], v[52:55]
ds_read_b128 a[184:187], v8 offset:25600
v_mfma_f32_16x16x32_bf16 v[52:55], v[104:107], a[132:135], v[52:55]
ds_read_b128 a[164:167], v8 offset:24576
s_waitcnt lgkmcnt(10)
v_mfma_f32_16x16x32_bf16 v[56:59], v[104:107], a[136:139], v[56:59]
ds_read_b128 a[160:163], v8 offset:8192
v_mfma_f32_16x16x32_bf16 v[56:59], v[108:111], a[156:159], v[56:59]
ds_read_b128 a[180:183], v8 offset:9216
s_waitcnt lgkmcnt(8)
v_mfma_f32_16x16x32_bf16 v[56:59], v[80:83], a[176:179], v[56:59]
ds_read_b128 a[200:203], v8 offset:10240
ds_read_b128 v[88:91], v2 offset:10240
v_mfma_f32_16x16x32_bf16 v[56:59], v[84:87], a[196:199], v[56:59]
ds_read_b128 a[220:223], v8 offset:11264
ds_read_b128 v[92:95], v2 offset:11264
s_waitcnt lgkmcnt(10)
v_mfma_f32_16x16x32_bf16 v[52:55], v[84:87], a[192:195], v[52:55]
ds_read_b128 a[224:227], v8 offset:27648
v_mfma_f32_16x16x32_bf16 v[52:55], v[80:83], a[172:175], v[52:55]
ds_read_b128 a[204:207], v8 offset:26624
s_waitcnt lgkmcnt(10)
v_mfma_f32_16x16x32_bf16 v[48:51], v[80:83], a[168:171], v[48:51]
ds_read_b128 a[208:211], v8 offset:43008
v_mfma_f32_16x16x32_bf16 v[48:51], v[84:87], a[188:191], v[48:51]
ds_read_b128 a[228:231], v8 offset:44032
s_waitcnt lgkmcnt(10)
v_mfma_f32_16x16x32_bf16 v[44:47], v[84:87], a[184:187], v[44:47]
ds_read_b128 a[232:235], v8 offset:60416
v_mfma_f32_16x16x32_bf16 v[44:47], v[80:83], a[164:167], v[44:47]
ds_read_b128 a[212:215], v8 offset:59392
s_waitcnt lgkmcnt(10)
v_mfma_f32_16x16x32_bf16 v[40:43], v[80:83], a[160:163], v[40:43]
ds_read_b128 a[216:219], v9 offset:10240
v_mfma_f32_16x16x32_bf16 v[40:43], v[84:87], a[180:183], v[40:43]
ds_read_b128 a[236:239], v9 offset:11264
s_waitcnt lgkmcnt(8)
v_mfma_f32_16x16x32_bf16 v[40:43], v[88:91], a[200:203], v[40:43]
ds_read_b128 v[192:195], v9 offset:12288
ds_read_b128 v[96:99], v2 offset:12288
v_mfma_f32_16x16x32_bf16 v[40:43], v[92:95], a[220:223], v[40:43]
ds_read_b128 v[212:215], v9 offset:13312
ds_read_b128 v[100:103], v2 offset:13312
s_waitcnt lgkmcnt(10)
v_mfma_f32_16x16x32_bf16 v[44:47], v[92:95], a[224:227], v[44:47]
ds_read_b128 v[208:211], v8 offset:62464
v_mfma_f32_16x16x32_bf16 v[44:47], v[88:91], a[204:207], v[44:47]
ds_read_b128 a[252:255], v8 offset:61440
s_waitcnt lgkmcnt(10)
v_mfma_f32_16x16x32_bf16 v[48:51], v[88:91], a[208:211], v[48:51]
ds_read_b128 a[248:251], v8 offset:45056
v_mfma_f32_16x16x32_bf16 v[48:51], v[92:95], a[228:231], v[48:51]
ds_read_b128 v[204:207], v8 offset:46080
s_waitcnt lgkmcnt(10)
v_mfma_f32_16x16x32_bf16 v[52:55], v[92:95], a[232:235], v[52:55]
ds_read_b128 v[200:203], v8 offset:29696
v_mfma_f32_16x16x32_bf16 v[52:55], v[88:91], a[212:215], v[52:55]
ds_read_b128 a[244:247], v8 offset:28672
s_waitcnt lgkmcnt(10)
v_mfma_f32_16x16x32_bf16 v[56:59], v[88:91], a[216:219], v[56:59]
ds_read_b128 a[240:243], v8 offset:12288
v_mfma_f32_16x16x32_bf16 v[56:59], v[92:95], a[236:239], v[56:59]
ds_read_b128 v[196:199], v8 offset:13312
s_waitcnt lgkmcnt(8)
v_mfma_f32_16x16x32_bf16 v[56:59], v[96:99], v[192:195], v[56:59]
ds_read_b128 v[216:219], v8 offset:14336
ds_read_b128 v[104:107], v2 offset:14336
v_mfma_f32_16x16x32_bf16 v[56:59], v[100:103], v[212:215], v[56:59]
ds_read_b128 v[236:239], v8 offset:15360
ds_read_b128 v[108:111], v2 offset:15360
s_waitcnt lgkmcnt(10)
v_mfma_f32_16x16x32_bf16 v[52:55], v[100:103], v[208:211], v[52:55]
ds_read_b128 v[240:243], v8 offset:31744
v_mfma_f32_16x16x32_bf16 v[52:55], v[96:99], a[252:255], v[52:55]
ds_read_b128 v[220:223], v8 offset:30720
s_waitcnt lgkmcnt(10)
v_mfma_f32_16x16x32_bf16 v[48:51], v[96:99], a[248:251], v[48:51]
ds_read_b128 v[224:227], v8 offset:47104
v_mfma_f32_16x16x32_bf16 v[48:51], v[100:103], v[204:207], v[48:51]
ds_read_b128 v[244:247], v8 offset:48128
s_waitcnt lgkmcnt(10)
v_mfma_f32_16x16x32_bf16 v[44:47], v[100:103], v[200:203], v[44:47]
ds_read_b128 v[248:251], v8 offset:64512
v_mfma_f32_16x16x32_bf16 v[44:47], v[96:99], a[244:247], v[44:47]
ds_read_b128 v[228:231], v8 offset:63488
s_waitcnt lgkmcnt(10)
v_mfma_f32_16x16x32_bf16 v[40:43], v[96:99], a[240:243], v[40:43]
ds_read_b128 v[232:235], v9 offset:14336
v_mfma_f32_16x16x32_bf16 v[40:43], v[100:103], v[196:199], v[40:43]
ds_read_b128 v[252:255], v9 offset:15360
s_waitcnt lgkmcnt(8)
v_mfma_f32_16x16x32_bf16 v[40:43], v[104:107], v[216:219], v[40:43]
v_mfma_f32_16x16x32_bf16 v[40:43], v[108:111], v[236:239], v[40:43]
s_waitcnt lgkmcnt(6)
v_mfma_f32_16x16x32_bf16 v[44:47], v[108:111], v[240:243], v[44:47]
v_mfma_f32_16x16x32_bf16 v[44:47], v[104:107], v[220:223], v[44:47]
s_waitcnt lgkmcnt(4)
v_mfma_f32_16x16x32_bf16 v[48:51], v[104:107], v[224:227], v[48:51]
v_mfma_f32_16x16x32_bf16 v[48:51], v[108:111], v[244:247], v[48:51]
s_waitcnt lgkmcnt(2)
v_mfma_f32_16x16x32_bf16 v[52:55], v[108:111], v[248:251], v[52:55]
v_mfma_f32_16x16x32_bf16 v[52:55], v[104:107], v[228:231], v[52:55]
s_waitcnt lgkmcnt(0)
v_mfma_f32_16x16x32_bf16 v[56:59], v[104:107], v[232:235], v[56:59]
v_mfma_f32_16x16x32_bf16 v[56:59], v[108:111], v[252:255], v[56:59]
v_and_b32 v7, 0xfffffffb, v4
v_max3_f32 v117, v40, v41, v42
v_max_f32 v117, v117, v43
v_mov_b32 v60, v117
v_max3_f32 v118, v44, v45, v46
v_max_f32 v118, v118, v47
v_mov_b32 v61, v118
v_max3_f32 v119, v48, v49, v50
v_max_f32 v119, v119, v51
v_mov_b32 v62, v119
v_max3_f32 v120, v52, v53, v54
v_max_f32 v120, v120, v55
v_mov_b32 v63, v120
v_max3_f32 v121, v56, v57, v58
v_max_f32 v121, v121, v59
v_mov_b32 v64, v121
v_permlane16_swap_b32 v60, v117
v_permlane16_swap_b32 v61, v118
v_permlane16_swap_b32 v62, v119
v_permlane16_swap_b32 v63, v120
v_permlane16_swap_b32 v64, v121
v_max_f32 v117, v117, v60
v_mov_b32 v60, v117
v_max_f32 v118, v118, v61
v_mov_b32 v61, v118
v_max_f32 v119, v119, v62
v_mov_b32 v62, v119
v_max_f32 v120, v120, v63
v_mov_b32 v63, v120
v_max_f32 v121, v121, v64
v_mov_b32 v64, v121
v_permlane32_swap_b32 v60, v117
v_permlane32_swap_b32 v61, v118
v_permlane32_swap_b32 v62, v119
v_permlane32_swap_b32 v63, v120
v_permlane32_swap_b32 v64, v121
v_max_f32 v117, v117, v60
v_max_f32 v118, v118, v61
v_max_f32 v119, v119, v62
v_max_f32 v120, v120, v63
v_max_f32 v121, v121, v64
v_add_f32 v117, 0x42200000, v117
v_add_f32 v118, 0x42200000, v118
v_add_f32 v119, 0x42200000, v119
v_add_f32 v120, 0x42200000, v120
v_add_f32 v121, 0x42200000, v121
ds_write_b32 v4, v117 offset:0
ds_write_b32 v4, v118 offset:512
ds_write_b32 v4, v119 offset:1024
ds_write_b32 v4, v120 offset:1536
ds_write_b32 v4, v121 offset:2048
s_waitcnt lgkmcnt(0)
s_barrier
ds_read_b64 v[60:61], v7 offset:0
ds_read_b64 v[62:63], v7 offset:512
ds_read_b64 v[64:65], v7 offset:1024
ds_read_b64 v[66:67], v7 offset:1536
ds_read_b64 v[68:69], v7 offset:2048
ds_read_b128 v[80:83], v2 offset:32768
ds_read_b128 v[84:87], v2 offset:33792
s_waitcnt lgkmcnt(6)
v_min_f32 v20, -v60, -v61
v_mov_b32 v21, v20
v_pk_mov_b32 v[22:23], v[20:21], v[20:21]
v_pk_add_f32 v[40:41], v[40:41], v[20:21]
v_pk_add_f32 v[42:43], v[42:43], v[20:21]
s_waitcnt lgkmcnt(5)
v_min_f32 v24, -v62, -v63
v_mov_b32 v25, v24
v_pk_mov_b32 v[26:27], v[24:25], v[24:25]
v_pk_add_f32 v[44:45], v[44:45], v[24:25]
v_pk_add_f32 v[46:47], v[46:47], v[24:25]
s_waitcnt lgkmcnt(4)
v_min_f32 v28, -v64, -v65
v_mov_b32 v29, v28
v_pk_mov_b32 v[30:31], v[28:29], v[28:29]
v_pk_add_f32 v[48:49], v[48:49], v[28:29]
v_pk_add_f32 v[50:51], v[50:51], v[28:29]
s_waitcnt lgkmcnt(3)
v_min_f32 v32, -v66, -v67
v_mov_b32 v33, v32
v_pk_mov_b32 v[34:35], v[32:33], v[32:33]
v_pk_add_f32 v[52:53], v[52:53], v[32:33]
v_pk_add_f32 v[54:55], v[54:55], v[32:33]
s_waitcnt lgkmcnt(2)
v_min_f32 v36, -v68, -v69
v_mov_b32 v37, v36
v_pk_mov_b32 v[38:39], v[36:37], v[36:37]
v_pk_add_f32 v[56:57], v[56:57], v[36:37]
v_pk_add_f32 v[58:59], v[58:59], v[36:37]
s_waitcnt lgkmcnt(0)
s_mov_b32 s27, 1
s_mov_b32 s47, s26
s_mov_b32 s26, 57
.p2align 6
L_qloop:
v_mfma_f32_16x16x32_bf16 v[76:79], v[80:83], a[16:19], v[36:39]
ds_read_b128 v[88:91], v2 offset:34816
v_mfma_f32_16x16x32_bf16 v[76:79], v[84:87], a[36:39], v[76:79]
ds_read_b128 v[92:95], v2 offset:35840
v_mfma_f32_16x16x32_bf16 v[72:75], v[84:87], a[32:35], v[32:35]
v_exp_f32 v124, v40
v_mfma_f32_16x16x32_bf16 v[72:75], v[80:83], a[12:15], v[72:75]
v_exp_f32 v125, v41
v_mfma_f32_16x16x32_bf16 v[68:71], v[80:83], a[8:11], v[28:31]
v_exp_f32 v126, v42
v_mfma_f32_16x16x32_bf16 v[68:71], v[84:87], a[28:31], v[68:71]
v_exp_f32 v127, v43
v_mfma_f32_16x16x32_bf16 v[64:67], v[84:87], a[24:27], v[24:27]
v_exp_f32 v128, v44
v_mfma_f32_16x16x32_bf16 v[64:67], v[80:83], a[4:7], v[64:67]
v_exp_f32 v129, v45
v_mfma_f32_16x16x32_bf16 v[60:63], v[80:83], a[0:3], v[20:23]
v_exp_f32 v130, v46
v_mfma_f32_16x16x32_bf16 v[60:63], v[84:87], a[20:23], v[60:63]
s_waitcnt lgkmcnt(0)
v_exp_f32 v131, v47
v_mfma_f32_16x16x32_bf16 v[60:63], v[88:91], a[40:43], v[60:63]
ds_read_b128 v[96:99], v2 offset:36864
v_cvt_pk_bf16_f32 v144, v124, v125
v_mfma_f32_16x16x32_bf16 v[60:63], v[92:95], a[60:63], v[60:63]
ds_read_b128 v[100:103], v2 offset:37888
v_cvt_pk_bf16_f32 v145, v126, v127
v_mfma_f32_16x16x32_bf16 v[64:67], v[92:95], a[64:67], v[64:67]
v_exp_f32 v132, v48
v_mfma_f32_16x16x32_bf16 v[64:67], v[88:91], a[44:47], v[64:67]
ds_write_b32 v3, v144 offset:0
v_mfma_f32_16x16x32_bf16 v[68:71], v[88:91], a[48:51], v[68:71]
v_exp_f32 v133, v49
v_mfma_f32_16x16x32_bf16 v[68:71], v[92:95], a[68:71], v[68:71]
ds_write_b32 v3, v145 offset:256
v_mfma_f32_16x16x32_bf16 v[72:75], v[92:95], a[72:75], v[72:75]
v_exp_f32 v134, v50
v_mfma_f32_16x16x32_bf16 v[72:75], v[88:91], a[52:55], v[72:75]
v_cvt_pk_bf16_f32 v146, v128, v129
v_cvt_pk_bf16_f32 v147, v130, v131
v_mfma_f32_16x16x32_bf16 v[76:79], v[88:91], a[56:59], v[76:79]
v_exp_f32 v135, v51
v_mfma_f32_16x16x32_bf16 v[76:79], v[92:95], a[76:79], v[76:79]
s_waitcnt lgkmcnt(2)
v_exp_f32 v136, v52
v_mfma_f32_16x16x32_bf16 v[76:79], v[96:99], a[96:99], v[76:79]
ds_read_b128 v[104:107], v2 offset:38912
v_cvt_pk_bf16_f32 v148, v132, v133
v_mfma_f32_16x16x32_bf16 v[76:79], v[100:103], a[116:119], v[76:79]
ds_read_b128 v[108:111], v2 offset:39936
v_cvt_pk_bf16_f32 v149, v134, v135
v_mfma_f32_16x16x32_bf16 v[72:75], v[100:103], a[112:115], v[72:75]
v_exp_f32 v137, v53
v_mfma_f32_16x16x32_bf16 v[72:75], v[96:99], a[92:95], v[72:75]
ds_write_b32 v3, v146 offset:1024
v_mfma_f32_16x16x32_bf16 v[68:71], v[96:99], a[88:91], v[68:71]
v_exp_f32 v138, v54
v_mfma_f32_16x16x32_bf16 v[68:71], v[100:103], a[108:111], v[68:71]
ds_write_b32 v3, v147 offset:1280
v_mfma_f32_16x16x32_bf16 v[64:67], v[100:103], a[104:107], v[64:67]
v_exp_f32 v139, v55
v_mfma_f32_16x16x32_bf16 v[64:67], v[96:99], a[84:87], v[64:67]
ds_write_b32 v3, v148 offset:2048
v_mfma_f32_16x16x32_bf16 v[60:63], v[96:99], a[80:83], v[60:63]
v_exp_f32 v140, v56
v_mfma_f32_16x16x32_bf16 v[60:63], v[100:103], a[100:103], v[60:63]
s_waitcnt lgkmcnt(3)
v_exp_f32 v141, v57
v_mfma_f32_16x16x32_bf16 v[60:63], v[104:107], a[120:123], v[60:63]
ds_read_b128 v[80:83], v2 offset:40960
v_cvt_pk_bf16_f32 v150, v136, v137
v_mfma_f32_16x16x32_bf16 v[60:63], v[108:111], a[140:143], v[60:63]
ds_read_b128 v[84:87], v2 offset:41984
v_cvt_pk_bf16_f32 v151, v138, v139
v_mfma_f32_16x16x32_bf16 v[64:67], v[108:111], a[144:147], v[64:67]
v_exp_f32 v142, v58
v_mfma_f32_16x16x32_bf16 v[64:67], v[104:107], a[124:127], v[64:67]
v_exp_f32 v143, v59
v_mfma_f32_16x16x32_bf16 v[68:71], v[104:107], a[128:131], v[68:71]
ds_write_b32 v3, v149 offset:2304
v_mfma_f32_16x16x32_bf16 v[68:71], v[108:111], a[148:151], v[68:71]
ds_write_b32 v3, v150 offset:3072
v_mfma_f32_16x16x32_bf16 v[72:75], v[108:111], a[152:155], v[72:75]
ds_write_b32 v3, v151 offset:3328
v_mfma_f32_16x16x32_bf16 v[72:75], v[104:107], a[132:135], v[72:75]
v_cvt_pk_bf16_f32 v152, v140, v141
v_cvt_pk_bf16_f32 v153, v142, v143
v_mfma_f32_16x16x32_bf16 v[76:79], v[104:107], a[136:139], v[76:79]
ds_write_b32 v3, v152 offset:4096
v_mfma_f32_16x16x32_bf16 v[76:79], v[108:111], a[156:159], v[76:79]
s_waitcnt lgkmcnt(4)
v_or3_b32 v7, v144, v145, v146
v_or3_b32 v7, v7, v147, v148
v_mfma_f32_16x16x32_bf16 v[76:79], v[80:83], a[176:179], v[76:79]
ds_read_b128 v[88:91], v2 offset:43008
v_or3_b32 v7, v7, v149, v150
v_mfma_f32_16x16x32_bf16 v[76:79], v[84:87], a[196:199], v[76:79]
ds_read_b128 v[92:95], v2 offset:44032
v_or3_b32 v7, v7, v151, v152
v_mfma_f32_16x16x32_bf16 v[72:75], v[84:87], a[192:195], v[72:75]
v_bitop3_b32 v7, v7, v153, s41 bitop3:0xa8
v_cmp_ne_u32 vcc, 0, v7
v_mfma_f32_16x16x32_bf16 v[72:75], v[80:83], a[172:175], v[72:75]
ds_write_b32 v3, v153 offset:4352
v_mfma_f32_16x16x32_bf16 v[68:71], v[80:83], a[168:171], v[68:71]
s_cbranch_vccnz L_setflag1
L_flagset1:
v_mfma_f32_16x16x32_bf16 v[68:71], v[84:87], a[188:191], v[68:71]
v_mfma_f32_16x16x32_bf16 v[64:67], v[84:87], a[184:187], v[64:67]
v_mfma_f32_16x16x32_bf16 v[64:67], v[80:83], a[164:167], v[64:67]
s_waitcnt vmcnt(0) lgkmcnt(0)
s_barrier
v_mfma_f32_16x16x32_bf16 v[60:63], v[80:83], a[160:163], v[60:63]
s_add_u32 m0, s29, 0
ds_read_b32 v5, v6
v_mfma_f32_16x16x32_bf16 v[60:63], v[84:87], a[180:183], v[60:63]
s_add_u32 s34, s28, 0
v_mfma_f32_16x16x32_bf16 v[60:63], v[88:91], a[200:203], v[60:63]
ds_read_b128 v[96:99], v2 offset:45056
v_mfma_f32_16x16x32_bf16 v[60:63], v[92:95], a[220:223], v[60:63]
ds_read_b128 v[100:103], v2 offset:46080
v_mfma_f32_16x16x32_bf16 v[64:67], v[92:95], a[224:227], v[64:67]
buffer_load_dwordx4 v1, s[8:11], s34 offen offset:0 sc1 lds
v_mfma_f32_16x16x32_bf16 v[64:67], v[88:91], a[204:207], v[64:67]
s_waitcnt lgkmcnt(2)
v_cmp_eq_u32 vcc, s27, v5
v_mfma_f32_16x16x32_bf16 v[68:71], v[88:91], a[208:211], v[68:71]
buffer_load_dwordx4 v1, s[8:11], s34 offen offset:1024 sc1 lds
v_mfma_f32_16x16x32_bf16 v[68:71], v[92:95], a[228:231], v[68:71]
s_cbranch_vccnz L_qrec1
L_qback1:
v_mfma_f32_16x16x32_bf16 v[72:75], v[92:95], a[232:235], v[72:75]
buffer_load_dwordx4 v1, s[8:11], s34 offen offset:2048 sc1 lds
v_mfma_f32_16x16x32_bf16 v[72:75], v[88:91], a[212:215], v[72:75]
v_add_f32 v112, v112, v124
v_add_f32 v113, v113, v128
v_mfma_f32_16x16x32_bf16 v[76:79], v[88:91], a[216:219], v[76:79]
v_add_f32 v114, v114, v132
v_add_f32 v115, v115, v136
v_mfma_f32_16x16x32_bf16 v[76:79], v[92:95], a[236:239], v[76:79]
s_waitcnt lgkmcnt(0)
v_add_f32 v116, v116, v140
v_add_f32 v112, v112, v125
v_mfma_f32_16x16x32_bf16 v[76:79], v[96:99], v[192:195], v[76:79]
ds_read_b128 v[104:107], v2 offset:47104
v_add_f32 v113, v113, v129
v_mfma_f32_16x16x32_bf16 v[76:79], v[100:103], v[212:215], v[76:79]
ds_read_b128 v[108:111], v2 offset:48128
v_add_f32 v114, v114, v133
v_mfma_f32_16x16x32_bf16 v[72:75], v[100:103], v[208:211], v[72:75]
buffer_load_dwordx4 v1, s[8:11], s34 offen offset:3072 sc1 lds
v_mfma_f32_16x16x32_bf16 v[72:75], v[96:99], a[252:255], v[72:75]
s_add_u32 m0, s29, 4096
s_add_u32 s34, s28, 4096
v_add_f32 v115, v115, v137
v_mfma_f32_16x16x32_bf16 v[68:71], v[96:99], a[248:251], v[68:71]
buffer_load_dwordx4 v1, s[8:11], s34 offen offset:0 sc1 lds
v_mfma_f32_16x16x32_bf16 v[68:71], v[100:103], v[204:207], v[68:71]
v_add_f32 v116, v116, v141
v_add_f32 v112, v112, v126
v_mfma_f32_16x16x32_bf16 v[64:67], v[100:103], v[200:203], v[64:67]
v_add_f32 v113, v113, v130
v_add_f32 v114, v114, v134
v_mfma_f32_16x16x32_bf16 v[64:67], v[96:99], a[244:247], v[64:67]
v_add_f32 v115, v115, v138
v_add_f32 v116, v116, v142
v_mfma_f32_16x16x32_bf16 v[60:63], v[96:99], a[240:243], v[60:63]
buffer_load_dwordx4 v1, s[8:11], s34 offen offset:1024 sc1 lds
v_mfma_f32_16x16x32_bf16 v[60:63], v[100:103], v[196:199], v[60:63]
s_waitcnt lgkmcnt(0)
s_add_u32 s28, s28, 32768
v_xor_b32 v2, 0x10000, v2
v_mfma_f32_16x16x32_bf16 v[60:63], v[104:107], v[216:219], v[60:63]
s_add_u32 s29, s29, 32768
ds_read_b128 v[80:83], v2 offset:0
v_mfma_f32_16x16x32_bf16 v[60:63], v[108:111], v[236:239], v[60:63]
s_and_b32 s29, s29, 0x1ffff
ds_read_b128 v[84:87], v2 offset:1024
v_mfma_f32_16x16x32_bf16 v[64:67], v[108:111], v[240:243], v[64:67]
buffer_load_dword v123, v122, s[8:11], 0 offen sc1
v_mfma_f32_16x16x32_bf16 v[64:67], v[104:107], v[220:223], v[64:67]
s_cmp_eq_u32 s28, s30
s_cselect_b32 s28, s46, s28
v_add_f32 v112, v112, v127
v_mfma_f32_16x16x32_bf16 v[68:71], v[104:107], v[224:227], v[68:71]
v_add_f32 v113, v113, v131
v_add_f32 v114, v114, v135
v_mfma_f32_16x16x32_bf16 v[68:71], v[108:111], v[244:247], v[68:71]
v_add_f32 v115, v115, v139
v_add_f32 v116, v116, v143
v_mfma_f32_16x16x32_bf16 v[72:75], v[108:111], v[248:251], v[72:75]
v_mfma_f32_16x16x32_bf16 v[72:75], v[104:107], v[228:231], v[72:75]
s_add_u32 s27, s27, 1
s_cmp_eq_u32 s27, s26
v_mfma_f32_16x16x32_bf16 v[76:79], v[104:107], v[232:235], v[76:79]
v_mfma_f32_16x16x32_bf16 v[76:79], v[108:111], v[252:255], v[76:79]
s_waitcnt lgkmcnt(0)
s_cbranch_scc1 L_qfin0
v_mfma_f32_16x16x32_bf16 v[56:59], v[80:83], a[16:19], v[36:39]
ds_read_b128 v[88:91], v2 offset:2048
v_mfma_f32_16x16x32_bf16 v[56:59], v[84:87], a[36:39], v[56:59]
ds_read_b128 v[92:95], v2 offset:3072
v_mfma_f32_16x16x32_bf16 v[52:55], v[84:87], a[32:35], v[32:35]
v_exp_f32 v124, v60
v_mfma_f32_16x16x32_bf16 v[52:55], v[80:83], a[12:15], v[52:55]
v_exp_f32 v125, v61
v_mfma_f32_16x16x32_bf16 v[48:51], v[80:83], a[8:11], v[28:31]
v_exp_f32 v126, v62
v_mfma_f32_16x16x32_bf16 v[48:51], v[84:87], a[28:31], v[48:51]
v_exp_f32 v127, v63
v_mfma_f32_16x16x32_bf16 v[44:47], v[84:87], a[24:27], v[24:27]
v_exp_f32 v128, v64
v_mfma_f32_16x16x32_bf16 v[44:47], v[80:83], a[4:7], v[44:47]
v_exp_f32 v129, v65
v_mfma_f32_16x16x32_bf16 v[40:43], v[80:83], a[0:3], v[20:23]
v_exp_f32 v130, v66
v_mfma_f32_16x16x32_bf16 v[40:43], v[84:87], a[20:23], v[40:43]
s_waitcnt lgkmcnt(0)
v_exp_f32 v131, v67
v_mfma_f32_16x16x32_bf16 v[40:43], v[88:91], a[40:43], v[40:43]
ds_read_b128 v[96:99], v2 offset:4096
v_cvt_pk_bf16_f32 v144, v124, v125
v_mfma_f32_16x16x32_bf16 v[40:43], v[92:95], a[60:63], v[40:43]
ds_read_b128 v[100:103], v2 offset:5120
v_cvt_pk_bf16_f32 v145, v126, v127
v_mfma_f32_16x16x32_bf16 v[44:47], v[92:95], a[64:67], v[44:47]
v_exp_f32 v132, v68
v_mfma_f32_16x16x32_bf16 v[44:47], v[88:91], a[44:47], v[44:47]
ds_write_b32 v3, v144 offset:5120
v_mfma_f32_16x16x32_bf16 v[48:51], v[88:91], a[48:51], v[48:51]
v_exp_f32 v133, v69
v_mfma_f32_16x16x32_bf16 v[48:51], v[92:95], a[68:71], v[48:51]
ds_write_b32 v3, v145 offset:5376
v_mfma_f32_16x16x32_bf16 v[52:55], v[92:95], a[72:75], v[52:55]
v_exp_f32 v134, v70
v_mfma_f32_16x16x32_bf16 v[52:55], v[88:91], a[52:55], v[52:55]
v_cvt_pk_bf16_f32 v146, v128, v129
v_cvt_pk_bf16_f32 v147, v130, v131
v_mfma_f32_16x16x32_bf16 v[56:59], v[88:91], a[56:59], v[56:59]
v_exp_f32 v135, v71
v_mfma_f32_16x16x32_bf16 v[56:59], v[92:95], a[76:79], v[56:59]
s_waitcnt lgkmcnt(2)
v_exp_f32 v136, v72
v_mfma_f32_16x16x32_bf16 v[56:59], v[96:99], a[96:99], v[56:59]
ds_read_b128 v[104:107], v2 offset:6144
v_cvt_pk_bf16_f32 v148, v132, v133
v_mfma_f32_16x16x32_bf16 v[56:59], v[100:103], a[116:119], v[56:59]
ds_read_b128 v[108:111], v2 offset:7168
v_cvt_pk_bf16_f32 v149, v134, v135
v_mfma_f32_16x16x32_bf16 v[52:55], v[100:103], a[112:115], v[52:55]
v_exp_f32 v137, v73
v_mfma_f32_16x16x32_bf16 v[52:55], v[96:99], a[92:95], v[52:55]
ds_write_b32 v3, v146 offset:6144
v_mfma_f32_16x16x32_bf16 v[48:51], v[96:99], a[88:91], v[48:51]
v_exp_f32 v138, v74
v_mfma_f32_16x16x32_bf16 v[48:51], v[100:103], a[108:111], v[48:51]
ds_write_b32 v3, v147 offset:6400
v_mfma_f32_16x16x32_bf16 v[44:47], v[100:103], a[104:107], v[44:47]
v_exp_f32 v139, v75
v_mfma_f32_16x16x32_bf16 v[44:47], v[96:99], a[84:87], v[44:47]
ds_write_b32 v3, v148 offset:7168
v_mfma_f32_16x16x32_bf16 v[40:43], v[96:99], a[80:83], v[40:43]
v_exp_f32 v140, v76
v_mfma_f32_16x16x32_bf16 v[40:43], v[100:103], a[100:103], v[40:43]
s_waitcnt lgkmcnt(3)
v_exp_f32 v141, v77
v_mfma_f32_16x16x32_bf16 v[40:43], v[104:107], a[120:123], v[40:43]
ds_read_b128 v[80:83], v2 offset:8192
v_cvt_pk_bf16_f32 v150, v136, v137
v_mfma_f32_16x16x32_bf16 v[40:43], v[108:111], a[140:143], v[40:43]
ds_read_b128 v[84:87], v2 offset:9216
v_cvt_pk_bf16_f32 v151, v138, v139
v_mfma_f32_16x16x32_bf16 v[44:47], v[108:111], a[144:147], v[44:47]
v_exp_f32 v142, v78
v_mfma_f32_16x16x32_bf16 v[44:47], v[104:107], a[124:127], v[44:47]
v_exp_f32 v143, v79
v_mfma_f32_16x16x32_bf16 v[48:51], v[104:107], a[128:131], v[48:51]
ds_write_b32 v3, v149 offset:7424
v_mfma_f32_16x16x32_bf16 v[48:51], v[108:111], a[148:151], v[48:51]
ds_write_b32 v3, v150 offset:8192
v_mfma_f32_16x16x32_bf16 v[52:55], v[108:111], a[152:155], v[52:55]
ds_write_b32 v3, v151 offset:8448
v_mfma_f32_16x16x32_bf16 v[52:55], v[104:107], a[132:135], v[52:55]
v_cvt_pk_bf16_f32 v152, v140, v141
v_cvt_pk_bf16_f32 v153, v142, v143
v_mfma_f32_16x16x32_bf16 v[56:59], v[104:107], a[136:139], v[56:59]
ds_write_b32 v3, v152 offset:9216
v_mfma_f32_16x16x32_bf16 v[56:59], v[108:111], a[156:159], v[56:59]
s_waitcnt lgkmcnt(4)
v_or3_b32 v7, v144, v145, v146
v_or3_b32 v7, v7, v147, v148
v_mfma_f32_16x16x32_bf16 v[56:59], v[80:83], a[176:179], v[56:59]
ds_read_b128 v[88:91], v2 offset:10240
v_or3_b32 v7, v7, v149, v150
v_mfma_f32_16x16x32_bf16 v[56:59], v[84:87], a[196:199], v[56:59]
ds_read_b128 v[92:95], v2 offset:11264
v_or3_b32 v7, v7, v151, v152
v_mfma_f32_16x16x32_bf16 v[52:55], v[84:87], a[192:195], v[52:55]
v_bitop3_b32 v7, v7, v153, s41 bitop3:0xa8
v_cmp_ne_u32 vcc, 0, v7
v_mfma_f32_16x16x32_bf16 v[52:55], v[80:83], a[172:175], v[52:55]
ds_write_b32 v3, v153 offset:9472
v_mfma_f32_16x16x32_bf16 v[48:51], v[80:83], a[168:171], v[48:51]
s_cbranch_vccnz L_setflag0
L_flagset0:
v_mfma_f32_16x16x32_bf16 v[48:51], v[84:87], a[188:191], v[48:51]
v_mfma_f32_16x16x32_bf16 v[44:47], v[84:87], a[184:187], v[44:47]
v_mfma_f32_16x16x32_bf16 v[44:47], v[80:83], a[164:167], v[44:47]
s_waitcnt vmcnt(0) lgkmcnt(0)
s_barrier
v_mfma_f32_16x16x32_bf16 v[40:43], v[80:83], a[160:163], v[40:43]
s_add_u32 m0, s29, 0
ds_read_b32 v5, v6
v_mfma_f32_16x16x32_bf16 v[40:43], v[84:87], a[180:183], v[40:43]
s_add_u32 s34, s28, 0
v_mfma_f32_16x16x32_bf16 v[40:43], v[88:91], a[200:203], v[40:43]
ds_read_b128 v[96:99], v2 offset:12288
v_mfma_f32_16x16x32_bf16 v[40:43], v[92:95], a[220:223], v[40:43]
ds_read_b128 v[100:103], v2 offset:13312
v_mfma_f32_16x16x32_bf16 v[44:47], v[92:95], a[224:227], v[44:47]
buffer_load_dwordx4 v1, s[8:11], s34 offen offset:0 sc1 lds
v_mfma_f32_16x16x32_bf16 v[44:47], v[88:91], a[204:207], v[44:47]
s_waitcnt lgkmcnt(2)
v_cmp_eq_u32 vcc, s27, v5
v_mfma_f32_16x16x32_bf16 v[48:51], v[88:91], a[208:211], v[48:51]
buffer_load_dwordx4 v1, s[8:11], s34 offen offset:1024 sc1 lds
v_mfma_f32_16x16x32_bf16 v[48:51], v[92:95], a[228:231], v[48:51]
s_cbranch_vccnz L_qrec0
L_qback0:
v_mfma_f32_16x16x32_bf16 v[52:55], v[92:95], a[232:235], v[52:55]
buffer_load_dwordx4 v1, s[8:11], s34 offen offset:2048 sc1 lds
v_mfma_f32_16x16x32_bf16 v[52:55], v[88:91], a[212:215], v[52:55]
v_add_f32 v112, v112, v124
v_add_f32 v113, v113, v128
v_mfma_f32_16x16x32_bf16 v[56:59], v[88:91], a[216:219], v[56:59]
v_add_f32 v114, v114, v132
v_add_f32 v115, v115, v136
v_mfma_f32_16x16x32_bf16 v[56:59], v[92:95], a[236:239], v[56:59]
s_waitcnt lgkmcnt(0)
v_add_f32 v116, v116, v140
v_add_f32 v112, v112, v125
v_mfma_f32_16x16x32_bf16 v[56:59], v[96:99], v[192:195], v[56:59]
ds_read_b128 v[104:107], v2 offset:14336
v_add_f32 v113, v113, v129
v_mfma_f32_16x16x32_bf16 v[56:59], v[100:103], v[212:215], v[56:59]
ds_read_b128 v[108:111], v2 offset:15360
v_add_f32 v114, v114, v133
v_mfma_f32_16x16x32_bf16 v[52:55], v[100:103], v[208:211], v[52:55]
buffer_load_dwordx4 v1, s[8:11], s34 offen offset:3072 sc1 lds
v_mfma_f32_16x16x32_bf16 v[52:55], v[96:99], a[252:255], v[52:55]
s_add_u32 m0, s29, 4096
s_add_u32 s34, s28, 4096
v_add_f32 v115, v115, v137
v_mfma_f32_16x16x32_bf16 v[48:51], v[96:99], a[248:251], v[48:51]
buffer_load_dwordx4 v1, s[8:11], s34 offen offset:0 sc1 lds
v_mfma_f32_16x16x32_bf16 v[48:51], v[100:103], v[204:207], v[48:51]
v_add_f32 v116, v116, v141
v_add_f32 v112, v112, v126
v_mfma_f32_16x16x32_bf16 v[44:47], v[100:103], v[200:203], v[44:47]
v_add_f32 v113, v113, v130
v_add_f32 v114, v114, v134
v_mfma_f32_16x16x32_bf16 v[44:47], v[96:99], a[244:247], v[44:47]
v_add_f32 v115, v115, v138
v_add_f32 v116, v116, v142
v_mfma_f32_16x16x32_bf16 v[40:43], v[96:99], a[240:243], v[40:43]
buffer_load_dwordx4 v1, s[8:11], s34 offen offset:1024 sc1 lds
v_mfma_f32_16x16x32_bf16 v[40:43], v[100:103], v[196:199], v[40:43]
s_waitcnt lgkmcnt(0)
s_add_u32 s28, s28, 32768
s_add_u32 s29, s29, 32768
v_mfma_f32_16x16x32_bf16 v[40:43], v[104:107], v[216:219], v[40:43]
s_and_b32 s29, s29, 0x1ffff
ds_read_b128 v[80:83], v2 offset:32768
v_mfma_f32_16x16x32_bf16 v[40:43], v[108:111], v[236:239], v[40:43]
ds_read_b128 v[84:87], v2 offset:33792
v_add_f32 v112, v112, v127
v_mfma_f32_16x16x32_bf16 v[44:47], v[108:111], v[240:243], v[44:47]
s_cmp_eq_u32 s28, s30
s_cselect_b32 s28, s46, s28
v_add_f32 v113, v113, v131
v_mfma_f32_16x16x32_bf16 v[44:47], v[104:107], v[220:223], v[44:47]
v_add_f32 v114, v114, v135
v_add_f32 v115, v115, v139
v_mfma_f32_16x16x32_bf16 v[48:51], v[104:107], v[224:227], v[48:51]
v_add_f32 v116, v116, v143
v_mfma_f32_16x16x32_bf16 v[48:51], v[108:111], v[244:247], v[48:51]
v_mfma_f32_16x16x32_bf16 v[52:55], v[108:111], v[248:251], v[52:55]
v_mfma_f32_16x16x32_bf16 v[52:55], v[104:107], v[228:231], v[52:55]
s_add_u32 s27, s27, 1
s_cmp_lg_u32 s27, s26
v_mfma_f32_16x16x32_bf16 v[56:59], v[104:107], v[232:235], v[56:59]
v_mfma_f32_16x16x32_bf16 v[56:59], v[108:111], v[252:255], v[56:59]
s_waitcnt lgkmcnt(0)
s_cbranch_scc1 L_qloop
L_qfin1:
s_cmp_lg_u32 s27, s47
s_cbranch_scc1 L_qmid
s_nop 3
v_exp_f32 v124, v40
v_exp_f32 v125, v41
v_exp_f32 v126, v42
v_exp_f32 v127, v43
v_cvt_pk_bf16_f32 v144, v124, v125
v_cvt_pk_bf16_f32 v145, v126, v127
ds_write_b32 v3, v144 offset:0
ds_write_b32 v3, v145 offset:256
v_exp_f32 v128, v44
v_exp_f32 v129, v45
v_exp_f32 v130, v46
v_exp_f32 v131, v47
v_cvt_pk_bf16_f32 v146, v128, v129
v_cvt_pk_bf16_f32 v147, v130, v131
ds_write_b32 v3, v146 offset:1024
ds_write_b32 v3, v147 offset:1280
v_exp_f32 v132, v48
v_exp_f32 v133, v49
v_exp_f32 v134, v50
v_exp_f32 v135, v51
v_cvt_pk_bf16_f32 v148, v132, v133
v_cvt_pk_bf16_f32 v149, v134, v135
ds_write_b32 v3, v148 offset:2048
ds_write_b32 v3, v149 offset:2304
v_exp_f32 v136, v52
v_exp_f32 v137, v53
v_exp_f32 v138, v54
v_exp_f32 v139, v55
v_cvt_pk_bf16_f32 v150, v136, v137
v_cvt_pk_bf16_f32 v151, v138, v139
ds_write_b32 v3, v150 offset:3072
ds_write_b32 v3, v151 offset:3328
v_exp_f32 v140, v56
v_exp_f32 v141, v57
v_exp_f32 v142, v58
v_exp_f32 v143, v59
v_cvt_pk_bf16_f32 v152, v140, v141
v_cvt_pk_bf16_f32 v153, v142, v143
ds_write_b32 v3, v152 offset:4096
ds_write_b32 v3, v153 offset:4352
v_or3_b32 v7, v144, v145, v146
v_or3_b32 v7, v7, v147, v148
v_or3_b32 v7, v7, v149, v150
v_or3_b32 v7, v7, v151, v152
v_bitop3_b32 v7, v7, v153, s41 bitop3:0xa8
v_cmp_ne_u32 vcc, 0, v7
s_cbranch_vccnz L_setflagf1
L_flagsetf1:
s_waitcnt vmcnt(0) lgkmcnt(0)
s_barrier
ds_read_b32 v5, v6
s_waitcnt lgkmcnt(0)
v_cmp_eq_u32 vcc, s27, v5
s_cbranch_vccnz L_qrecf1
L_qbackf1:
s_branch L_qend
L_qfin0:
s_nop 3
v_exp_f32 v124, v60
v_exp_f32 v125, v61
v_exp_f32 v126, v62
v_exp_f32 v127, v63
v_cvt_pk_bf16_f32 v144, v124, v125
v_cvt_pk_bf16_f32 v145, v126, v127
ds_write_b32 v3, v144 offset:5120
ds_write_b32 v3, v145 offset:5376
v_exp_f32 v128, v64
v_exp_f32 v129, v65
v_exp_f32 v130, v66
v_exp_f32 v131, v67
v_cvt_pk_bf16_f32 v146, v128, v129
v_cvt_pk_bf16_f32 v147, v130, v131
ds_write_b32 v3, v146 offset:6144
ds_write_b32 v3, v147 offset:6400
v_exp_f32 v132, v68
v_exp_f32 v133, v69
v_exp_f32 v134, v70
v_exp_f32 v135, v71
v_cvt_pk_bf16_f32 v148, v132, v133
v_cvt_pk_bf16_f32 v149, v134, v135
ds_write_b32 v3, v148 offset:7168
ds_write_b32 v3, v149 offset:7424
v_exp_f32 v136, v72
v_exp_f32 v137, v73
v_exp_f32 v138, v74
v_exp_f32 v139, v75
v_cvt_pk_bf16_f32 v150, v136, v137
v_cvt_pk_bf16_f32 v151, v138, v139
ds_write_b32 v3, v150 offset:8192
ds_write_b32 v3, v151 offset:8448
v_exp_f32 v140, v76
v_exp_f32 v141, v77
v_exp_f32 v142, v78
v_exp_f32 v143, v79
v_cvt_pk_bf16_f32 v152, v140, v141
v_cvt_pk_bf16_f32 v153, v142, v143
ds_write_b32 v3, v152 offset:9216
ds_write_b32 v3, v153 offset:9472
v_or3_b32 v7, v144, v145, v146
v_or3_b32 v7, v7, v147, v148
v_or3_b32 v7, v7, v149, v150
v_or3_b32 v7, v7, v151, v152
v_bitop3_b32 v7, v7, v153, s41 bitop3:0xa8
v_cmp_ne_u32 vcc, 0, v7
s_cbranch_vccnz L_setflagf0
L_flagsetf0:
s_waitcnt vmcnt(0) lgkmcnt(0)
s_barrier
ds_read_b32 v5, v6
s_waitcnt lgkmcnt(0)
v_cmp_eq_u32 vcc, s27, v5
s_cbranch_vccnz L_qrecf0
L_qbackf0:
L_qend:
v_add_f32 v112, v112, v124
v_add_f32 v112, v112, v125
v_add_f32 v112, v112, v126
v_add_f32 v112, v112, v127
v_mov_b32 v7, v112
s_nop 0
s_add_u32 s49, s48, 0
buffer_load_dwordx4 a[96:99], v1, s[8:11], s49 offen offset:0 sc1
buffer_load_dwordx4 a[100:103], v1, s[8:11], s49 offen offset:1024 sc1
v_permlane16_swap_b32 v7, v112
v_add_f32 v112, v112, v7
v_mov_b32 v7, v112
s_nop 0
buffer_load_dwordx4 a[104:107], v1, s[8:11], s49 offen offset:2048 sc1
buffer_load_dwordx4 a[108:111], v1, s[8:11], s49 offen offset:3072 sc1
s_add_u32 s49, s48, 4096
v_permlane32_swap_b32 v7, v112
v_add_f32 v112, v112, v7
ds_write_b32 v4, v112 offset:0
ds_write_b32 v4, v20 offset:4096
buffer_load_dwordx4 a[112:115], v1, s[8:11], s49 offen offset:0 sc1
buffer_load_dwordx4 a[116:119], v1, s[8:11], s49 offen offset:1024 sc1
v_add_f32 v113, v113, v128
v_add_f32 v113, v113, v129
v_add_f32 v113, v113, v130
v_add_f32 v113, v113, v131
v_mov_b32 v7, v113
s_nop 0
buffer_load_dwordx4 a[120:123], v1, s[8:11], s49 offen offset:2048 sc1
buffer_load_dwordx4 a[124:127], v1, s[8:11], s49 offen offset:3072 sc1
s_add_u32 s49, s48, 8192
v_permlane16_swap_b32 v7, v113
v_add_f32 v113, v113, v7
v_mov_b32 v7, v113
s_nop 0
buffer_load_dwordx4 a[128:131], v1, s[8:11], s49 offen offset:0 sc1
buffer_load_dwordx4 a[132:135], v1, s[8:11], s49 offen offset:1024 sc1
v_permlane32_swap_b32 v7, v113
v_add_f32 v113, v113, v7
ds_write_b32 v4, v113 offset:512
ds_write_b32 v4, v24 offset:4608
buffer_load_dwordx4 a[136:139], v1, s[8:11], s49 offen offset:2048 sc1
buffer_load_dwordx4 a[140:143], v1, s[8:11], s49 offen offset:3072 sc1
s_add_u32 s49, s48, 12288
v_add_f32 v114, v114, v132
v_add_f32 v114, v114, v133
v_add_f32 v114, v114, v134
v_add_f32 v114, v114, v135
v_mov_b32 v7, v114
s_nop 0
buffer_load_dwordx4 a[144:147], v1, s[8:11], s49 offen offset:0 sc1
buffer_load_dwordx4 a[148:151], v1, s[8:11], s49 offen offset:1024 sc1
v_permlane16_swap_b32 v7, v114
v_add_f32 v114, v114, v7
v_mov_b32 v7, v114
s_nop 0
buffer_load_dwordx4 a[152:155], v1, s[8:11], s49 offen offset:2048 sc1
buffer_load_dwordx4 a[156:159], v1, s[8:11], s49 offen offset:3072 sc1
s_add_u32 s49, s48, 32768
v_permlane32_swap_b32 v7, v114
v_add_f32 v114, v114, v7
ds_write_b32 v4, v114 offset:1024
ds_write_b32 v4, v28 offset:5120
buffer_load_dwordx4 a[160:163], v1, s[8:11], s49 offen offset:0 sc1
buffer_load_dwordx4 a[164:167], v1, s[8:11], s49 offen offset:1024 sc1
v_add_f32 v115, v115, v136
v_add_f32 v115, v115, v137
v_add_f32 v115, v115, v138
v_add_f32 v115, v115, v139
v_mov_b32 v7, v115
s_nop 0
buffer_load_dwordx4 a[168:171], v1, s[8:11], s49 offen offset:2048 sc1
buffer_load_dwordx4 a[172:175], v1, s[8:11], s49 offen offset:3072 sc1
s_add_u32 s49, s48, 36864
v_permlane16_swap_b32 v7, v115
v_add_f32 v115, v115, v7
v_mov_b32 v7, v115
s_nop 0
buffer_load_dwordx4 a[176:179], v1, s[8:11], s49 offen offset:0 sc1
buffer_load_dwordx4 a[180:183], v1, s[8:11], s49 offen offset:1024 sc1
v_permlane32_swap_b32 v7, v115
v_add_f32 v115, v115, v7
ds_write_b32 v4, v115 offset:1536
ds_write_b32 v4, v32 offset:5632
buffer_load_dwordx4 a[184:187], v1, s[8:11], s49 offen offset:2048 sc1
buffer_load_dwordx4 a[188:191], v1, s[8:11], s49 offen offset:3072 sc1
s_add_u32 s49, s48, 40960
v_add_f32 v116, v116, v140
v_add_f32 v116, v116, v141
v_add_f32 v116, v116, v142
v_add_f32 v116, v116, v143
v_mov_b32 v7, v116
s_nop 0
buffer_load_dwordx4 a[192:195], v1, s[8:11], s49 offen offset:0 sc1
buffer_load_dwordx4 a[196:199], v1, s[8:11], s49 offen offset:1024 sc1
v_permlane16_swap_b32 v7, v116
v_add_f32 v116, v116, v7
v_mov_b32 v7, v116
s_nop 0
buffer_load_dwordx4 a[200:203], v1, s[8:11], s49 offen offset:2048 sc1
buffer_load_dwordx4 a[204:207], v1, s[8:11], s49 offen offset:3072 sc1
s_add_u32 s49, s48, 45056
v_permlane32_swap_b32 v7, v116
v_add_f32 v116, v116, v7
ds_write_b32 v4, v116 offset:2048
ds_write_b32 v4, v36 offset:6144
buffer_load_dwordx4 a[208:211], v1, s[8:11], s49 offen offset:0 sc1
buffer_load_dwordx4 a[212:215], v1, s[8:11], s49 offen offset:1024 sc1
buffer_load_dwordx4 a[216:219], v1, s[8:11], s49 offen offset:2048 sc1
buffer_load_dwordx4 a[220:223], v1, s[8:11], s49 offen offset:3072 sc1
s_waitcnt lgkmcnt(0)
s_barrier
v_and_b32 v7, 0xfffffffb, v4
ds_read_b64 v[10:11], v7 offset:0
ds_read_b32 v20, v7 offset:4096
ds_read_b64 v[12:13], v7 offset:512
ds_read_b32 v21, v7 offset:4608
ds_read_b64 v[14:15], v7 offset:1024
ds_read_b32 v22, v7 offset:5120
ds_read_b64 v[16:17], v7 offset:1536
ds_read_b32 v23, v7 offset:5632
ds_read_b64 v[18:19], v7 offset:2048
ds_read_b32 v24, v7 offset:6144
s_waitcnt lgkmcnt(0)
v_add_f32 v10, v10, v11
v_mov_b32 v11, v20
v_add_f32 v12, v12, v13
v_mov_b32 v13, v21
v_add_f32 v14, v14, v15
v_mov_b32 v15, v22
v_add_f32 v16, v16, v17
v_mov_b32 v17, v23
v_add_f32 v18, v18, v19
v_mov_b32 v19, v24
s_barrier
s_cmp_lg_u32 s21, 0
s_cbranch_scc1 L_qt1
s_mul_i32 s34, s24, 500
s_add_u32 s34, s34, s39
s_lshl_b32 s34, s34, 7
s_add_u32 s34, s34, 41943040
v_and_b32 v7, 15, v0
v_lshlrev_b32 v7, 3, v7
buffer_store_dwordx2 v[10:11], v7, s[8:11], s34 offen offset:0 sc1
buffer_store_dwordx2 v[12:13], v7, s[8:11], s34 offen offset:128 sc1
buffer_store_dwordx2 v[14:15], v7, s[8:11], s34 offen offset:256 sc1
buffer_store_dwordx2 v[16:17], v7, s[8:11], s34 offen offset:384 sc1
buffer_store_dwordx2 v[18:19], v7, s[8:11], s34 offen offset:512 sc1
L_qt1:
s_branch L_tailq
L_qmid:
v_cmp_ne_u32 vcc, s7, v123
s_mov_b32 s26, s47
s_cbranch_vccnz L_spinW
L_okW:
s_branch L_qloop
L_spinW:
s_mov_b32 s57, 0
L_spinW_l:
buffer_load_dword v5, v122, s[8:11], 0 offen sc1
s_waitcnt vmcnt(0)
v_cmp_ne_u32 vcc, s7, v5
s_cbranch_vccz L_okW
s_add_u32 s57, s57, 1
s_cmp_lt_u32 s57, 0x40000
s_cbranch_scc1 L_spinW_l
s_branch L_okW
L_spinX:
s_mov_b32 s57, 0
L_spinX_l:
buffer_load_dword v5, v58, s[8:11], 0 offen sc1
s_waitcnt vmcnt(0)
v_cmp_ne_u32 vcc, s7, v5
s_cbranch_vccz L_okX
s_add_u32 s57, s57, 1
s_cmp_lt_u32 s57, 0x40000
s_cbranch_scc1 L_spinX_l
s_branch L_okX
L_spinQ:
s_mov_b32 s57, 0
L_spinQ_l:
buffer_load_dword v5, v59, s[8:11], 0 offen sc1
s_waitcnt vmcnt(0)
v_cmp_ne_u32 vcc, s7, v5
s_cbranch_vccz L_okQ
s_add_u32 s57, s57, 1
s_cmp_lt_u32 s57, 0x40000
s_cbranch_scc1 L_spinQ_l
s_branch L_okQ
L_setflag0:
v_mov_b32 v7, s27
ds_write_b32 v6, v7
s_waitcnt lgkmcnt(0)
s_branch L_flagset0
L_setflag1:
v_mov_b32 v7, s27
ds_write_b32 v6, v7
s_waitcnt lgkmcnt(0)
s_branch L_flagset1
L_setflagf0:
v_mov_b32 v7, s27
ds_write_b32 v6, v7
s_waitcnt lgkmcnt(0)
s_branch L_flagsetf0
L_setflagf1:
v_mov_b32 v7, s27
ds_write_b32 v6, v7
s_waitcnt lgkmcnt(0)
s_branch L_flagsetf1
L_qrecf0:
s_mov_b32 s38, 1
s_branch L_qrecx0
L_qrec0:
s_mov_b32 s38, 0
L_qrecx0:
s_nop 15
v_max3_f32 v117, v60, v61, v62
v_max_f32 v117, v117, v63
v_mov_b32 v7, v117
s_nop 1
v_permlane16_swap_b32 v7, v117
v_max_f32 v117, v117, v7
v_mov_b32 v7, v117
s_nop 1
v_permlane32_swap_b32 v7, v117
v_max_f32 v117, v117, v7
v_add_f32 v117, 0x42200000, v117
ds_write_b32 v4, v117 offset:0
v_max3_f32 v118, v64, v65, v66
v_max_f32 v118, v118, v67
v_mov_b32 v7, v118
s_nop 1
v_permlane16_swap_b32 v7, v118
v_max_f32 v118, v118, v7
v_mov_b32 v7, v118
s_nop 1
v_permlane32_swap_b32 v7, v118
v_max_f32 v118, v118, v7
v_add_f32 v118, 0x42200000, v118
ds_write_b32 v4, v118 offset:512
v_max3_f32 v119, v68, v69, v70
v_max_f32 v119, v119, v71
v_mov_b32 v7, v119
s_nop 1
v_permlane16_swap_b32 v7, v119
v_max_f32 v119, v119, v7
v_mov_b32 v7, v119
s_nop 1
v_permlane32_swap_b32 v7, v119
v_max_f32 v119, v119, v7
v_add_f32 v119, 0x42200000, v119
ds_write_b32 v4, v119 offset:1024
v_max3_f32 v120, v72, v73, v74
v_max_f32 v120, v120, v75
v_mov_b32 v7, v120
s_nop 1
v_permlane16_swap_b32 v7, v120
v_max_f32 v120, v120, v7
v_mov_b32 v7, v120
s_nop 1
v_permlane32_swap_b32 v7, v120
v_max_f32 v120, v120, v7
v_add_f32 v120, 0x42200000, v120
ds_write_b32 v4, v120 offset:1536
v_max3_f32 v121, v76, v77, v78
v_max_f32 v121, v121, v79
v_mov_b32 v7, v121
s_nop 1
v_permlane16_swap_b32 v7, v121
v_max_f32 v121, v121, v7
v_mov_b32 v7, v121
s_nop 1
v_permlane32_swap_b32 v7, v121
v_max_f32 v121, v121, v7
v_add_f32 v121, 0x42200000, v121
ds_write_b32 v4, v121 offset:2048
s_waitcnt lgkmcnt(0)
s_barrier
v_and_b32 v5, 0xfffffffb, v4
ds_read_b64 v[8:9], v5 offset:0
s_waitcnt lgkmcnt(0)
v_max3_f32 v7, v8, v9, 0
v_sub_f32 v8, 0, v7
v_exp_f32 v8, v8
v_sub_f32 v40, v40, v7
v_sub_f32 v60, v60, v7
v_sub_f32 v20, v20, v7
v_sub_f32 v41, v41, v7
v_sub_f32 v61, v61, v7
v_sub_f32 v21, v21, v7
v_sub_f32 v42, v42, v7
v_sub_f32 v62, v62, v7
v_sub_f32 v22, v22, v7
v_sub_f32 v43, v43, v7
v_sub_f32 v63, v63, v7
v_sub_f32 v23, v23, v7
v_mul_f32 v112, v112, v8
ds_read_b64 v[8:9], v5 offset:512
s_waitcnt lgkmcnt(0)
v_max3_f32 v7, v8, v9, 0
v_sub_f32 v8, 0, v7
v_exp_f32 v8, v8
v_sub_f32 v44, v44, v7
v_sub_f32 v64, v64, v7
v_sub_f32 v24, v24, v7
v_sub_f32 v45, v45, v7
v_sub_f32 v65, v65, v7
v_sub_f32 v25, v25, v7
v_sub_f32 v46, v46, v7
v_sub_f32 v66, v66, v7
v_sub_f32 v26, v26, v7
v_sub_f32 v47, v47, v7
v_sub_f32 v67, v67, v7
v_sub_f32 v27, v27, v7
v_mul_f32 v113, v113, v8
ds_read_b64 v[8:9], v5 offset:1024
s_waitcnt lgkmcnt(0)
v_max3_f32 v7, v8, v9, 0
v_sub_f32 v8, 0, v7
v_exp_f32 v8, v8
v_sub_f32 v48, v48, v7
v_sub_f32 v68, v68, v7
v_sub_f32 v28, v28, v7
v_sub_f32 v49, v49, v7
v_sub_f32 v69, v69, v7
v_sub_f32 v29, v29, v7
v_sub_f32 v50, v50, v7
v_sub_f32 v70, v70, v7
v_sub_f32 v30, v30, v7
v_sub_f32 v51, v51, v7
v_sub_f32 v71, v71, v7
v_sub_f32 v31, v31, v7
v_mul_f32 v114, v114, v8
ds_read_b64 v[8:9], v5 offset:1536
s_waitcnt lgkmcnt(0)
v_max3_f32 v7, v8, v9, 0
v_sub_f32 v8, 0, v7
v_exp_f32 v8, v8
v_sub_f32 v52, v52, v7
v_sub_f32 v72, v72, v7
v_sub_f32 v32, v32, v7
v_sub_f32 v53, v53, v7
v_sub_f32 v73, v73, v7
v_sub_f32 v33, v33, v7
v_sub_f32 v54, v54, v7
v_sub_f32 v74, v74, v7
v_sub_f32 v34, v34, v7
v_sub_f32 v55, v55, v7
v_sub_f32 v75, v75, v7
v_sub_f32 v35, v35, v7
v_mul_f32 v115, v115, v8
ds_read_b64 v[8:9], v5 offset:2048
s_waitcnt lgkmcnt(0)
v_max3_f32 v7, v8, v9, 0
v_sub_f32 v8, 0, v7
v_exp_f32 v8, v8
v_sub_f32 v56, v56, v7
v_sub_f32 v76, v76, v7
v_sub_f32 v36, v36, v7
v_sub_f32 v57, v57, v7
v_sub_f32 v77, v77, v7
v_sub_f32 v37, v37, v7
v_sub_f32 v58, v58, v7
v_sub_f32 v78, v78, v7
v_sub_f32 v38, v38, v7
v_sub_f32 v59, v59, v7
v_sub_f32 v79, v79, v7
v_sub_f32 v39, v39, v7
v_mul_f32 v116, v116, v8
v_exp_f32 v124, v60
v_exp_f32 v125, v61
v_exp_f32 v126, v62
v_exp_f32 v127, v63
v_cvt_pk_bf16_f32 v144, v124, v125
v_cvt_pk_bf16_f32 v145, v126, v127
ds_write_b32 v3, v144 offset:5120
ds_write_b32 v3, v145 offset:5376
v_exp_f32 v128, v64
v_exp_f32 v129, v65
v_exp_f32 v130, v66
v_exp_f32 v131, v67
v_cvt_pk_bf16_f32 v146, v128, v129
v_cvt_pk_bf16_f32 v147, v130, v131
ds_write_b32 v3, v146 offset:6144
ds_write_b32 v3, v147 offset:6400
v_exp_f32 v132, v68
v_exp_f32 v133, v69
v_exp_f32 v134, v70
v_exp_f32 v135, v71
v_cvt_pk_bf16_f32 v148, v132, v133
v_cvt_pk_bf16_f32 v149, v134, v135
ds_write_b32 v3, v148 offset:7168
ds_write_b32 v3, v149 offset:7424
v_exp_f32 v136, v72
v_exp_f32 v137, v73
v_exp_f32 v138, v74
v_exp_f32 v139, v75
v_cvt_pk_bf16_f32 v150, v136, v137
v_cvt_pk_bf16_f32 v151, v138, v139
ds_write_b32 v3, v150 offset:8192
ds_write_b32 v3, v151 offset:8448
v_exp_f32 v140, v76
v_exp_f32 v141, v77
v_exp_f32 v142, v78
v_exp_f32 v143, v79
v_cvt_pk_bf16_f32 v152, v140, v141
v_cvt_pk_bf16_f32 v153, v142, v143
ds_write_b32 v3, v152 offset:9216
ds_write_b32 v3, v153 offset:9472
s_waitcnt lgkmcnt(0)
s_barrier
s_cmp_eq_u32 s38, 0
s_cbranch_scc1 L_qback0
s_branch L_qbackf0
L_qrecf1:
s_mov_b32 s38, 1
s_branch L_qrecx1
L_qrec1:
s_mov_b32 s38, 0
L_qrecx1:
s_nop 15
v_max3_f32 v117, v40, v41, v42
v_max_f32 v117, v117, v43
v_mov_b32 v7, v117
s_nop 1
v_permlane16_swap_b32 v7, v117
v_max_f32 v117, v117, v7
v_mov_b32 v7, v117
s_nop 1
v_permlane32_swap_b32 v7, v117
v_max_f32 v117, v117, v7
v_add_f32 v117, 0x42200000, v117
ds_write_b32 v4, v117 offset:0
v_max3_f32 v118, v44, v45, v46
v_max_f32 v118, v118, v47
v_mov_b32 v7, v118
s_nop 1
v_permlane16_swap_b32 v7, v118
v_max_f32 v118, v118, v7
v_mov_b32 v7, v118
s_nop 1
v_permlane32_swap_b32 v7, v118
v_max_f32 v118, v118, v7
v_add_f32 v118, 0x42200000, v118
ds_write_b32 v4, v118 offset:512
v_max3_f32 v119, v48, v49, v50
v_max_f32 v119, v119, v51
v_mov_b32 v7, v119
s_nop 1
v_permlane16_swap_b32 v7, v119
v_max_f32 v119, v119, v7
v_mov_b32 v7, v119
s_nop 1
v_permlane32_swap_b32 v7, v119
v_max_f32 v119, v119, v7
v_add_f32 v119, 0x42200000, v119
ds_write_b32 v4, v119 offset:1024
v_max3_f32 v120, v52, v53, v54
v_max_f32 v120, v120, v55
v_mov_b32 v7, v120
s_nop 1
v_permlane16_swap_b32 v7, v120
v_max_f32 v120, v120, v7
v_mov_b32 v7, v120
s_nop 1
v_permlane32_swap_b32 v7, v120
v_max_f32 v120, v120, v7
v_add_f32 v120, 0x42200000, v120
ds_write_b32 v4, v120 offset:1536
v_max3_f32 v121, v56, v57, v58
v_max_f32 v121, v121, v59
v_mov_b32 v7, v121
s_nop 1
v_permlane16_swap_b32 v7, v121
v_max_f32 v121, v121, v7
v_mov_b32 v7, v121
s_nop 1
v_permlane32_swap_b32 v7, v121
v_max_f32 v121, v121, v7
v_add_f32 v121, 0x42200000, v121
ds_write_b32 v4, v121 offset:2048
s_waitcnt lgkmcnt(0)
s_barrier
v_and_b32 v5, 0xfffffffb, v4
ds_read_b64 v[8:9], v5 offset:0
s_waitcnt lgkmcnt(0)
v_max3_f32 v7, v8, v9, 0
v_sub_f32 v8, 0, v7
v_exp_f32 v8, v8
v_sub_f32 v40, v40, v7
v_sub_f32 v60, v60, v7
v_sub_f32 v20, v20, v7
v_sub_f32 v41, v41, v7
v_sub_f32 v61, v61, v7
v_sub_f32 v21, v21, v7
v_sub_f32 v42, v42, v7
v_sub_f32 v62, v62, v7
v_sub_f32 v22, v22, v7
v_sub_f32 v43, v43, v7
v_sub_f32 v63, v63, v7
v_sub_f32 v23, v23, v7
v_mul_f32 v112, v112, v8
ds_read_b64 v[8:9], v5 offset:512
s_waitcnt lgkmcnt(0)
v_max3_f32 v7, v8, v9, 0
v_sub_f32 v8, 0, v7
v_exp_f32 v8, v8
v_sub_f32 v44, v44, v7
v_sub_f32 v64, v64, v7
v_sub_f32 v24, v24, v7
v_sub_f32 v45, v45, v7
v_sub_f32 v65, v65, v7
v_sub_f32 v25, v25, v7
v_sub_f32 v46, v46, v7
v_sub_f32 v66, v66, v7
v_sub_f32 v26, v26, v7
v_sub_f32 v47, v47, v7
v_sub_f32 v67, v67, v7
v_sub_f32 v27, v27, v7
v_mul_f32 v113, v113, v8
ds_read_b64 v[8:9], v5 offset:1024
s_waitcnt lgkmcnt(0)
v_max3_f32 v7, v8, v9, 0
v_sub_f32 v8, 0, v7
v_exp_f32 v8, v8
v_sub_f32 v48, v48, v7
v_sub_f32 v68, v68, v7
v_sub_f32 v28, v28, v7
v_sub_f32 v49, v49, v7
v_sub_f32 v69, v69, v7
v_sub_f32 v29, v29, v7
v_sub_f32 v50, v50, v7
v_sub_f32 v70, v70, v7
v_sub_f32 v30, v30, v7
v_sub_f32 v51, v51, v7
v_sub_f32 v71, v71, v7
v_sub_f32 v31, v31, v7
v_mul_f32 v114, v114, v8
ds_read_b64 v[8:9], v5 offset:1536
s_waitcnt lgkmcnt(0)
v_max3_f32 v7, v8, v9, 0
v_sub_f32 v8, 0, v7
v_exp_f32 v8, v8
v_sub_f32 v52, v52, v7
v_sub_f32 v72, v72, v7
v_sub_f32 v32, v32, v7
v_sub_f32 v53, v53, v7
v_sub_f32 v73, v73, v7
v_sub_f32 v33, v33, v7
v_sub_f32 v54, v54, v7
v_sub_f32 v74, v74, v7
v_sub_f32 v34, v34, v7
v_sub_f32 v55, v55, v7
v_sub_f32 v75, v75, v7
v_sub_f32 v35, v35, v7
v_mul_f32 v115, v115, v8
ds_read_b64 v[8:9], v5 offset:2048
s_waitcnt lgkmcnt(0)
v_max3_f32 v7, v8, v9, 0
v_sub_f32 v8, 0, v7
v_exp_f32 v8, v8
v_sub_f32 v56, v56, v7
v_sub_f32 v76, v76, v7
v_sub_f32 v36, v36, v7
v_sub_f32 v57, v57, v7
v_sub_f32 v77, v77, v7
v_sub_f32 v37, v37, v7
v_sub_f32 v58, v58, v7
v_sub_f32 v78, v78, v7
v_sub_f32 v38, v38, v7
v_sub_f32 v59, v59, v7
v_sub_f32 v79, v79, v7
v_sub_f32 v39, v39, v7
v_mul_f32 v116, v116, v8
v_exp_f32 v124, v40
v_exp_f32 v125, v41
v_exp_f32 v126, v42
v_exp_f32 v127, v43
v_cvt_pk_bf16_f32 v144, v124, v125
v_cvt_pk_bf16_f32 v145, v126, v127
ds_write_b32 v3, v144 offset:0
ds_write_b32 v3, v145 offset:256
v_exp_f32 v128, v44
v_exp_f32 v129, v45
v_exp_f32 v130, v46
v_exp_f32 v131, v47
v_cvt_pk_bf16_f32 v146, v128, v129
v_cvt_pk_bf16_f32 v147, v130, v131
ds_write_b32 v3, v146 offset:1024
ds_write_b32 v3, v147 offset:1280
v_exp_f32 v132, v48
v_exp_f32 v133, v49
v_exp_f32 v134, v50
v_exp_f32 v135, v51
v_cvt_pk_bf16_f32 v148, v132, v133
v_cvt_pk_bf16_f32 v149, v134, v135
ds_write_b32 v3, v148 offset:2048
ds_write_b32 v3, v149 offset:2304
v_exp_f32 v136, v52
v_exp_f32 v137, v53
v_exp_f32 v138, v54
v_exp_f32 v139, v55
v_cvt_pk_bf16_f32 v150, v136, v137
v_cvt_pk_bf16_f32 v151, v138, v139
ds_write_b32 v3, v150 offset:3072
ds_write_b32 v3, v151 offset:3328
v_exp_f32 v140, v56
v_exp_f32 v141, v57
v_exp_f32 v142, v58
v_exp_f32 v143, v59
v_cvt_pk_bf16_f32 v152, v140, v141
v_cvt_pk_bf16_f32 v153, v142, v143
ds_write_b32 v3, v152 offset:4096
ds_write_b32 v3, v153 offset:4352
s_waitcnt lgkmcnt(0)
s_barrier
s_cmp_eq_u32 s38, 0
s_cbranch_scc1 L_qback1
s_branch L_qbackf1
L_pv:
v_mov_b32 v12, 0
v_mov_b32 v13, 0
v_mov_b32 v14, 0
v_mov_b32 v15, 0
s_nop 1
s_add_u32 m0, s29, 0
s_add_u32 s34, s28, 0
v_mfma_f32_32x32x16_bf16 v[32:47], v[12:15], v[12:15], 0
buffer_load_dwordx4 v1, s[8:11], s34 offen offset:0 sc1 lds
v_mfma_f32_32x32x16_bf16 v[48:63], v[12:15], v[12:15], 0
buffer_load_dwordx4 v1, s[8:11], s34 offen offset:1024 sc1 lds
v_mfma_f32_32x32x16_bf16 v[64:79], v[12:15], v[12:15], 0
buffer_load_dwordx4 v1, s[8:11], s34 offen offset:2048 sc1 lds
v_mfma_f32_32x32x16_bf16 v[80:95], v[12:15], v[12:15], 0
buffer_load_dwordx4 v1, s[8:11], s34 offen offset:3072 sc1 lds
s_add_u32 m0, s29, 4096
s_add_u32 s34, s28, 4096
v_mfma_f32_32x32x16_bf16 v[96:111], v[12:15], v[12:15], 0
buffer_load_dwordx4 v1, s[8:11], s34 offen offset:0 sc1 lds
v_mfma_f32_32x32x16_bf16 v[112:127], v[12:15], v[12:15], 0
buffer_load_dwordx4 v1, s[8:11], s34 offen offset:1024 sc1 lds
v_mfma_f32_32x32x16_bf16 v[128:143], v[12:15], v[12:15], 0
buffer_load_dwordx4 v1, s[8:11], s34 offen offset:2048 sc1 lds
v_mfma_f32_32x32x16_bf16 v[144:159], v[12:15], v[12:15], 0
buffer_load_dwordx4 v1, s[8:11], s34 offen offset:3072 sc1 lds
s_add_u32 m0, s29, 8192
s_add_u32 s34, s28, 8192
v_mfma_f32_32x32x16_bf16 v[160:175], v[12:15], v[12:15], 0
buffer_load_dwordx4 v1, s[8:11], s34 offen offset:0 sc1 lds
v_mfma_f32_32x32x16_bf16 v[176:191], v[12:15], v[12:15], 0
buffer_load_dwordx4 v1, s[8:11], s34 offen offset:1024 sc1 lds
v_mfma_f32_32x32x16_bf16 v[192:207], v[12:15], v[12:15], 0
buffer_load_dwordx4 v1, s[8:11], s34 offen offset:2048 sc1 lds
v_mfma_f32_32x32x16_bf16 v[208:223], v[12:15], v[12:15], 0
buffer_load_dwordx4 v1, s[8:11], s34 offen offset:3072 sc1 lds
s_add_u32 m0, s29, 12288
s_add_u32 s34, s28, 12288
v_mfma_f32_32x32x16_bf16 v[224:239], v[12:15], v[12:15], 0
buffer_load_dwordx4 v1, s[8:11], s34 offen offset:0 sc1 lds
v_mfma_f32_32x32x16_bf16 v[240:255], v[12:15], v[12:15], 0
buffer_load_dwordx4 v1, s[8:11], s34 offen offset:1024 sc1 lds
v_mfma_f32_32x32x16_bf16 a[0:15], v[12:15], v[12:15], 0
buffer_load_dwordx4 v1, s[8:11], s34 offen offset:2048 sc1 lds
v_mfma_f32_32x32x16_bf16 a[16:31], v[12:15], v[12:15], 0
buffer_load_dwordx4 v1, s[8:11], s34 offen offset:3072 sc1 lds
s_add_u32 s28, s28, 32768
s_add_u32 s29, s29, 32768
s_and_b32 s29, s29, 0x1ffff
s_cmp_eq_u32 s28, s30
s_cselect_b32 s28, s46, s28
v_mfma_f32_32x32x16_bf16 a[32:47], v[12:15], v[12:15], 0
v_mfma_f32_32x32x16_bf16 a[48:63], v[12:15], v[12:15], 0
v_mfma_f32_32x32x16_bf16 a[64:79], v[12:15], v[12:15], 0
v_mfma_f32_32x32x16_bf16 a[80:95], v[12:15], v[12:15], 0
v_lshrrev_b32 v7, 4, v0
v_sub_u32 v7, 0, v7
v_bfe_u32 v5, v0, 1, 1
v_xor_b32 v7, v7, v5
v_and_b32 v7, 3, v7
v_lshlrev_b32 v7, 4, v7
v_lshrrev_b32 v5, 2, v0
v_lshl_add_u32 v7, v5, 6, v7
v_and_b32 v5, 1, v0
v_lshl_add_u32 v7, v5, 3, v7
s_lshl_b32 s36, s21, 13
v_add_u32 v2, s36, v7
v_xor_b32 v8, 32, v2
v_lshlrev_b32 v3, 2, v0
v_add_u32 v3, 131072, v3
s_waitcnt vmcnt(0)
s_barrier
s_add_u32 m0, s29, 0
s_add_u32 s34, s28, 0
buffer_load_dwordx4 v1, s[8:11], s34 offen offset:0 sc1 lds
buffer_load_dwordx4 v1, s[8:11], s34 offen offset:1024 sc1 lds
buffer_load_dwordx4 v1, s[8:11], s34 offen offset:2048 sc1 lds
buffer_load_dwordx4 v1, s[8:11], s34 offen offset:3072 sc1 lds
s_add_u32 m0, s29, 4096
s_add_u32 s34, s28, 4096
buffer_load_dwordx4 v1, s[8:11], s34 offen offset:0 sc1 lds
buffer_load_dwordx4 v1, s[8:11], s34 offen offset:1024 sc1 lds
buffer_load_dwordx4 v1, s[8:11], s34 offen offset:2048 sc1 lds
buffer_load_dwordx4 v1, s[8:11], s34 offen offset:3072 sc1 lds
s_add_u32 m0, s29, 8192
s_add_u32 s34, s28, 8192
buffer_load_dwordx4 v1, s[8:11], s34 offen offset:0 sc1 lds
buffer_load_dwordx4 v1, s[8:11], s34 offen offset:1024 sc1 lds
buffer_load_dwordx4 v1, s[8:11], s34 offen offset:2048 sc1 lds
buffer_load_dwordx4 v1, s[8:11], s34 offen offset:3072 sc1 lds
s_add_u32 m0, s29, 12288
s_add_u32 s34, s28, 12288
buffer_load_dwordx4 v1, s[8:11], s34 offen offset:0 sc1 lds
buffer_load_dwordx4 v1, s[8:11], s34 offen offset:1024 sc1 lds
buffer_load_dwordx4 v1, s[8:11], s34 offen offset:2048 sc1 lds
buffer_load_dwordx4 v1, s[8:11], s34 offen offset:3072 sc1 lds
s_add_u32 s28, s28, 32768
s_add_u32 s29, s29, 32768
s_and_b32 s29, s29, 0x1ffff
s_cmp_eq_u32 s28, s30
s_cselect_b32 s28, s46, s28
ds_read_b64_tr_b16 a[96:97], v2 offset:0
ds_read_b64_tr_b16 a[98:99], v2 offset:16384
ds_read_b64_tr_b16 a[100:101], v8 offset:0
ds_read_b64_tr_b16 a[102:103], v8 offset:16384
ds_read_b64_tr_b16 a[104:105], v2 offset:1024
ds_read_b64_tr_b16 a[106:107], v2 offset:17408
ds_read_b64_tr_b16 a[108:109], v8 offset:1024
ds_read_b64_tr_b16 a[110:111], v8 offset:17408
ds_read_b64_tr_b16 a[112:113], v2 offset:2048
ds_read_b64_tr_b16 a[114:115], v2 offset:18432
ds_read_b64_tr_b16 a[116:117], v8 offset:2048
ds_read_b64_tr_b16 a[118:119], v8 offset:18432
s_waitcnt vmcnt(4)
s_barrier
ds_read_b32 v5, v6
ds_read2st64_b32 a[128:129], v3 offset0:0 offset1:1
ds_read2st64_b32 a[130:131], v3 offset0:2 offset1:3
ds_read2st64_b32 a[132:133], v3 offset0:4 offset1:5
ds_read2st64_b32 a[134:135], v3 offset0:6 offset1:7
ds_read2st64_b32 a[136:137], v3 offset0:8 offset1:9
ds_read2st64_b32 a[138:139], v3 offset0:10 offset1:11
ds_read2st64_b32 a[140:141], v3 offset0:12 offset1:13
ds_read2st64_b32 a[142:143], v3 offset0:14 offset1:15
ds_read2st64_b32 a[144:145], v3 offset0:16 offset1:17
ds_read2st64_b32 a[146:147], v3 offset0:18 offset1:19
s_mov_b32 s27, 2
s_add_u32 s26, s26, 2
s_waitcnt lgkmcnt(0)
v_cmp_eq_u32 vcc, 1, v5
s_cbranch_vccnz L_prec1
.p2align 6
L_ploop:
v_mfma_f32_16x16x32_bf16 v[32:35], a[96:99], a[128:131], v[32:35]
s_add_u32 m0, s29, 4096
ds_read_b64_tr_b16 a[120:121], v2 offset:3072
v_mfma_f32_16x16x32_bf16 v[36:39], a[100:103], a[128:131], v[36:39]
s_add_u32 s34, s28, 4096
ds_read_b64_tr_b16 a[122:123], v2 offset:19456
v_mfma_f32_16x16x32_bf16 v[100:103], a[100:103], a[132:135], v[100:103]
buffer_load_dwordx4 v1, s[8:11], s34 offen offset:2048 sc1 lds
v_mfma_f32_16x16x32_bf16 v[96:99], a[96:99], a[132:135], v[96:99]
v_mfma_f32_16x16x32_bf16 v[160:163], a[96:99], a[136:139], v[160:163]
buffer_load_dwordx4 v1, s[8:11], s34 offen offset:3072 sc1 lds
v_mfma_f32_16x16x32_bf16 v[164:167], a[100:103], a[136:139], v[164:167]
ds_read_b64_tr_b16 a[124:125], v8 offset:3072
v_mfma_f32_16x16x32_bf16 v[228:231], a[100:103], a[140:143], v[228:231]
s_add_u32 m0, s29, 8192
ds_read_b64_tr_b16 a[126:127], v8 offset:19456
v_mfma_f32_16x16x32_bf16 v[224:227], a[96:99], a[140:143], v[224:227]
s_add_u32 s34, s28, 8192
v_mfma_f32_16x16x32_bf16 a[32:35], a[96:99], a[144:147], a[32:35]
v_mfma_f32_16x16x32_bf16 a[36:39], a[100:103], a[144:147], a[36:39]
buffer_load_dwordx4 v1, s[8:11], s34 offen offset:0 sc1 lds
v_mfma_f32_16x16x32_bf16 a[40:43], a[104:107], a[144:147], a[40:43]
ds_read_b64_tr_b16 a[96:97], v2 offset:4096
v_mfma_f32_16x16x32_bf16 a[44:47], a[108:111], a[144:147], a[44:47]
ds_read_b64_tr_b16 a[98:99], v2 offset:20480
v_mfma_f32_16x16x32_bf16 v[236:239], a[108:111], a[140:143], v[236:239]
v_mfma_f32_16x16x32_bf16 v[232:235], a[104:107], a[140:143], v[232:235]
v_mfma_f32_16x16x32_bf16 v[168:171], a[104:107], a[136:139], v[168:171]
buffer_load_dwordx4 v1, s[8:11], s34 offen offset:1024 sc1 lds
v_mfma_f32_16x16x32_bf16 v[172:175], a[108:111], a[136:139], v[172:175]
s_waitcnt lgkmcnt(6)
ds_read_b64_tr_b16 a[100:101], v8 offset:4096
v_mfma_f32_16x16x32_bf16 v[108:111], a[108:111], a[132:135], v[108:111]
ds_read_b64_tr_b16 a[102:103], v8 offset:20480
v_mfma_f32_16x16x32_bf16 v[104:107], a[104:107], a[132:135], v[104:107]
v_mfma_f32_16x16x32_bf16 v[40:43], a[104:107], a[128:131], v[40:43]
v_mfma_f32_16x16x32_bf16 v[44:47], a[108:111], a[128:131], v[44:47]
buffer_load_dwordx4 v1, s[8:11], s34 offen offset:2048 sc1 lds
v_mfma_f32_16x16x32_bf16 v[48:51], a[112:115], a[128:131], v[48:51]
ds_read_b64_tr_b16 a[104:105], v2 offset:5120
v_mfma_f32_16x16x32_bf16 v[52:55], a[116:119], a[128:131], v[52:55]
ds_read_b64_tr_b16 a[106:107], v2 offset:21504
v_mfma_f32_16x16x32_bf16 v[116:119], a[116:119], a[132:135], v[116:119]
v_mfma_f32_16x16x32_bf16 v[112:115], a[112:115], a[132:135], v[112:115]
v_mfma_f32_16x16x32_bf16 v[176:179], a[112:115], a[136:139], v[176:179]
buffer_load_dwordx4 v1, s[8:11], s34 offen offset:3072 sc1 lds
v_mfma_f32_16x16x32_bf16 v[180:183], a[116:119], a[136:139], v[180:183]
s_waitcnt lgkmcnt(6)
ds_read_b64_tr_b16 a[108:109], v8 offset:5120
v_mfma_f32_16x16x32_bf16 v[244:247], a[116:119], a[140:143], v[244:247]
s_add_u32 m0, s29, 12288
ds_read_b64_tr_b16 a[110:111], v8 offset:21504
v_mfma_f32_16x16x32_bf16 v[240:243], a[112:115], a[140:143], v[240:243]
s_add_u32 s34, s28, 12288
v_mfma_f32_16x16x32_bf16 a[48:51], a[112:115], a[144:147], a[48:51]
buffer_load_dwordx4 v1, s[8:11], s34 offen offset:0 sc1 lds
v_mfma_f32_16x16x32_bf16 a[52:55], a[116:119], a[144:147], a[52:55]
v_mfma_f32_16x16x32_bf16 a[56:59], a[120:123], a[144:147], a[56:59]
ds_read_b64_tr_b16 a[112:113], v2 offset:6144
v_mfma_f32_16x16x32_bf16 a[60:63], a[124:127], a[144:147], a[60:63]
ds_read_b64_tr_b16 a[114:115], v2 offset:22528
v_mfma_f32_16x16x32_bf16 v[252:255], a[124:127], a[140:143], v[252:255]
v_mfma_f32_16x16x32_bf16 v[248:251], a[120:123], a[140:143], v[248:251]
buffer_load_dwordx4 v1, s[8:11], s34 offen offset:1024 sc1 lds
v_mfma_f32_16x16x32_bf16 v[184:187], a[120:123], a[136:139], v[184:187]
v_mfma_f32_16x16x32_bf16 v[188:191], a[124:127], a[136:139], v[188:191]
s_waitcnt lgkmcnt(6)
ds_read_b64_tr_b16 a[116:117], v8 offset:6144
v_mfma_f32_16x16x32_bf16 v[124:127], a[124:127], a[132:135], v[124:127]
ds_read_b64_tr_b16 a[118:119], v8 offset:22528
v_mfma_f32_16x16x32_bf16 v[120:123], a[120:123], a[132:135], v[120:123]
v_mfma_f32_16x16x32_bf16 v[56:59], a[120:123], a[128:131], v[56:59]
buffer_load_dwordx4 v1, s[8:11], s34 offen offset:2048 sc1 lds
v_mfma_f32_16x16x32_bf16 v[60:63], a[124:127], a[128:131], v[60:63]
v_mfma_f32_16x16x32_bf16 v[64:67], a[96:99], a[128:131], v[64:67]
ds_read_b64_tr_b16 a[120:121], v2 offset:7168
v_mfma_f32_16x16x32_bf16 v[68:71], a[100:103], a[128:131], v[68:71]
ds_read_b64_tr_b16 a[122:123], v2 offset:23552
v_mfma_f32_16x16x32_bf16 v[132:135], a[100:103], a[132:135], v[132:135]
v_mfma_f32_16x16x32_bf16 v[128:131], a[96:99], a[132:135], v[128:131]
buffer_load_dwordx4 v1, s[8:11], s34 offen offset:3072 sc1 lds
v_mfma_f32_16x16x32_bf16 v[192:195], a[96:99], a[136:139], v[192:195]
s_add_u32 s28, s28, 32768
s_add_u32 s29, s29, 32768
s_and_b32 s29, s29, 0x1ffff
v_mfma_f32_16x16x32_bf16 v[196:199], a[100:103], a[136:139], v[196:199]
s_waitcnt lgkmcnt(6)
ds_read_b64_tr_b16 a[124:125], v8 offset:7168
v_mfma_f32_16x16x32_bf16 a[4:7], a[100:103], a[140:143], a[4:7]
ds_read_b64_tr_b16 a[126:127], v8 offset:23552
v_mfma_f32_16x16x32_bf16 a[0:3], a[96:99], a[140:143], a[0:3]
s_cmp_eq_u32 s28, s30
s_cselect_b32 s28, s46, s28
v_mfma_f32_16x16x32_bf16 a[64:67], a[96:99], a[144:147], a[64:67]
v_mfma_f32_16x16x32_bf16 a[68:71], a[100:103], a[144:147], a[68:71]
v_mfma_f32_16x16x32_bf16 a[72:75], a[104:107], a[144:147], a[72:75]
ds_read_b64_tr_b16 a[96:97], v2 offset:32768
v_mfma_f32_16x16x32_bf16 a[76:79], a[108:111], a[144:147], a[76:79]
ds_read_b64_tr_b16 a[98:99], v2 offset:49152
v_mfma_f32_16x16x32_bf16 a[12:15], a[108:111], a[140:143], a[12:15]
v_mfma_f32_16x16x32_bf16 a[8:11], a[104:107], a[140:143], a[8:11]
v_mfma_f32_16x16x32_bf16 v[200:203], a[104:107], a[136:139], v[200:203]
v_mfma_f32_16x16x32_bf16 v[204:207], a[108:111], a[136:139], v[204:207]
s_waitcnt lgkmcnt(6)
ds_read_b64_tr_b16 a[100:101], v8 offset:32768
v_mfma_f32_16x16x32_bf16 v[140:143], a[108:111], a[132:135], v[140:143]
ds_read_b64_tr_b16 a[102:103], v8 offset:49152
v_mfma_f32_16x16x32_bf16 v[136:139], a[104:107], a[132:135], v[136:139]
s_waitcnt vmcnt(4) lgkmcnt(4)
s_barrier
v_mfma_f32_16x16x32_bf16 v[72:75], a[104:107], a[128:131], v[72:75]
ds_read_b32 v5, v6
v_mfma_f32_16x16x32_bf16 v[76:79], a[108:111], a[128:131], v[76:79]
ds_read2st64_b32 a[148:149], v3 offset0:20 offset1:21
v_mfma_f32_16x16x32_bf16 v[80:83], a[112:115], a[128:131], v[80:83]
ds_read_b64_tr_b16 a[104:105], v2 offset:33792
v_mfma_f32_16x16x32_bf16 v[84:87], a[116:119], a[128:131], v[84:87]
ds_read_b64_tr_b16 a[106:107], v2 offset:50176
v_mfma_f32_16x16x32_bf16 v[148:151], a[116:119], a[132:135], v[148:151]
ds_read2st64_b32 a[150:151], v3 offset0:22 offset1:23
v_mfma_f32_16x16x32_bf16 v[144:147], a[112:115], a[132:135], v[144:147]
ds_read2st64_b32 a[152:153], v3 offset0:24 offset1:25
v_mfma_f32_16x16x32_bf16 v[208:211], a[112:115], a[136:139], v[208:211]
ds_read2st64_b32 a[154:155], v3 offset0:26 offset1:27
v_mfma_f32_16x16x32_bf16 v[212:215], a[116:119], a[136:139], v[212:215]
ds_read_b64_tr_b16 a[108:109], v8 offset:33792
v_mfma_f32_16x16x32_bf16 a[20:23], a[116:119], a[140:143], a[20:23]
ds_read_b64_tr_b16 a[110:111], v8 offset:50176
v_mfma_f32_16x16x32_bf16 a[16:19], a[112:115], a[140:143], a[16:19]
ds_read2st64_b32 a[156:157], v3 offset0:28 offset1:29
v_mfma_f32_16x16x32_bf16 a[80:83], a[112:115], a[144:147], a[80:83]
ds_read2st64_b32 a[158:159], v3 offset0:30 offset1:31
v_mfma_f32_16x16x32_bf16 a[84:87], a[116:119], a[144:147], a[84:87]
ds_read2st64_b32 a[160:161], v3 offset0:32 offset1:33
v_mfma_f32_16x16x32_bf16 a[88:91], a[120:123], a[144:147], a[88:91]
ds_read_b64_tr_b16 a[112:113], v2 offset:34816
v_mfma_f32_16x16x32_bf16 a[92:95], a[124:127], a[144:147], a[92:95]
ds_read_b64_tr_b16 a[114:115], v2 offset:51200
v_mfma_f32_16x16x32_bf16 a[28:31], a[124:127], a[140:143], a[28:31]
ds_read2st64_b32 a[162:163], v3 offset0:34 offset1:35
v_mfma_f32_16x16x32_bf16 a[24:27], a[120:123], a[140:143], a[24:27]
ds_read2st64_b32 a[164:165], v3 offset0:36 offset1:37
v_mfma_f32_16x16x32_bf16 v[216:219], a[120:123], a[136:139], v[216:219]
ds_read2st64_b32 a[166:167], v3 offset0:38 offset1:39
v_mfma_f32_16x16x32_bf16 v[220:223], a[124:127], a[136:139], v[220:223]
ds_read_b64_tr_b16 a[116:117], v8 offset:34816
v_mfma_f32_16x16x32_bf16 v[156:159], a[124:127], a[132:135], v[156:159]
ds_read_b64_tr_b16 a[118:119], v8 offset:51200
v_mfma_f32_16x16x32_bf16 v[152:155], a[120:123], a[132:135], v[152:155]
s_waitcnt lgkmcnt(15)
v_cmp_eq_u32 vcc, s27, v5
v_mfma_f32_16x16x32_bf16 v[88:91], a[120:123], a[128:131], v[88:91]
s_add_u32 s27, s27, 1
s_cmp_eq_u32 s27, s26
s_waitcnt lgkmcnt(2)
v_mfma_f32_16x16x32_bf16 v[92:95], a[124:127], a[128:131], v[92:95]
s_cbranch_vccnz L_prec0
L_pback0:
s_cbranch_scc1 L_pend
v_mfma_f32_16x16x32_bf16 v[32:35], a[96:99], a[148:151], v[32:35]
s_add_u32 m0, s29, 4096
ds_read_b64_tr_b16 a[120:121], v2 offset:35840
v_mfma_f32_16x16x32_bf16 v[36:39], a[100:103], a[148:151], v[36:39]
s_add_u32 s34, s28, 4096
ds_read_b64_tr_b16 a[122:123], v2 offset:52224
v_mfma_f32_16x16x32_bf16 v[100:103], a[100:103], a[152:155], v[100:103]
buffer_load_dwordx4 v1, s[8:11], s34 offen offset:2048 sc1 lds
v_mfma_f32_16x16x32_bf16 v[96:99], a[96:99], a[152:155], v[96:99]
v_mfma_f32_16x16x32_bf16 v[160:163], a[96:99], a[156:159], v[160:163]
buffer_load_dwordx4 v1, s[8:11], s34 offen offset:3072 sc1 lds
v_mfma_f32_16x16x32_bf16 v[164:167], a[100:103], a[156:159], v[164:167]
ds_read_b64_tr_b16 a[124:125], v8 offset:35840
v_mfma_f32_16x16x32_bf16 v[228:231], a[100:103], a[160:163], v[228:231]
s_add_u32 m0, s29, 8192
ds_read_b64_tr_b16 a[126:127], v8 offset:52224
v_mfma_f32_16x16x32_bf16 v[224:227], a[96:99], a[160:163], v[224:227]
s_add_u32 s34, s28, 8192
v_mfma_f32_16x16x32_bf16 a[32:35], a[96:99], a[164:167], a[32:35]
v_mfma_f32_16x16x32_bf16 a[36:39], a[100:103], a[164:167], a[36:39]
buffer_load_dwordx4 v1, s[8:11], s34 offen offset:0 sc1 lds
v_mfma_f32_16x16x32_bf16 a[40:43], a[104:107], a[164:167], a[40:43]
ds_read_b64_tr_b16 a[96:97], v2 offset:36864
v_mfma_f32_16x16x32_bf16 a[44:47], a[108:111], a[164:167], a[44:47]
ds_read_b64_tr_b16 a[98:99], v2 offset:53248
v_mfma_f32_16x16x32_bf16 v[236:239], a[108:111], a[160:163], v[236:239]
v_mfma_f32_16x16x32_bf16 v[232:235], a[104:107], a[160:163], v[232:235]
v_mfma_f32_16x16x32_bf16 v[168:171], a[104:107], a[156:159], v[168:171]
buffer_load_dwordx4 v1, s[8:11], s34 offen offset:1024 sc1 lds
v_mfma_f32_16x16x32_bf16 v[172:175], a[108:111], a[156:159], v[172:175]
s_waitcnt lgkmcnt(6)
ds_read_b64_tr_b16 a[100:101], v8 offset:36864
v_mfma_f32_16x16x32_bf16 v[108:111], a[108:111], a[152:155], v[108:111]
ds_read_b64_tr_b16 a[102:103], v8 offset:53248
v_mfma_f32_16x16x32_bf16 v[104:107], a[104:107], a[152:155], v[104:107]
v_mfma_f32_16x16x32_bf16 v[40:43], a[104:107], a[148:151], v[40:43]
v_mfma_f32_16x16x32_bf16 v[44:47], a[108:111], a[148:151], v[44:47]
buffer_load_dwordx4 v1, s[8:11], s34 offen offset:2048 sc1 lds
v_mfma_f32_16x16x32_bf16 v[48:51], a[112:115], a[148:151], v[48:51]
ds_read_b64_tr_b16 a[104:105], v2 offset:37888
v_mfma_f32_16x16x32_bf16 v[52:55], a[116:119], a[148:151], v[52:55]
ds_read_b64_tr_b16 a[106:107], v2 offset:54272
v_mfma_f32_16x16x32_bf16 v[116:119], a[116:119], a[152:155], v[116:119]
v_mfma_f32_16x16x32_bf16 v[112:115], a[112:115], a[152:155], v[112:115]
v_mfma_f32_16x16x32_bf16 v[176:179], a[112:115], a[156:159], v[176:179]
buffer_load_dwordx4 v1, s[8:11], s34 offen offset:3072 sc1 lds
v_mfma_f32_16x16x32_bf16 v[180:183], a[116:119], a[156:159], v[180:183]
s_waitcnt lgkmcnt(6)
ds_read_b64_tr_b16 a[108:109], v8 offset:37888
v_mfma_f32_16x16x32_bf16 v[244:247], a[116:119], a[160:163], v[244:247]
s_add_u32 m0, s29, 12288
ds_read_b64_tr_b16 a[110:111], v8 offset:54272
v_mfma_f32_16x16x32_bf16 v[240:243], a[112:115], a[160:163], v[240:243]
s_add_u32 s34, s28, 12288
v_mfma_f32_16x16x32_bf16 a[48:51], a[112:115], a[164:167], a[48:51]
buffer_load_dwordx4 v1, s[8:11], s34 offen offset:0 sc1 lds
v_mfma_f32_16x16x32_bf16 a[52:55], a[116:119], a[164:167], a[52:55]
v_mfma_f32_16x16x32_bf16 a[56:59], a[120:123], a[164:167], a[56:59]
ds_read_b64_tr_b16 a[112:113], v2 offset:38912
v_mfma_f32_16x16x32_bf16 a[60:63], a[124:127], a[164:167], a[60:63]
ds_read_b64_tr_b16 a[114:115], v2 offset:55296
v_mfma_f32_16x16x32_bf16 v[252:255], a[124:127], a[160:163], v[252:255]
v_mfma_f32_16x16x32_bf16 v[248:251], a[120:123], a[160:163], v[248:251]
buffer_load_dwordx4 v1, s[8:11], s34 offen offset:1024 sc1 lds
v_mfma_f32_16x16x32_bf16 v[184:187], a[120:123], a[156:159], v[184:187]
v_mfma_f32_16x16x32_bf16 v[188:191], a[124:127], a[156:159], v[188:191]
s_waitcnt lgkmcnt(6)
ds_read_b64_tr_b16 a[116:117], v8 offset:38912
v_mfma_f32_16x16x32_bf16 v[124:127], a[124:127], a[152:155], v[124:127]
ds_read_b64_tr_b16 a[118:119], v8 offset:55296
v_mfma_f32_16x16x32_bf16 v[120:123], a[120:123], a[152:155], v[120:123]
v_mfma_f32_16x16x32_bf16 v[56:59], a[120:123], a[148:151], v[56:59]
buffer_load_dwordx4 v1, s[8:11], s34 offen offset:2048 sc1 lds
v_mfma_f32_16x16x32_bf16 v[60:63], a[124:127], a[148:151], v[60:63]
v_mfma_f32_16x16x32_bf16 v[64:67], a[96:99], a[148:151], v[64:67]
ds_read_b64_tr_b16 a[120:121], v2 offset:39936
v_mfma_f32_16x16x32_bf16 v[68:71], a[100:103], a[148:151], v[68:71]
ds_read_b64_tr_b16 a[122:123], v2 offset:56320
v_mfma_f32_16x16x32_bf16 v[132:135], a[100:103], a[152:155], v[132:135]
v_mfma_f32_16x16x32_bf16 v[128:131], a[96:99], a[152:155], v[128:131]
buffer_load_dwordx4 v1, s[8:11], s34 offen offset:3072 sc1 lds
v_mfma_f32_16x16x32_bf16 v[192:195], a[96:99], a[156:159], v[192:195]
s_add_u32 s28, s28, 32768
s_add_u32 s29, s29, 32768
s_and_b32 s29, s29, 0x1ffff
v_mfma_f32_16x16x32_bf16 v[196:199], a[100:103], a[156:159], v[196:199]
s_waitcnt lgkmcnt(6)
ds_read_b64_tr_b16 a[124:125], v8 offset:39936
v_mfma_f32_16x16x32_bf16 a[4:7], a[100:103], a[160:163], a[4:7]
ds_read_b64_tr_b16 a[126:127], v8 offset:56320
v_xor_b32 v2, 0x10000, v2
v_mfma_f32_16x16x32_bf16 a[0:3], a[96:99], a[160:163], a[0:3]
s_cmp_eq_u32 s28, s30
s_cselect_b32 s28, s46, s28
v_mfma_f32_16x16x32_bf16 a[64:67], a[96:99], a[164:167], a[64:67]
v_mfma_f32_16x16x32_bf16 a[68:71], a[100:103], a[164:167], a[68:71]
v_mfma_f32_16x16x32_bf16 a[72:75], a[104:107], a[164:167], a[72:75]
ds_read_b64_tr_b16 a[96:97], v2 offset:0
v_mfma_f32_16x16x32_bf16 a[76:79], a[108:111], a[164:167], a[76:79]
ds_read_b64_tr_b16 a[98:99], v2 offset:16384
v_xor_b32 v8, 0x10000, v8
v_mfma_f32_16x16x32_bf16 a[12:15], a[108:111], a[160:163], a[12:15]
v_mfma_f32_16x16x32_bf16 a[8:11], a[104:107], a[160:163], a[8:11]
v_mfma_f32_16x16x32_bf16 v[200:203], a[104:107], a[156:159], v[200:203]
v_mfma_f32_16x16x32_bf16 v[204:207], a[108:111], a[156:159], v[204:207]
s_waitcnt lgkmcnt(6)
ds_read_b64_tr_b16 a[100:101], v8 offset:0
v_mfma_f32_16x16x32_bf16 v[140:143], a[108:111], a[152:155], v[140:143]
ds_read_b64_tr_b16 a[102:103], v8 offset:16384
v_mfma_f32_16x16x32_bf16 v[136:139], a[104:107], a[152:155], v[136:139]
s_waitcnt vmcnt(4) lgkmcnt(4)
s_barrier
v_mfma_f32_16x16x32_bf16 v[72:75], a[104:107], a[148:151], v[72:75]
ds_read_b32 v5, v6
v_mfma_f32_16x16x32_bf16 v[76:79], a[108:111], a[148:151], v[76:79]
ds_read2st64_b32 a[128:129], v3 offset0:0 offset1:1
v_mfma_f32_16x16x32_bf16 v[80:83], a[112:115], a[148:151], v[80:83]
ds_read_b64_tr_b16 a[104:105], v2 offset:1024
v_mfma_f32_16x16x32_bf16 v[84:87], a[116:119], a[148:151], v[84:87]
ds_read_b64_tr_b16 a[106:107], v2 offset:17408
v_mfma_f32_16x16x32_bf16 v[148:151], a[116:119], a[152:155], v[148:151]
ds_read2st64_b32 a[130:131], v3 offset0:2 offset1:3
v_mfma_f32_16x16x32_bf16 v[144:147], a[112:115], a[152:155], v[144:147]
ds_read2st64_b32 a[132:133], v3 offset0:4 offset1:5
v_mfma_f32_16x16x32_bf16 v[208:211], a[112:115], a[156:159], v[208:211]
ds_read2st64_b32 a[134:135], v3 offset0:6 offset1:7
v_mfma_f32_16x16x32_bf16 v[212:215], a[116:119], a[156:159], v[212:215]
ds_read_b64_tr_b16 a[108:109], v8 offset:1024
v_mfma_f32_16x16x32_bf16 a[20:23], a[116:119], a[160:163], a[20:23]
ds_read_b64_tr_b16 a[110:111], v8 offset:17408
v_mfma_f32_16x16x32_bf16 a[16:19], a[112:115], a[160:163], a[16:19]
ds_read2st64_b32 a[136:137], v3 offset0:8 offset1:9
v_mfma_f32_16x16x32_bf16 a[80:83], a[112:115], a[164:167], a[80:83]
ds_read2st64_b32 a[138:139], v3 offset0:10 offset1:11
v_mfma_f32_16x16x32_bf16 a[84:87], a[116:119], a[164:167], a[84:87]
ds_read2st64_b32 a[140:141], v3 offset0:12 offset1:13
v_mfma_f32_16x16x32_bf16 a[88:91], a[120:123], a[164:167], a[88:91]
ds_read_b64_tr_b16 a[112:113], v2 offset:2048
v_mfma_f32_16x16x32_bf16 a[92:95], a[124:127], a[164:167], a[92:95]
ds_read_b64_tr_b16 a[114:115], v2 offset:18432
v_mfma_f32_16x16x32_bf16 a[28:31], a[124:127], a[160:163], a[28:31]
ds_read2st64_b32 a[142:143], v3 offset0:14 offset1:15
v_mfma_f32_16x16x32_bf16 a[24:27], a[120:123], a[160:163], a[24:27]
ds_read2st64_b32 a[144:145], v3 offset0:16 offset1:17
v_mfma_f32_16x16x32_bf16 v[216:219], a[120:123], a[156:159], v[216:219]
ds_read2st64_b32 a[146:147], v3 offset0:18 offset1:19
v_mfma_f32_16x16x32_bf16 v[220:223], a[124:127], a[156:159], v[220:223]
ds_read_b64_tr_b16 a[116:117], v8 offset:2048
v_mfma_f32_16x16x32_bf16 v[156:159], a[124:127], a[152:155], v[156:159]
ds_read_b64_tr_b16 a[118:119], v8 offset:18432
v_mfma_f32_16x16x32_bf16 v[152:155], a[120:123], a[152:155], v[152:155]
s_waitcnt lgkmcnt(15)
v_cmp_eq_u32 vcc, s27, v5
v_mfma_f32_16x16x32_bf16 v[88:91], a[120:123], a[148:151], v[88:91]
s_add_u32 s27, s27, 1
s_cmp_lg_u32 s27, s26
s_waitcnt lgkmcnt(2)
v_mfma_f32_16x16x32_bf16 v[92:95], a[124:127], a[148:151], v[92:95]
s_cbranch_vccnz L_prec1
L_pback1:
s_cbranch_scc1 L_ploop
L_pend:
s_add_u32 s34, s29, 32768
s_and_b32 s34, s34, 0x1ffff
v_add_u32 v10, s34, v1
s_add_u32 s34, s29, 65536
s_and_b32 s34, s34, 0x1ffff
v_add_u32 v11, s34, v1
s_add_u32 s34, s29, 98304
s_and_b32 s34, s34, 0x1ffff
v_add_u32 v12, s34, v1
s_mul_i32 s34, s24, 500
s_add_u32 s34, s34, s39
s_lshl_b32 s34, s34, 14
s_lshl_b32 s35, s21, 13
s_add_u32 s34, s34, s35
s_add_u32 s38, s34, 16777216
v_add_u32 v2, s35, v1
v_add_u32 v3, 0x10000, v2
v_cvt_pk_bf16_f32 v32, v32, v33
v_cvt_pk_bf16_f32 v33, v34, v35
v_cvt_pk_bf16_f32 v34, v36, v37
v_cvt_pk_bf16_f32 v35, v38, v39
ds_read_b128 a[96:99], v10 offset:0
ds_read_b128 a[100:103], v10 offset:1024
ds_read_b128 a[104:107], v10 offset:2048
ds_read_b128 a[108:111], v10 offset:3072
ds_read_b128 a[112:115], v10 offset:4096
s_waitcnt vmcnt(0)
s_add_u32 s37, s38, 0
buffer_store_dwordx4 v[32:35], v1, s[8:11], s37 offen offset:0 sc1
v_cvt_pk_bf16_f32 v40, v40, v41
v_cvt_pk_bf16_f32 v41, v42, v43
v_cvt_pk_bf16_f32 v42, v44, v45
v_cvt_pk_bf16_f32 v43, v46, v47
ds_read_b128 a[116:119], v10 offset:5120
ds_read_b128 a[120:123], v10 offset:6144
ds_read_b128 a[124:127], v10 offset:7168
ds_read_b128 a[128:131], v10 offset:8192
ds_read_b128 a[132:135], v10 offset:9216
s_add_u32 s37, s38, 0
buffer_store_dwordx4 v[40:43], v1, s[8:11], s37 offen offset:1024 sc1
v_cvt_pk_bf16_f32 v48, v48, v49
v_cvt_pk_bf16_f32 v49, v50, v51
v_cvt_pk_bf16_f32 v50, v52, v53
v_cvt_pk_bf16_f32 v51, v54, v55
ds_read_b128 a[136:139], v10 offset:10240
ds_read_b128 a[140:143], v10 offset:11264
ds_read_b128 a[144:147], v10 offset:12288
ds_read_b128 a[148:151], v10 offset:13312
ds_read_b128 a[152:155], v10 offset:14336
s_add_u32 s37, s38, 0
buffer_store_dwordx4 v[48:51], v1, s[8:11], s37 offen offset:2048 sc1
v_cvt_pk_bf16_f32 v56, v56, v57
v_cvt_pk_bf16_f32 v57, v58, v59
v_cvt_pk_bf16_f32 v58, v60, v61
v_cvt_pk_bf16_f32 v59, v62, v63
ds_read_b128 a[156:159], v10 offset:15360
ds_read_b128 a[160:163], v11 offset:0
ds_read_b128 a[164:167], v11 offset:1024
ds_read_b128 a[168:171], v11 offset:2048
ds_read_b128 a[172:175], v11 offset:3072
s_add_u32 s37, s38, 0
buffer_store_dwordx4 v[56:59], v1, s[8:11], s37 offen offset:3072 sc1
v_cvt_pk_bf16_f32 v64, v64, v65
v_cvt_pk_bf16_f32 v65, v66, v67
v_cvt_pk_bf16_f32 v66, v68, v69
v_cvt_pk_bf16_f32 v67, v70, v71
ds_read_b128 a[176:179], v11 offset:4096
ds_read_b128 a[180:183], v11 offset:5120
ds_read_b128 a[184:187], v11 offset:6144
ds_read_b128 a[188:191], v11 offset:7168
ds_read_b128 a[192:195], v11 offset:8192
s_add_u32 s37, s38, 4096
buffer_store_dwordx4 v[64:67], v1, s[8:11], s37 offen offset:0 sc1
v_cvt_pk_bf16_f32 v72, v72, v73
v_cvt_pk_bf16_f32 v73, v74, v75
v_cvt_pk_bf16_f32 v74, v76, v77
v_cvt_pk_bf16_f32 v75, v78, v79
ds_read_b128 a[196:199], v11 offset:9216
ds_read_b128 a[200:203], v11 offset:10240
ds_read_b128 a[204:207], v11 offset:11264
ds_read_b128 a[208:211], v11 offset:12288
ds_read_b128 a[212:215], v11 offset:13312
s_add_u32 s37, s38, 4096
buffer_store_dwordx4 v[72:75], v1, s[8:11], s37 offen offset:1024 sc1
v_cvt_pk_bf16_f32 v80, v80, v81
v_cvt_pk_bf16_f32 v81, v82, v83
v_cvt_pk_bf16_f32 v82, v84, v85
v_cvt_pk_bf16_f32 v83, v86, v87
ds_read_b128 a[216:219], v11 offset:14336
ds_read_b128 a[220:223], v11 offset:15360
ds_read_b128 a[224:227], v12 offset:8192
ds_read_b128 a[228:231], v12 offset:9216
ds_read_b128 a[232:235], v12 offset:10240
s_add_u32 s37, s38, 4096
buffer_store_dwordx4 v[80:83], v1, s[8:11], s37 offen offset:2048 sc1
v_cvt_pk_bf16_f32 v88, v88, v89
v_cvt_pk_bf16_f32 v89, v90, v91
v_cvt_pk_bf16_f32 v90, v92, v93
v_cvt_pk_bf16_f32 v91, v94, v95
ds_read_b128 a[236:239], v12 offset:11264
ds_read_b128 a[240:243], v12 offset:12288
ds_read_b128 a[244:247], v12 offset:13312
ds_read_b128 a[248:251], v12 offset:14336
ds_read_b128 a[252:255], v12 offset:15360
s_add_u32 s37, s38, 4096
buffer_store_dwordx4 v[88:91], v1, s[8:11], s37 offen offset:3072 sc1
v_cvt_pk_bf16_f32 v96, v96, v97
v_cvt_pk_bf16_f32 v97, v98, v99
v_cvt_pk_bf16_f32 v98, v100, v101
v_cvt_pk_bf16_f32 v99, v102, v103
s_waitcnt lgkmcnt(0)
s_barrier
ds_write_b128 v2, v[96:99] offset:16384
ds_write_b128 v2, v[32:35] offset:0
s_add_u32 s37, s38, 16384
buffer_store_dwordx4 v[96:99], v1, s[8:11], s37 offen offset:0 sc1
v_cvt_pk_bf16_f32 v104, v104, v105
v_cvt_pk_bf16_f32 v105, v106, v107
v_cvt_pk_bf16_f32 v106, v108, v109
v_cvt_pk_bf16_f32 v107, v110, v111
ds_write_b128 v2, v[104:107] offset:17408
ds_write_b128 v2, v[40:43] offset:1024
s_add_u32 s37, s38, 16384
buffer_store_dwordx4 v[104:107], v1, s[8:11], s37 offen offset:1024 sc1
v_cvt_pk_bf16_f32 v112, v112, v113
v_cvt_pk_bf16_f32 v113, v114, v115
v_cvt_pk_bf16_f32 v114, v116, v117
v_cvt_pk_bf16_f32 v115, v118, v119
ds_write_b128 v2, v[112:115] offset:18432
ds_write_b128 v2, v[48:51] offset:2048
s_add_u32 s37, s38, 16384
buffer_store_dwordx4 v[112:115], v1, s[8:11], s37 offen offset:2048 sc1
v_cvt_pk_bf16_f32 v120, v120, v121
v_cvt_pk_bf16_f32 v121, v122, v123
v_cvt_pk_bf16_f32 v122, v124, v125
v_cvt_pk_bf16_f32 v123, v126, v127
ds_write_b128 v2, v[120:123] offset:19456
ds_write_b128 v2, v[56:59] offset:3072
s_add_u32 s37, s38, 16384
buffer_store_dwordx4 v[120:123], v1, s[8:11], s37 offen offset:3072 sc1
v_cvt_pk_bf16_f32 v128, v128, v129
v_cvt_pk_bf16_f32 v129, v130, v131
v_cvt_pk_bf16_f32 v130, v132, v133
v_cvt_pk_bf16_f32 v131, v134, v135
ds_write_b128 v2, v[128:131] offset:20480
ds_write_b128 v2, v[64:67] offset:4096
s_add_u32 s37, s38, 20480
buffer_store_dwordx4 v[128:131], v1, s[8:11], s37 offen offset:0 sc1
v_cvt_pk_bf16_f32 v136, v136, v137
v_cvt_pk_bf16_f32 v137, v138, v139
v_cvt_pk_bf16_f32 v138, v140, v141
v_cvt_pk_bf16_f32 v139, v142, v143
ds_write_b128 v2, v[136:139] offset:21504
ds_write_b128 v2, v[72:75] offset:5120
s_add_u32 s37, s38, 20480
buffer_store_dwordx4 v[136:139], v1, s[8:11], s37 offen offset:1024 sc1
v_cvt_pk_bf16_f32 v144, v144, v145
v_cvt_pk_bf16_f32 v145, v146, v147
v_cvt_pk_bf16_f32 v146, v148, v149
v_cvt_pk_bf16_f32 v147, v150, v151
ds_write_b128 v2, v[144:147] offset:22528
ds_write_b128 v2, v[80:83] offset:6144
s_add_u32 s37, s38, 20480
buffer_store_dwordx4 v[144:147], v1, s[8:11], s37 offen offset:2048 sc1
v_cvt_pk_bf16_f32 v152, v152, v153
v_cvt_pk_bf16_f32 v153, v154, v155
v_cvt_pk_bf16_f32 v154, v156, v157
v_cvt_pk_bf16_f32 v155, v158, v159
ds_write_b128 v2, v[152:155] offset:23552
ds_write_b128 v2, v[88:91] offset:7168
s_add_u32 s37, s38, 20480
buffer_store_dwordx4 v[152:155], v1, s[8:11], s37 offen offset:3072 sc1
v_cvt_pk_bf16_f32 v160, v160, v161
v_cvt_pk_bf16_f32 v161, v162, v163
v_cvt_pk_bf16_f32 v162, v164, v165
v_cvt_pk_bf16_f32 v163, v166, v167
ds_write_b128 v2, v[160:163] offset:32768
s_add_u32 s37, s38, 32768
buffer_store_dwordx4 v[160:163], v1, s[8:11], s37 offen offset:0 sc1
v_cvt_pk_bf16_f32 v168, v168, v169
v_cvt_pk_bf16_f32 v169, v170, v171
v_cvt_pk_bf16_f32 v170, v172, v173
v_cvt_pk_bf16_f32 v171, v174, v175
ds_write_b128 v2, v[168:171] offset:33792
s_add_u32 s37, s38, 32768
buffer_store_dwordx4 v[168:171], v1, s[8:11], s37 offen offset:1024 sc1
v_cvt_pk_bf16_f32 v176, v176, v177
v_cvt_pk_bf16_f32 v177, v178, v179
v_cvt_pk_bf16_f32 v178, v180, v181
v_cvt_pk_bf16_f32 v179, v182, v183
ds_write_b128 v2, v[176:179] offset:34816
s_add_u32 s37, s38, 32768
buffer_store_dwordx4 v[176:179], v1, s[8:11], s37 offen offset:2048 sc1
v_cvt_pk_bf16_f32 v184, v184, v185
v_cvt_pk_bf16_f32 v185, v186, v187
v_cvt_pk_bf16_f32 v186, v188, v189
v_cvt_pk_bf16_f32 v187, v190, v191
ds_write_b128 v2, v[184:187] offset:35840
s_add_u32 s37, s38, 32768
buffer_store_dwordx4 v[184:187], v1, s[8:11], s37 offen offset:3072 sc1
v_cvt_pk_bf16_f32 v192, v192, v193
v_cvt_pk_bf16_f32 v193, v194, v195
v_cvt_pk_bf16_f32 v194, v196, v197
v_cvt_pk_bf16_f32 v195, v198, v199
ds_write_b128 v2, v[192:195] offset:36864
s_add_u32 s37, s38, 36864
buffer_store_dwordx4 v[192:195], v1, s[8:11], s37 offen offset:0 sc1
v_cvt_pk_bf16_f32 v200, v200, v201
v_cvt_pk_bf16_f32 v201, v202, v203
v_cvt_pk_bf16_f32 v202, v204, v205
v_cvt_pk_bf16_f32 v203, v206, v207
ds_write_b128 v2, v[200:203] offset:37888
s_add_u32 s37, s38, 36864
buffer_store_dwordx4 v[200:203], v1, s[8:11], s37 offen offset:1024 sc1
v_cvt_pk_bf16_f32 v208, v208, v209
v_cvt_pk_bf16_f32 v209, v210, v211
v_cvt_pk_bf16_f32 v210, v212, v213
v_cvt_pk_bf16_f32 v211, v214, v215
ds_write_b128 v2, v[208:211] offset:38912
s_add_u32 s37, s38, 36864
buffer_store_dwordx4 v[208:211], v1, s[8:11], s37 offen offset:2048 sc1
v_cvt_pk_bf16_f32 v216, v216, v217
v_cvt_pk_bf16_f32 v217, v218, v219
v_cvt_pk_bf16_f32 v218, v220, v221
v_cvt_pk_bf16_f32 v219, v222, v223
ds_write_b128 v2, v[216:219] offset:39936
s_add_u32 s37, s38, 36864
buffer_store_dwordx4 v[216:219], v1, s[8:11], s37 offen offset:3072 sc1
v_cvt_pk_bf16_f32 v224, v224, v225
v_cvt_pk_bf16_f32 v225, v226, v227
v_cvt_pk_bf16_f32 v226, v228, v229
v_cvt_pk_bf16_f32 v227, v230, v231
ds_write_b128 v2, v[224:227] offset:49152
s_add_u32 s37, s38, 49152
buffer_store_dwordx4 v[224:227], v1, s[8:11], s37 offen offset:0 sc1
v_cvt_pk_bf16_f32 v232, v232, v233
v_cvt_pk_bf16_f32 v233, v234, v235
v_cvt_pk_bf16_f32 v234, v236, v237
v_cvt_pk_bf16_f32 v235, v238, v239
ds_write_b128 v2, v[232:235] offset:50176
s_add_u32 s37, s38, 49152
buffer_store_dwordx4 v[232:235], v1, s[8:11], s37 offen offset:1024 sc1
v_cvt_pk_bf16_f32 v240, v240, v241
v_cvt_pk_bf16_f32 v241, v242, v243
v_cvt_pk_bf16_f32 v242, v244, v245
v_cvt_pk_bf16_f32 v243, v246, v247
ds_write_b128 v2, v[240:243] offset:51200
s_add_u32 s37, s38, 49152
buffer_store_dwordx4 v[240:243], v1, s[8:11], s37 offen offset:2048 sc1
v_cvt_pk_bf16_f32 v248, v248, v249
v_cvt_pk_bf16_f32 v249, v250, v251
v_cvt_pk_bf16_f32 v250, v252, v253
v_cvt_pk_bf16_f32 v251, v254, v255
ds_write_b128 v2, v[248:251] offset:52224
s_add_u32 s37, s38, 49152
buffer_store_dwordx4 v[248:251], v1, s[8:11], s37 offen offset:3072 sc1
v_accvgpr_read_b32 v32, a0
v_accvgpr_read_b32 v33, a1
v_accvgpr_read_b32 v34, a2
v_accvgpr_read_b32 v35, a3
v_accvgpr_read_b32 v36, a4
v_accvgpr_read_b32 v37, a5
v_accvgpr_read_b32 v38, a6
v_accvgpr_read_b32 v39, a7
v_cvt_pk_bf16_f32 v116, v32, v33
v_cvt_pk_bf16_f32 v117, v34, v35
v_cvt_pk_bf16_f32 v118, v36, v37
v_cvt_pk_bf16_f32 v119, v38, v39
ds_write_b128 v2, v[116:119] offset:53248
s_add_u32 s37, s38, 53248
buffer_store_dwordx4 v[116:119], v1, s[8:11], s37 offen offset:0 sc1
v_accvgpr_read_b32 v40, a8
v_accvgpr_read_b32 v41, a9
v_accvgpr_read_b32 v42, a10
v_accvgpr_read_b32 v43, a11
v_accvgpr_read_b32 v44, a12
v_accvgpr_read_b32 v45, a13
v_accvgpr_read_b32 v46, a14
v_accvgpr_read_b32 v47, a15
v_cvt_pk_bf16_f32 v124, v40, v41
v_cvt_pk_bf16_f32 v125, v42, v43
v_cvt_pk_bf16_f32 v126, v44, v45
v_cvt_pk_bf16_f32 v127, v46, v47
ds_write_b128 v2, v[124:127] offset:54272
s_add_u32 s37, s38, 53248
buffer_store_dwordx4 v[124:127], v1, s[8:11], s37 offen offset:1024 sc1
v_accvgpr_read_b32 v48, a16
v_accvgpr_read_b32 v49, a17
v_accvgpr_read_b32 v50, a18
v_accvgpr_read_b32 v51, a19
v_accvgpr_read_b32 v52, a20
v_accvgpr_read_b32 v53, a21
v_accvgpr_read_b32 v54, a22
v_accvgpr_read_b32 v55, a23
v_cvt_pk_bf16_f32 v132, v48, v49
v_cvt_pk_bf16_f32 v133, v50, v51
v_cvt_pk_bf16_f32 v134, v52, v53
v_cvt_pk_bf16_f32 v135, v54, v55
ds_write_b128 v2, v[132:135] offset:55296
s_add_u32 s37, s38, 53248
buffer_store_dwordx4 v[132:135], v1, s[8:11], s37 offen offset:2048 sc1
v_accvgpr_read_b32 v56, a24
v_accvgpr_read_b32 v57, a25
v_accvgpr_read_b32 v58, a26
v_accvgpr_read_b32 v59, a27
v_accvgpr_read_b32 v60, a28
v_accvgpr_read_b32 v61, a29
v_accvgpr_read_b32 v62, a30
v_accvgpr_read_b32 v63, a31
v_cvt_pk_bf16_f32 v140, v56, v57
v_cvt_pk_bf16_f32 v141, v58, v59
v_cvt_pk_bf16_f32 v142, v60, v61
v_cvt_pk_bf16_f32 v143, v62, v63
ds_write_b128 v2, v[140:143] offset:56320
s_add_u32 s37, s38, 53248
buffer_store_dwordx4 v[140:143], v1, s[8:11], s37 offen offset:3072 sc1
v_accvgpr_read_b32 v64, a32
v_accvgpr_read_b32 v65, a33
v_accvgpr_read_b32 v66, a34
v_accvgpr_read_b32 v67, a35
v_accvgpr_read_b32 v68, a36
v_accvgpr_read_b32 v69, a37
v_accvgpr_read_b32 v70, a38
v_accvgpr_read_b32 v71, a39
v_cvt_pk_bf16_f32 v180, v64, v65
v_cvt_pk_bf16_f32 v181, v66, v67
v_cvt_pk_bf16_f32 v182, v68, v69
v_cvt_pk_bf16_f32 v183, v70, v71
ds_write_b128 v3, v[180:183] offset:0
s_add_u32 s37, s38, 65536
buffer_store_dwordx4 v[180:183], v1, s[8:11], s37 offen offset:0 sc1
v_accvgpr_read_b32 v72, a40
v_accvgpr_read_b32 v73, a41
v_accvgpr_read_b32 v74, a42
v_accvgpr_read_b32 v75, a43
v_accvgpr_read_b32 v76, a44
v_accvgpr_read_b32 v77, a45
v_accvgpr_read_b32 v78, a46
v_accvgpr_read_b32 v79, a47
v_cvt_pk_bf16_f32 v188, v72, v73
v_cvt_pk_bf16_f32 v189, v74, v75
v_cvt_pk_bf16_f32 v190, v76, v77
v_cvt_pk_bf16_f32 v191, v78, v79
ds_write_b128 v3, v[188:191] offset:1024
s_add_u32 s37, s38, 65536
buffer_store_dwordx4 v[188:191], v1, s[8:11], s37 offen offset:1024 sc1
v_accvgpr_read_b32 v80, a48
v_accvgpr_read_b32 v81, a49
v_accvgpr_read_b32 v82, a50
v_accvgpr_read_b32 v83, a51
v_accvgpr_read_b32 v84, a52
v_accvgpr_read_b32 v85, a53
v_accvgpr_read_b32 v86, a54
v_accvgpr_read_b32 v87, a55
v_cvt_pk_bf16_f32 v196, v80, v81
v_cvt_pk_bf16_f32 v197, v82, v83
v_cvt_pk_bf16_f32 v198, v84, v85
v_cvt_pk_bf16_f32 v199, v86, v87
ds_write_b128 v3, v[196:199] offset:2048
s_add_u32 s37, s38, 65536
buffer_store_dwordx4 v[196:199], v1, s[8:11], s37 offen offset:2048 sc1
v_accvgpr_read_b32 v88, a56
v_accvgpr_read_b32 v89, a57
v_accvgpr_read_b32 v90, a58
v_accvgpr_read_b32 v91, a59
v_accvgpr_read_b32 v92, a60
v_accvgpr_read_b32 v93, a61
v_accvgpr_read_b32 v94, a62
v_accvgpr_read_b32 v95, a63
v_cvt_pk_bf16_f32 v204, v88, v89
v_cvt_pk_bf16_f32 v205, v90, v91
v_cvt_pk_bf16_f32 v206, v92, v93
v_cvt_pk_bf16_f32 v207, v94, v95
ds_write_b128 v3, v[204:207] offset:3072
s_add_u32 s37, s38, 65536
buffer_store_dwordx4 v[204:207], v1, s[8:11], s37 offen offset:3072 sc1
v_accvgpr_read_b32 v32, a64
v_accvgpr_read_b32 v33, a65
v_accvgpr_read_b32 v34, a66
v_accvgpr_read_b32 v35, a67
v_accvgpr_read_b32 v36, a68
v_accvgpr_read_b32 v37, a69
v_accvgpr_read_b32 v38, a70
v_accvgpr_read_b32 v39, a71
v_cvt_pk_bf16_f32 v212, v32, v33
v_cvt_pk_bf16_f32 v213, v34, v35
v_cvt_pk_bf16_f32 v214, v36, v37
v_cvt_pk_bf16_f32 v215, v38, v39
ds_write_b128 v3, v[212:215] offset:4096
s_add_u32 s37, s38, 69632
buffer_store_dwordx4 v[212:215], v1, s[8:11], s37 offen offset:0 sc1
v_accvgpr_read_b32 v40, a72
v_accvgpr_read_b32 v41, a73
v_accvgpr_read_b32 v42, a74
v_accvgpr_read_b32 v43, a75
v_accvgpr_read_b32 v44, a76
v_accvgpr_read_b32 v45, a77
v_accvgpr_read_b32 v46, a78
v_accvgpr_read_b32 v47, a79
v_cvt_pk_bf16_f32 v220, v40, v41
v_cvt_pk_bf16_f32 v221, v42, v43
v_cvt_pk_bf16_f32 v222, v44, v45
v_cvt_pk_bf16_f32 v223, v46, v47
ds_write_b128 v3, v[220:223] offset:5120
s_add_u32 s37, s38, 69632
buffer_store_dwordx4 v[220:223], v1, s[8:11], s37 offen offset:1024 sc1
v_accvgpr_read_b32 v48, a80
v_accvgpr_read_b32 v49, a81
v_accvgpr_read_b32 v50, a82
v_accvgpr_read_b32 v51, a83
v_accvgpr_read_b32 v52, a84
v_accvgpr_read_b32 v53, a85
v_accvgpr_read_b32 v54, a86
v_accvgpr_read_b32 v55, a87
v_cvt_pk_bf16_f32 v228, v48, v49
v_cvt_pk_bf16_f32 v229, v50, v51
v_cvt_pk_bf16_f32 v230, v52, v53
v_cvt_pk_bf16_f32 v231, v54, v55
ds_write_b128 v3, v[228:231] offset:6144
s_add_u32 s37, s38, 69632
buffer_store_dwordx4 v[228:231], v1, s[8:11], s37 offen offset:2048 sc1
v_accvgpr_read_b32 v56, a88
v_accvgpr_read_b32 v57, a89
v_accvgpr_read_b32 v58, a90
v_accvgpr_read_b32 v59, a91
v_accvgpr_read_b32 v60, a92
v_accvgpr_read_b32 v61, a93
v_accvgpr_read_b32 v62, a94
v_accvgpr_read_b32 v63, a95
v_cvt_pk_bf16_f32 v236, v56, v57
v_cvt_pk_bf16_f32 v237, v58, v59
v_cvt_pk_bf16_f32 v238, v60, v61
v_cvt_pk_bf16_f32 v239, v62, v63
ds_write_b128 v3, v[236:239] offset:7168
s_add_u32 s37, s38, 69632
buffer_store_dwordx4 v[236:239], v1, s[8:11], s37 offen offset:3072 sc1
s_waitcnt lgkmcnt(0)
s_barrier
ds_read_b128 v[144:147], v1 offset:0
ds_read_b128 v[148:151], v1 offset:1024
ds_read_b128 v[152:155], v1 offset:16384
ds_read_b128 v[156:159], v1 offset:17408
ds_read_b128 v[160:163], v1 offset:32768
ds_read_b128 v[164:167], v1 offset:33792
s_waitcnt lgkmcnt(4)
v_mfma_f32_16x16x32_bf16 v[32:35], a[96:99], v[144:147], 0
ds_read_b128 v[168:171], v1 offset:2048
v_mfma_f32_16x16x32_bf16 v[32:35], a[112:115], v[148:151], v[32:35]
v_min_u32 v30, 1, v0
v_lshlrev_b32 v30, 30, v30
v_mov_b32 v31, s7
v_mfma_f32_16x16x32_bf16 v[36:39], a[116:119], v[148:151], 0
v_and_b32 v9, 0xfffffffb, v4
v_mfma_f32_16x16x32_bf16 v[36:39], a[100:103], v[144:147], v[36:39]
ds_read_b64 v[10:11], v9 offset:0
v_mfma_f32_16x16x32_bf16 v[40:43], a[104:107], v[144:147], 0
ds_read_b128 v[172:175], v1 offset:3072
v_mfma_f32_16x16x32_bf16 v[40:43], a[120:123], v[148:151], v[40:43]
ds_read_b32 v20, v9 offset:4096
v_mfma_f32_16x16x32_bf16 v[44:47], a[124:127], v[148:151], 0
ds_read_b64 v[12:13], v9 offset:512
v_mfma_f32_16x16x32_bf16 v[44:47], a[108:111], v[144:147], v[44:47]
ds_read_b32 v21, v9 offset:4608
s_waitcnt lgkmcnt(8)
v_mfma_f32_16x16x32_bf16 v[60:63], a[108:111], v[152:155], 0
ds_read_b128 v[144:147], v1 offset:18432
v_mfma_f32_16x16x32_bf16 v[60:63], a[124:127], v[156:159], v[60:63]
ds_read_b64 v[14:15], v9 offset:1024
v_mfma_f32_16x16x32_bf16 v[56:59], a[120:123], v[156:159], 0
ds_read_b32 v22, v9 offset:5120
v_mfma_f32_16x16x32_bf16 v[56:59], a[104:107], v[152:155], v[56:59]
ds_read_b64 v[16:17], v9 offset:1536
v_mfma_f32_16x16x32_bf16 v[52:55], a[100:103], v[152:155], 0
ds_read_b128 v[148:151], v1 offset:19456
v_mfma_f32_16x16x32_bf16 v[52:55], a[116:119], v[156:159], v[52:55]
ds_read_b32 v23, v9 offset:5632
v_mfma_f32_16x16x32_bf16 v[48:51], a[112:115], v[156:159], 0
ds_read_b64 v[18:19], v9 offset:2048
v_mfma_f32_16x16x32_bf16 v[48:51], a[96:99], v[152:155], v[48:51]
ds_read_b32 v24, v9 offset:6144
s_waitcnt lgkmcnt(14)
v_mfma_f32_16x16x32_bf16 v[64:67], a[96:99], v[160:163], 0
ds_read_b128 v[152:155], v1 offset:34816
v_mfma_f32_16x16x32_bf16 v[64:67], a[112:115], v[164:167], v[64:67]
v_mfma_f32_16x16x32_bf16 v[68:71], a[116:119], v[164:167], 0
v_mfma_f32_16x16x32_bf16 v[68:71], a[100:103], v[160:163], v[68:71]
v_mfma_f32_16x16x32_bf16 v[72:75], a[104:107], v[160:163], 0
ds_read_b128 v[156:159], v1 offset:35840
v_mfma_f32_16x16x32_bf16 v[72:75], a[120:123], v[164:167], v[72:75]
v_mfma_f32_16x16x32_bf16 v[76:79], a[124:127], v[164:167], 0
v_mfma_f32_16x16x32_bf16 v[76:79], a[108:111], v[160:163], v[76:79]
s_waitcnt lgkmcnt(13)
v_mfma_f32_16x16x32_bf16 v[44:47], a[140:143], v[168:171], v[44:47]
ds_read_b128 v[160:163], v1 offset:4096
v_mfma_f32_16x16x32_bf16 v[44:47], a[156:159], v[172:175], v[44:47]
v_mfma_f32_16x16x32_bf16 v[40:43], a[152:155], v[172:175], v[40:43]
v_mfma_f32_16x16x32_bf16 v[40:43], a[136:139], v[168:171], v[40:43]
v_mfma_f32_16x16x32_bf16 v[36:39], a[132:135], v[168:171], v[36:39]
ds_read_b128 v[164:167], v1 offset:5120
v_mfma_f32_16x16x32_bf16 v[36:39], a[148:151], v[172:175], v[36:39]
v_mfma_f32_16x16x32_bf16 v[32:35], a[144:147], v[172:175], v[32:35]
v_mfma_f32_16x16x32_bf16 v[32:35], a[128:131], v[168:171], v[32:35]
s_waitcnt vmcnt(0)
s_waitcnt lgkmcnt(7)
v_mfma_f32_16x16x32_bf16 v[48:51], a[128:131], v[144:147], v[48:51]
ds_read_b128 v[168:171], v1 offset:20480
v_mfma_f32_16x16x32_bf16 v[48:51], a[144:147], v[148:151], v[48:51]
buffer_store_dword v31, v30, s[8:11], s52 offen sc1
v_mfma_f32_16x16x32_bf16 v[52:55], a[148:151], v[148:151], v[52:55]
s_add_u32 s49, s48, 65536
v_add_f32 v10, v10, v11
v_mov_b32 v11, v20
v_mfma_f32_16x16x32_bf16 v[52:55], a[132:135], v[144:147], v[52:55]
buffer_load_dwordx4 a[0:3], v1, s[8:11], s49 offen offset:0 sc1
v_mfma_f32_16x16x32_bf16 v[56:59], a[136:139], v[144:147], v[56:59]
ds_read_b128 v[172:175], v1 offset:21504
v_add_f32 v12, v12, v13
v_mfma_f32_16x16x32_bf16 v[56:59], a[152:155], v[148:151], v[56:59]
buffer_load_dwordx4 a[4:7], v1, s[8:11], s49 offen offset:1024 sc1
v_mfma_f32_16x16x32_bf16 v[60:63], a[156:159], v[148:151], v[60:63]
v_mov_b32 v13, v21
v_add_f32 v14, v14, v15
v_mfma_f32_16x16x32_bf16 v[60:63], a[140:143], v[144:147], v[60:63]
buffer_load_dwordx4 a[8:11], v1, s[8:11], s49 offen offset:2048 sc1
s_waitcnt lgkmcnt(4)
v_mfma_f32_16x16x32_bf16 v[76:79], a[140:143], v[152:155], v[76:79]
ds_read_b128 v[144:147], v1 offset:36864
v_mov_b32 v15, v22
v_mfma_f32_16x16x32_bf16 v[76:79], a[156:159], v[156:159], v[76:79]
buffer_load_dwordx4 a[12:15], v1, s[8:11], s49 offen offset:3072 sc1
v_mfma_f32_16x16x32_bf16 v[72:75], a[152:155], v[156:159], v[72:75]
s_add_u32 s49, s48, 69632
v_add_f32 v16, v16, v17
v_mov_b32 v17, v23
v_mfma_f32_16x16x32_bf16 v[72:75], a[136:139], v[152:155], v[72:75]
buffer_load_dwordx4 a[16:19], v1, s[8:11], s49 offen offset:0 sc1
v_mfma_f32_16x16x32_bf16 v[68:71], a[132:135], v[152:155], v[68:71]
ds_read_b128 v[148:151], v1 offset:37888
v_add_f32 v18, v18, v19
v_mfma_f32_16x16x32_bf16 v[68:71], a[148:151], v[156:159], v[68:71]
buffer_load_dwordx4 a[20:23], v1, s[8:11], s49 offen offset:1024 sc1
v_mfma_f32_16x16x32_bf16 v[64:67], a[144:147], v[156:159], v[64:67]
v_mov_b32 v19, v24
v_add_u32 v2, 0x10000, v1
v_mfma_f32_16x16x32_bf16 v[64:67], a[128:131], v[152:155], v[64:67]
buffer_load_dwordx4 a[24:27], v1, s[8:11], s49 offen offset:2048 sc1
s_waitcnt lgkmcnt(4)
v_mfma_f32_16x16x32_bf16 v[32:35], a[160:163], v[160:163], v[32:35]
ds_read_b128 v[152:155], v1 offset:6144
v_add_u32 v3, 81920, v1
v_mfma_f32_16x16x32_bf16 v[32:35], a[176:179], v[164:167], v[32:35]
buffer_load_dwordx4 a[28:31], v1, s[8:11], s49 offen offset:3072 sc1
v_mfma_f32_16x16x32_bf16 v[36:39], a[180:183], v[164:167], v[36:39]
s_add_u32 s49, s48, 98304
v_bfe_u32 v8, v0, 2, 2
v_sub_u32 v8, 0, v8
v_mfma_f32_16x16x32_bf16 v[36:39], a[164:167], v[160:163], v[36:39]
buffer_load_dwordx4 a[32:35], v1, s[8:11], s49 offen offset:0 sc1
v_mfma_f32_16x16x32_bf16 v[40:43], a[168:171], v[160:163], v[40:43]
ds_read_b128 v[156:159], v1 offset:7168
v_lshrrev_b32 v6, 4, v0
v_mfma_f32_16x16x32_bf16 v[40:43], a[184:187], v[164:167], v[40:43]
buffer_load_dwordx4 a[36:39], v1, s[8:11], s49 offen offset:1024 sc1
v_mfma_f32_16x16x32_bf16 v[44:47], a[188:191], v[164:167], v[44:47]
v_xor_b32 v8, v8, v6
v_and_b32 v8, 3, v8
v_mfma_f32_16x16x32_bf16 v[44:47], a[172:175], v[160:163], v[44:47]
buffer_load_dwordx4 a[40:43], v1, s[8:11], s49 offen offset:2048 sc1
s_waitcnt lgkmcnt(4)
v_mfma_f32_16x16x32_bf16 v[60:63], a[172:175], v[168:171], v[60:63]
ds_read_b128 v[160:163], v1 offset:22528
v_and_b32 v6, 15, v0
v_mfma_f32_16x16x32_bf16 v[60:63], a[188:191], v[172:175], v[60:63]
buffer_load_dwordx4 a[44:47], v1, s[8:11], s49 offen offset:3072 sc1
v_mfma_f32_16x16x32_bf16 v[56:59], a[184:187], v[172:175], v[56:59]
s_add_u32 s49, s48, 102400
v_lshl_add_u32 v6, v6, 2, v8
v_lshlrev_b32 v6, 4, v6
v_mfma_f32_16x16x32_bf16 v[56:59], a[168:171], v[168:171], v[56:59]
buffer_load_dwordx4 a[48:51], v1, s[8:11], s49 offen offset:0 sc1
v_mfma_f32_16x16x32_bf16 v[52:55], a[164:167], v[168:171], v[52:55]
ds_read_b128 v[164:167], v1 offset:23552
v_add_u32 v6, s58, v6
v_mfma_f32_16x16x32_bf16 v[52:55], a[180:183], v[172:175], v[52:55]
buffer_load_dwordx4 a[52:55], v1, s[8:11], s49 offen offset:1024 sc1
v_mfma_f32_16x16x32_bf16 v[48:51], a[176:179], v[172:175], v[48:51]
v_add_u32 v8, s58, v1
v_add_u32 v4, 0x10000, v8
v_mfma_f32_16x16x32_bf16 v[48:51], a[160:163], v[168:171], v[48:51]
buffer_load_dwordx4 a[56:59], v1, s[8:11], s49 offen offset:2048 sc1
s_waitcnt lgkmcnt(4)
v_mfma_f32_16x16x32_bf16 v[64:67], a[160:163], v[144:147], v[64:67]
ds_read_b128 v[168:171], v1 offset:38912
v_lshrrev_b32 v7, 4, v0
v_mfma_f32_16x16x32_bf16 v[64:67], a[176:179], v[148:151], v[64:67]
buffer_load_dwordx4 a[60:63], v1, s[8:11], s49 offen offset:3072 sc1
v_mfma_f32_16x16x32_bf16 v[68:71], a[180:183], v[148:151], v[68:71]
s_add_u32 s49, s48, 106496
v_sub_u32 v7, 0, v7
v_xor_b32 v7, v7, v0
v_mfma_f32_16x16x32_bf16 v[68:71], a[164:167], v[144:147], v[68:71]
buffer_load_dwordx4 a[64:67], v1, s[8:11], s49 offen offset:0 sc1
v_mfma_f32_16x16x32_bf16 v[72:75], a[168:171], v[144:147], v[72:75]
ds_read_b128 v[172:175], v1 offset:39936
v_and_b32 v7, 3, v7
v_mfma_f32_16x16x32_bf16 v[72:75], a[184:187], v[148:151], v[72:75]
buffer_load_dwordx4 a[68:71], v1, s[8:11], s49 offen offset:1024 sc1
v_mfma_f32_16x16x32_bf16 v[76:79], a[188:191], v[148:151], v[76:79]
v_lshlrev_b32 v7, 4, v7
v_lshrrev_b32 v9, 2, v0
v_mfma_f32_16x16x32_bf16 v[76:79], a[172:175], v[144:147], v[76:79]
buffer_load_dwordx4 a[72:75], v1, s[8:11], s49 offen offset:2048 sc1
s_waitcnt lgkmcnt(4)
v_mfma_f32_16x16x32_bf16 v[44:47], a[204:207], v[152:155], v[44:47]
ds_read_b128 v[144:147], v1 offset:8192
v_lshl_add_u32 v7, v9, 10, v7
v_mfma_f32_16x16x32_bf16 v[44:47], a[220:223], v[156:159], v[44:47]
buffer_load_dwordx4 a[76:79], v1, s[8:11], s49 offen offset:3072 sc1
v_mfma_f32_16x16x32_bf16 v[40:43], a[216:219], v[156:159], v[40:43]
s_add_u32 s49, s48, 110592
v_and_b32 v252, 15, v0
v_lshlrev_b32 v252, 3, v252
v_mfma_f32_16x16x32_bf16 v[40:43], a[200:203], v[152:155], v[40:43]
buffer_load_dwordx4 a[80:83], v1, s[8:11], s49 offen offset:0 sc1
v_mfma_f32_16x16x32_bf16 v[36:39], a[196:199], v[152:155], v[36:39]
ds_read_b128 v[148:151], v1 offset:9216
v_add_u32 v252, 155648, v252
s_mul_i32 s35, s25, 4415120
v_mfma_f32_16x16x32_bf16 v[36:39], a[212:215], v[156:159], v[36:39]
buffer_load_dwordx4 a[84:87], v1, s[8:11], s49 offen offset:1024 sc1
v_mfma_f32_16x16x32_bf16 v[32:35], a[208:211], v[156:159], v[32:35]
s_add_u32 s36, s35, 4359931
s_lshr_b32 s35, s35, 22
s_lshr_b32 s36, s36, 22
v_and_b32 v250, 3, v0
v_add_u32 v250, s35, v250
v_mfma_f32_16x16x32_bf16 v[32:35], a[192:195], v[152:155], v[32:35]
buffer_load_dwordx4 a[88:91], v1, s[8:11], s49 offen offset:2048 sc1
s_waitcnt lgkmcnt(4)
v_mfma_f32_16x16x32_bf16 v[48:51], a[192:195], v[160:163], v[48:51]
ds_read_b128 v[152:155], v1 offset:24576
v_min_u32 v250, s36, v250
s_mul_i32 s35, s23, 6784
v_mfma_f32_16x16x32_bf16 v[48:51], a[208:211], v[164:167], v[48:51]
buffer_load_dwordx4 a[92:95], v1, s[8:11], s49 offen offset:3072 sc1
v_mfma_f32_16x16x32_bf16 v[52:55], a[212:215], v[164:167], v[52:55]
s_add_u32 s35, s35, 0x340c800
v_lshl_add_u32 v250, v250, 7, s35
s_mul_i32 s57, s25, 80
v_and_b32 v236, 15, v0
v_mfma_f32_16x16x32_bf16 v[52:55], a[196:199], v[160:163], v[52:55]
v_add_u32 v236, s57, v236
v_lshrrev_b32 v237, 4, v0
v_mfma_f32_16x16x32_bf16 v[56:59], a[200:203], v[160:163], v[56:59]
ds_read_b128 v[156:159], v1 offset:25600
v_lshlrev_b32 v237, 8, v237
v_mfma_f32_16x16x32_bf16 v[56:59], a[216:219], v[164:167], v[56:59]
v_add_u32 v238, 0, v236
v_mul_u32_u24 v239, 0xd795, v238
v_mfma_f32_16x16x32_bf16 v[60:63], a[220:223], v[164:167], v[60:63]
v_lshrrev_b32 v239, 22, v239
v_lshl_add_u32 v238, v239, 2, v238
v_mfma_f32_16x16x32_bf16 v[60:63], a[204:207], v[160:163], v[60:63]
v_and_b32 v239, 15, v238
v_lshl_add_u32 v239, v239, 4, v237
s_waitcnt lgkmcnt(4)
v_mfma_f32_16x16x32_bf16 v[76:79], a[204:207], v[168:171], v[76:79]
ds_read_b128 v[160:163], v1 offset:40960
v_lshrrev_b32 v238, 4, v238
v_mfma_f32_16x16x32_bf16 v[76:79], a[220:223], v[172:175], v[76:79]
v_lshl_add_u32 v249, v238, 14, v239
v_add_u32 v238, 16, v236
v_mfma_f32_16x16x32_bf16 v[72:75], a[216:219], v[172:175], v[72:75]
v_mul_u32_u24 v239, 0xd795, v238
v_lshrrev_b32 v239, 22, v239
v_mfma_f32_16x16x32_bf16 v[72:75], a[200:203], v[168:171], v[72:75]
v_lshl_add_u32 v238, v239, 2, v238
v_and_b32 v239, 15, v238
v_mfma_f32_16x16x32_bf16 v[68:71], a[196:199], v[168:171], v[68:71]
ds_read_b128 v[164:167], v1 offset:41984
v_lshl_add_u32 v239, v239, 4, v237
v_mfma_f32_16x16x32_bf16 v[68:71], a[212:215], v[172:175], v[68:71]
v_lshrrev_b32 v238, 4, v238
v_lshl_add_u32 v251, v238, 14, v239
v_mfma_f32_16x16x32_bf16 v[64:67], a[208:211], v[172:175], v[64:67]
v_add_u32 v238, 32, v236
v_mul_u32_u24 v239, 0xd795, v238
v_mfma_f32_16x16x32_bf16 v[64:67], a[192:195], v[168:171], v[64:67]
v_lshrrev_b32 v239, 22, v239
v_lshl_add_u32 v238, v239, 2, v238
s_waitcnt vmcnt(16) lgkmcnt(4)
v_mfma_f32_16x16x32_bf16 v[32:35], a[0:3], v[144:147], v[32:35]
ds_read_b128 v[168:171], v1 offset:10240
v_and_b32 v239, 15, v238
v_mfma_f32_16x16x32_bf16 v[32:35], a[16:19], v[148:151], v[32:35]
v_lshl_add_u32 v239, v239, 4, v237
v_lshrrev_b32 v238, 4, v238
v_mfma_f32_16x16x32_bf16 v[36:39], a[20:23], v[148:151], v[36:39]
v_lshl_add_u32 v253, v238, 14, v239
v_add_u32 v238, 48, v236
v_mfma_f32_16x16x32_bf16 v[36:39], a[4:7], v[144:147], v[36:39]
v_mul_u32_u24 v239, 0xd795, v238
v_lshrrev_b32 v239, 22, v239
v_mfma_f32_16x16x32_bf16 v[40:43], a[8:11], v[144:147], v[40:43]
ds_read_b128 v[172:175], v1 offset:11264
v_lshl_add_u32 v238, v239, 2, v238
v_mfma_f32_16x16x32_bf16 v[40:43], a[24:27], v[148:151], v[40:43]
v_and_b32 v239, 15, v238
v_lshl_add_u32 v239, v239, 4, v237
v_mfma_f32_16x16x32_bf16 v[44:47], a[28:31], v[148:151], v[44:47]
v_lshrrev_b32 v238, 4, v238
v_lshl_add_u32 v254, v238, 14, v239
v_mfma_f32_16x16x32_bf16 v[44:47], a[12:15], v[144:147], v[44:47]
v_add_u32 v238, 64, v236
v_mul_u32_u24 v239, 0xd795, v238
s_waitcnt lgkmcnt(4)
v_mfma_f32_16x16x32_bf16 v[60:63], a[12:15], v[152:155], v[60:63]
ds_read_b128 v[144:147], v1 offset:26624
v_lshrrev_b32 v239, 22, v239
v_mfma_f32_16x16x32_bf16 v[60:63], a[28:31], v[156:159], v[60:63]
v_lshl_add_u32 v238, v239, 2, v238
v_and_b32 v239, 15, v238
v_mfma_f32_16x16x32_bf16 v[56:59], a[24:27], v[156:159], v[56:59]
v_lshl_add_u32 v239, v239, 4, v237
v_lshrrev_b32 v238, 4, v238
v_mfma_f32_16x16x32_bf16 v[56:59], a[8:11], v[152:155], v[56:59]
v_lshl_add_u32 v255, v238, 14, v239
v_mfma_f32_16x16x32_bf16 v[52:55], a[4:7], v[152:155], v[52:55]
ds_read_b128 v[148:151], v1 offset:27648
v_mfma_f32_16x16x32_bf16 v[52:55], a[20:23], v[156:159], v[52:55]
v_mfma_f32_16x16x32_bf16 v[48:51], a[16:19], v[156:159], v[48:51]
v_mfma_f32_16x16x32_bf16 v[48:51], a[0:3], v[152:155], v[48:51]
s_waitcnt lgkmcnt(4)
v_mfma_f32_16x16x32_bf16 v[64:67], a[0:3], v[160:163], v[64:67]
ds_read_b128 v[152:155], v1 offset:43008
v_mfma_f32_16x16x32_bf16 v[64:67], a[16:19], v[164:167], v[64:67]
v_mfma_f32_16x16x32_bf16 v[68:71], a[20:23], v[164:167], v[68:71]
v_mfma_f32_16x16x32_bf16 v[68:71], a[4:7], v[160:163], v[68:71]
v_mfma_f32_16x16x32_bf16 v[72:75], a[8:11], v[160:163], v[72:75]
ds_read_b128 v[156:159], v1 offset:44032
v_mfma_f32_16x16x32_bf16 v[72:75], a[24:27], v[164:167], v[72:75]
v_mfma_f32_16x16x32_bf16 v[76:79], a[28:31], v[164:167], v[76:79]
v_mfma_f32_16x16x32_bf16 v[76:79], a[12:15], v[160:163], v[76:79]
s_waitcnt lgkmcnt(4)
v_mfma_f32_16x16x32_bf16 v[44:47], a[236:239], v[168:171], v[44:47]
ds_read_b128 v[160:163], v1 offset:12288
v_mfma_f32_16x16x32_bf16 v[44:47], a[252:255], v[172:175], v[44:47]
v_mfma_f32_16x16x32_bf16 v[40:43], a[248:251], v[172:175], v[40:43]
v_mfma_f32_16x16x32_bf16 v[40:43], a[232:235], v[168:171], v[40:43]
v_mfma_f32_16x16x32_bf16 v[36:39], a[228:231], v[168:171], v[36:39]
ds_read_b128 v[164:167], v1 offset:13312
v_mfma_f32_16x16x32_bf16 v[36:39], a[244:247], v[172:175], v[36:39]
v_mfma_f32_16x16x32_bf16 v[32:35], a[240:243], v[172:175], v[32:35]
v_mfma_f32_16x16x32_bf16 v[32:35], a[224:227], v[168:171], v[32:35]
s_waitcnt lgkmcnt(4)
v_mfma_f32_16x16x32_bf16 v[48:51], a[224:227], v[144:147], v[48:51]
ds_read_b128 v[168:171], v1 offset:28672
v_mfma_f32_16x16x32_bf16 v[48:51], a[240:243], v[148:151], v[48:51]
v_mfma_f32_16x16x32_bf16 v[52:55], a[244:247], v[148:151], v[52:55]
v_mfma_f32_16x16x32_bf16 v[52:55], a[228:231], v[144:147], v[52:55]
v_mfma_f32_16x16x32_bf16 v[56:59], a[232:235], v[144:147], v[56:59]
ds_read_b128 v[172:175], v1 offset:29696
v_mfma_f32_16x16x32_bf16 v[56:59], a[248:251], v[148:151], v[56:59]
v_mfma_f32_16x16x32_bf16 v[60:63], a[252:255], v[148:151], v[60:63]
v_mfma_f32_16x16x32_bf16 v[60:63], a[236:239], v[144:147], v[60:63]
s_waitcnt lgkmcnt(4)
v_mfma_f32_16x16x32_bf16 v[76:79], a[236:239], v[152:155], v[76:79]
ds_read_b128 v[144:147], v1 offset:45056
v_mfma_f32_16x16x32_bf16 v[76:79], a[252:255], v[156:159], v[76:79]
v_mfma_f32_16x16x32_bf16 v[72:75], a[248:251], v[156:159], v[72:75]
v_mfma_f32_16x16x32_bf16 v[72:75], a[232:235], v[152:155], v[72:75]
v_mfma_f32_16x16x32_bf16 v[68:71], a[228:231], v[152:155], v[68:71]
ds_read_b128 v[148:151], v1 offset:46080
v_mfma_f32_16x16x32_bf16 v[68:71], a[244:247], v[156:159], v[68:71]
v_mfma_f32_16x16x32_bf16 v[64:67], a[240:243], v[156:159], v[64:67]
v_mfma_f32_16x16x32_bf16 v[64:67], a[224:227], v[152:155], v[64:67]
s_waitcnt vmcnt(8) lgkmcnt(4)
v_mfma_f32_16x16x32_bf16 v[32:35], a[32:35], v[160:163], v[32:35]
ds_read_b128 v[152:155], v1 offset:14336
v_mfma_f32_16x16x32_bf16 v[32:35], a[48:51], v[164:167], v[32:35]
v_mfma_f32_16x16x32_bf16 v[36:39], a[52:55], v[164:167], v[36:39]
v_mfma_f32_16x16x32_bf16 v[36:39], a[36:39], v[160:163], v[36:39]
v_mfma_f32_16x16x32_bf16 v[40:43], a[40:43], v[160:163], v[40:43]
ds_read_b128 v[156:159], v1 offset:15360
v_mfma_f32_16x16x32_bf16 v[40:43], a[56:59], v[164:167], v[40:43]
v_mfma_f32_16x16x32_bf16 v[44:47], a[60:63], v[164:167], v[44:47]
v_mfma_f32_16x16x32_bf16 v[44:47], a[44:47], v[160:163], v[44:47]
s_waitcnt lgkmcnt(4)
v_mfma_f32_16x16x32_bf16 v[60:63], a[44:47], v[168:171], v[60:63]
ds_read_b128 v[160:163], v1 offset:30720
v_mfma_f32_16x16x32_bf16 v[60:63], a[60:63], v[172:175], v[60:63]
v_mfma_f32_16x16x32_bf16 v[56:59], a[56:59], v[172:175], v[56:59]
v_mfma_f32_16x16x32_bf16 v[56:59], a[40:43], v[168:171], v[56:59]
v_mfma_f32_16x16x32_bf16 v[52:55], a[36:39], v[168:171], v[52:55]
ds_read_b128 v[164:167], v1 offset:31744
v_mfma_f32_16x16x32_bf16 v[52:55], a[52:55], v[172:175], v[52:55]
v_mfma_f32_16x16x32_bf16 v[48:51], a[48:51], v[172:175], v[48:51]
v_mfma_f32_16x16x32_bf16 v[48:51], a[32:35], v[168:171], v[48:51]
s_waitcnt lgkmcnt(4)
v_mfma_f32_16x16x32_bf16 v[64:67], a[32:35], v[144:147], v[64:67]
ds_read_b128 v[168:171], v1 offset:47104
v_mfma_f32_16x16x32_bf16 v[64:67], a[48:51], v[148:151], v[64:67]
v_mfma_f32_16x16x32_bf16 v[68:71], a[52:55], v[148:151], v[68:71]
v_mfma_f32_16x16x32_bf16 v[68:71], a[36:39], v[144:147], v[68:71]
v_mfma_f32_16x16x32_bf16 v[72:75], a[40:43], v[144:147], v[72:75]
ds_read_b128 v[172:175], v1 offset:48128
v_mfma_f32_16x16x32_bf16 v[72:75], a[56:59], v[148:151], v[72:75]
v_mfma_f32_16x16x32_bf16 v[76:79], a[60:63], v[148:151], v[76:79]
v_mfma_f32_16x16x32_bf16 v[76:79], a[44:47], v[144:147], v[76:79]
s_waitcnt vmcnt(0) lgkmcnt(4)
v_mfma_f32_16x16x32_bf16 v[44:47], a[76:79], v[152:155], v[44:47]
v_mfma_f32_16x16x32_bf16 v[44:47], a[92:95], v[156:159], v[44:47]
v_mfma_f32_16x16x32_bf16 v[40:43], a[88:91], v[156:159], v[40:43]
v_mfma_f32_16x16x32_bf16 v[40:43], a[72:75], v[152:155], v[40:43]
v_mfma_f32_16x16x32_bf16 v[36:39], a[68:71], v[152:155], v[36:39]
v_mfma_f32_16x16x32_bf16 v[36:39], a[84:87], v[156:159], v[36:39]
v_mfma_f32_16x16x32_bf16 v[32:35], a[80:83], v[156:159], v[32:35]
v_mfma_f32_16x16x32_bf16 v[32:35], a[64:67], v[152:155], v[32:35]
s_waitcnt lgkmcnt(2)
v_mfma_f32_16x16x32_bf16 v[48:51], a[64:67], v[160:163], v[48:51]
v_mfma_f32_16x16x32_bf16 v[48:51], a[80:83], v[164:167], v[48:51]
v_mfma_f32_16x16x32_bf16 v[52:55], a[84:87], v[164:167], v[52:55]
v_mfma_f32_16x16x32_bf16 v[52:55], a[68:71], v[160:163], v[52:55]
v_mfma_f32_16x16x32_bf16 v[56:59], a[72:75], v[160:163], v[56:59]
v_mfma_f32_16x16x32_bf16 v[56:59], a[88:91], v[164:167], v[56:59]
v_mfma_f32_16x16x32_bf16 v[60:63], a[92:95], v[164:167], v[60:63]
v_mfma_f32_16x16x32_bf16 v[60:63], a[76:79], v[160:163], v[60:63]
s_waitcnt lgkmcnt(0)
v_mfma_f32_16x16x32_bf16 v[76:79], a[76:79], v[168:171], v[76:79]
v_mfma_f32_16x16x32_bf16 v[76:79], a[92:95], v[172:175], v[76:79]
v_mfma_f32_16x16x32_bf16 v[72:75], a[88:91], v[172:175], v[72:75]
v_mfma_f32_16x16x32_bf16 v[72:75], a[72:75], v[168:171], v[72:75]
v_mfma_f32_16x16x32_bf16 v[68:71], a[68:71], v[168:171], v[68:71]
v_mfma_f32_16x16x32_bf16 v[68:71], a[84:87], v[172:175], v[68:71]
v_mfma_f32_16x16x32_bf16 v[64:67], a[80:83], v[172:175], v[64:67]
v_mfma_f32_16x16x32_bf16 v[64:67], a[64:67], v[168:171], v[64:67]
L_tail2:
s_add_u32 s48, s45, s58
s_waitcnt vmcnt(8)
s_barrier
ds_read_b128 v[144:147], v3 offset:0
ds_read_b128 v[148:151], v3 offset:1024
ds_read_b128 v[152:155], v3 offset:2048
ds_read_b128 v[156:159], v3 offset:3072
ds_read_b128 v[160:163], v3 offset:4096
ds_read_b128 v[164:167], v3 offset:5120
s_waitcnt lgkmcnt(4)
v_mfma_f32_16x16x32_bf16 v[124:127], a[108:111], v[144:147], 0
ds_read_b128 v[168:171], v3 offset:6144
v_mfma_f32_16x16x32_bf16 v[124:127], a[124:127], v[148:151], v[124:127]
s_add_u32 s34, s48, 49152
v_mfma_f32_16x16x32_bf16 v[120:123], a[120:123], v[148:151], 0
buffer_load_dwordx4 v[80:83], v1, s[8:11], s34 offen offset:0 sc1
v_mfma_f32_16x16x32_bf16 v[120:123], a[104:107], v[144:147], v[120:123]
ds_read_b64 v[216:217], v252 offset:0
v_mfma_f32_16x16x32_bf16 v[116:119], a[100:103], v[144:147], 0
ds_read_b128 v[172:175], v3 offset:7168
v_mfma_f32_16x16x32_bf16 v[116:119], a[116:119], v[148:151], v[116:119]
ds_read_b64 v[218:219], v252 offset:128
v_mfma_f32_16x16x32_bf16 v[112:115], a[112:115], v[148:151], 0
ds_read_b64 v[220:221], v252 offset:256
v_mfma_f32_16x16x32_bf16 v[112:115], a[96:99], v[144:147], v[112:115]
ds_read_b64 v[222:223], v252 offset:384
s_waitcnt lgkmcnt(8)
v_mfma_f32_16x16x32_bf16 v[112:115], a[128:131], v[152:155], v[112:115]
ds_read_b128 v[144:147], v3 offset:8192
v_mfma_f32_16x16x32_bf16 v[112:115], a[144:147], v[156:159], v[112:115]
buffer_load_dwordx4 v[84:87], v1, s[8:11], s34 offen offset:1024 sc1
v_mfma_f32_16x16x32_bf16 v[116:119], a[148:151], v[156:159], v[116:119]
ds_read_b64 v[224:225], v252 offset:512
v_mfma_f32_16x16x32_bf16 v[116:119], a[132:135], v[152:155], v[116:119]
s_waitcnt lgkmcnt(6)
v_min_f32 v248, v11, v217
v_sub_f32 v11, v248, v11
v_mfma_f32_16x16x32_bf16 v[120:123], a[136:139], v[152:155], v[120:123]
ds_read_b128 v[148:151], v3 offset:9216
v_sub_f32 v217, v248, v217
v_mfma_f32_16x16x32_bf16 v[120:123], a[152:155], v[156:159], v[120:123]
v_exp_f32 v11, v11
v_mfma_f32_16x16x32_bf16 v[124:127], a[156:159], v[156:159], v[124:127]
v_exp_f32 v217, v217
v_mul_f32 v10, v10, v11
v_mfma_f32_16x16x32_bf16 v[124:127], a[140:143], v[152:155], v[124:127]
buffer_load_dwordx4 v[88:91], v1, s[8:11], s34 offen offset:2048 sc1
v_mfma_f32_16x16x32_bf16 v[124:127], a[172:175], v[160:163], v[124:127]
ds_read_b128 v[152:155], v3 offset:10240
v_fmac_f32 v10, v216, v217
v_mfma_f32_16x16x32_bf16 v[124:127], a[188:191], v[164:167], v[124:127]
v_rcp_f32 v10, v10
v_mfma_f32_16x16x32_bf16 v[120:123], a[184:187], v[164:167], v[120:123]
s_nop 0
v_mul_f32 v20, v11, v10
v_mul_f32 v21, v217, v10
v_mfma_f32_16x16x32_bf16 v[120:123], a[168:171], v[160:163], v[120:123]
s_waitcnt lgkmcnt(6)
v_min_f32 v248, v13, v219
v_sub_f32 v13, v248, v13
v_mfma_f32_16x16x32_bf16 v[116:119], a[164:167], v[160:163], v[116:119]
ds_read_b128 v[156:159], v3 offset:11264
v_sub_f32 v219, v248, v219
v_mfma_f32_16x16x32_bf16 v[116:119], a[180:183], v[164:167], v[116:119]
buffer_load_dwordx4 v[92:95], v1, s[8:11], s34 offen offset:3072 sc1
v_mfma_f32_16x16x32_bf16 v[112:115], a[176:179], v[164:167], v[112:115]
v_exp_f32 v13, v13
v_mfma_f32_16x16x32_bf16 v[112:115], a[160:163], v[160:163], v[112:115]
v_exp_f32 v219, v219
v_mul_f32 v12, v12, v13
v_mfma_f32_16x16x32_bf16 v[112:115], a[192:195], v[168:171], v[112:115]
ds_read_b128 v[160:163], v3 offset:12288
v_fmac_f32 v12, v218, v219
v_mfma_f32_16x16x32_bf16 v[112:115], a[208:211], v[172:175], v[112:115]
v_rcp_f32 v12, v12
s_nop 0
v_mfma_f32_16x16x32_bf16 v[116:119], a[212:215], v[172:175], v[116:119]
s_add_u32 m0, s58, 114688
s_add_u32 s34, s48, 32768
v_mul_f32 v22, v13, v12
v_mfma_f32_16x16x32_bf16 v[116:119], a[196:199], v[168:171], v[116:119]
buffer_load_dwordx4 v1, s[8:11], s34 offen offset:0 sc1 lds
v_mfma_f32_16x16x32_bf16 v[120:123], a[200:203], v[168:171], v[120:123]
ds_read_b128 v[164:167], v3 offset:13312
v_mul_f32 v23, v219, v12
v_mfma_f32_16x16x32_bf16 v[120:123], a[216:219], v[172:175], v[120:123]
s_waitcnt lgkmcnt(8)
v_min_f32 v248, v15, v221
v_sub_f32 v15, v248, v15
v_sub_f32 v221, v248, v221
v_mfma_f32_16x16x32_bf16 v[124:127], a[220:223], v[172:175], v[124:127]
v_exp_f32 v15, v15
v_mfma_f32_16x16x32_bf16 v[124:127], a[204:207], v[168:171], v[124:127]
v_exp_f32 v221, v221
v_mul_f32 v14, v14, v15
s_waitcnt lgkmcnt(4)
v_mfma_f32_16x16x32_bf16 v[124:127], a[12:15], v[144:147], v[124:127]
ds_read_b128 v[168:171], v3 offset:14336
v_fmac_f32 v14, v220, v221
v_mfma_f32_16x16x32_bf16 v[124:127], a[28:31], v[148:151], v[124:127]
buffer_load_dwordx4 v1, s[8:11], s34 offen offset:1024 sc1 lds
v_mfma_f32_16x16x32_bf16 v[120:123], a[24:27], v[148:151], v[120:123]
v_rcp_f32 v14, v14
v_mfma_f32_16x16x32_bf16 v[120:123], a[8:11], v[144:147], v[120:123]
s_nop 0
v_mul_f32 v24, v15, v14
v_mul_f32 v25, v221, v14
v_mfma_f32_16x16x32_bf16 v[116:119], a[4:7], v[144:147], v[116:119]
ds_read_b128 v[172:175], v3 offset:15360
v_mfma_f32_16x16x32_bf16 v[116:119], a[20:23], v[148:151], v[116:119]
v_min_f32 v248, v17, v223
v_sub_f32 v17, v248, v17
v_mfma_f32_16x16x32_bf16 v[112:115], a[16:19], v[148:151], v[112:115]
s_waitcnt vmcnt(6)
s_barrier
v_mfma_f32_16x16x32_bf16 v[112:115], a[0:3], v[144:147], v[112:115]
buffer_load_dwordx4 v1, s[8:11], s34 offen offset:2048 sc1 lds
s_waitcnt lgkmcnt(4)
v_mfma_f32_16x16x32_bf16 v[112:115], a[224:227], v[152:155], v[112:115]
ds_read_b128 v[144:147], v3 offset:16384
v_sub_f32 v223, v248, v223
v_mfma_f32_16x16x32_bf16 v[112:115], a[240:243], v[156:159], v[112:115]
v_exp_f32 v17, v17
v_mfma_f32_16x16x32_bf16 v[116:119], a[244:247], v[156:159], v[116:119]
v_exp_f32 v223, v223
v_mfma_f32_16x16x32_bf16 v[116:119], a[228:231], v[152:155], v[116:119]
v_mul_f32 v16, v16, v17
v_fmac_f32 v16, v222, v223
v_mfma_f32_16x16x32_bf16 v[120:123], a[232:235], v[152:155], v[120:123]
ds_read_b128 v[148:151], v3 offset:17408
v_rcp_f32 v16, v16
v_mfma_f32_16x16x32_bf16 v[120:123], a[248:251], v[156:159], v[120:123]
buffer_load_dwordx4 v1, s[8:11], s34 offen offset:3072 sc1 lds
v_mfma_f32_16x16x32_bf16 v[124:127], a[252:255], v[156:159], v[124:127]
s_nop 0
v_mul_f32 v26, v17, v16
v_mul_f32 v27, v223, v16
v_mfma_f32_16x16x32_bf16 v[124:127], a[236:239], v[152:155], v[124:127]
v_min_f32 v248, v19, v225
v_sub_f32 v19, v248, v19
s_waitcnt lgkmcnt(4)
v_mfma_f32_16x16x32_bf16 v[124:127], a[44:47], v[160:163], v[124:127]
ds_read_b128 v[152:155], v3 offset:18432
v_sub_f32 v225, v248, v225
v_mfma_f32_16x16x32_bf16 v[124:127], a[60:63], v[164:167], v[124:127]
v_exp_f32 v19, v19
v_mfma_f32_16x16x32_bf16 v[120:123], a[56:59], v[164:167], v[120:123]
s_add_u32 s34, s48, 65536
v_exp_f32 v225, v225
v_mfma_f32_16x16x32_bf16 v[120:123], a[40:43], v[160:163], v[120:123]
buffer_load_dwordx4 v[96:99], v1, s[8:11], s34 offen offset:0 sc1
v_mfma_f32_16x16x32_bf16 v[116:119], a[36:39], v[160:163], v[116:119]
ds_read_b128 v[156:159], v3 offset:19456
v_mul_f32 v18, v18, v19
v_mfma_f32_16x16x32_bf16 v[116:119], a[52:55], v[164:167], v[116:119]
v_fmac_f32 v18, v224, v225
v_mfma_f32_16x16x32_bf16 v[112:115], a[48:51], v[164:167], v[112:115]
v_rcp_f32 v18, v18
v_mfma_f32_16x16x32_bf16 v[112:115], a[32:35], v[160:163], v[112:115]
s_nop 0
v_mul_f32 v28, v19, v18
v_mul_f32 v29, v225, v18
s_waitcnt lgkmcnt(4)
v_mfma_f32_16x16x32_bf16 v[112:115], a[64:67], v[168:171], v[112:115]
ds_read_b128 v[160:163], v3 offset:20480
ds_read_b128 v[240:243], v8 offset:49152
v_mfma_f32_16x16x32_bf16 v[112:115], a[80:83], v[172:175], v[112:115]
buffer_load_dwordx4 v[100:103], v1, s[8:11], s34 offen offset:1024 sc1
v_mfma_f32_16x16x32_bf16 v[116:119], a[84:87], v[172:175], v[116:119]
ds_read_b128 v[244:247], v8 offset:50176
v_mfma_f32_16x16x32_bf16 v[116:119], a[68:71], v[168:171], v[116:119]
s_waitcnt vmcnt(9)
v_lshlrev_b32 v224, 16, v80
v_and_b32 v225, s59, v80
v_mfma_f32_16x16x32_bf16 v[120:123], a[72:75], v[168:171], v[120:123]
ds_read_b128 v[164:167], v3 offset:21504
v_lshlrev_b32 v226, 16, v81
v_mfma_f32_16x16x32_bf16 v[120:123], a[88:91], v[172:175], v[120:123]
v_and_b32 v227, s59, v81
v_lshlrev_b32 v228, 16, v82
v_mfma_f32_16x16x32_bf16 v[124:127], a[92:95], v[172:175], v[124:127]
v_and_b32 v229, s59, v82
v_lshlrev_b32 v230, 16, v83
v_mfma_f32_16x16x32_bf16 v[124:127], a[76:79], v[168:171], v[124:127]
buffer_load_dwordx4 v[104:107], v1, s[8:11], s34 offen offset:2048 sc1
s_waitcnt lgkmcnt(6)
v_mfma_f32_16x16x32_bf16 v[140:143], a[108:111], v[144:147], 0
ds_read_b128 v[168:171], v3 offset:22528
v_and_b32 v231, s59, v83
v_mfma_f32_16x16x32_bf16 v[140:143], a[124:127], v[148:151], v[140:143]
s_waitcnt lgkmcnt(3)
v_lshlrev_b32 v216, 16, v240
v_and_b32 v217, s59, v240
v_mfma_f32_16x16x32_bf16 v[136:139], a[120:123], v[148:151], 0
v_lshlrev_b32 v218, 16, v241
v_and_b32 v219, s59, v241
v_mfma_f32_16x16x32_bf16 v[136:139], a[104:107], v[144:147], v[136:139]
v_lshlrev_b32 v220, 16, v242
v_and_b32 v221, s59, v242
v_lshlrev_b32 v222, 16, v243
v_and_b32 v223, s59, v243
v_pk_mul_f32 v[224:225], v[224:225], v[26:27] op_sel:[0,1] op_sel_hi:[1,1]
v_pk_mul_f32 v[226:227], v[226:227], v[26:27] op_sel:[0,1] op_sel_hi:[1,1]
v_pk_mul_f32 v[228:229], v[228:229], v[26:27] op_sel:[0,1] op_sel_hi:[1,1]
v_pk_mul_f32 v[230:231], v[230:231], v[26:27] op_sel:[0,1] op_sel_hi:[1,1]
v_pk_fma_f32 v[216:217], v[216:217], v[26:27], v[224:225] op_sel_hi:[1,0,1]
v_pk_fma_f32 v[218:219], v[218:219], v[26:27], v[226:227] op_sel_hi:[1,0,1]
v_pk_fma_f32 v[220:221], v[220:221], v[26:27], v[228:229] op_sel_hi:[1,0,1]
v_pk_fma_f32 v[222:223], v[222:223], v[26:27], v[230:231] op_sel_hi:[1,0,1]
v_mfma_f32_16x16x32_bf16 v[132:135], a[100:103], v[144:147], 0
ds_read_b128 v[172:175], v3 offset:23552
v_mfma_f32_16x16x32_bf16 v[132:135], a[116:119], v[148:151], v[132:135]
buffer_load_dwordx4 v[108:111], v1, s[8:11], s34 offen offset:3072 sc1
v_mfma_f32_16x16x32_bf16 v[128:131], a[112:115], v[148:151], 0
ds_read_b128 v[240:243], v8 offset:51200
v_cvt_pk_bf16_f32 v232, v216, v217
v_mfma_f32_16x16x32_bf16 v[128:131], a[96:99], v[144:147], v[128:131]
v_cvt_pk_bf16_f32 v233, v218, v219
v_cvt_pk_bf16_f32 v234, v220, v221
v_mfma_f32_16x16x32_bf16 v[128:131], a[128:131], v[152:155], v[128:131]
ds_read_b128 v[144:147], v3 offset:24576
v_cvt_pk_bf16_f32 v235, v222, v223
v_mfma_f32_16x16x32_bf16 v[128:131], a[144:147], v[156:159], v[128:131]
ds_write_b128 v8, v[232:235] offset:49152
v_mfma_f32_16x16x32_bf16 v[132:135], a[148:151], v[156:159], v[132:135]
s_waitcnt vmcnt(10)
v_lshlrev_b32 v224, 16, v84
v_and_b32 v225, s59, v84
v_mfma_f32_16x16x32_bf16 v[132:135], a[132:135], v[152:155], v[132:135]
v_lshlrev_b32 v226, 16, v85
v_and_b32 v227, s59, v85
v_mfma_f32_16x16x32_bf16 v[136:139], a[136:139], v[152:155], v[136:139]
ds_read_b128 v[148:151], v3 offset:25600
v_lshlrev_b32 v228, 16, v86
v_mfma_f32_16x16x32_bf16 v[136:139], a[152:155], v[156:159], v[136:139]
v_and_b32 v229, s59, v86
v_lshlrev_b32 v230, 16, v87
v_mfma_f32_16x16x32_bf16 v[140:143], a[156:159], v[156:159], v[140:143]
v_and_b32 v231, s59, v87
v_mfma_f32_16x16x32_bf16 v[140:143], a[140:143], v[152:155], v[140:143]
s_waitcnt lgkmcnt(7)
v_lshlrev_b32 v216, 16, v244
v_and_b32 v217, s59, v244
s_waitcnt lgkmcnt(6)
v_mfma_f32_16x16x32_bf16 v[140:143], a[172:175], v[160:163], v[140:143]
ds_read_b128 v[152:155], v3 offset:26624
v_lshlrev_b32 v218, 16, v245
v_mfma_f32_16x16x32_bf16 v[140:143], a[188:191], v[164:167], v[140:143]
v_and_b32 v219, s59, v245
v_lshlrev_b32 v220, 16, v246
v_and_b32 v221, s59, v246
v_lshlrev_b32 v222, 16, v247
v_and_b32 v223, s59, v247
v_pk_mul_f32 v[224:225], v[224:225], v[26:27] op_sel:[0,1] op_sel_hi:[1,1]
v_pk_mul_f32 v[226:227], v[226:227], v[26:27] op_sel:[0,1] op_sel_hi:[1,1]
v_pk_mul_f32 v[228:229], v[228:229], v[26:27] op_sel:[0,1] op_sel_hi:[1,1]
v_pk_mul_f32 v[230:231], v[230:231], v[26:27] op_sel:[0,1] op_sel_hi:[1,1]
v_pk_fma_f32 v[216:217], v[216:217], v[26:27], v[224:225] op_sel_hi:[1,0,1]
v_pk_fma_f32 v[218:219], v[218:219], v[26:27], v[226:227] op_sel_hi:[1,0,1]
v_pk_fma_f32 v[220:221], v[220:221], v[26:27], v[228:229] op_sel_hi:[1,0,1]
v_pk_fma_f32 v[222:223], v[222:223], v[26:27], v[230:231] op_sel_hi:[1,0,1]
v_mfma_f32_16x16x32_bf16 v[136:139], a[184:187], v[164:167], v[136:139]
ds_read_b128 v[244:247], v8 offset:52224
v_cvt_pk_bf16_f32 v236, v216, v217
v_mfma_f32_16x16x32_bf16 v[136:139], a[168:171], v[160:163], v[136:139]
v_cvt_pk_bf16_f32 v237, v218, v219
v_cvt_pk_bf16_f32 v238, v220, v221
v_mfma_f32_16x16x32_bf16 v[132:135], a[164:167], v[160:163], v[132:135]
ds_read_b128 v[156:159], v3 offset:27648
v_cvt_pk_bf16_f32 v239, v222, v223
v_mfma_f32_16x16x32_bf16 v[132:135], a[180:183], v[164:167], v[132:135]
ds_write_b128 v8, v[236:239] offset:50176
v_mfma_f32_16x16x32_bf16 v[128:131], a[176:179], v[164:167], v[128:131]
s_waitcnt vmcnt(9)
v_lshlrev_b32 v224, 16, v88
v_and_b32 v225, s59, v88
v_lshlrev_b32 v226, 16, v89
v_mfma_f32_16x16x32_bf16 v[128:131], a[160:163], v[160:163], v[128:131]
v_and_b32 v227, s59, v89
v_lshlrev_b32 v228, 16, v90
s_waitcnt lgkmcnt(8)
v_mfma_f32_16x16x32_bf16 v[128:131], a[192:195], v[168:171], v[128:131]
ds_read_b128 v[160:163], v3 offset:28672
v_and_b32 v229, s59, v90
v_mfma_f32_16x16x32_bf16 v[128:131], a[208:211], v[172:175], v[128:131]
v_lshlrev_b32 v230, 16, v91
v_and_b32 v231, s59, v91
v_mfma_f32_16x16x32_bf16 v[132:135], a[212:215], v[172:175], v[132:135]
s_waitcnt lgkmcnt(8)
v_lshlrev_b32 v216, 16, v240
v_and_b32 v217, s59, v240
v_mfma_f32_16x16x32_bf16 v[132:135], a[196:199], v[168:171], v[132:135]
v_lshlrev_b32 v218, 16, v241
v_and_b32 v219, s59, v241
v_mfma_f32_16x16x32_bf16 v[136:139], a[200:203], v[168:171], v[136:139]
ds_read_b128 v[164:167], v3 offset:29696
v_lshlrev_b32 v220, 16, v242
v_and_b32 v221, s59, v242
v_lshlrev_b32 v222, 16, v243
v_and_b32 v223, s59, v243
v_pk_mul_f32 v[224:225], v[224:225], v[26:27] op_sel:[0,1] op_sel_hi:[1,1]
v_pk_mul_f32 v[226:227], v[226:227], v[26:27] op_sel:[0,1] op_sel_hi:[1,1]
v_pk_mul_f32 v[228:229], v[228:229], v[26:27] op_sel:[0,1] op_sel_hi:[1,1]
v_pk_mul_f32 v[230:231], v[230:231], v[26:27] op_sel:[0,1] op_sel_hi:[1,1]
v_pk_fma_f32 v[216:217], v[216:217], v[26:27], v[224:225] op_sel_hi:[1,0,1]
v_pk_fma_f32 v[218:219], v[218:219], v[26:27], v[226:227] op_sel_hi:[1,0,1]
v_pk_fma_f32 v[220:221], v[220:221], v[26:27], v[228:229] op_sel_hi:[1,0,1]
v_pk_fma_f32 v[222:223], v[222:223], v[26:27], v[230:231] op_sel_hi:[1,0,1]
v_mfma_f32_16x16x32_bf16 v[136:139], a[216:219], v[172:175], v[136:139]
v_cvt_pk_bf16_f32 v232, v216, v217
v_cvt_pk_bf16_f32 v233, v218, v219
v_mfma_f32_16x16x32_bf16 v[140:143], a[220:223], v[172:175], v[140:143]
v_cvt_pk_bf16_f32 v234, v220, v221
v_cvt_pk_bf16_f32 v235, v222, v223
v_mfma_f32_16x16x32_bf16 v[140:143], a[204:207], v[168:171], v[140:143]
ds_write_b128 v8, v[232:235] offset:51200
s_waitcnt lgkmcnt(7)
v_mfma_f32_16x16x32_bf16 v[140:143], a[12:15], v[144:147], v[140:143]
ds_read_b128 v[168:171], v3 offset:30720
s_waitcnt vmcnt(8)
v_lshlrev_b32 v224, 16, v92
v_mfma_f32_16x16x32_bf16 v[140:143], a[28:31], v[148:151], v[140:143]
v_and_b32 v225, s59, v92
v_lshlrev_b32 v226, 16, v93
v_mfma_f32_16x16x32_bf16 v[136:139], a[24:27], v[148:151], v[136:139]
v_and_b32 v227, s59, v93
v_lshlrev_b32 v228, 16, v94
v_mfma_f32_16x16x32_bf16 v[136:139], a[8:11], v[144:147], v[136:139]
v_and_b32 v229, s59, v94
v_lshlrev_b32 v230, 16, v95
v_mfma_f32_16x16x32_bf16 v[132:135], a[4:7], v[144:147], v[132:135]
ds_read_b128 v[172:175], v3 offset:31744
v_and_b32 v231, s59, v95
v_mfma_f32_16x16x32_bf16 v[132:135], a[20:23], v[148:151], v[132:135]
s_waitcnt lgkmcnt(7)
v_lshlrev_b32 v216, 16, v244
v_and_b32 v217, s59, v244
v_mfma_f32_16x16x32_bf16 v[128:131], a[16:19], v[148:151], v[128:131]
s_waitcnt vmcnt(4)
s_barrier
v_mfma_f32_16x16x32_bf16 v[128:131], a[0:3], v[144:147], v[128:131]
v_lshlrev_b32 v218, 16, v245
v_and_b32 v219, s59, v245
s_waitcnt lgkmcnt(6)
v_mfma_f32_16x16x32_bf16 v[128:131], a[224:227], v[152:155], v[128:131]
ds_read_b128 v[144:147], v3 offset:32768
v_lshlrev_b32 v220, 16, v246
v_and_b32 v221, s59, v246
v_lshlrev_b32 v222, 16, v247
v_and_b32 v223, s59, v247
v_pk_mul_f32 v[224:225], v[224:225], v[26:27] op_sel:[0,1] op_sel_hi:[1,1]
v_pk_mul_f32 v[226:227], v[226:227], v[26:27] op_sel:[0,1] op_sel_hi:[1,1]
v_pk_mul_f32 v[228:229], v[228:229], v[26:27] op_sel:[0,1] op_sel_hi:[1,1]
v_pk_mul_f32 v[230:231], v[230:231], v[26:27] op_sel:[0,1] op_sel_hi:[1,1]
v_pk_fma_f32 v[216:217], v[216:217], v[26:27], v[224:225] op_sel_hi:[1,0,1]
v_pk_fma_f32 v[218:219], v[218:219], v[26:27], v[226:227] op_sel_hi:[1,0,1]
v_pk_fma_f32 v[220:221], v[220:221], v[26:27], v[228:229] op_sel_hi:[1,0,1]
v_pk_fma_f32 v[222:223], v[222:223], v[26:27], v[230:231] op_sel_hi:[1,0,1]
v_mfma_f32_16x16x32_bf16 v[128:131], a[240:243], v[156:159], v[128:131]
v_cvt_pk_bf16_f32 v236, v216, v217
v_cvt_pk_bf16_f32 v237, v218, v219
v_mfma_f32_16x16x32_bf16 v[132:135], a[244:247], v[156:159], v[132:135]
v_cvt_pk_bf16_f32 v238, v220, v221
v_cvt_pk_bf16_f32 v239, v222, v223
v_mfma_f32_16x16x32_bf16 v[132:135], a[228:231], v[152:155], v[132:135]
ds_write_b128 v8, v[236:239] offset:52224
v_mul_f32 v32, v32, v20
v_mfma_f32_16x16x32_bf16 v[136:139], a[232:235], v[152:155], v[136:139]
ds_read_b128 v[148:151], v3 offset:33792
v_mul_f32 v33, v33, v20
v_mfma_f32_16x16x32_bf16 v[136:139], a[248:251], v[156:159], v[136:139]
v_mul_f32 v34, v34, v20
v_mul_f32 v35, v35, v20
v_mfma_f32_16x16x32_bf16 v[140:143], a[252:255], v[156:159], v[140:143]
v_mul_f32 v36, v36, v20
v_mul_f32 v37, v37, v20
v_mfma_f32_16x16x32_bf16 v[140:143], a[236:239], v[152:155], v[140:143]
buffer_load_dword v5, v250, s[8:11], 0 offen sc1
s_waitcnt lgkmcnt(6)
v_mfma_f32_16x16x32_bf16 v[140:143], a[44:47], v[160:163], v[140:143]
ds_read_b128 v[152:155], v3 offset:34816
v_mul_f32 v38, v38, v20
v_mfma_f32_16x16x32_bf16 v[140:143], a[60:63], v[164:167], v[140:143]
v_mul_f32 v39, v39, v20
v_mul_f32 v40, v40, v20
v_mfma_f32_16x16x32_bf16 v[136:139], a[56:59], v[164:167], v[136:139]
v_mul_f32 v41, v41, v20
v_mul_f32 v42, v42, v20
v_mfma_f32_16x16x32_bf16 v[136:139], a[40:43], v[160:163], v[136:139]
v_mul_f32 v43, v43, v20
v_mul_f32 v44, v44, v20
v_mfma_f32_16x16x32_bf16 v[132:135], a[36:39], v[160:163], v[132:135]
ds_read_b128 v[156:159], v3 offset:35840
v_mul_f32 v45, v45, v20
v_mfma_f32_16x16x32_bf16 v[132:135], a[52:55], v[164:167], v[132:135]
v_mul_f32 v46, v46, v20
v_mul_f32 v47, v47, v20
v_mfma_f32_16x16x32_bf16 v[128:131], a[48:51], v[164:167], v[128:131]
v_fmac_f32 v32, v112, v21
v_fmac_f32 v33, v113, v21
v_mfma_f32_16x16x32_bf16 v[128:131], a[32:35], v[160:163], v[128:131]
v_fmac_f32 v34, v114, v21
v_fmac_f32 v35, v115, v21
s_waitcnt lgkmcnt(5)
v_mfma_f32_16x16x32_bf16 v[128:131], a[64:67], v[168:171], v[128:131]
ds_read_b128 v[160:163], v3 offset:36864
v_fmac_f32 v36, v116, v21
v_mfma_f32_16x16x32_bf16 v[128:131], a[80:83], v[172:175], v[128:131]
v_fmac_f32 v37, v117, v21
v_fmac_f32 v38, v118, v21
v_mfma_f32_16x16x32_bf16 v[132:135], a[84:87], v[172:175], v[132:135]
v_fmac_f32 v39, v119, v21
v_fmac_f32 v40, v120, v21
v_mfma_f32_16x16x32_bf16 v[132:135], a[68:71], v[168:171], v[132:135]
v_fmac_f32 v41, v121, v21
v_fmac_f32 v42, v122, v21
v_mfma_f32_16x16x32_bf16 v[136:139], a[72:75], v[168:171], v[136:139]
ds_read_b128 v[164:167], v3 offset:37888
v_fmac_f32 v43, v123, v21
v_mfma_f32_16x16x32_bf16 v[136:139], a[88:91], v[172:175], v[136:139]
v_fmac_f32 v44, v124, v21
v_fmac_f32 v45, v125, v21
v_mfma_f32_16x16x32_bf16 v[140:143], a[92:95], v[172:175], v[140:143]
v_fmac_f32 v46, v126, v21
v_fmac_f32 v47, v127, v21
v_mfma_f32_16x16x32_bf16 v[140:143], a[76:79], v[168:171], v[140:143]
ds_read_b128 v[240:243], v4 offset:0
ds_read_b128 v[244:247], v4 offset:1024
s_waitcnt lgkmcnt(6)
v_mfma_f32_16x16x32_bf16 v[124:127], a[108:111], v[144:147], 0
ds_read_b128 v[168:171], v3 offset:38912
s_waitcnt vmcnt(4)
v_lshlrev_b32 v224, 16, v96
v_mfma_f32_16x16x32_bf16 v[124:127], a[124:127], v[148:151], v[124:127]
v_and_b32 v225, s59, v96
v_lshlrev_b32 v226, 16, v97
v_mfma_f32_16x16x32_bf16 v[120:123], a[120:123], v[148:151], 0
v_and_b32 v227, s59, v97
v_lshlrev_b32 v228, 16, v98
v_mfma_f32_16x16x32_bf16 v[120:123], a[104:107], v[144:147], v[120:123]
v_and_b32 v229, s59, v98
v_lshlrev_b32 v230, 16, v99
v_mfma_f32_16x16x32_bf16 v[116:119], a[100:103], v[144:147], 0
ds_read_b128 v[172:175], v3 offset:39936
v_and_b32 v231, s59, v99
v_mfma_f32_16x16x32_bf16 v[116:119], a[116:119], v[148:151], v[116:119]
s_waitcnt lgkmcnt(3)
v_lshlrev_b32 v216, 16, v240
v_and_b32 v217, s59, v240
v_lshlrev_b32 v218, 16, v241
v_and_b32 v219, s59, v241
v_lshlrev_b32 v220, 16, v242
v_and_b32 v221, s59, v242
v_lshlrev_b32 v222, 16, v243
v_and_b32 v223, s59, v243
v_pk_mul_f32 v[224:225], v[224:225], v[28:29] op_sel:[0,1] op_sel_hi:[1,1]
v_pk_mul_f32 v[226:227], v[226:227], v[28:29] op_sel:[0,1] op_sel_hi:[1,1]
v_pk_mul_f32 v[228:229], v[228:229], v[28:29] op_sel:[0,1] op_sel_hi:[1,1]
v_pk_mul_f32 v[230:231], v[230:231], v[28:29] op_sel:[0,1] op_sel_hi:[1,1]
v_pk_fma_f32 v[216:217], v[216:217], v[28:29], v[224:225] op_sel_hi:[1,0,1]
v_pk_fma_f32 v[218:219], v[218:219], v[28:29], v[226:227] op_sel_hi:[1,0,1]
v_pk_fma_f32 v[220:221], v[220:221], v[28:29], v[228:229] op_sel_hi:[1,0,1]
v_pk_fma_f32 v[222:223], v[222:223], v[28:29], v[230:231] op_sel_hi:[1,0,1]
v_mfma_f32_16x16x32_bf16 v[112:115], a[112:115], v[148:151], 0
ds_read_b128 v[240:243], v4 offset:2048
v_cvt_pk_bf16_f32 v232, v216, v217
v_mfma_f32_16x16x32_bf16 v[112:115], a[96:99], v[144:147], v[112:115]
v_cvt_pk_bf16_f32 v233, v218, v219
v_cvt_pk_bf16_f32 v234, v220, v221
v_mfma_f32_16x16x32_bf16 v[112:115], a[128:131], v[152:155], v[112:115]
ds_read_b128 v[144:147], v3 offset:40960
v_cvt_pk_bf16_f32 v235, v222, v223
v_mfma_f32_16x16x32_bf16 v[112:115], a[144:147], v[156:159], v[112:115]
ds_write_b128 v4, v[232:235] offset:0
v_mfma_f32_16x16x32_bf16 v[116:119], a[148:151], v[156:159], v[116:119]
s_waitcnt vmcnt(3)
v_lshlrev_b32 v224, 16, v100
v_and_b32 v225, s59, v100
v_lshlrev_b32 v226, 16, v101
v_mfma_f32_16x16x32_bf16 v[116:119], a[132:135], v[152:155], v[116:119]
v_and_b32 v227, s59, v101
v_lshlrev_b32 v228, 16, v102
v_mfma_f32_16x16x32_bf16 v[120:123], a[136:139], v[152:155], v[120:123]
ds_read_b128 v[148:151], v3 offset:41984
v_and_b32 v229, s59, v102
v_mfma_f32_16x16x32_bf16 v[120:123], a[152:155], v[156:159], v[120:123]
v_lshlrev_b32 v230, 16, v103
v_and_b32 v231, s59, v103
v_mfma_f32_16x16x32_bf16 v[124:127], a[156:159], v[156:159], v[124:127]
s_waitcnt lgkmcnt(6)
v_lshlrev_b32 v216, 16, v244
v_and_b32 v217, s59, v244
v_mfma_f32_16x16x32_bf16 v[124:127], a[140:143], v[152:155], v[124:127]
s_waitcnt vmcnt(0)
v_cmp_ne_u32 vcc, s7, v5
v_lshlrev_b32 v218, 16, v245
v_mfma_f32_16x16x32_bf16 v[124:127], a[172:175], v[160:163], v[124:127]
ds_read_b128 v[152:155], v3 offset:43008
v_and_b32 v219, s59, v245
v_mfma_f32_16x16x32_bf16 v[124:127], a[188:191], v[164:167], v[124:127]
s_cbranch_vccnz L_spinC
L_okC:
v_lshlrev_b32 v220, 16, v246
v_and_b32 v221, s59, v246
v_lshlrev_b32 v222, 16, v247
v_and_b32 v223, s59, v247
v_pk_mul_f32 v[224:225], v[224:225], v[28:29] op_sel:[0,1] op_sel_hi:[1,1]
v_pk_mul_f32 v[226:227], v[226:227], v[28:29] op_sel:[0,1] op_sel_hi:[1,1]
v_pk_mul_f32 v[228:229], v[228:229], v[28:29] op_sel:[0,1] op_sel_hi:[1,1]
v_pk_mul_f32 v[230:231], v[230:231], v[28:29] op_sel:[0,1] op_sel_hi:[1,1]
v_pk_fma_f32 v[216:217], v[216:217], v[28:29], v[224:225] op_sel_hi:[1,0,1]
v_pk_fma_f32 v[218:219], v[218:219], v[28:29], v[226:227] op_sel_hi:[1,0,1]
v_pk_fma_f32 v[220:221], v[220:221], v[28:29], v[228:229] op_sel_hi:[1,0,1]
v_pk_fma_f32 v[222:223], v[222:223], v[28:29], v[230:231] op_sel_hi:[1,0,1]
v_mfma_f32_16x16x32_bf16 v[120:123], a[184:187], v[164:167], v[120:123]
buffer_load_dwordx4 v[176:179], v249, s[8:11], s55 offen offset:0 sc1
v_mfma_f32_16x16x32_bf16 v[120:123], a[168:171], v[160:163], v[120:123]
ds_read_b128 v[244:247], v4 offset:3072
v_cvt_pk_bf16_f32 v236, v216, v217
v_cvt_pk_bf16_f32 v237, v218, v219
v_cvt_pk_bf16_f32 v238, v220, v221
v_mfma_f32_16x16x32_bf16 v[116:119], a[164:167], v[160:163], v[116:119]
ds_read_b128 v[156:159], v3 offset:44032
v_cvt_pk_bf16_f32 v239, v222, v223
v_mfma_f32_16x16x32_bf16 v[116:119], a[180:183], v[164:167], v[116:119]
ds_write_b128 v4, v[236:239] offset:1024
v_mfma_f32_16x16x32_bf16 v[112:115], a[176:179], v[164:167], v[112:115]
buffer_load_dwordx4 v[180:183], v249, s[8:11], s55 offen offset:1024 sc1
v_mfma_f32_16x16x32_bf16 v[112:115], a[160:163], v[160:163], v[112:115]
v_lshlrev_b32 v224, 16, v104
v_and_b32 v225, s59, v104
v_lshlrev_b32 v226, 16, v105
v_and_b32 v227, s59, v105
v_lshlrev_b32 v228, 16, v106
v_and_b32 v229, s59, v106
v_lshlrev_b32 v230, 16, v107
s_waitcnt lgkmcnt(8)
v_mfma_f32_16x16x32_bf16 v[112:115], a[192:195], v[168:171], v[112:115]
ds_read_b128 v[160:163], v3 offset:45056
v_and_b32 v231, s59, v107
v_mfma_f32_16x16x32_bf16 v[112:115], a[208:211], v[172:175], v[112:115]
s_waitcnt lgkmcnt(8)
v_lshlrev_b32 v216, 16, v240
v_and_b32 v217, s59, v240
v_lshlrev_b32 v218, 16, v241
v_and_b32 v219, s59, v241
v_lshlrev_b32 v220, 16, v242
v_and_b32 v221, s59, v242
v_lshlrev_b32 v222, 16, v243
v_and_b32 v223, s59, v243
v_pk_mul_f32 v[224:225], v[224:225], v[28:29] op_sel:[0,1] op_sel_hi:[1,1]
v_pk_mul_f32 v[226:227], v[226:227], v[28:29] op_sel:[0,1] op_sel_hi:[1,1]
v_pk_mul_f32 v[228:229], v[228:229], v[28:29] op_sel:[0,1] op_sel_hi:[1,1]
v_pk_mul_f32 v[230:231], v[230:231], v[28:29] op_sel:[0,1] op_sel_hi:[1,1]
v_pk_fma_f32 v[216:217], v[216:217], v[28:29], v[224:225] op_sel_hi:[1,0,1]
v_pk_fma_f32 v[218:219], v[218:219], v[28:29], v[226:227] op_sel_hi:[1,0,1]
v_pk_fma_f32 v[220:221], v[220:221], v[28:29], v[228:229] op_sel_hi:[1,0,1]
v_pk_fma_f32 v[222:223], v[222:223], v[28:29], v[230:231] op_sel_hi:[1,0,1]
v_cvt_pk_bf16_f32 v232, v216, v217
v_mfma_f32_16x16x32_bf16 v[116:119], a[212:215], v[172:175], v[116:119]
buffer_load_dwordx4 v[184:187], v251, s[8:11], s55 offen offset:0 sc1
v_mfma_f32_16x16x32_bf16 v[116:119], a[196:199], v[168:171], v[116:119]
v_cvt_pk_bf16_f32 v233, v218, v219
v_cvt_pk_bf16_f32 v234, v220, v221
v_mfma_f32_16x16x32_bf16 v[120:123], a[200:203], v[168:171], v[120:123]
ds_read_b128 v[164:167], v3 offset:46080
v_cvt_pk_bf16_f32 v235, v222, v223
v_mfma_f32_16x16x32_bf16 v[120:123], a[216:219], v[172:175], v[120:123]
ds_write_b128 v4, v[232:235] offset:2048
v_mfma_f32_16x16x32_bf16 v[124:127], a[220:223], v[172:175], v[124:127]
buffer_load_dwordx4 v[188:191], v251, s[8:11], s55 offen offset:1024 sc1
v_mfma_f32_16x16x32_bf16 v[124:127], a[204:207], v[168:171], v[124:127]
v_lshlrev_b32 v224, 16, v108
v_and_b32 v225, s59, v108
v_lshlrev_b32 v226, 16, v109
v_and_b32 v227, s59, v109
v_lshlrev_b32 v228, 16, v110
v_and_b32 v229, s59, v110
v_lshlrev_b32 v230, 16, v111
s_waitcnt lgkmcnt(7)
v_mfma_f32_16x16x32_bf16 v[124:127], a[12:15], v[144:147], v[124:127]
ds_read_b128 v[168:171], v3 offset:47104
v_and_b32 v231, s59, v111
v_mfma_f32_16x16x32_bf16 v[124:127], a[28:31], v[148:151], v[124:127]
s_waitcnt lgkmcnt(6)
v_lshlrev_b32 v216, 16, v244
v_and_b32 v217, s59, v244
v_lshlrev_b32 v218, 16, v245
v_and_b32 v219, s59, v245
v_lshlrev_b32 v220, 16, v246
v_and_b32 v221, s59, v246
v_lshlrev_b32 v222, 16, v247
v_and_b32 v223, s59, v247
v_pk_mul_f32 v[224:225], v[224:225], v[28:29] op_sel:[0,1] op_sel_hi:[1,1]
v_pk_mul_f32 v[226:227], v[226:227], v[28:29] op_sel:[0,1] op_sel_hi:[1,1]
v_pk_mul_f32 v[228:229], v[228:229], v[28:29] op_sel:[0,1] op_sel_hi:[1,1]
v_pk_mul_f32 v[230:231], v[230:231], v[28:29] op_sel:[0,1] op_sel_hi:[1,1]
v_pk_fma_f32 v[216:217], v[216:217], v[28:29], v[224:225] op_sel_hi:[1,0,1]
v_pk_fma_f32 v[218:219], v[218:219], v[28:29], v[226:227] op_sel_hi:[1,0,1]
v_pk_fma_f32 v[220:221], v[220:221], v[28:29], v[228:229] op_sel_hi:[1,0,1]
v_pk_fma_f32 v[222:223], v[222:223], v[28:29], v[230:231] op_sel_hi:[1,0,1]
v_cvt_pk_bf16_f32 v236, v216, v217
v_mfma_f32_16x16x32_bf16 v[120:123], a[24:27], v[148:151], v[120:123]
buffer_load_dwordx4 v[192:195], v253, s[8:11], s55 offen offset:0 sc1
v_mfma_f32_16x16x32_bf16 v[120:123], a[8:11], v[144:147], v[120:123]
v_cvt_pk_bf16_f32 v237, v218, v219
v_cvt_pk_bf16_f32 v238, v220, v221
v_mfma_f32_16x16x32_bf16 v[116:119], a[4:7], v[144:147], v[116:119]
ds_read_b128 v[172:175], v3 offset:48128
v_cvt_pk_bf16_f32 v239, v222, v223
v_mfma_f32_16x16x32_bf16 v[116:119], a[20:23], v[148:151], v[116:119]
ds_write_b128 v4, v[236:239] offset:3072
v_mfma_f32_16x16x32_bf16 v[112:115], a[16:19], v[148:151], v[112:115]
s_barrier
v_mfma_f32_16x16x32_bf16 v[112:115], a[0:3], v[144:147], v[112:115]
buffer_load_dwordx4 v[196:199], v253, s[8:11], s55 offen offset:1024 sc1
s_waitcnt lgkmcnt(7)
v_mfma_f32_16x16x32_bf16 v[112:115], a[224:227], v[152:155], v[112:115]
ds_read_b128 v[144:147], v1 offset:49152
v_mul_f32 v48, v48, v22
v_mfma_f32_16x16x32_bf16 v[112:115], a[240:243], v[156:159], v[112:115]
v_mul_f32 v49, v49, v22
v_mul_f32 v50, v50, v22
v_mfma_f32_16x16x32_bf16 v[116:119], a[244:247], v[156:159], v[116:119]
v_mul_f32 v51, v51, v22
v_mul_f32 v52, v52, v22
v_mfma_f32_16x16x32_bf16 v[116:119], a[228:231], v[152:155], v[116:119]
buffer_load_dwordx4 v[200:203], v254, s[8:11], s55 offen offset:0 sc1
v_mfma_f32_16x16x32_bf16 v[120:123], a[232:235], v[152:155], v[120:123]
ds_read_b128 v[148:151], v1 offset:50176
v_mul_f32 v53, v53, v22
v_mfma_f32_16x16x32_bf16 v[120:123], a[248:251], v[156:159], v[120:123]
v_mul_f32 v54, v54, v22
v_mul_f32 v55, v55, v22
v_mfma_f32_16x16x32_bf16 v[124:127], a[252:255], v[156:159], v[124:127]
v_mul_f32 v56, v56, v22
v_mul_f32 v57, v57, v22
v_mfma_f32_16x16x32_bf16 v[124:127], a[236:239], v[152:155], v[124:127]
buffer_load_dwordx4 v[204:207], v254, s[8:11], s55 offen offset:1024 sc1
s_waitcnt lgkmcnt(6)
v_mfma_f32_16x16x32_bf16 v[124:127], a[44:47], v[160:163], v[124:127]
ds_read_b128 v[152:155], v1 offset:51200
v_mul_f32 v58, v58, v22
v_mfma_f32_16x16x32_bf16 v[124:127], a[60:63], v[164:167], v[124:127]
v_mul_f32 v59, v59, v22
v_mul_f32 v60, v60, v22
v_mfma_f32_16x16x32_bf16 v[120:123], a[56:59], v[164:167], v[120:123]
v_mul_f32 v61, v61, v22
v_mul_f32 v62, v62, v22
v_mfma_f32_16x16x32_bf16 v[120:123], a[40:43], v[160:163], v[120:123]
buffer_load_dwordx4 v[208:211], v255, s[8:11], s55 offen offset:0 sc1
v_mfma_f32_16x16x32_bf16 v[116:119], a[36:39], v[160:163], v[116:119]
ds_read_b128 v[156:159], v1 offset:52224
v_mul_f32 v63, v63, v22
v_mfma_f32_16x16x32_bf16 v[116:119], a[52:55], v[164:167], v[116:119]
v_fmac_f32 v48, v128, v23
v_fmac_f32 v49, v129, v23
v_mfma_f32_16x16x32_bf16 v[112:115], a[48:51], v[164:167], v[112:115]
v_fmac_f32 v50, v130, v23
v_fmac_f32 v51, v131, v23
v_mfma_f32_16x16x32_bf16 v[112:115], a[32:35], v[160:163], v[112:115]
buffer_load_dwordx4 v[212:215], v255, s[8:11], s55 offen offset:1024 sc1
s_waitcnt lgkmcnt(5)
v_mfma_f32_16x16x32_bf16 v[112:115], a[64:67], v[168:171], v[112:115]
ds_read_b128 v[160:163], v1 offset:53248
v_fmac_f32 v52, v132, v23
v_mfma_f32_16x16x32_bf16 v[112:115], a[80:83], v[172:175], v[112:115]
v_fmac_f32 v53, v133, v23
v_fmac_f32 v54, v134, v23
v_mfma_f32_16x16x32_bf16 v[116:119], a[84:87], v[172:175], v[116:119]
v_fmac_f32 v55, v135, v23
v_fmac_f32 v56, v136, v23
v_mfma_f32_16x16x32_bf16 v[116:119], a[68:71], v[168:171], v[116:119]
v_fmac_f32 v57, v137, v23
v_fmac_f32 v58, v138, v23
v_mfma_f32_16x16x32_bf16 v[120:123], a[72:75], v[168:171], v[120:123]
ds_read_b128 v[164:167], v1 offset:54272
v_fmac_f32 v59, v139, v23
v_mfma_f32_16x16x32_bf16 v[120:123], a[88:91], v[172:175], v[120:123]
v_fmac_f32 v60, v140, v23
v_fmac_f32 v61, v141, v23
v_mfma_f32_16x16x32_bf16 v[124:127], a[92:95], v[172:175], v[124:127]
v_fmac_f32 v62, v142, v23
v_fmac_f32 v63, v143, v23
v_mfma_f32_16x16x32_bf16 v[124:127], a[76:79], v[168:171], v[124:127]
s_waitcnt vmcnt(9)
v_lshlrev_b32 v216, 16, v176
v_and_b32 v217, s59, v176
v_lshlrev_b32 v218, 16, v177
v_and_b32 v219, s59, v177
v_lshlrev_b32 v220, 16, v178
s_waitcnt lgkmcnt(4)
v_mfma_f32_16x16x32_bf16 v[140:143], a[108:111], v[144:147], 0
ds_read_b128 v[168:171], v1 offset:55296
v_and_b32 v221, s59, v178
v_mfma_f32_16x16x32_bf16 v[140:143], a[124:127], v[148:151], v[140:143]
v_lshlrev_b32 v222, 16, v179
v_and_b32 v223, s59, v179
v_mfma_f32_16x16x32_bf16 v[136:139], a[120:123], v[148:151], 0
s_waitcnt vmcnt(8)
v_lshlrev_b32 v224, 16, v180
v_and_b32 v225, s59, v180
v_lshlrev_b32 v226, 16, v181
v_mfma_f32_16x16x32_bf16 v[136:139], a[104:107], v[144:147], v[136:139]
v_and_b32 v227, s59, v181
v_lshlrev_b32 v228, 16, v182
v_mfma_f32_16x16x32_bf16 v[132:135], a[100:103], v[144:147], 0
ds_read_b128 v[172:175], v1 offset:56320
v_and_b32 v229, s59, v182
v_mfma_f32_16x16x32_bf16 v[132:135], a[116:119], v[148:151], v[132:135]
v_lshlrev_b32 v230, 16, v183
v_and_b32 v231, s59, v183
v_mfma_f32_16x16x32_bf16 v[128:131], a[112:115], v[148:151], 0
v_add_f32 v216, v216, v32
v_add_f32 v217, v217, v33
v_mfma_f32_16x16x32_bf16 v[128:131], a[96:99], v[144:147], v[128:131]
v_add_f32 v218, v218, v34
v_add_f32 v219, v219, v35
s_waitcnt lgkmcnt(4)
v_mfma_f32_16x16x32_bf16 v[128:131], a[128:131], v[152:155], v[128:131]
ds_read_b128 v[144:147], v1 offset:57344
v_add_f32 v220, v220, v36
v_mfma_f32_16x16x32_bf16 v[128:131], a[144:147], v[156:159], v[128:131]
v_add_f32 v221, v221, v37
v_add_f32 v222, v222, v38
v_mfma_f32_16x16x32_bf16 v[132:135], a[148:151], v[156:159], v[132:135]
v_add_f32 v223, v223, v39
v_cvt_pk_bf16_f32 v232, v216, v217
v_mfma_f32_16x16x32_bf16 v[132:135], a[132:135], v[152:155], v[132:135]
v_cvt_pk_bf16_f32 v233, v218, v219
v_cvt_pk_bf16_f32 v234, v220, v221
v_mfma_f32_16x16x32_bf16 v[136:139], a[136:139], v[152:155], v[136:139]
ds_read_b128 v[148:151], v1 offset:58368
v_cvt_pk_bf16_f32 v235, v222, v223
v_mfma_f32_16x16x32_bf16 v[136:139], a[152:155], v[156:159], v[136:139]
ds_write_b128 v6, v[232:235] offset:0
v_mfma_f32_16x16x32_bf16 v[140:143], a[156:159], v[156:159], v[140:143]
ds_read_b128 v[240:243], v8 offset:0
v_add_f32 v224, v224, v40
v_add_f32 v225, v225, v41
v_mfma_f32_16x16x32_bf16 v[140:143], a[140:143], v[152:155], v[140:143]
v_add_f32 v226, v226, v42
v_add_f32 v227, v227, v43
s_waitcnt lgkmcnt(6)
v_mfma_f32_16x16x32_bf16 v[140:143], a[172:175], v[160:163], v[140:143]
ds_read_b128 v[152:155], v1 offset:59392
v_add_f32 v228, v228, v44
v_mfma_f32_16x16x32_bf16 v[140:143], a[188:191], v[164:167], v[140:143]
v_add_f32 v229, v229, v45
v_add_f32 v230, v230, v46
v_mfma_f32_16x16x32_bf16 v[136:139], a[184:187], v[164:167], v[136:139]
v_add_f32 v231, v231, v47
v_cvt_pk_bf16_f32 v236, v224, v225
v_mfma_f32_16x16x32_bf16 v[136:139], a[168:171], v[160:163], v[136:139]
v_cvt_pk_bf16_f32 v237, v226, v227
v_cvt_pk_bf16_f32 v238, v228, v229
v_mfma_f32_16x16x32_bf16 v[132:135], a[164:167], v[160:163], v[132:135]
ds_read_b128 v[156:159], v1 offset:60416
v_cvt_pk_bf16_f32 v239, v230, v231
v_mfma_f32_16x16x32_bf16 v[132:135], a[180:183], v[164:167], v[132:135]
ds_write_b128 v6, v[236:239] offset:1024
v_mfma_f32_16x16x32_bf16 v[128:131], a[176:179], v[164:167], v[128:131]
ds_read_b128 v[244:247], v8 offset:1024
v_mul_f32 v64, v64, v24
v_mul_f32 v65, v65, v24
v_mul_f32 v66, v66, v24
v_mul_f32 v67, v67, v24
v_mfma_f32_16x16x32_bf16 v[128:131], a[160:163], v[160:163], v[128:131]
v_mul_f32 v68, v68, v24
v_mul_f32 v69, v69, v24
s_waitcnt lgkmcnt(8)
v_mfma_f32_16x16x32_bf16 v[128:131], a[192:195], v[168:171], v[128:131]
ds_read_b128 v[160:163], v1 offset:61440
v_mul_f32 v70, v70, v24
v_mfma_f32_16x16x32_bf16 v[128:131], a[208:211], v[172:175], v[128:131]
v_mul_f32 v71, v71, v24
v_mul_f32 v72, v72, v24
v_mfma_f32_16x16x32_bf16 v[132:135], a[212:215], v[172:175], v[132:135]
v_mul_f32 v73, v73, v24
v_mul_f32 v74, v74, v24
v_mfma_f32_16x16x32_bf16 v[132:135], a[196:199], v[168:171], v[132:135]
v_mul_f32 v75, v75, v24
v_mul_f32 v76, v76, v24
v_mfma_f32_16x16x32_bf16 v[136:139], a[200:203], v[168:171], v[136:139]
ds_read_b128 v[164:167], v1 offset:62464
v_mul_f32 v77, v77, v24
v_mfma_f32_16x16x32_bf16 v[136:139], a[216:219], v[172:175], v[136:139]
v_mul_f32 v78, v78, v24
v_mul_f32 v79, v79, v24
v_mfma_f32_16x16x32_bf16 v[140:143], a[220:223], v[172:175], v[140:143]
v_fmac_f32 v64, v112, v25
v_fmac_f32 v65, v113, v25
v_mfma_f32_16x16x32_bf16 v[140:143], a[204:207], v[168:171], v[140:143]
v_fmac_f32 v66, v114, v25
v_fmac_f32 v67, v115, v25
s_waitcnt lgkmcnt(8)
v_mfma_f32_16x16x32_bf16 v[140:143], a[12:15], v[144:147], v[140:143]
ds_read_b128 v[168:171], v1 offset:63488
v_fmac_f32 v68, v116, v25
v_mfma_f32_16x16x32_bf16 v[140:143], a[28:31], v[148:151], v[140:143]
v_fmac_f32 v69, v117, v25
v_fmac_f32 v70, v118, v25
v_mfma_f32_16x16x32_bf16 v[136:139], a[24:27], v[148:151], v[136:139]
v_fmac_f32 v71, v119, v25
v_fmac_f32 v72, v120, v25
v_mfma_f32_16x16x32_bf16 v[136:139], a[8:11], v[144:147], v[136:139]
v_fmac_f32 v73, v121, v25
v_fmac_f32 v74, v122, v25
v_mfma_f32_16x16x32_bf16 v[132:135], a[4:7], v[144:147], v[132:135]
ds_read_b128 v[172:175], v1 offset:64512
v_fmac_f32 v75, v123, v25
v_mfma_f32_16x16x32_bf16 v[132:135], a[20:23], v[148:151], v[132:135]
v_fmac_f32 v76, v124, v25
v_fmac_f32 v77, v125, v25
v_mfma_f32_16x16x32_bf16 v[128:131], a[16:19], v[148:151], v[128:131]
s_barrier
v_mfma_f32_16x16x32_bf16 v[128:131], a[0:3], v[144:147], v[128:131]
v_fmac_f32 v78, v126, v25
v_fmac_f32 v79, v127, v25
s_waitcnt lgkmcnt(6)
v_mfma_f32_16x16x32_bf16 v[128:131], a[224:227], v[152:155], v[128:131]
ds_read_b128 v[144:147], v2 offset:0
s_add_u32 s35, s56, 0
v_mfma_f32_16x16x32_bf16 v[128:131], a[240:243], v[156:159], v[128:131]
buffer_store_dwordx4 v[240:243], v7, s[16:19], s35 offen offset:0 nt
v_mfma_f32_16x16x32_bf16 v[132:135], a[244:247], v[156:159], v[132:135]
s_waitcnt lgkmcnt(5)
buffer_store_dwordx4 v[244:247], v7, s[16:19], s35 offen offset:64 nt
v_mfma_f32_16x16x32_bf16 v[132:135], a[228:231], v[152:155], v[132:135]
s_waitcnt vmcnt(9)
v_lshlrev_b32 v216, 16, v184
v_and_b32 v217, s59, v184
v_lshlrev_b32 v218, 16, v185
v_and_b32 v219, s59, v185
v_lshlrev_b32 v220, 16, v186
v_mfma_f32_16x16x32_bf16 v[136:139], a[232:235], v[152:155], v[136:139]
ds_read_b128 v[148:151], v2 offset:1024
v_and_b32 v221, s59, v186
v_mfma_f32_16x16x32_bf16 v[136:139], a[248:251], v[156:159], v[136:139]
v_lshlrev_b32 v222, 16, v187
v_and_b32 v223, s59, v187
v_mfma_f32_16x16x32_bf16 v[140:143], a[252:255], v[156:159], v[140:143]
s_waitcnt vmcnt(8)
v_lshlrev_b32 v224, 16, v188
v_and_b32 v225, s59, v188
v_lshlrev_b32 v226, 16, v189
v_mfma_f32_16x16x32_bf16 v[140:143], a[236:239], v[152:155], v[140:143]
v_and_b32 v227, s59, v189
v_lshlrev_b32 v228, 16, v190
s_waitcnt lgkmcnt(4)
v_mfma_f32_16x16x32_bf16 v[140:143], a[44:47], v[160:163], v[140:143]
ds_read_b128 v[152:155], v2 offset:2048
v_and_b32 v229, s59, v190
v_mfma_f32_16x16x32_bf16 v[140:143], a[60:63], v[164:167], v[140:143]
v_lshlrev_b32 v230, 16, v191
v_and_b32 v231, s59, v191
v_mfma_f32_16x16x32_bf16 v[136:139], a[56:59], v[164:167], v[136:139]
v_add_f32 v216, v216, v48
v_add_f32 v217, v217, v49
v_mfma_f32_16x16x32_bf16 v[136:139], a[40:43], v[160:163], v[136:139]
v_add_f32 v218, v218, v50
v_add_f32 v219, v219, v51
v_mfma_f32_16x16x32_bf16 v[132:135], a[36:39], v[160:163], v[132:135]
ds_read_b128 v[156:159], v2 offset:3072
v_add_f32 v220, v220, v52
v_mfma_f32_16x16x32_bf16 v[132:135], a[52:55], v[164:167], v[132:135]
v_add_f32 v221, v221, v53
v_add_f32 v222, v222, v54
v_mfma_f32_16x16x32_bf16 v[128:131], a[48:51], v[164:167], v[128:131]
v_add_f32 v223, v223, v55
v_cvt_pk_bf16_f32 v232, v216, v217
v_mfma_f32_16x16x32_bf16 v[128:131], a[32:35], v[160:163], v[128:131]
v_cvt_pk_bf16_f32 v233, v218, v219
v_cvt_pk_bf16_f32 v234, v220, v221
s_waitcnt lgkmcnt(4)
v_mfma_f32_16x16x32_bf16 v[128:131], a[64:67], v[168:171], v[128:131]
ds_read_b128 v[160:163], v2 offset:4096
v_cvt_pk_bf16_f32 v235, v222, v223
v_mfma_f32_16x16x32_bf16 v[128:131], a[80:83], v[172:175], v[128:131]
ds_write_b128 v6, v[232:235] offset:0
v_mfma_f32_16x16x32_bf16 v[132:135], a[84:87], v[172:175], v[132:135]
ds_read_b128 v[240:243], v8 offset:0
v_add_f32 v224, v224, v56
v_add_f32 v225, v225, v57
v_add_f32 v226, v226, v58
v_add_f32 v227, v227, v59
v_add_f32 v228, v228, v60
v_mfma_f32_16x16x32_bf16 v[132:135], a[68:71], v[168:171], v[132:135]
v_add_f32 v229, v229, v61
v_add_f32 v230, v230, v62
v_mfma_f32_16x16x32_bf16 v[136:139], a[72:75], v[168:171], v[136:139]
ds_read_b128 v[164:167], v2 offset:5120
v_add_f32 v231, v231, v63
v_mfma_f32_16x16x32_bf16 v[136:139], a[88:91], v[172:175], v[136:139]
v_cvt_pk_bf16_f32 v236, v224, v225
v_cvt_pk_bf16_f32 v237, v226, v227
v_mfma_f32_16x16x32_bf16 v[140:143], a[92:95], v[172:175], v[140:143]
v_cvt_pk_bf16_f32 v238, v228, v229
v_cvt_pk_bf16_f32 v239, v230, v231
v_mfma_f32_16x16x32_bf16 v[140:143], a[76:79], v[168:171], v[140:143]
ds_write_b128 v6, v[236:239] offset:1024
s_waitcnt lgkmcnt(7)
v_mfma_f32_16x16x32_bf16 v[124:127], a[108:111], v[144:147], 0
ds_read_b128 v[168:171], v2 offset:6144
ds_read_b128 v[244:247], v8 offset:1024
v_mfma_f32_16x16x32_bf16 v[124:127], a[124:127], v[148:151], v[124:127]
s_waitcnt vmcnt(7)
v_lshlrev_b32 v216, 16, v192
v_and_b32 v217, s59, v192
v_lshlrev_b32 v218, 16, v193
v_mfma_f32_16x16x32_bf16 v[120:123], a[120:123], v[148:151], 0
v_and_b32 v219, s59, v193
v_lshlrev_b32 v220, 16, v194
v_mfma_f32_16x16x32_bf16 v[120:123], a[104:107], v[144:147], v[120:123]
v_and_b32 v221, s59, v194
v_lshlrev_b32 v222, 16, v195
v_mfma_f32_16x16x32_bf16 v[116:119], a[100:103], v[144:147], 0
ds_read_b128 v[172:175], v2 offset:7168
v_and_b32 v223, s59, v195
v_mfma_f32_16x16x32_bf16 v[116:119], a[116:119], v[148:151], v[116:119]
s_waitcnt vmcnt(6)
v_lshlrev_b32 v224, 16, v196
v_and_b32 v225, s59, v196
v_lshlrev_b32 v226, 16, v197
v_and_b32 v227, s59, v197
v_mfma_f32_16x16x32_bf16 v[112:115], a[112:115], v[148:151], 0
v_lshlrev_b32 v228, 16, v198
v_and_b32 v229, s59, v198
v_mfma_f32_16x16x32_bf16 v[112:115], a[96:99], v[144:147], v[112:115]
v_lshlrev_b32 v230, 16, v199
v_and_b32 v231, s59, v199
s_waitcnt lgkmcnt(8)
v_mfma_f32_16x16x32_bf16 v[112:115], a[128:131], v[152:155], v[112:115]
ds_read_b128 v[144:147], v2 offset:8192
s_add_u32 s35, s56, 16384
v_mfma_f32_16x16x32_bf16 v[112:115], a[144:147], v[156:159], v[112:115]
s_waitcnt lgkmcnt(6)
buffer_store_dwordx4 v[240:243], v7, s[16:19], s35 offen offset:0 nt
v_mfma_f32_16x16x32_bf16 v[116:119], a[148:151], v[156:159], v[116:119]
s_waitcnt lgkmcnt(2)
buffer_store_dwordx4 v[244:247], v7, s[16:19], s35 offen offset:64 nt
v_add_f32 v216, v216, v64
v_add_f32 v217, v217, v65
v_mfma_f32_16x16x32_bf16 v[116:119], a[132:135], v[152:155], v[116:119]
v_add_f32 v218, v218, v66
v_add_f32 v219, v219, v67
v_mfma_f32_16x16x32_bf16 v[120:123], a[136:139], v[152:155], v[120:123]
ds_read_b128 v[148:151], v2 offset:9216
v_add_f32 v220, v220, v68
v_mfma_f32_16x16x32_bf16 v[120:123], a[152:155], v[156:159], v[120:123]
v_add_f32 v221, v221, v69
v_add_f32 v222, v222, v70
v_mfma_f32_16x16x32_bf16 v[124:127], a[156:159], v[156:159], v[124:127]
v_add_f32 v223, v223, v71
v_cvt_pk_bf16_f32 v232, v216, v217
v_mfma_f32_16x16x32_bf16 v[124:127], a[140:143], v[152:155], v[124:127]
v_cvt_pk_bf16_f32 v233, v218, v219
v_cvt_pk_bf16_f32 v234, v220, v221
v_mfma_f32_16x16x32_bf16 v[124:127], a[172:175], v[160:163], v[124:127]
ds_read_b128 v[152:155], v2 offset:10240
v_cvt_pk_bf16_f32 v235, v222, v223
v_mfma_f32_16x16x32_bf16 v[124:127], a[188:191], v[164:167], v[124:127]
ds_write_b128 v6, v[232:235] offset:0
v_mfma_f32_16x16x32_bf16 v[120:123], a[184:187], v[164:167], v[120:123]
ds_read_b128 v[240:243], v8 offset:0
v_add_f32 v224, v224, v72
v_add_f32 v225, v225, v73
v_mfma_f32_16x16x32_bf16 v[120:123], a[168:171], v[160:163], v[120:123]
v_add_f32 v226, v226, v74
v_add_f32 v227, v227, v75
v_mfma_f32_16x16x32_bf16 v[116:119], a[164:167], v[160:163], v[116:119]
ds_read_b128 v[156:159], v2 offset:11264
v_add_f32 v228, v228, v76
v_mfma_f32_16x16x32_bf16 v[116:119], a[180:183], v[164:167], v[116:119]
v_add_f32 v229, v229, v77
v_add_f32 v230, v230, v78
v_mfma_f32_16x16x32_bf16 v[112:115], a[176:179], v[164:167], v[112:115]
v_add_f32 v231, v231, v79
v_cvt_pk_bf16_f32 v236, v224, v225
v_mfma_f32_16x16x32_bf16 v[112:115], a[160:163], v[160:163], v[112:115]
v_cvt_pk_bf16_f32 v237, v226, v227
v_cvt_pk_bf16_f32 v238, v228, v229
s_waitcnt lgkmcnt(6)
v_mfma_f32_16x16x32_bf16 v[112:115], a[192:195], v[168:171], v[112:115]
ds_read_b128 v[160:163], v2 offset:12288
v_cvt_pk_bf16_f32 v239, v230, v231
v_mfma_f32_16x16x32_bf16 v[112:115], a[208:211], v[172:175], v[112:115]
ds_write_b128 v6, v[236:239] offset:1024
v_mfma_f32_16x16x32_bf16 v[116:119], a[212:215], v[172:175], v[116:119]
ds_read_b128 v[244:247], v8 offset:1024
s_waitcnt vmcnt(7)
v_lshlrev_b32 v216, 16, v200
v_mfma_f32_16x16x32_bf16 v[116:119], a[196:199], v[168:171], v[116:119]
v_and_b32 v217, s59, v200
v_lshlrev_b32 v218, 16, v201
v_mfma_f32_16x16x32_bf16 v[120:123], a[200:203], v[168:171], v[120:123]
ds_read_b128 v[164:167], v2 offset:13312
v_and_b32 v219, s59, v201
v_mfma_f32_16x16x32_bf16 v[120:123], a[216:219], v[172:175], v[120:123]
v_lshlrev_b32 v220, 16, v202
v_and_b32 v221, s59, v202
v_mfma_f32_16x16x32_bf16 v[124:127], a[220:223], v[172:175], v[124:127]
v_lshlrev_b32 v222, 16, v203
v_and_b32 v223, s59, v203
v_mfma_f32_16x16x32_bf16 v[124:127], a[204:207], v[168:171], v[124:127]
s_waitcnt vmcnt(6)
v_lshlrev_b32 v224, 16, v204
v_and_b32 v225, s59, v204
s_waitcnt lgkmcnt(8)
v_mfma_f32_16x16x32_bf16 v[124:127], a[12:15], v[144:147], v[124:127]
ds_read_b128 v[168:171], v2 offset:14336
v_lshlrev_b32 v226, 16, v205
v_mfma_f32_16x16x32_bf16 v[124:127], a[28:31], v[148:151], v[124:127]
v_and_b32 v227, s59, v205
v_lshlrev_b32 v228, 16, v206
v_mfma_f32_16x16x32_bf16 v[120:123], a[24:27], v[148:151], v[120:123]
v_and_b32 v229, s59, v206
v_lshlrev_b32 v230, 16, v207
v_mfma_f32_16x16x32_bf16 v[120:123], a[8:11], v[144:147], v[120:123]
v_and_b32 v231, s59, v207
s_add_u32 s35, s56, 32768
v_mfma_f32_16x16x32_bf16 v[116:119], a[4:7], v[144:147], v[116:119]
ds_read_b128 v[172:175], v2 offset:15360
v_mfma_f32_16x16x32_bf16 v[116:119], a[20:23], v[148:151], v[116:119]
s_waitcnt lgkmcnt(7)
buffer_store_dwordx4 v[240:243], v7, s[16:19], s35 offen offset:0 nt
v_mfma_f32_16x16x32_bf16 v[112:115], a[16:19], v[148:151], v[112:115]
s_waitcnt lgkmcnt(3)
buffer_store_dwordx4 v[244:247], v7, s[16:19], s35 offen offset:64 nt
v_mfma_f32_16x16x32_bf16 v[112:115], a[0:3], v[144:147], v[112:115]
v_add_f32 v216, v216, v128
v_add_f32 v217, v217, v129
v_mfma_f32_16x16x32_bf16 v[112:115], a[224:227], v[152:155], v[112:115]
v_add_f32 v218, v218, v130
v_add_f32 v219, v219, v131
v_mfma_f32_16x16x32_bf16 v[112:115], a[240:243], v[156:159], v[112:115]
v_add_f32 v220, v220, v132
v_add_f32 v221, v221, v133
v_mfma_f32_16x16x32_bf16 v[116:119], a[244:247], v[156:159], v[116:119]
v_add_f32 v222, v222, v134
v_add_f32 v223, v223, v135
v_mfma_f32_16x16x32_bf16 v[116:119], a[228:231], v[152:155], v[116:119]
v_cvt_pk_bf16_f32 v232, v216, v217
v_cvt_pk_bf16_f32 v233, v218, v219
v_mfma_f32_16x16x32_bf16 v[120:123], a[232:235], v[152:155], v[120:123]
v_cvt_pk_bf16_f32 v234, v220, v221
v_cvt_pk_bf16_f32 v235, v222, v223
v_mfma_f32_16x16x32_bf16 v[120:123], a[248:251], v[156:159], v[120:123]
ds_write_b128 v6, v[232:235] offset:0
v_mfma_f32_16x16x32_bf16 v[124:127], a[252:255], v[156:159], v[124:127]
ds_read_b128 v[240:243], v8 offset:0
v_add_f32 v224, v224, v136
v_add_f32 v225, v225, v137
v_mfma_f32_16x16x32_bf16 v[124:127], a[236:239], v[152:155], v[124:127]
v_add_f32 v226, v226, v138
v_add_f32 v227, v227, v139
s_waitcnt lgkmcnt(4)
v_mfma_f32_16x16x32_bf16 v[124:127], a[44:47], v[160:163], v[124:127]
v_add_f32 v228, v228, v140
v_add_f32 v229, v229, v141
v_mfma_f32_16x16x32_bf16 v[124:127], a[60:63], v[164:167], v[124:127]
v_add_f32 v230, v230, v142
v_add_f32 v231, v231, v143
v_mfma_f32_16x16x32_bf16 v[120:123], a[56:59], v[164:167], v[120:123]
v_cvt_pk_bf16_f32 v236, v224, v225
v_cvt_pk_bf16_f32 v237, v226, v227
v_mfma_f32_16x16x32_bf16 v[120:123], a[40:43], v[160:163], v[120:123]
v_cvt_pk_bf16_f32 v238, v228, v229
v_cvt_pk_bf16_f32 v239, v230, v231
v_mfma_f32_16x16x32_bf16 v[116:119], a[36:39], v[160:163], v[116:119]
ds_write_b128 v6, v[236:239] offset:1024
v_mfma_f32_16x16x32_bf16 v[116:119], a[52:55], v[164:167], v[116:119]
ds_read_b128 v[244:247], v8 offset:1024
v_mfma_f32_16x16x32_bf16 v[112:115], a[48:51], v[164:167], v[112:115]
s_waitcnt vmcnt(7)
v_lshlrev_b32 v216, 16, v208
v_and_b32 v217, s59, v208
v_mfma_f32_16x16x32_bf16 v[112:115], a[32:35], v[160:163], v[112:115]
v_lshlrev_b32 v218, 16, v209
v_and_b32 v219, s59, v209
s_waitcnt lgkmcnt(4)
v_mfma_f32_16x16x32_bf16 v[112:115], a[64:67], v[168:171], v[112:115]
v_lshlrev_b32 v220, 16, v210
v_and_b32 v221, s59, v210
v_mfma_f32_16x16x32_bf16 v[112:115], a[80:83], v[172:175], v[112:115]
v_lshlrev_b32 v222, 16, v211
v_and_b32 v223, s59, v211
v_mfma_f32_16x16x32_bf16 v[116:119], a[84:87], v[172:175], v[116:119]
s_waitcnt vmcnt(6)
v_lshlrev_b32 v224, 16, v212
v_and_b32 v225, s59, v212
v_lshlrev_b32 v226, 16, v213
v_mfma_f32_16x16x32_bf16 v[116:119], a[68:71], v[168:171], v[116:119]
v_and_b32 v227, s59, v213
v_lshlrev_b32 v228, 16, v214
v_mfma_f32_16x16x32_bf16 v[120:123], a[72:75], v[168:171], v[120:123]
v_and_b32 v229, s59, v214
v_lshlrev_b32 v230, 16, v215
v_mfma_f32_16x16x32_bf16 v[120:123], a[88:91], v[172:175], v[120:123]
v_and_b32 v231, s59, v215
s_add_u32 s35, s56, 49152
v_mfma_f32_16x16x32_bf16 v[124:127], a[92:95], v[172:175], v[124:127]
s_waitcnt lgkmcnt(2)
buffer_store_dwordx4 v[240:243], v7, s[16:19], s35 offen offset:0 nt
v_mfma_f32_16x16x32_bf16 v[124:127], a[76:79], v[168:171], v[124:127]
s_waitcnt lgkmcnt(0)
buffer_store_dwordx4 v[244:247], v7, s[16:19], s35 offen offset:64 nt
s_nop 5
v_pk_add_f32 v[216:217], v[216:217], v[112:113]
v_pk_add_f32 v[218:219], v[218:219], v[114:115]
v_pk_add_f32 v[220:221], v[220:221], v[116:117]
v_pk_add_f32 v[222:223], v[222:223], v[118:119]
v_cvt_pk_bf16_f32 v232, v216, v217
v_cvt_pk_bf16_f32 v233, v218, v219
v_cvt_pk_bf16_f32 v234, v220, v221
v_cvt_pk_bf16_f32 v235, v222, v223
ds_write_b128 v6, v[232:235] offset:0
ds_read_b128 v[240:243], v8 offset:0
v_pk_add_f32 v[224:225], v[224:225], v[120:121]
v_pk_add_f32 v[226:227], v[226:227], v[122:123]
v_pk_add_f32 v[228:229], v[228:229], v[124:125]
v_pk_add_f32 v[230:231], v[230:231], v[126:127]
v_cvt_pk_bf16_f32 v236, v224, v225
v_cvt_pk_bf16_f32 v237, v226, v227
v_cvt_pk_bf16_f32 v238, v228, v229
v_cvt_pk_bf16_f32 v239, v230, v231
ds_write_b128 v6, v[236:239] offset:1024
ds_read_b128 v[244:247], v8 offset:1024
s_add_u32 s35, s56, 65536
s_waitcnt lgkmcnt(2)
buffer_store_dwordx4 v[240:243], v7, s[16:19], s35 offen offset:0 nt
s_waitcnt lgkmcnt(0)
buffer_store_dwordx4 v[244:247], v7, s[16:19], s35 offen offset:64 nt
s_branch L_k2_fin
L_tailq:
v_add_u32 v2, 0x10000, v1
v_add_u32 v3, 81920, v1
v_bfe_u32 v8, v0, 2, 2
v_sub_u32 v8, 0, v8
v_lshrrev_b32 v6, 4, v0
v_xor_b32 v8, v8, v6
v_and_b32 v8, 3, v8
v_and_b32 v6, 15, v0
v_lshl_add_u32 v6, v6, 2, v8
v_lshlrev_b32 v6, 4, v6
v_add_u32 v6, s58, v6
v_add_u32 v8, s58, v1
v_add_u32 v4, 0x10000, v8
v_lshrrev_b32 v7, 4, v0
v_sub_u32 v7, 0, v7
v_xor_b32 v7, v7, v0
v_and_b32 v7, 3, v7
v_lshlrev_b32 v7, 4, v7
v_lshrrev_b32 v9, 2, v0
v_lshl_add_u32 v7, v9, 10, v7
v_and_b32 v252, 15, v0
v_lshlrev_b32 v252, 3, v252
v_add_u32 v252, 155648, v252
s_mul_i32 s35, s25, 4415120
s_add_u32 s36, s35, 4359931
s_lshr_b32 s35, s35, 22
s_lshr_b32 s36, s36, 22
v_and_b32 v250, 3, v0
v_add_u32 v250, s35, v250
v_min_u32 v250, s36, v250
s_mul_i32 s35, s23, 6784
s_add_u32 s35, s35, 0x340c800
v_lshl_add_u32 v250, v250, 7, s35
s_xor_b32 s35, s3, 2
s_lshl_b32 s35, s35, 8
s_add_u32 s35, s35, 0x3400000
v_and_b32 v9, 1, v0
v_lshl_add_u32 v9, v9, 7, s35
s_lshl_b32 s36, s21, 13
s_add_u32 s53, s53, s36
s_mul_i32 s57, s25, 80
v_and_b32 v236, 15, v0
v_add_u32 v236, s57, v236
v_lshrrev_b32 v237, 4, v0
v_lshlrev_b32 v237, 8, v237
v_add_u32 v238, 0, v236
v_mul_u32_u24 v239, 0xd795, v238
v_lshrrev_b32 v239, 22, v239
v_lshl_add_u32 v238, v239, 2, v238
v_and_b32 v239, 15, v238
v_lshl_add_u32 v239, v239, 4, v237
v_lshrrev_b32 v238, 4, v238
v_lshl_add_u32 v249, v238, 14, v239
v_add_u32 v238, 16, v236
v_mul_u32_u24 v239, 0xd795, v238
v_lshrrev_b32 v239, 22, v239
v_lshl_add_u32 v238, v239, 2, v238
v_and_b32 v239, 15, v238
v_lshl_add_u32 v239, v239, 4, v237
v_lshrrev_b32 v238, 4, v238
v_lshl_add_u32 v251, v238, 14, v239
v_add_u32 v238, 32, v236
v_mul_u32_u24 v239, 0xd795, v238
v_lshrrev_b32 v239, 22, v239
v_lshl_add_u32 v238, v239, 2, v238
v_and_b32 v239, 15, v238
v_lshl_add_u32 v239, v239, 4, v237
v_lshrrev_b32 v238, 4, v238
v_lshl_add_u32 v253, v238, 14, v239
v_add_u32 v238, 48, v236
v_mul_u32_u24 v239, 0xd795, v238
v_lshrrev_b32 v239, 22, v239
v_lshl_add_u32 v238, v239, 2, v238
v_and_b32 v239, 15, v238
v_lshl_add_u32 v239, v239, 4, v237
v_lshrrev_b32 v238, 4, v238
v_lshl_add_u32 v254, v238, 14, v239
v_add_u32 v238, 64, v236
v_mul_u32_u24 v239, 0xd795, v238
v_lshrrev_b32 v239, 22, v239
v_lshl_add_u32 v238, v239, 2, v238
v_and_b32 v239, 15, v238
v_lshl_add_u32 v239, v239, 4, v237
v_lshrrev_b32 v238, 4, v238
v_lshl_add_u32 v255, v238, 14, v239
s_waitcnt vmcnt(0) lgkmcnt(0)
s_barrier
ds_read_b128 v[144:147], v1 offset:0
ds_read_b128 v[148:151], v1 offset:1024
ds_read_b128 v[152:155], v1 offset:16384
ds_read_b128 v[156:159], v1 offset:17408
ds_read_b128 v[160:163], v1 offset:32768
ds_read_b128 v[164:167], v1 offset:33792
s_waitcnt lgkmcnt(4)
v_mfma_f32_16x16x32_bf16 v[32:35], a[96:99], v[144:147], 0
ds_read_b128 v[168:171], v1 offset:2048
s_add_u32 s49, s48, 65536
v_mfma_f32_16x16x32_bf16 v[32:35], a[112:115], v[148:151], v[32:35]
buffer_load_dwordx4 a[0:3], v1, s[8:11], s49 offen offset:0 sc1
v_mfma_f32_16x16x32_bf16 v[36:39], a[116:119], v[148:151], 0
v_mfma_f32_16x16x32_bf16 v[36:39], a[100:103], v[144:147], v[36:39]
buffer_load_dwordx4 a[4:7], v1, s[8:11], s49 offen offset:1024 sc1
v_mfma_f32_16x16x32_bf16 v[40:43], a[104:107], v[144:147], 0
ds_read_b128 v[172:175], v1 offset:3072
v_mfma_f32_16x16x32_bf16 v[40:43], a[120:123], v[148:151], v[40:43]
buffer_load_dwordx4 a[8:11], v1, s[8:11], s49 offen offset:2048 sc1
v_mfma_f32_16x16x32_bf16 v[44:47], a[124:127], v[148:151], 0
v_mfma_f32_16x16x32_bf16 v[44:47], a[108:111], v[144:147], v[44:47]
buffer_load_dwordx4 a[12:15], v1, s[8:11], s49 offen offset:3072 sc1
s_waitcnt lgkmcnt(4)
v_mfma_f32_16x16x32_bf16 v[60:63], a[108:111], v[152:155], 0
ds_read_b128 v[144:147], v1 offset:18432
s_add_u32 s49, s48, 69632
v_mfma_f32_16x16x32_bf16 v[60:63], a[124:127], v[156:159], v[60:63]
buffer_load_dwordx4 a[16:19], v1, s[8:11], s49 offen offset:0 sc1
v_mfma_f32_16x16x32_bf16 v[56:59], a[120:123], v[156:159], 0
v_mfma_f32_16x16x32_bf16 v[56:59], a[104:107], v[152:155], v[56:59]
buffer_load_dwordx4 a[20:23], v1, s[8:11], s49 offen offset:1024 sc1
v_mfma_f32_16x16x32_bf16 v[52:55], a[100:103], v[152:155], 0
ds_read_b128 v[148:151], v1 offset:19456
v_mfma_f32_16x16x32_bf16 v[52:55], a[116:119], v[156:159], v[52:55]
buffer_load_dwordx4 a[24:27], v1, s[8:11], s49 offen offset:2048 sc1
v_mfma_f32_16x16x32_bf16 v[48:51], a[112:115], v[156:159], 0
v_mfma_f32_16x16x32_bf16 v[48:51], a[96:99], v[152:155], v[48:51]
buffer_load_dwordx4 a[28:31], v1, s[8:11], s49 offen offset:3072 sc1
s_waitcnt lgkmcnt(4)
v_mfma_f32_16x16x32_bf16 v[64:67], a[96:99], v[160:163], 0
ds_read_b128 v[152:155], v1 offset:34816
s_add_u32 s49, s48, 73728
v_mfma_f32_16x16x32_bf16 v[64:67], a[112:115], v[164:167], v[64:67]
buffer_load_dwordx4 a[224:227], v1, s[8:11], s49 offen offset:0 sc1
v_mfma_f32_16x16x32_bf16 v[68:71], a[116:119], v[164:167], 0
v_mfma_f32_16x16x32_bf16 v[68:71], a[100:103], v[160:163], v[68:71]
buffer_load_dwordx4 a[228:231], v1, s[8:11], s49 offen offset:1024 sc1
v_mfma_f32_16x16x32_bf16 v[72:75], a[104:107], v[160:163], 0
ds_read_b128 v[156:159], v1 offset:35840
v_mfma_f32_16x16x32_bf16 v[72:75], a[120:123], v[164:167], v[72:75]
buffer_load_dwordx4 a[232:235], v1, s[8:11], s49 offen offset:2048 sc1
v_mfma_f32_16x16x32_bf16 v[76:79], a[124:127], v[164:167], 0
v_mfma_f32_16x16x32_bf16 v[76:79], a[108:111], v[160:163], v[76:79]
buffer_load_dwordx4 a[236:239], v1, s[8:11], s49 offen offset:3072 sc1
s_waitcnt lgkmcnt(4)
v_mfma_f32_16x16x32_bf16 v[44:47], a[140:143], v[168:171], v[44:47]
ds_read_b128 v[160:163], v1 offset:4096
s_add_u32 s49, s48, 77824
v_mfma_f32_16x16x32_bf16 v[44:47], a[156:159], v[172:175], v[44:47]
buffer_load_dwordx4 a[240:243], v1, s[8:11], s49 offen offset:0 sc1
v_mfma_f32_16x16x32_bf16 v[40:43], a[152:155], v[172:175], v[40:43]
v_mfma_f32_16x16x32_bf16 v[40:43], a[136:139], v[168:171], v[40:43]
buffer_load_dwordx4 a[244:247], v1, s[8:11], s49 offen offset:1024 sc1
v_mfma_f32_16x16x32_bf16 v[36:39], a[132:135], v[168:171], v[36:39]
ds_read_b128 v[164:167], v1 offset:5120
v_mfma_f32_16x16x32_bf16 v[36:39], a[148:151], v[172:175], v[36:39]
buffer_load_dwordx4 a[248:251], v1, s[8:11], s49 offen offset:2048 sc1
v_mfma_f32_16x16x32_bf16 v[32:35], a[144:147], v[172:175], v[32:35]
v_mfma_f32_16x16x32_bf16 v[32:35], a[128:131], v[168:171], v[32:35]
buffer_load_dwordx4 a[252:255], v1, s[8:11], s49 offen offset:3072 sc1
s_waitcnt lgkmcnt(4)
v_mfma_f32_16x16x32_bf16 v[48:51], a[128:131], v[144:147], v[48:51]
ds_read_b128 v[168:171], v1 offset:20480
s_add_u32 s49, s48, 98304
v_mfma_f32_16x16x32_bf16 v[48:51], a[144:147], v[148:151], v[48:51]
buffer_load_dwordx4 a[32:35], v1, s[8:11], s49 offen offset:0 sc1
v_mfma_f32_16x16x32_bf16 v[52:55], a[148:151], v[148:151], v[52:55]
v_mfma_f32_16x16x32_bf16 v[52:55], a[132:135], v[144:147], v[52:55]
buffer_load_dwordx4 a[36:39], v1, s[8:11], s49 offen offset:1024 sc1
v_mfma_f32_16x16x32_bf16 v[56:59], a[136:139], v[144:147], v[56:59]
ds_read_b128 v[172:175], v1 offset:21504
v_mfma_f32_16x16x32_bf16 v[56:59], a[152:155], v[148:151], v[56:59]
buffer_load_dwordx4 a[40:43], v1, s[8:11], s49 offen offset:2048 sc1
v_mfma_f32_16x16x32_bf16 v[60:63], a[156:159], v[148:151], v[60:63]
v_mfma_f32_16x16x32_bf16 v[60:63], a[140:143], v[144:147], v[60:63]
buffer_load_dwordx4 a[44:47], v1, s[8:11], s49 offen offset:3072 sc1
s_waitcnt lgkmcnt(4)
v_mfma_f32_16x16x32_bf16 v[76:79], a[140:143], v[152:155], v[76:79]
ds_read_b128 v[144:147], v1 offset:36864
s_add_u32 s49, s48, 102400
v_mfma_f32_16x16x32_bf16 v[76:79], a[156:159], v[156:159], v[76:79]
buffer_load_dwordx4 a[48:51], v1, s[8:11], s49 offen offset:0 sc1
v_mfma_f32_16x16x32_bf16 v[72:75], a[152:155], v[156:159], v[72:75]
v_mfma_f32_16x16x32_bf16 v[72:75], a[136:139], v[152:155], v[72:75]
buffer_load_dwordx4 a[52:55], v1, s[8:11], s49 offen offset:1024 sc1
v_mfma_f32_16x16x32_bf16 v[68:71], a[132:135], v[152:155], v[68:71]
ds_read_b128 v[148:151], v1 offset:37888
v_mfma_f32_16x16x32_bf16 v[68:71], a[148:151], v[156:159], v[68:71]
buffer_load_dwordx4 a[56:59], v1, s[8:11], s49 offen offset:2048 sc1
v_mfma_f32_16x16x32_bf16 v[64:67], a[144:147], v[156:159], v[64:67]
v_mfma_f32_16x16x32_bf16 v[64:67], a[128:131], v[152:155], v[64:67]
buffer_load_dwordx4 a[60:63], v1, s[8:11], s49 offen offset:3072 sc1
s_waitcnt lgkmcnt(4)
v_mfma_f32_16x16x32_bf16 v[32:35], a[160:163], v[160:163], v[32:35]
ds_read_b128 v[152:155], v1 offset:6144
s_add_u32 s49, s48, 106496
v_mfma_f32_16x16x32_bf16 v[32:35], a[176:179], v[164:167], v[32:35]
buffer_load_dwordx4 a[64:67], v1, s[8:11], s49 offen offset:0 sc1
v_mfma_f32_16x16x32_bf16 v[36:39], a[180:183], v[164:167], v[36:39]
v_mfma_f32_16x16x32_bf16 v[36:39], a[164:167], v[160:163], v[36:39]
buffer_load_dwordx4 a[68:71], v1, s[8:11], s49 offen offset:1024 sc1
v_mfma_f32_16x16x32_bf16 v[40:43], a[168:171], v[160:163], v[40:43]
ds_read_b128 v[156:159], v1 offset:7168
v_mfma_f32_16x16x32_bf16 v[40:43], a[184:187], v[164:167], v[40:43]
buffer_load_dwordx4 a[72:75], v1, s[8:11], s49 offen offset:2048 sc1
v_mfma_f32_16x16x32_bf16 v[44:47], a[188:191], v[164:167], v[44:47]
v_mfma_f32_16x16x32_bf16 v[44:47], a[172:175], v[160:163], v[44:47]
buffer_load_dwordx4 a[76:79], v1, s[8:11], s49 offen offset:3072 sc1
s_waitcnt lgkmcnt(4)
v_mfma_f32_16x16x32_bf16 v[60:63], a[172:175], v[168:171], v[60:63]
ds_read_b128 v[160:163], v1 offset:22528
s_add_u32 s49, s48, 110592
v_mfma_f32_16x16x32_bf16 v[60:63], a[188:191], v[172:175], v[60:63]
buffer_load_dwordx4 a[80:83], v1, s[8:11], s49 offen offset:0 sc1
v_mfma_f32_16x16x32_bf16 v[56:59], a[184:187], v[172:175], v[56:59]
v_mfma_f32_16x16x32_bf16 v[56:59], a[168:171], v[168:171], v[56:59]
buffer_load_dwordx4 a[84:87], v1, s[8:11], s49 offen offset:1024 sc1
v_mfma_f32_16x16x32_bf16 v[52:55], a[164:167], v[168:171], v[52:55]
ds_read_b128 v[164:167], v1 offset:23552
v_mfma_f32_16x16x32_bf16 v[52:55], a[180:183], v[172:175], v[52:55]
buffer_load_dwordx4 a[88:91], v1, s[8:11], s49 offen offset:2048 sc1
v_mfma_f32_16x16x32_bf16 v[48:51], a[176:179], v[172:175], v[48:51]
v_mfma_f32_16x16x32_bf16 v[48:51], a[160:163], v[168:171], v[48:51]
buffer_load_dwordx4 a[92:95], v1, s[8:11], s49 offen offset:3072 sc1
s_waitcnt lgkmcnt(4)
v_mfma_f32_16x16x32_bf16 v[64:67], a[160:163], v[144:147], v[64:67]
ds_read_b128 v[168:171], v1 offset:38912
v_mfma_f32_16x16x32_bf16 v[64:67], a[176:179], v[148:151], v[64:67]
buffer_load_dword v5, v9, s[8:11], 0 offen sc1
v_mfma_f32_16x16x32_bf16 v[68:71], a[180:183], v[148:151], v[68:71]
v_mfma_f32_16x16x32_bf16 v[68:71], a[164:167], v[144:147], v[68:71]
v_mfma_f32_16x16x32_bf16 v[72:75], a[168:171], v[144:147], v[72:75]
ds_read_b128 v[172:175], v1 offset:39936
v_mfma_f32_16x16x32_bf16 v[72:75], a[184:187], v[148:151], v[72:75]
v_mfma_f32_16x16x32_bf16 v[76:79], a[188:191], v[148:151], v[76:79]
v_mfma_f32_16x16x32_bf16 v[76:79], a[172:175], v[144:147], v[76:79]
s_waitcnt lgkmcnt(4)
v_mfma_f32_16x16x32_bf16 v[44:47], a[204:207], v[152:155], v[44:47]
ds_read_b128 v[144:147], v1 offset:8192
v_mfma_f32_16x16x32_bf16 v[44:47], a[220:223], v[156:159], v[44:47]
v_mfma_f32_16x16x32_bf16 v[40:43], a[216:219], v[156:159], v[40:43]
v_mfma_f32_16x16x32_bf16 v[40:43], a[200:203], v[152:155], v[40:43]
v_mfma_f32_16x16x32_bf16 v[36:39], a[196:199], v[152:155], v[36:39]
ds_read_b128 v[148:151], v1 offset:9216
v_mfma_f32_16x16x32_bf16 v[36:39], a[212:215], v[156:159], v[36:39]
v_mfma_f32_16x16x32_bf16 v[32:35], a[208:211], v[156:159], v[32:35]
v_mfma_f32_16x16x32_bf16 v[32:35], a[192:195], v[152:155], v[32:35]
s_waitcnt lgkmcnt(4)
v_mfma_f32_16x16x32_bf16 v[48:51], a[192:195], v[160:163], v[48:51]
ds_read_b128 v[152:155], v1 offset:24576
v_mfma_f32_16x16x32_bf16 v[48:51], a[208:211], v[164:167], v[48:51]
v_mfma_f32_16x16x32_bf16 v[52:55], a[212:215], v[164:167], v[52:55]
v_mfma_f32_16x16x32_bf16 v[52:55], a[196:199], v[160:163], v[52:55]
v_mfma_f32_16x16x32_bf16 v[56:59], a[200:203], v[160:163], v[56:59]
ds_read_b128 v[156:159], v1 offset:25600
v_mfma_f32_16x16x32_bf16 v[56:59], a[216:219], v[164:167], v[56:59]
v_mfma_f32_16x16x32_bf16 v[60:63], a[220:223], v[164:167], v[60:63]
v_mfma_f32_16x16x32_bf16 v[60:63], a[204:207], v[160:163], v[60:63]
s_waitcnt lgkmcnt(4)
v_mfma_f32_16x16x32_bf16 v[76:79], a[204:207], v[168:171], v[76:79]
ds_read_b128 v[160:163], v1 offset:40960
v_mfma_f32_16x16x32_bf16 v[76:79], a[220:223], v[172:175], v[76:79]
v_mfma_f32_16x16x32_bf16 v[72:75], a[216:219], v[172:175], v[72:75]
v_mfma_f32_16x16x32_bf16 v[72:75], a[200:203], v[168:171], v[72:75]
v_mfma_f32_16x16x32_bf16 v[68:71], a[196:199], v[168:171], v[68:71]
ds_read_b128 v[164:167], v1 offset:41984
v_mfma_f32_16x16x32_bf16 v[68:71], a[212:215], v[172:175], v[68:71]
v_mfma_f32_16x16x32_bf16 v[64:67], a[208:211], v[172:175], v[64:67]
v_mfma_f32_16x16x32_bf16 v[64:67], a[192:195], v[168:171], v[64:67]
s_waitcnt vmcnt(25) lgkmcnt(4)
v_mfma_f32_16x16x32_bf16 v[32:35], a[0:3], v[144:147], v[32:35]
ds_read_b128 v[168:171], v1 offset:10240
v_mfma_f32_16x16x32_bf16 v[32:35], a[16:19], v[148:151], v[32:35]
s_waitcnt vmcnt(0)
v_cmp_ne_u32 vcc, s7, v5
v_mfma_f32_16x16x32_bf16 v[36:39], a[20:23], v[148:151], v[36:39]
v_mfma_f32_16x16x32_bf16 v[36:39], a[4:7], v[144:147], v[36:39]
s_cbranch_vccnz L_spinP
L_okP:
v_mfma_f32_16x16x32_bf16 v[40:43], a[8:11], v[144:147], v[40:43]
ds_read_b128 v[172:175], v1 offset:11264
s_add_u32 m0, s36, 81920
s_add_u32 s34, s53, 0
v_mfma_f32_16x16x32_bf16 v[40:43], a[24:27], v[148:151], v[40:43]
buffer_load_dwordx4 v1, s[8:11], s34 offen offset:0 sc1 lds
v_mfma_f32_16x16x32_bf16 v[44:47], a[28:31], v[148:151], v[44:47]
v_mfma_f32_16x16x32_bf16 v[44:47], a[12:15], v[144:147], v[44:47]
buffer_load_dwordx4 v1, s[8:11], s34 offen offset:1024 sc1 lds
s_waitcnt lgkmcnt(4)
v_mfma_f32_16x16x32_bf16 v[60:63], a[12:15], v[152:155], v[60:63]
ds_read_b128 v[144:147], v1 offset:26624
v_mfma_f32_16x16x32_bf16 v[60:63], a[28:31], v[156:159], v[60:63]
buffer_load_dwordx4 v1, s[8:11], s34 offen offset:2048 sc1 lds
v_mfma_f32_16x16x32_bf16 v[56:59], a[24:27], v[156:159], v[56:59]
v_mfma_f32_16x16x32_bf16 v[56:59], a[8:11], v[152:155], v[56:59]
buffer_load_dwordx4 v1, s[8:11], s34 offen offset:3072 sc1 lds
v_mfma_f32_16x16x32_bf16 v[52:55], a[4:7], v[152:155], v[52:55]
ds_read_b128 v[148:151], v1 offset:27648
s_add_u32 m0, s36, 86016
s_add_u32 s34, s53, 4096
v_mfma_f32_16x16x32_bf16 v[52:55], a[20:23], v[156:159], v[52:55]
buffer_load_dwordx4 v1, s[8:11], s34 offen offset:0 sc1 lds
v_mfma_f32_16x16x32_bf16 v[48:51], a[16:19], v[156:159], v[48:51]
v_mfma_f32_16x16x32_bf16 v[48:51], a[0:3], v[152:155], v[48:51]
buffer_load_dwordx4 v1, s[8:11], s34 offen offset:1024 sc1 lds
s_waitcnt lgkmcnt(4)
v_mfma_f32_16x16x32_bf16 v[64:67], a[0:3], v[160:163], v[64:67]
ds_read_b128 v[152:155], v1 offset:43008
v_mfma_f32_16x16x32_bf16 v[64:67], a[16:19], v[164:167], v[64:67]
buffer_load_dwordx4 v1, s[8:11], s34 offen offset:2048 sc1 lds
v_mfma_f32_16x16x32_bf16 v[68:71], a[20:23], v[164:167], v[68:71]
v_mfma_f32_16x16x32_bf16 v[68:71], a[4:7], v[160:163], v[68:71]
buffer_load_dwordx4 v1, s[8:11], s34 offen offset:3072 sc1 lds
v_mfma_f32_16x16x32_bf16 v[72:75], a[8:11], v[160:163], v[72:75]
ds_read_b128 v[156:159], v1 offset:44032
s_mov_b32 m0, 155648
v_mfma_f32_16x16x32_bf16 v[72:75], a[24:27], v[164:167], v[72:75]
buffer_load_dwordx4 v1, s[8:11], s54 offen sc1 lds
v_mfma_f32_16x16x32_bf16 v[76:79], a[28:31], v[164:167], v[76:79]
s_add_u32 m0, s36, 98304
s_add_u32 s34, s53, 16384
v_mfma_f32_16x16x32_bf16 v[76:79], a[12:15], v[160:163], v[76:79]
buffer_load_dwordx4 v1, s[8:11], s34 offen offset:0 sc1 lds
s_waitcnt lgkmcnt(4)
v_mfma_f32_16x16x32_bf16 v[44:47], a[236:239], v[168:171], v[44:47]
ds_read_b128 v[160:163], v1 offset:12288
v_mfma_f32_16x16x32_bf16 v[44:47], a[252:255], v[172:175], v[44:47]
v_mfma_f32_16x16x32_bf16 v[40:43], a[248:251], v[172:175], v[40:43]
v_mfma_f32_16x16x32_bf16 v[40:43], a[232:235], v[168:171], v[40:43]
buffer_load_dwordx4 v1, s[8:11], s34 offen offset:1024 sc1 lds
v_mfma_f32_16x16x32_bf16 v[36:39], a[228:231], v[168:171], v[36:39]
ds_read_b128 v[164:167], v1 offset:13312
v_mfma_f32_16x16x32_bf16 v[36:39], a[244:247], v[172:175], v[36:39]
v_mfma_f32_16x16x32_bf16 v[32:35], a[240:243], v[172:175], v[32:35]
v_mfma_f32_16x16x32_bf16 v[32:35], a[224:227], v[168:171], v[32:35]
buffer_load_dwordx4 v1, s[8:11], s34 offen offset:2048 sc1 lds
s_waitcnt lgkmcnt(4)
v_mfma_f32_16x16x32_bf16 v[48:51], a[224:227], v[144:147], v[48:51]
ds_read_b128 v[168:171], v1 offset:28672
v_mfma_f32_16x16x32_bf16 v[48:51], a[240:243], v[148:151], v[48:51]
v_mfma_f32_16x16x32_bf16 v[52:55], a[244:247], v[148:151], v[52:55]
v_mfma_f32_16x16x32_bf16 v[52:55], a[228:231], v[144:147], v[52:55]
buffer_load_dwordx4 v1, s[8:11], s34 offen offset:3072 sc1 lds
v_mfma_f32_16x16x32_bf16 v[56:59], a[232:235], v[144:147], v[56:59]
ds_read_b128 v[172:175], v1 offset:29696
v_mfma_f32_16x16x32_bf16 v[56:59], a[248:251], v[148:151], v[56:59]
v_mfma_f32_16x16x32_bf16 v[60:63], a[252:255], v[148:151], v[60:63]
s_add_u32 m0, s36, 102400
s_add_u32 s34, s53, 20480
v_mfma_f32_16x16x32_bf16 v[60:63], a[236:239], v[144:147], v[60:63]
buffer_load_dwordx4 v1, s[8:11], s34 offen offset:0 sc1 lds
s_waitcnt lgkmcnt(4)
v_mfma_f32_16x16x32_bf16 v[76:79], a[236:239], v[152:155], v[76:79]
ds_read_b128 v[144:147], v1 offset:45056
v_mfma_f32_16x16x32_bf16 v[76:79], a[252:255], v[156:159], v[76:79]
v_mfma_f32_16x16x32_bf16 v[72:75], a[248:251], v[156:159], v[72:75]
v_mfma_f32_16x16x32_bf16 v[72:75], a[232:235], v[152:155], v[72:75]
buffer_load_dwordx4 v1, s[8:11], s34 offen offset:1024 sc1 lds
v_mfma_f32_16x16x32_bf16 v[68:71], a[228:231], v[152:155], v[68:71]
ds_read_b128 v[148:151], v1 offset:46080
v_mfma_f32_16x16x32_bf16 v[68:71], a[244:247], v[156:159], v[68:71]
v_mfma_f32_16x16x32_bf16 v[64:67], a[240:243], v[156:159], v[64:67]
v_mfma_f32_16x16x32_bf16 v[64:67], a[224:227], v[152:155], v[64:67]
buffer_load_dwordx4 v1, s[8:11], s34 offen offset:2048 sc1 lds
s_waitcnt lgkmcnt(4)
v_mfma_f32_16x16x32_bf16 v[32:35], a[32:35], v[160:163], v[32:35]
ds_read_b128 v[152:155], v1 offset:14336
v_mfma_f32_16x16x32_bf16 v[32:35], a[48:51], v[164:167], v[32:35]
v_mfma_f32_16x16x32_bf16 v[36:39], a[52:55], v[164:167], v[36:39]
v_mfma_f32_16x16x32_bf16 v[36:39], a[36:39], v[160:163], v[36:39]
buffer_load_dwordx4 v1, s[8:11], s34 offen offset:3072 sc1 lds
v_mfma_f32_16x16x32_bf16 v[40:43], a[40:43], v[160:163], v[40:43]
ds_read_b128 v[156:159], v1 offset:15360
v_mfma_f32_16x16x32_bf16 v[40:43], a[56:59], v[164:167], v[40:43]
v_mfma_f32_16x16x32_bf16 v[44:47], a[60:63], v[164:167], v[44:47]
v_mfma_f32_16x16x32_bf16 v[44:47], a[44:47], v[160:163], v[44:47]
s_waitcnt lgkmcnt(4)
v_mfma_f32_16x16x32_bf16 v[60:63], a[44:47], v[168:171], v[60:63]
ds_read_b128 v[160:163], v1 offset:30720
v_mfma_f32_16x16x32_bf16 v[60:63], a[60:63], v[172:175], v[60:63]
v_mfma_f32_16x16x32_bf16 v[56:59], a[56:59], v[172:175], v[56:59]
v_mfma_f32_16x16x32_bf16 v[56:59], a[40:43], v[168:171], v[56:59]
v_mfma_f32_16x16x32_bf16 v[52:55], a[36:39], v[168:171], v[52:55]
ds_read_b128 v[164:167], v1 offset:31744
v_mfma_f32_16x16x32_bf16 v[52:55], a[52:55], v[172:175], v[52:55]
v_mfma_f32_16x16x32_bf16 v[48:51], a[48:51], v[172:175], v[48:51]
v_mfma_f32_16x16x32_bf16 v[48:51], a[32:35], v[168:171], v[48:51]
s_waitcnt lgkmcnt(4)
v_mfma_f32_16x16x32_bf16 v[64:67], a[32:35], v[144:147], v[64:67]
ds_read_b128 v[168:171], v1 offset:47104
v_mfma_f32_16x16x32_bf16 v[64:67], a[48:51], v[148:151], v[64:67]
v_mfma_f32_16x16x32_bf16 v[68:71], a[52:55], v[148:151], v[68:71]
v_mfma_f32_16x16x32_bf16 v[68:71], a[36:39], v[144:147], v[68:71]
v_mfma_f32_16x16x32_bf16 v[72:75], a[40:43], v[144:147], v[72:75]
ds_read_b128 v[172:175], v1 offset:48128
v_mfma_f32_16x16x32_bf16 v[72:75], a[56:59], v[148:151], v[72:75]
v_mfma_f32_16x16x32_bf16 v[76:79], a[60:63], v[148:151], v[76:79]
v_mfma_f32_16x16x32_bf16 v[76:79], a[44:47], v[144:147], v[76:79]
s_waitcnt lgkmcnt(4)
v_mfma_f32_16x16x32_bf16 v[44:47], a[76:79], v[152:155], v[44:47]
v_mfma_f32_16x16x32_bf16 v[44:47], a[92:95], v[156:159], v[44:47]
v_mfma_f32_16x16x32_bf16 v[40:43], a[88:91], v[156:159], v[40:43]
v_mfma_f32_16x16x32_bf16 v[40:43], a[72:75], v[152:155], v[40:43]
v_mfma_f32_16x16x32_bf16 v[36:39], a[68:71], v[152:155], v[36:39]
v_mfma_f32_16x16x32_bf16 v[36:39], a[84:87], v[156:159], v[36:39]
v_mfma_f32_16x16x32_bf16 v[32:35], a[80:83], v[156:159], v[32:35]
v_mfma_f32_16x16x32_bf16 v[32:35], a[64:67], v[152:155], v[32:35]
s_waitcnt lgkmcnt(2)
v_mfma_f32_16x16x32_bf16 v[48:51], a[64:67], v[160:163], v[48:51]
v_mfma_f32_16x16x32_bf16 v[48:51], a[80:83], v[164:167], v[48:51]
v_mfma_f32_16x16x32_bf16 v[52:55], a[84:87], v[164:167], v[52:55]
v_mfma_f32_16x16x32_bf16 v[52:55], a[68:71], v[160:163], v[52:55]
v_mfma_f32_16x16x32_bf16 v[56:59], a[72:75], v[160:163], v[56:59]
v_mfma_f32_16x16x32_bf16 v[56:59], a[88:91], v[164:167], v[56:59]
v_mfma_f32_16x16x32_bf16 v[60:63], a[92:95], v[164:167], v[60:63]
v_mfma_f32_16x16x32_bf16 v[60:63], a[76:79], v[160:163], v[60:63]
s_waitcnt lgkmcnt(0)
v_mfma_f32_16x16x32_bf16 v[76:79], a[76:79], v[168:171], v[76:79]
v_mfma_f32_16x16x32_bf16 v[76:79], a[92:95], v[172:175], v[76:79]
v_mfma_f32_16x16x32_bf16 v[72:75], a[88:91], v[172:175], v[72:75]
v_mfma_f32_16x16x32_bf16 v[72:75], a[72:75], v[168:171], v[72:75]
v_mfma_f32_16x16x32_bf16 v[68:71], a[68:71], v[168:171], v[68:71]
v_mfma_f32_16x16x32_bf16 v[68:71], a[84:87], v[172:175], v[68:71]
v_mfma_f32_16x16x32_bf16 v[64:67], a[80:83], v[172:175], v[64:67]
v_mfma_f32_16x16x32_bf16 v[64:67], a[64:67], v[168:171], v[64:67]
s_branch L_tail2
L_spinP:
s_mov_b32 s57, 0
L_spinP_l:
buffer_load_dword v5, v9, s[8:11], 0 offen sc1
s_waitcnt vmcnt(0)
v_cmp_ne_u32 vcc, s7, v5
s_cbranch_vccz L_okP
s_add_u32 s57, s57, 1
s_cmp_lt_u32 s57, 0x40000
s_cbranch_scc1 L_spinP_l
s_branch L_okP
L_spinC:
s_mov_b32 s57, 0
L_spinC_l:
buffer_load_dword v5, v250, s[8:11], 0 offen sc1
s_waitcnt vmcnt(0)
v_cmp_ne_u32 vcc, s7, v5
s_cbranch_vccz L_okC
s_add_u32 s57, s57, 1
s_cmp_lt_u32 s57, 0x40000
s_cbranch_scc1 L_spinC_l
s_branch L_okC
L_prec0:
s_mov_b32 s38, 0
s_branch L_precx
L_prec1:
s_mov_b32 s38, 1
L_precx:
s_waitcnt lgkmcnt(0)
s_barrier
v_and_b32 v7, 0xfffffffb, v4
ds_read_b64 v[10:11], v7 offset:0
ds_read_b64 v[12:13], v7 offset:512
ds_read_b64 v[14:15], v7 offset:1024
ds_read_b64 v[16:17], v7 offset:1536
ds_read_b64 v[18:19], v7 offset:2048
s_waitcnt lgkmcnt(0)
v_max3_f32 v10, v10, v11, 0
v_sub_f32 v10, 0, v10
v_exp_f32 v10, v10
v_max3_f32 v12, v12, v13, 0
v_sub_f32 v12, 0, v12
v_exp_f32 v12, v12
v_max3_f32 v14, v14, v15, 0
v_sub_f32 v14, 0, v14
v_exp_f32 v14, v14
v_max3_f32 v16, v16, v17, 0
v_sub_f32 v16, 0, v16
v_exp_f32 v16, v16
v_max3_f32 v18, v18, v19, 0
v_sub_f32 v18, 0, v18
v_exp_f32 v18, v18
s_nop 7
v_mul_f32 v32, v32, v10
v_mul_f32 v33, v33, v10
v_mul_f32 v34, v34, v10
v_mul_f32 v35, v35, v10
v_mul_f32 v36, v36, v10
v_mul_f32 v37, v37, v10
v_mul_f32 v38, v38, v10
v_mul_f32 v39, v39, v10
v_mul_f32 v40, v40, v10
v_mul_f32 v41, v41, v10
v_mul_f32 v42, v42, v10
v_mul_f32 v43, v43, v10
v_mul_f32 v44, v44, v10
v_mul_f32 v45, v45, v10
v_mul_f32 v46, v46, v10
v_mul_f32 v47, v47, v10
v_mul_f32 v48, v48, v10
v_mul_f32 v49, v49, v10
v_mul_f32 v50, v50, v10
v_mul_f32 v51, v51, v10
v_mul_f32 v52, v52, v10
v_mul_f32 v53, v53, v10
v_mul_f32 v54, v54, v10
v_mul_f32 v55, v55, v10
v_mul_f32 v56, v56, v10
v_mul_f32 v57, v57, v10
v_mul_f32 v58, v58, v10
v_mul_f32 v59, v59, v10
v_mul_f32 v60, v60, v10
v_mul_f32 v61, v61, v10
v_mul_f32 v62, v62, v10
v_mul_f32 v63, v63, v10
v_mul_f32 v64, v64, v10
v_mul_f32 v65, v65, v10
v_mul_f32 v66, v66, v10
v_mul_f32 v67, v67, v10
v_mul_f32 v68, v68, v10
v_mul_f32 v69, v69, v10
v_mul_f32 v70, v70, v10
v_mul_f32 v71, v71, v10
v_mul_f32 v72, v72, v10
v_mul_f32 v73, v73, v10
v_mul_f32 v74, v74, v10
v_mul_f32 v75, v75, v10
v_mul_f32 v76, v76, v10
v_mul_f32 v77, v77, v10
v_mul_f32 v78, v78, v10
v_mul_f32 v79, v79, v10
v_mul_f32 v80, v80, v10
v_mul_f32 v81, v81, v10
v_mul_f32 v82, v82, v10
v_mul_f32 v83, v83, v10
v_mul_f32 v84, v84, v10
v_mul_f32 v85, v85, v10
v_mul_f32 v86, v86, v10
v_mul_f32 v87, v87, v10
v_mul_f32 v88, v88, v10
v_mul_f32 v89, v89, v10
v_mul_f32 v90, v90, v10
v_mul_f32 v91, v91, v10
v_mul_f32 v92, v92, v10
v_mul_f32 v93, v93, v10
v_mul_f32 v94, v94, v10
v_mul_f32 v95, v95, v10
v_mul_f32 v96, v96, v12
v_mul_f32 v97, v97, v12
v_mul_f32 v98, v98, v12
v_mul_f32 v99, v99, v12
v_mul_f32 v100, v100, v12
v_mul_f32 v101, v101, v12
v_mul_f32 v102, v102, v12
v_mul_f32 v103, v103, v12
v_mul_f32 v104, v104, v12
v_mul_f32 v105, v105, v12
v_mul_f32 v106, v106, v12
v_mul_f32 v107, v107, v12
v_mul_f32 v108, v108, v12
v_mul_f32 v109, v109, v12
v_mul_f32 v110, v110, v12
v_mul_f32 v111, v111, v12
v_mul_f32 v112, v112, v12
v_mul_f32 v113, v113, v12
v_mul_f32 v114, v114, v12
v_mul_f32 v115, v115, v12
v_mul_f32 v116, v116, v12
v_mul_f32 v117, v117, v12
v_mul_f32 v118, v118, v12
v_mul_f32 v119, v119, v12
v_mul_f32 v120, v120, v12
v_mul_f32 v121, v121, v12
v_mul_f32 v122, v122, v12
v_mul_f32 v123, v123, v12
v_mul_f32 v124, v124, v12
v_mul_f32 v125, v125, v12
v_mul_f32 v126, v126, v12
v_mul_f32 v127, v127, v12
v_mul_f32 v128, v128, v12
v_mul_f32 v129, v129, v12
v_mul_f32 v130, v130, v12
v_mul_f32 v131, v131, v12
v_mul_f32 v132, v132, v12
v_mul_f32 v133, v133, v12
v_mul_f32 v134, v134, v12
v_mul_f32 v135, v135, v12
v_mul_f32 v136, v136, v12
v_mul_f32 v137, v137, v12
v_mul_f32 v138, v138, v12
v_mul_f32 v139, v139, v12
v_mul_f32 v140, v140, v12
v_mul_f32 v141, v141, v12
v_mul_f32 v142, v142, v12
v_mul_f32 v143, v143, v12
v_mul_f32 v144, v144, v12
v_mul_f32 v145, v145, v12
v_mul_f32 v146, v146, v12
v_mul_f32 v147, v147, v12
v_mul_f32 v148, v148, v12
v_mul_f32 v149, v149, v12
v_mul_f32 v150, v150, v12
v_mul_f32 v151, v151, v12
v_mul_f32 v152, v152, v12
v_mul_f32 v153, v153, v12
v_mul_f32 v154, v154, v12
v_mul_f32 v155, v155, v12
v_mul_f32 v156, v156, v12
v_mul_f32 v157, v157, v12
v_mul_f32 v158, v158, v12
v_mul_f32 v159, v159, v12
v_mul_f32 v160, v160, v14
v_mul_f32 v161, v161, v14
v_mul_f32 v162, v162, v14
v_mul_f32 v163, v163, v14
v_mul_f32 v164, v164, v14
v_mul_f32 v165, v165, v14
v_mul_f32 v166, v166, v14
v_mul_f32 v167, v167, v14
v_mul_f32 v168, v168, v14
v_mul_f32 v169, v169, v14
v_mul_f32 v170, v170, v14
v_mul_f32 v171, v171, v14
v_mul_f32 v172, v172, v14
v_mul_f32 v173, v173, v14
v_mul_f32 v174, v174, v14
v_mul_f32 v175, v175, v14
v_mul_f32 v176, v176, v14
v_mul_f32 v177, v177, v14
v_mul_f32 v178, v178, v14
v_mul_f32 v179, v179, v14
v_mul_f32 v180, v180, v14
v_mul_f32 v181, v181, v14
v_mul_f32 v182, v182, v14
v_mul_f32 v183, v183, v14
v_mul_f32 v184, v184, v14
v_mul_f32 v185, v185, v14
v_mul_f32 v186, v186, v14
v_mul_f32 v187, v187, v14
v_mul_f32 v188, v188, v14
v_mul_f32 v189, v189, v14
v_mul_f32 v190, v190, v14
v_mul_f32 v191, v191, v14
v_mul_f32 v192, v192, v14
v_mul_f32 v193, v193, v14
v_mul_f32 v194, v194, v14
v_mul_f32 v195, v195, v14
v_mul_f32 v196, v196, v14
v_mul_f32 v197, v197, v14
v_mul_f32 v198, v198, v14
v_mul_f32 v199, v199, v14
v_mul_f32 v200, v200, v14
v_mul_f32 v201, v201, v14
v_mul_f32 v202, v202, v14
v_mul_f32 v203, v203, v14
v_mul_f32 v204, v204, v14
v_mul_f32 v205, v205, v14
v_mul_f32 v206, v206, v14
v_mul_f32 v207, v207, v14
v_mul_f32 v208, v208, v14
v_mul_f32 v209, v209, v14
v_mul_f32 v210, v210, v14
v_mul_f32 v211, v211, v14
v_mul_f32 v212, v212, v14
v_mul_f32 v213, v213, v14
v_mul_f32 v214, v214, v14
v_mul_f32 v215, v215, v14
v_mul_f32 v216, v216, v14
v_mul_f32 v217, v217, v14
v_mul_f32 v218, v218, v14
v_mul_f32 v219, v219, v14
v_mul_f32 v220, v220, v14
v_mul_f32 v221, v221, v14
v_mul_f32 v222, v222, v14
v_mul_f32 v223, v223, v14
v_mul_f32 v224, v224, v16
v_mul_f32 v225, v225, v16
v_mul_f32 v226, v226, v16
v_mul_f32 v227, v227, v16
v_mul_f32 v228, v228, v16
v_mul_f32 v229, v229, v16
v_mul_f32 v230, v230, v16
v_mul_f32 v231, v231, v16
v_mul_f32 v232, v232, v16
v_mul_f32 v233, v233, v16
v_mul_f32 v234, v234, v16
v_mul_f32 v235, v235, v16
v_mul_f32 v236, v236, v16
v_mul_f32 v237, v237, v16
v_mul_f32 v238, v238, v16
v_mul_f32 v239, v239, v16
v_mul_f32 v240, v240, v16
v_mul_f32 v241, v241, v16
v_mul_f32 v242, v242, v16
v_mul_f32 v243, v243, v16
v_mul_f32 v244, v244, v16
v_mul_f32 v245, v245, v16
v_mul_f32 v246, v246, v16
v_mul_f32 v247, v247, v16
v_mul_f32 v248, v248, v16
v_mul_f32 v249, v249, v16
v_mul_f32 v250, v250, v16
v_mul_f32 v251, v251, v16
v_mul_f32 v252, v252, v16
v_mul_f32 v253, v253, v16
v_mul_f32 v254, v254, v16
v_mul_f32 v255, v255, v16
v_accvgpr_read_b32 v24, a0
v_accvgpr_read_b32 v25, a1
v_accvgpr_read_b32 v26, a2
v_accvgpr_read_b32 v27, a3
v_accvgpr_read_b32 v28, a4
v_accvgpr_read_b32 v29, a5
v_accvgpr_read_b32 v30, a6
v_accvgpr_read_b32 v31, a7
v_mul_f32 v24, v24, v16
v_mul_f32 v25, v25, v16
v_mul_f32 v26, v26, v16
v_mul_f32 v27, v27, v16
v_mul_f32 v28, v28, v16
v_mul_f32 v29, v29, v16
v_mul_f32 v30, v30, v16
v_mul_f32 v31, v31, v16
v_accvgpr_write_b32 a0, v24
v_accvgpr_write_b32 a1, v25
v_accvgpr_write_b32 a2, v26
v_accvgpr_write_b32 a3, v27
v_accvgpr_write_b32 a4, v28
v_accvgpr_write_b32 a5, v29
v_accvgpr_write_b32 a6, v30
v_accvgpr_write_b32 a7, v31
v_accvgpr_read_b32 v24, a8
v_accvgpr_read_b32 v25, a9
v_accvgpr_read_b32 v26, a10
v_accvgpr_read_b32 v27, a11
v_accvgpr_read_b32 v28, a12
v_accvgpr_read_b32 v29, a13
v_accvgpr_read_b32 v30, a14
v_accvgpr_read_b32 v31, a15
v_mul_f32 v24, v24, v16
v_mul_f32 v25, v25, v16
v_mul_f32 v26, v26, v16
v_mul_f32 v27, v27, v16
v_mul_f32 v28, v28, v16
v_mul_f32 v29, v29, v16
v_mul_f32 v30, v30, v16
v_mul_f32 v31, v31, v16
v_accvgpr_write_b32 a8, v24
v_accvgpr_write_b32 a9, v25
v_accvgpr_write_b32 a10, v26
v_accvgpr_write_b32 a11, v27
v_accvgpr_write_b32 a12, v28
v_accvgpr_write_b32 a13, v29
v_accvgpr_write_b32 a14, v30
v_accvgpr_write_b32 a15, v31
v_accvgpr_read_b32 v24, a16
v_accvgpr_read_b32 v25, a17
v_accvgpr_read_b32 v26, a18
v_accvgpr_read_b32 v27, a19
v_accvgpr_read_b32 v28, a20
v_accvgpr_read_b32 v29, a21
v_accvgpr_read_b32 v30, a22
v_accvgpr_read_b32 v31, a23
v_mul_f32 v24, v24, v16
v_mul_f32 v25, v25, v16
v_mul_f32 v26, v26, v16
v_mul_f32 v27, v27, v16
v_mul_f32 v28, v28, v16
v_mul_f32 v29, v29, v16
v_mul_f32 v30, v30, v16
v_mul_f32 v31, v31, v16
v_accvgpr_write_b32 a16, v24
v_accvgpr_write_b32 a17, v25
v_accvgpr_write_b32 a18, v26
v_accvgpr_write_b32 a19, v27
v_accvgpr_write_b32 a20, v28
v_accvgpr_write_b32 a21, v29
v_accvgpr_write_b32 a22, v30
v_accvgpr_write_b32 a23, v31
v_accvgpr_read_b32 v24, a24
v_accvgpr_read_b32 v25, a25
v_accvgpr_read_b32 v26, a26
v_accvgpr_read_b32 v27, a27
v_accvgpr_read_b32 v28, a28
v_accvgpr_read_b32 v29, a29
v_accvgpr_read_b32 v30, a30
v_accvgpr_read_b32 v31, a31
v_mul_f32 v24, v24, v16
v_mul_f32 v25, v25, v16
v_mul_f32 v26, v26, v16
v_mul_f32 v27, v27, v16
v_mul_f32 v28, v28, v16
v_mul_f32 v29, v29, v16
v_mul_f32 v30, v30, v16
v_mul_f32 v31, v31, v16
v_accvgpr_write_b32 a24, v24
v_accvgpr_write_b32 a25, v25
v_accvgpr_write_b32 a26, v26
v_accvgpr_write_b32 a27, v27
v_accvgpr_write_b32 a28, v28
v_accvgpr_write_b32 a29, v29
v_accvgpr_write_b32 a30, v30
v_accvgpr_write_b32 a31, v31
v_accvgpr_read_b32 v24, a32
v_accvgpr_read_b32 v25, a33
v_accvgpr_read_b32 v26, a34
v_accvgpr_read_b32 v27, a35
v_accvgpr_read_b32 v28, a36
v_accvgpr_read_b32 v29, a37
v_accvgpr_read_b32 v30, a38
v_accvgpr_read_b32 v31, a39
v_mul_f32 v24, v24, v18
v_mul_f32 v25, v25, v18
v_mul_f32 v26, v26, v18
v_mul_f32 v27, v27, v18
v_mul_f32 v28, v28, v18
v_mul_f32 v29, v29, v18
v_mul_f32 v30, v30, v18
v_mul_f32 v31, v31, v18
v_accvgpr_write_b32 a32, v24
v_accvgpr_write_b32 a33, v25
v_accvgpr_write_b32 a34, v26
v_accvgpr_write_b32 a35, v27
v_accvgpr_write_b32 a36, v28
v_accvgpr_write_b32 a37, v29
v_accvgpr_write_b32 a38, v30
v_accvgpr_write_b32 a39, v31
v_accvgpr_read_b32 v24, a40
v_accvgpr_read_b32 v25, a41
v_accvgpr_read_b32 v26, a42
v_accvgpr_read_b32 v27, a43
v_accvgpr_read_b32 v28, a44
v_accvgpr_read_b32 v29, a45
v_accvgpr_read_b32 v30, a46
v_accvgpr_read_b32 v31, a47
v_mul_f32 v24, v24, v18
v_mul_f32 v25, v25, v18
v_mul_f32 v26, v26, v18
v_mul_f32 v27, v27, v18
v_mul_f32 v28, v28, v18
v_mul_f32 v29, v29, v18
v_mul_f32 v30, v30, v18
v_mul_f32 v31, v31, v18
v_accvgpr_write_b32 a40, v24
v_accvgpr_write_b32 a41, v25
v_accvgpr_write_b32 a42, v26
v_accvgpr_write_b32 a43, v27
v_accvgpr_write_b32 a44, v28
v_accvgpr_write_b32 a45, v29
v_accvgpr_write_b32 a46, v30
v_accvgpr_write_b32 a47, v31
v_accvgpr_read_b32 v24, a48
v_accvgpr_read_b32 v25, a49
v_accvgpr_read_b32 v26, a50
v_accvgpr_read_b32 v27, a51
v_accvgpr_read_b32 v28, a52
v_accvgpr_read_b32 v29, a53
v_accvgpr_read_b32 v30, a54
v_accvgpr_read_b32 v31, a55
v_mul_f32 v24, v24, v18
v_mul_f32 v25, v25, v18
v_mul_f32 v26, v26, v18
v_mul_f32 v27, v27, v18
v_mul_f32 v28, v28, v18
v_mul_f32 v29, v29, v18
v_mul_f32 v30, v30, v18
v_mul_f32 v31, v31, v18
v_accvgpr_write_b32 a48, v24
v_accvgpr_write_b32 a49, v25
v_accvgpr_write_b32 a50, v26
v_accvgpr_write_b32 a51, v27
v_accvgpr_write_b32 a52, v28
v_accvgpr_write_b32 a53, v29
v_accvgpr_write_b32 a54, v30
v_accvgpr_write_b32 a55, v31
v_accvgpr_read_b32 v24, a56
v_accvgpr_read_b32 v25, a57
v_accvgpr_read_b32 v26, a58
v_accvgpr_read_b32 v27, a59
v_accvgpr_read_b32 v28, a60
v_accvgpr_read_b32 v29, a61
v_accvgpr_read_b32 v30, a62
v_accvgpr_read_b32 v31, a63
v_mul_f32 v24, v24, v18
v_mul_f32 v25, v25, v18
v_mul_f32 v26, v26, v18
v_mul_f32 v27, v27, v18
v_mul_f32 v28, v28, v18
v_mul_f32 v29, v29, v18
v_mul_f32 v30, v30, v18
v_mul_f32 v31, v31, v18
v_accvgpr_write_b32 a56, v24
v_accvgpr_write_b32 a57, v25
v_accvgpr_write_b32 a58, v26
v_accvgpr_write_b32 a59, v27
v_accvgpr_write_b32 a60, v28
v_accvgpr_write_b32 a61, v29
v_accvgpr_write_b32 a62, v30
v_accvgpr_write_b32 a63, v31
v_accvgpr_read_b32 v24, a64
v_accvgpr_read_b32 v25, a65
v_accvgpr_read_b32 v26, a66
v_accvgpr_read_b32 v27, a67
v_accvgpr_read_b32 v28, a68
v_accvgpr_read_b32 v29, a69
v_accvgpr_read_b32 v30, a70
v_accvgpr_read_b32 v31, a71
v_mul_f32 v24, v24, v18
v_mul_f32 v25, v25, v18
v_mul_f32 v26, v26, v18
v_mul_f32 v27, v27, v18
v_mul_f32 v28, v28, v18
v_mul_f32 v29, v29, v18
v_mul_f32 v30, v30, v18
v_mul_f32 v31, v31, v18
v_accvgpr_write_b32 a64, v24
v_accvgpr_write_b32 a65, v25
v_accvgpr_write_b32 a66, v26
v_accvgpr_write_b32 a67, v27
v_accvgpr_write_b32 a68, v28
v_accvgpr_write_b32 a69, v29
v_accvgpr_write_b32 a70, v30
v_accvgpr_write_b32 a71, v31
v_accvgpr_read_b32 v24, a72
v_accvgpr_read_b32 v25, a73
v_accvgpr_read_b32 v26, a74
v_accvgpr_read_b32 v27, a75
v_accvgpr_read_b32 v28, a76
v_accvgpr_read_b32 v29, a77
v_accvgpr_read_b32 v30, a78
v_accvgpr_read_b32 v31, a79
v_mul_f32 v24, v24, v18
v_mul_f32 v25, v25, v18
v_mul_f32 v26, v26, v18
v_mul_f32 v27, v27, v18
v_mul_f32 v28, v28, v18
v_mul_f32 v29, v29, v18
v_mul_f32 v30, v30, v18
v_mul_f32 v31, v31, v18
v_accvgpr_write_b32 a72, v24
v_accvgpr_write_b32 a73, v25
v_accvgpr_write_b32 a74, v26
v_accvgpr_write_b32 a75, v27
v_accvgpr_write_b32 a76, v28
v_accvgpr_write_b32 a77, v29
v_accvgpr_write_b32 a78, v30
v_accvgpr_write_b32 a79, v31
v_accvgpr_read_b32 v24, a80
v_accvgpr_read_b32 v25, a81
v_accvgpr_read_b32 v26, a82
v_accvgpr_read_b32 v27, a83
v_accvgpr_read_b32 v28, a84
v_accvgpr_read_b32 v29, a85
v_accvgpr_read_b32 v30, a86
v_accvgpr_read_b32 v31, a87
v_mul_f32 v24, v24, v18
v_mul_f32 v25, v25, v18
v_mul_f32 v26, v26, v18
v_mul_f32 v27, v27, v18
v_mul_f32 v28, v28, v18
v_mul_f32 v29, v29, v18
v_mul_f32 v30, v30, v18
v_mul_f32 v31, v31, v18
v_accvgpr_write_b32 a80, v24
v_accvgpr_write_b32 a81, v25
v_accvgpr_write_b32 a82, v26
v_accvgpr_write_b32 a83, v27
v_accvgpr_write_b32 a84, v28
v_accvgpr_write_b32 a85, v29
v_accvgpr_write_b32 a86, v30
v_accvgpr_write_b32 a87, v31
v_accvgpr_read_b32 v24, a88
v_accvgpr_read_b32 v25, a89
v_accvgpr_read_b32 v26, a90
v_accvgpr_read_b32 v27, a91
v_accvgpr_read_b32 v28, a92
v_accvgpr_read_b32 v29, a93
v_accvgpr_read_b32 v30, a94
v_accvgpr_read_b32 v31, a95
v_mul_f32 v24, v24, v18
v_mul_f32 v25, v25, v18
v_mul_f32 v26, v26, v18
v_mul_f32 v27, v27, v18
v_mul_f32 v28, v28, v18
v_mul_f32 v29, v29, v18
v_mul_f32 v30, v30, v18
v_mul_f32 v31, v31, v18
v_accvgpr_write_b32 a88, v24
v_accvgpr_write_b32 a89, v25
v_accvgpr_write_b32 a90, v26
v_accvgpr_write_b32 a91, v27
v_accvgpr_write_b32 a92, v28
v_accvgpr_write_b32 a93, v29
v_accvgpr_write_b32 a94, v30
v_accvgpr_write_b32 a95, v31
s_barrier
s_cmp_eq_u32 s38, 0
s_cbranch_scc0 L_precy
ds_read2st64_b32 a[148:149], v3 offset0:20 offset1:21
ds_read2st64_b32 a[150:151], v3 offset0:22 offset1:23
ds_read2st64_b32 a[152:153], v3 offset0:24 offset1:25
ds_read2st64_b32 a[154:155], v3 offset0:26 offset1:27
ds_read2st64_b32 a[156:157], v3 offset0:28 offset1:29
ds_read2st64_b32 a[158:159], v3 offset0:30 offset1:31
ds_read2st64_b32 a[160:161], v3 offset0:32 offset1:33
ds_read2st64_b32 a[162:163], v3 offset0:34 offset1:35
ds_read2st64_b32 a[164:165], v3 offset0:36 offset1:37
ds_read2st64_b32 a[166:167], v3 offset0:38 offset1:39
s_waitcnt lgkmcnt(0)
s_cmp_eq_u32 s27, s26
s_branch L_pback0
L_precy:
ds_read2st64_b32 a[128:129], v3 offset0:0 offset1:1
ds_read2st64_b32 a[130:131], v3 offset0:2 offset1:3
ds_read2st64_b32 a[132:133], v3 offset0:4 offset1:5
ds_read2st64_b32 a[134:135], v3 offset0:6 offset1:7
ds_read2st64_b32 a[136:137], v3 offset0:8 offset1:9
ds_read2st64_b32 a[138:139], v3 offset0:10 offset1:11
ds_read2st64_b32 a[140:141], v3 offset0:12 offset1:13
ds_read2st64_b32 a[142:143], v3 offset0:14 offset1:15
ds_read2st64_b32 a[144:145], v3 offset0:16 offset1:17
ds_read2st64_b32 a[146:147], v3 offset0:18 offset1:19
s_waitcnt lgkmcnt(0)
s_cmp_lg_u32 s27, s26
s_branch L_pback1
L_spin0:
s_mov_b32 s21, 0
L_spin0_l:
buffer_load_dword v19, v18, s[8:11], 0 offen sc1
s_waitcnt vmcnt(0)
v_cmp_ne_u32 vcc, s7, v19
s_cbranch_vccz L_ok0
s_add_u32 s21, s21, 1
s_cmp_lt_u32 s21, 0x40000
s_cbranch_scc1 L_spin0_l
s_branch L_ok0
L_k2_fin:
s_endpgm
L_k2_conv:
s_mov_b32 s12, s48
s_and_b32 s13, s49, 0xffff
s_mov_b32 s14, 0x1400
s_mov_b32 s15, 0x20000
s_mov_b32 s16, s36
s_and_b32 s17, s37, 0xffff
s_mov_b32 s18, 0x7d0000
s_mov_b32 s19, 0x20000
s_mov_b32 s64, s50
s_and_b32 s65, s51, 0xffff
s_mov_b32 s66, 0x80000
s_mov_b32 s67, 0x20000
s_sub_u32 s21, s3, 200
s_and_b32 s22, s21, 15
s_lshr_b32 s23, s21, 4
s_lshl_b32 s24, s22, 15
s_lshl_b32 s25, s20, 8
s_add_u32 s24, s24, s25
s_add_u32 s25, s24, 4096
s_lshl_b32 s26, s20, 12
s_add_u32 s26, s26, 98304
s_add_u32 m0, s26, 0
s_nop 0
buffer_load_dwordx4 v4, s[64:67], s24 offen offset:0 lds
s_add_u32 m0, s26, 960
s_nop 0
buffer_load_dwordx4 v4, s[64:67], s24 offen offset:64 lds
s_add_u32 m0, s26, 1920
s_nop 0
buffer_load_dwordx4 v4, s[64:67], s24 offen offset:128 lds
s_add_u32 m0, s26, 2880
s_nop 0
buffer_load_dwordx4 v4, s[64:67], s24 offen offset:192 lds
s_add_u32 m0, s26, 16384
s_nop 0
buffer_load_dwordx4 v4, s[64:67], s25 offen offset:0 lds
s_add_u32 m0, s26, 17344
s_nop 0
buffer_load_dwordx4 v4, s[64:67], s25 offen offset:64 lds
s_add_u32 m0, s26, 18304
s_nop 0
buffer_load_dwordx4 v4, s[64:67], s25 offen offset:128 lds
s_add_u32 m0, s26, 19264
s_nop 0
buffer_load_dwordx4 v4, s[64:67], s25 offen offset:192 lds
s_mul_i32 s23, s23, 12
s_mul_i32 s27, s20, 3
s_add_u32 s23, s23, s27
s_lshl_b32 s22, s22, 10
s_add_u32 s22, s22, 0x3080000
s_add_u32 s27, s23, 0
s_min_u32 s34, s27, 31
s_lshl_b32 s34, s34, 14
s_add_u32 s28, s34, 0x3380000
s_add_u32 s34, s34, s22
s_cmp_lt_u32 s27, 32
s_cselect_b32 s31, s34, 0x10000000
s_add_u32 s27, s23, 1
s_min_u32 s34, s27, 31
s_lshl_b32 s34, s34, 14
s_add_u32 s29, s34, 0x3380000
s_add_u32 s34, s34, s22
s_cmp_lt_u32 s27, 32
s_cselect_b32 s32, s34, 0x10000000
s_add_u32 s27, s23, 2
s_min_u32 s34, s27, 31
s_lshl_b32 s34, s34, 14
s_add_u32 s30, s34, 0x3380000
s_add_u32 s34, s34, s22
s_cmp_lt_u32 s27, 32
s_cselect_b32 s33, s34, 0x10000000
s_barrier
buffer_load_dwordx4 a[0:3], v1, s[8:11], s28 offen offset:0 sc1
buffer_load_dwordx4 a[4:7], v1, s[8:11], s29 offen offset:0 sc1
buffer_load_dwordx4 a[8:11], v1, s[8:11], s30 offen offset:0 sc1
buffer_load_dwordx4 a[12:15], v1, s[8:11], s28 offen offset:1024 sc1
buffer_load_dwordx4 a[16:19], v1, s[8:11], s29 offen offset:1024 sc1
buffer_load_dwordx4 a[20:23], v1, s[8:11], s30 offen offset:1024 sc1
buffer_load_dwordx4 a[24:27], v1, s[8:11], s28 offen offset:2048 sc1
buffer_load_dwordx4 a[28:31], v1, s[8:11], s29 offen offset:2048 sc1
buffer_load_dwordx4 a[32:35], v1, s[8:11], s30 offen offset:2048 sc1
buffer_load_dwordx4 a[36:39], v1, s[8:11], s28 offen offset:3072 sc1
buffer_load_dwordx4 a[40:43], v1, s[8:11], s29 offen offset:3072 sc1
buffer_load_dwordx4 a[44:47], v1, s[8:11], s30 offen offset:3072 sc1
s_add_u32 s28, s28, 4096
s_add_u32 s29, s29, 4096
s_add_u32 s30, s30, 4096
buffer_load_dwordx4 a[48:51], v1, s[8:11], s28 offen offset:0 sc1
buffer_load_dwordx4 a[52:55], v1, s[8:11], s29 offen offset:0 sc1
buffer_load_dwordx4 a[56:59], v1, s[8:11], s30 offen offset:0 sc1
buffer_load_dwordx4 a[60:63], v1, s[8:11], s28 offen offset:1024 sc1
buffer_load_dwordx4 a[64:67], v1, s[8:11], s29 offen offset:1024 sc1
buffer_load_dwordx4 a[68:71], v1, s[8:11], s30 offen offset:1024 sc1
buffer_load_dwordx4 a[72:75], v1, s[8:11], s28 offen offset:2048 sc1
buffer_load_dwordx4 a[76:79], v1, s[8:11], s29 offen offset:2048 sc1
buffer_load_dwordx4 a[80:83], v1, s[8:11], s30 offen offset:2048 sc1
buffer_load_dwordx4 a[84:87], v1, s[8:11], s28 offen offset:3072 sc1
buffer_load_dwordx4 a[88:91], v1, s[8:11], s29 offen offset:3072 sc1
buffer_load_dwordx4 a[92:95], v1, s[8:11], s30 offen offset:3072 sc1
s_add_u32 s28, s28, 4096
s_add_u32 s29, s29, 4096
s_add_u32 s30, s30, 4096
v_bfe_u32 v3, v0, 2, 2
v_sub_u32 v3, 0, v3
v_lshrrev_b32 v2, 4, v0
v_xor_b32 v3, v3, v2
v_and_b32 v3, 3, v3
v_and_b32 v2, 15, v0
v_lshl_add_u32 v2, v2, 2, v3
v_lshlrev_b32 v2, 4, v2
v_add_u32 v2, 98304, v2
s_waitcnt vmcnt(24)
s_barrier
ds_read_b128 v[192:195], v2 offset:0
ds_read_b128 v[196:199], v2 offset:16384
ds_read_b128 v[200:203], v2 offset:1024
ds_read_b128 v[204:207], v2 offset:17408
ds_read_b128 v[208:211], v2 offset:2048
ds_read_b128 v[212:215], v2 offset:18432
ds_read_b128 v[216:219], v2 offset:3072
ds_read_b128 v[220:223], v2 offset:19456
buffer_load_dwordx4 a[96:99], v1, s[8:11], s28 offen offset:0 sc1
buffer_load_dwordx4 a[100:103], v1, s[8:11], s29 offen offset:0 sc1
buffer_load_dwordx4 a[104:107], v1, s[8:11], s30 offen offset:0 sc1
ds_read_b128 v[224:227], v2 offset:4096
ds_read_b128 v[228:231], v2 offset:20480
s_waitcnt vmcnt(24) lgkmcnt(8)
v_mfma_f32_16x16x32_bf16 v[92:95], v[192:195], a[0:3], 0
v_mfma_f32_16x16x32_bf16 v[96:99], v[196:199], a[0:3], 0
v_mfma_f32_16x16x32_bf16 v[100:103], v[192:195], a[4:7], 0
v_mfma_f32_16x16x32_bf16 v[104:107], v[196:199], a[4:7], 0
v_mfma_f32_16x16x32_bf16 v[108:111], v[192:195], a[8:11], 0
v_mfma_f32_16x16x32_bf16 v[112:115], v[196:199], a[8:11], 0
buffer_load_dwordx4 a[108:111], v1, s[8:11], s28 offen offset:1024 sc1
buffer_load_dwordx4 a[112:115], v1, s[8:11], s29 offen offset:1024 sc1
buffer_load_dwordx4 a[116:119], v1, s[8:11], s30 offen offset:1024 sc1
ds_read_b128 v[232:235], v2 offset:5120
ds_read_b128 v[236:239], v2 offset:21504
s_waitcnt vmcnt(24) lgkmcnt(8)
v_mfma_f32_16x16x32_bf16 v[92:95], v[200:203], a[12:15], v[92:95]
v_mfma_f32_16x16x32_bf16 v[96:99], v[204:207], a[12:15], v[96:99]
v_mfma_f32_16x16x32_bf16 v[100:103], v[200:203], a[16:19], v[100:103]
v_mfma_f32_16x16x32_bf16 v[104:107], v[204:207], a[16:19], v[104:107]
v_mfma_f32_16x16x32_bf16 v[108:111], v[200:203], a[20:23], v[108:111]
v_mfma_f32_16x16x32_bf16 v[112:115], v[204:207], a[20:23], v[112:115]
buffer_load_dwordx4 a[120:123], v1, s[8:11], s28 offen offset:2048 sc1
buffer_load_dwordx4 a[124:127], v1, s[8:11], s29 offen offset:2048 sc1
buffer_load_dwordx4 a[128:131], v1, s[8:11], s30 offen offset:2048 sc1
ds_read_b128 v[240:243], v2 offset:6144
ds_read_b128 v[244:247], v2 offset:22528
s_waitcnt vmcnt(24) lgkmcnt(8)
v_mfma_f32_16x16x32_bf16 v[92:95], v[208:211], a[24:27], v[92:95]
v_mfma_f32_16x16x32_bf16 v[96:99], v[212:215], a[24:27], v[96:99]
v_mfma_f32_16x16x32_bf16 v[100:103], v[208:211], a[28:31], v[100:103]
v_mfma_f32_16x16x32_bf16 v[104:107], v[212:215], a[28:31], v[104:107]
v_mfma_f32_16x16x32_bf16 v[108:111], v[208:211], a[32:35], v[108:111]
v_mfma_f32_16x16x32_bf16 v[112:115], v[212:215], a[32:35], v[112:115]
buffer_load_dwordx4 a[132:135], v1, s[8:11], s28 offen offset:3072 sc1
buffer_load_dwordx4 a[136:139], v1, s[8:11], s29 offen offset:3072 sc1
buffer_load_dwordx4 a[140:143], v1, s[8:11], s30 offen offset:3072 sc1
s_add_u32 s28, s28, 4096
s_add_u32 s29, s29, 4096
s_add_u32 s30, s30, 4096
ds_read_b128 v[248:251], v2 offset:7168
ds_read_b128 v[252:255], v2 offset:23552
s_waitcnt vmcnt(24) lgkmcnt(8)
v_mfma_f32_16x16x32_bf16 v[92:95], v[216:219], a[36:39], v[92:95]
v_mfma_f32_16x16x32_bf16 v[96:99], v[220:223], a[36:39], v[96:99]
v_mfma_f32_16x16x32_bf16 v[100:103], v[216:219], a[40:43], v[100:103]
v_mfma_f32_16x16x32_bf16 v[104:107], v[220:223], a[40:43], v[104:107]
v_mfma_f32_16x16x32_bf16 v[108:111], v[216:219], a[44:47], v[108:111]
v_mfma_f32_16x16x32_bf16 v[112:115], v[220:223], a[44:47], v[112:115]
buffer_load_dwordx4 a[144:147], v1, s[8:11], s28 offen offset:0 sc1
buffer_load_dwordx4 a[148:151], v1, s[8:11], s29 offen offset:0 sc1
buffer_load_dwordx4 a[152:155], v1, s[8:11], s30 offen offset:0 sc1
ds_read_b128 v[192:195], v2 offset:8192
ds_read_b128 v[196:199], v2 offset:24576
s_waitcnt vmcnt(24) lgkmcnt(8)
v_mfma_f32_16x16x32_bf16 v[92:95], v[224:227], a[48:51], v[92:95]
v_mfma_f32_16x16x32_bf16 v[96:99], v[228:231], a[48:51], v[96:99]
v_mfma_f32_16x16x32_bf16 v[100:103], v[224:227], a[52:55], v[100:103]
v_mfma_f32_16x16x32_bf16 v[104:107], v[228:231], a[52:55], v[104:107]
v_mfma_f32_16x16x32_bf16 v[108:111], v[224:227], a[56:59], v[108:111]
v_mfma_f32_16x16x32_bf16 v[112:115], v[228:231], a[56:59], v[112:115]
buffer_load_dwordx4 a[156:159], v1, s[8:11], s28 offen offset:1024 sc1
buffer_load_dwordx4 a[160:163], v1, s[8:11], s29 offen offset:1024 sc1
buffer_load_dwordx4 a[164:167], v1, s[8:11], s30 offen offset:1024 sc1
ds_read_b128 v[200:203], v2 offset:9216
ds_read_b128 v[204:207], v2 offset:25600
s_waitcnt vmcnt(24) lgkmcnt(8)
v_mfma_f32_16x16x32_bf16 v[92:95], v[232:235], a[60:63], v[92:95]
v_mfma_f32_16x16x32_bf16 v[96:99], v[236:239], a[60:63], v[96:99]
v_mfma_f32_16x16x32_bf16 v[100:103], v[232:235], a[64:67], v[100:103]
v_mfma_f32_16x16x32_bf16 v[104:107], v[236:239], a[64:67], v[104:107]
v_mfma_f32_16x16x32_bf16 v[108:111], v[232:235], a[68:71], v[108:111]
v_mfma_f32_16x16x32_bf16 v[112:115], v[236:239], a[68:71], v[112:115]
buffer_load_dwordx4 a[168:171], v1, s[8:11], s28 offen offset:2048 sc1
buffer_load_dwordx4 a[172:175], v1, s[8:11], s29 offen offset:2048 sc1
buffer_load_dwordx4 a[176:179], v1, s[8:11], s30 offen offset:2048 sc1
ds_read_b128 v[208:211], v2 offset:10240
ds_read_b128 v[212:215], v2 offset:26624
s_waitcnt vmcnt(24) lgkmcnt(8)
v_mfma_f32_16x16x32_bf16 v[92:95], v[240:243], a[72:75], v[92:95]
v_mfma_f32_16x16x32_bf16 v[96:99], v[244:247], a[72:75], v[96:99]
v_mfma_f32_16x16x32_bf16 v[100:103], v[240:243], a[76:79], v[100:103]
v_mfma_f32_16x16x32_bf16 v[104:107], v[244:247], a[76:79], v[104:107]
v_mfma_f32_16x16x32_bf16 v[108:111], v[240:243], a[80:83], v[108:111]
v_mfma_f32_16x16x32_bf16 v[112:115], v[244:247], a[80:83], v[112:115]
buffer_load_dwordx4 a[180:183], v1, s[8:11], s28 offen offset:3072 sc1
buffer_load_dwordx4 a[184:187], v1, s[8:11], s29 offen offset:3072 sc1
buffer_load_dwordx4 a[188:191], v1, s[8:11], s30 offen offset:3072 sc1
s_add_u32 s28, s28, 4096
s_add_u32 s29, s29, 4096
s_add_u32 s30, s30, 4096
ds_read_b128 v[216:219], v2 offset:11264
ds_read_b128 v[220:223], v2 offset:27648
s_waitcnt vmcnt(24) lgkmcnt(8)
v_mfma_f32_16x16x32_bf16 v[92:95], v[248:251], a[84:87], v[92:95]
v_mfma_f32_16x16x32_bf16 v[96:99], v[252:255], a[84:87], v[96:99]
v_mfma_f32_16x16x32_bf16 v[100:103], v[248:251], a[88:91], v[100:103]
v_mfma_f32_16x16x32_bf16 v[104:107], v[252:255], a[88:91], v[104:107]
v_mfma_f32_16x16x32_bf16 v[108:111], v[248:251], a[92:95], v[108:111]
v_mfma_f32_16x16x32_bf16 v[112:115], v[252:255], a[92:95], v[112:115]
ds_read_b128 v[224:227], v2 offset:12288
ds_read_b128 v[228:231], v2 offset:28672
s_waitcnt vmcnt(21) lgkmcnt(8)
v_mfma_f32_16x16x32_bf16 v[92:95], v[192:195], a[96:99], v[92:95]
v_mfma_f32_16x16x32_bf16 v[96:99], v[196:199], a[96:99], v[96:99]
v_mfma_f32_16x16x32_bf16 v[100:103], v[192:195], a[100:103], v[100:103]
v_mfma_f32_16x16x32_bf16 v[104:107], v[196:199], a[100:103], v[104:107]
v_mfma_f32_16x16x32_bf16 v[108:111], v[192:195], a[104:107], v[108:111]
v_mfma_f32_16x16x32_bf16 v[112:115], v[196:199], a[104:107], v[112:115]
ds_read_b128 v[232:235], v2 offset:13312
ds_read_b128 v[236:239], v2 offset:29696
s_waitcnt vmcnt(18) lgkmcnt(8)
v_mfma_f32_16x16x32_bf16 v[92:95], v[200:203], a[108:111], v[92:95]
v_mfma_f32_16x16x32_bf16 v[96:99], v[204:207], a[108:111], v[96:99]
v_mfma_f32_16x16x32_bf16 v[100:103], v[200:203], a[112:115], v[100:103]
v_mfma_f32_16x16x32_bf16 v[104:107], v[204:207], a[112:115], v[104:107]
v_mfma_f32_16x16x32_bf16 v[108:111], v[200:203], a[116:119], v[108:111]
v_mfma_f32_16x16x32_bf16 v[112:115], v[204:207], a[116:119], v[112:115]
ds_read_b128 v[240:243], v2 offset:14336
ds_read_b128 v[244:247], v2 offset:30720
s_waitcnt vmcnt(15) lgkmcnt(8)
v_mfma_f32_16x16x32_bf16 v[92:95], v[208:211], a[120:123], v[92:95]
v_mfma_f32_16x16x32_bf16 v[96:99], v[212:215], a[120:123], v[96:99]
v_mfma_f32_16x16x32_bf16 v[100:103], v[208:211], a[124:127], v[100:103]
v_mfma_f32_16x16x32_bf16 v[104:107], v[212:215], a[124:127], v[104:107]
v_mfma_f32_16x16x32_bf16 v[108:111], v[208:211], a[128:131], v[108:111]
v_mfma_f32_16x16x32_bf16 v[112:115], v[212:215], a[128:131], v[112:115]
ds_read_b128 v[248:251], v2 offset:15360
ds_read_b128 v[252:255], v2 offset:31744
s_waitcnt vmcnt(12) lgkmcnt(8)
v_mfma_f32_16x16x32_bf16 v[92:95], v[216:219], a[132:135], v[92:95]
v_mfma_f32_16x16x32_bf16 v[96:99], v[220:223], a[132:135], v[96:99]
v_mfma_f32_16x16x32_bf16 v[100:103], v[216:219], a[136:139], v[100:103]
v_mfma_f32_16x16x32_bf16 v[104:107], v[220:223], a[136:139], v[104:107]
v_mfma_f32_16x16x32_bf16 v[108:111], v[216:219], a[140:143], v[108:111]
v_mfma_f32_16x16x32_bf16 v[112:115], v[220:223], a[140:143], v[112:115]
s_waitcnt vmcnt(9) lgkmcnt(6)
v_mfma_f32_16x16x32_bf16 v[92:95], v[224:227], a[144:147], v[92:95]
v_mfma_f32_16x16x32_bf16 v[96:99], v[228:231], a[144:147], v[96:99]
v_mfma_f32_16x16x32_bf16 v[100:103], v[224:227], a[148:151], v[100:103]
v_mfma_f32_16x16x32_bf16 v[104:107], v[228:231], a[148:151], v[104:107]
v_mfma_f32_16x16x32_bf16 v[108:111], v[224:227], a[152:155], v[108:111]
v_mfma_f32_16x16x32_bf16 v[112:115], v[228:231], a[152:155], v[112:115]
s_waitcnt vmcnt(6) lgkmcnt(4)
v_mfma_f32_16x16x32_bf16 v[92:95], v[232:235], a[156:159], v[92:95]
v_mfma_f32_16x16x32_bf16 v[96:99], v[236:239], a[156:159], v[96:99]
v_mfma_f32_16x16x32_bf16 v[100:103], v[232:235], a[160:163], v[100:103]
v_mfma_f32_16x16x32_bf16 v[104:107], v[236:239], a[160:163], v[104:107]
v_mfma_f32_16x16x32_bf16 v[108:111], v[232:235], a[164:167], v[108:111]
v_mfma_f32_16x16x32_bf16 v[112:115], v[236:239], a[164:167], v[112:115]
s_waitcnt vmcnt(3) lgkmcnt(2)
v_mfma_f32_16x16x32_bf16 v[92:95], v[240:243], a[168:171], v[92:95]
v_mfma_f32_16x16x32_bf16 v[96:99], v[244:247], a[168:171], v[96:99]
v_mfma_f32_16x16x32_bf16 v[100:103], v[240:243], a[172:175], v[100:103]
v_mfma_f32_16x16x32_bf16 v[104:107], v[244:247], a[172:175], v[104:107]
v_mfma_f32_16x16x32_bf16 v[108:111], v[240:243], a[176:179], v[108:111]
v_mfma_f32_16x16x32_bf16 v[112:115], v[244:247], a[176:179], v[112:115]
s_waitcnt vmcnt(0) lgkmcnt(0)
v_mfma_f32_16x16x32_bf16 v[92:95], v[248:251], a[180:183], v[92:95]
v_mfma_f32_16x16x32_bf16 v[96:99], v[252:255], a[180:183], v[96:99]
v_mfma_f32_16x16x32_bf16 v[100:103], v[248:251], a[184:187], v[100:103]
v_mfma_f32_16x16x32_bf16 v[104:107], v[252:255], a[184:187], v[104:107]
v_mfma_f32_16x16x32_bf16 v[108:111], v[248:251], a[188:191], v[108:111]
v_mfma_f32_16x16x32_bf16 v[112:115], v[252:255], a[188:191], v[112:115]
s_nop 7
v_cvt_pk_bf16_f32 v92, v92, v93
v_cvt_pk_bf16_f32 v93, v94, v95
v_cvt_pk_bf16_f32 v94, v96, v97
v_cvt_pk_bf16_f32 v95, v98, v99
buffer_store_dwordx4 v[92:95], v1, s[8:11], s31 offen sc1
v_cvt_pk_bf16_f32 v100, v100, v101
v_cvt_pk_bf16_f32 v101, v102, v103
v_cvt_pk_bf16_f32 v102, v104, v105
v_cvt_pk_bf16_f32 v103, v106, v107
buffer_store_dwordx4 v[100:103], v1, s[8:11], s32 offen sc1
v_cvt_pk_bf16_f32 v108, v108, v109
v_cvt_pk_bf16_f32 v109, v110, v111
v_cvt_pk_bf16_f32 v110, v112, v113
v_cvt_pk_bf16_f32 v111, v114, v115
buffer_store_dwordx4 v[108:111], v1, s[8:11], s33 offen sc1
s_lshl_b32 s26, s20, 8
v_lshl_add_u32 v68, v0, 2, s26
s_mov_b32 s30, 4096
buffer_load_dword v28, v68, s[12:15], 0 offen offset:0
buffer_load_dword v29, v68, s[12:15], 0 offen offset:1024
buffer_load_dword v30, v68, s[12:15], 0 offen offset:2048
buffer_load_dword v31, v68, s[12:15], 0 offen offset:3072
buffer_load_dword v32, v68, s[12:15], s30 offen offset:0
s_sub_u32 s21, s3, 200
s_mul_i32 s22, s21, 76
s_sub_u32 s22, s22, 2
s_mov_b32 s23, 0
s_mov_b32 s31, 0
s_lshl_b32 s27, s20, 12
s_mul_i32 s43, s20, 15360
s_add_u32 s43, s43, 102400
s_lshl_b32 s44, s3, 7
s_add_u32 s44, s44, 0x3410000
s_lshl_b32 s33, s20, 17
s_add_u32 s34, s33, 0x3080000
s_add_u32 s33, s33, 0x3200000
s_add_u32 s32, s33, 0x80000
s_mov_b32 s24, s6
s_mov_b32 s28, 0xffff0000
s_mov_b32 s46, 0xbdd2d3e8
s_mov_b32 s47, 0xc0135761
s_mov_b32 s48, 1.0
s_mov_b32 s49, 1.0
v_bfe_u32 v69, v0, 2, 2
v_sub_u32 v69, 0, v69
v_lshrrev_b32 v2, 4, v0
v_xor_b32 v69, v69, v2
v_and_b32 v69, 3, v69
v_and_b32 v2, 15, v0
v_lshl_add_u32 v2, v2, 2, v69
v_lshlrev_b32 v2, 4, v2
v_add_u32 v3, 0x10000, v2
v_add_u32 v4, 0x10000, v1
v_lshrrev_b32 v70, 4, v0
v_sub_u32 v69, 0, v70
v_xor_b32 v69, v69, v0
v_and_b32 v69, 3, v69
v_lshlrev_b32 v69, 4, v69
v_lshrrev_b32 v5, 2, v0
v_lshl_add_u32 v5, v5, 10, v69
v_and_b32 v69, 15, v0
v_mul_u32_u24 v69, 5, v69
v_lshl_add_u32 v71, v70, 8, s27
s_lshr_b32 s30, s27, 3
s_add_u32 s30, s30, 81920
v_lshl_add_u32 v11, v70, 5, s30
v_add_u32 v70, -2, v69
v_min_u32 v70, 78, v70
v_and_b32 v72, 15, v70
v_lshl_add_u32 v72, v72, 4, v71
v_lshrrev_b32 v70, 4, v70
v_lshl_add_u32 v6, v70, 14, v72
v_add_u32 v70, -1, v69
v_min_u32 v70, 79, v70
v_and_b32 v72, 15, v70
v_lshl_add_u32 v72, v72, 4, v71
v_lshrrev_b32 v70, 4, v70
v_lshl_add_u32 v7, v70, 14, v72
v_add_u32 v70, 0, v69
v_and_b32 v72, 15, v70
v_lshl_add_u32 v72, v72, 4, v71
v_lshrrev_b32 v70, 4, v70
v_lshl_add_u32 v8, v70, 14, v72
v_add_u32 v70, 1, v69
v_and_b32 v72, 15, v70
v_lshl_add_u32 v72, v72, 4, v71
v_lshrrev_b32 v70, 4, v70
v_lshl_add_u32 v9, v70, 14, v72
v_add_u32 v70, 2, v69
v_and_b32 v72, 15, v70
v_lshl_add_u32 v72, v72, 4, v71
v_lshrrev_b32 v70, 4, v70
v_lshl_add_u32 v10, v70, 14, v72
v_and_b32 v69, 3, v0
v_cmp_eq_u32 s[36:37], 1, v69
v_cmp_eq_u32 s[38:39], 2, v69
v_cmp_eq_u32 s[40:41], 3, v69
v_lshrrev_b32 v56, 2, v0
v_mul_u32_u24 v56, 5, v56
s_add_u32 s30, s22, 4000
v_add_u32 v56, s30, v56
v_lshrrev_b32 v57, 4, v5
s_movk_i32 s30, 4000
v_mov_b32 v60, 7999
v_add_u32 v58, 0, v56
v_med3_i32 v58, v58, s30, v60
v_lshrrev_b32 v59, 2, v58
v_sub_u32 v59, 0, v59
v_xor_b32 v59, v59, v57
v_and_b32 v59, 3, v59
v_and_b32 v12, 15, v58
v_lshl_add_u32 v59, v12, 2, v59
v_lshrrev_b32 v12, 4, v58
v_lshl_add_u32 v12, v12, 10, v59
v_lshlrev_b32 v12, 4, v12
v_add_u32 v58, 1, v56
v_med3_i32 v58, v58, s30, v60
v_lshrrev_b32 v59, 2, v58
v_sub_u32 v59, 0, v59
v_xor_b32 v59, v59, v57
v_and_b32 v59, 3, v59
v_and_b32 v13, 15, v58
v_lshl_add_u32 v59, v13, 2, v59
v_lshrrev_b32 v13, 4, v58
v_lshl_add_u32 v13, v13, 10, v59
v_lshlrev_b32 v13, 4, v13
v_add_u32 v58, 2, v56
v_med3_i32 v58, v58, s30, v60
v_lshrrev_b32 v59, 2, v58
v_sub_u32 v59, 0, v59
v_xor_b32 v59, v59, v57
v_and_b32 v59, 3, v59
v_and_b32 v14, 15, v58
v_lshl_add_u32 v59, v14, 2, v59
v_lshrrev_b32 v14, 4, v58
v_lshl_add_u32 v14, v14, 10, v59
v_lshlrev_b32 v14, 4, v14
v_add_u32 v58, 3, v56
v_med3_i32 v58, v58, s30, v60
v_lshrrev_b32 v59, 2, v58
v_sub_u32 v59, 0, v59
v_xor_b32 v59, v59, v57
v_and_b32 v59, 3, v59
v_and_b32 v15, 15, v58
v_lshl_add_u32 v59, v15, 2, v59
v_lshrrev_b32 v15, 4, v58
v_lshl_add_u32 v15, v15, 10, v59
v_lshlrev_b32 v15, 4, v15
v_add_u32 v58, 4, v56
v_med3_i32 v58, v58, s30, v60
v_lshrrev_b32 v59, 2, v58
v_sub_u32 v59, 0, v59
v_xor_b32 v59, v59, v57
v_and_b32 v59, 3, v59
v_and_b32 v16, 15, v58
v_lshl_add_u32 v59, v16, 2, v59
v_lshrrev_b32 v16, 4, v58
v_lshl_add_u32 v16, v16, 10, v59
v_lshlrev_b32 v16, 4, v16
v_lshlrev_b32 v69, 2, v0
v_add_u32 v69, 94720, v69
ds_write_b32 v69, v12 offset:0
ds_write_b32 v69, v13 offset:256
ds_write_b32 v69, v14 offset:512
ds_write_b32 v69, v15 offset:768
ds_write_b32 v69, v16 offset:1024
v_lshlrev_b32 v68, 1, v68
v_add_u32 v68, 81920, v68
s_waitcnt vmcnt(4)
v_lshlrev_b32 v48, 16, v28
v_and_b32 v49, s28, v28
ds_write_b64 v68, v[48:49] offset:0
s_waitcnt vmcnt(3)
v_lshlrev_b32 v50, 16, v29
v_and_b32 v51, s28, v29
ds_write_b64 v68, v[50:51] offset:2048
s_waitcnt vmcnt(2)
v_lshlrev_b32 v52, 16, v30
v_and_b32 v53, s28, v30
ds_write_b64 v68, v[52:53] offset:4096
s_waitcnt vmcnt(1)
v_lshlrev_b32 v54, 16, v31
v_and_b32 v55, s28, v31
ds_write_b64 v68, v[54:55] offset:6144
s_waitcnt vmcnt(0)
v_lshlrev_b32 v56, 16, v32
v_and_b32 v57, s28, v32
ds_write_b64 v68, v[56:57] offset:8192
L_c_tile:
s_waitcnt vmcnt(10) lgkmcnt(0)
s_barrier
s_mov_b32 s25, 0
ds_read_b128 a[16:19], v3 offset:0
ds_read_b128 a[36:39], v3 offset:1024
ds_read_b128 a[32:35], v2 offset:50176
ds_read_b128 a[12:15], v2 offset:49152
ds_read_b128 a[8:11], v2 offset:32768
ds_read_b128 a[28:31], v2 offset:33792
ds_read_b128 a[24:27], v2 offset:17408
ds_read_b128 a[4:7], v2 offset:16384
ds_read_b128 a[0:3], v2 offset:0
ds_read_b128 a[20:23], v2 offset:1024
s_waitcnt lgkmcnt(8)
v_mfma_f32_16x16x32_bf16 v[104:107], v[128:131], a[16:19], 0
ds_read_b128 a[40:43], v2 offset:2048
buffer_load_dwordx4 v[184:187], v1, s[8:11], s24 offen offset:2048 sc1
v_mfma_f32_16x16x32_bf16 v[104:107], v[132:135], a[36:39], v[104:107]
ds_read_b128 a[60:63], v2 offset:3072
s_waitcnt lgkmcnt(8)
v_mfma_f32_16x16x32_bf16 v[100:103], v[132:135], a[32:35], 0
ds_read_b128 a[64:67], v2 offset:19456
v_mov_b32 v12, 0x3f803f80
v_mfma_f32_16x16x32_bf16 v[100:103], v[128:131], a[12:15], v[100:103]
ds_read_b128 a[44:47], v2 offset:18432
v_mov_b32 v13, 0x3f803f80
s_waitcnt lgkmcnt(8)
v_mfma_f32_16x16x32_bf16 v[96:99], v[128:131], a[8:11], 0
ds_read_b128 a[48:51], v2 offset:34816
v_mov_b32 v14, 0x3f803f80
v_mfma_f32_16x16x32_bf16 v[96:99], v[132:135], a[28:31], v[96:99]
ds_read_b128 a[68:71], v2 offset:35840
buffer_load_dwordx4 v[188:191], v1, s[8:11], s24 offen offset:3072 sc1
s_waitcnt lgkmcnt(8)
v_mfma_f32_16x16x32_bf16 v[92:95], v[132:135], a[24:27], 0
ds_read_b128 a[72:75], v2 offset:52224
s_add_u32 s24, s24, 4096
v_mfma_f32_16x16x32_bf16 v[92:95], v[128:131], a[4:7], v[92:95]
ds_read_b128 a[52:55], v2 offset:51200
v_mov_b32 v15, 0x3f803f80
s_waitcnt lgkmcnt(8)
v_mfma_f32_16x16x32_bf16 v[88:91], v[128:131], a[0:3], 0
ds_read_b128 a[56:59], v3 offset:2048
v_mfma_f32_16x16x32_bf16 v[88:91], v[132:135], a[20:23], v[88:91]
ds_read_b128 a[76:79], v3 offset:3072
v_mov_b32 v48, 0
s_waitcnt lgkmcnt(8)
v_mfma_f32_16x16x32_bf16 v[88:91], v[136:139], a[40:43], v[88:91]
ds_read_b128 a[96:99], v3 offset:4096
buffer_load_dwordx4 v[128:131], v1, s[8:11], s24 offen offset:0 sc1
v_mfma_f32_16x16x32_bf16 v[88:91], v[140:143], a[60:63], v[88:91]
ds_read_b128 a[116:119], v3 offset:5120
v_mov_b32 v49, 0
s_waitcnt lgkmcnt(8)
v_mfma_f32_16x16x32_bf16 v[92:95], v[140:143], a[64:67], v[92:95]
ds_read_b128 a[112:115], v2 offset:54272
v_mov_b32 v50, 0
v_mfma_f32_16x16x32_bf16 v[92:95], v[136:139], a[44:47], v[92:95]
ds_read_b128 a[92:95], v2 offset:53248
v_mov_b32 v51, 0
s_waitcnt lgkmcnt(8)
v_mfma_f32_16x16x32_bf16 v[96:99], v[136:139], a[48:51], v[96:99]
ds_read_b128 a[88:91], v2 offset:36864
v_mov_b32 v52, 0
v_mfma_f32_16x16x32_bf16 v[96:99], v[140:143], a[68:71], v[96:99]
ds_read_b128 a[108:111], v2 offset:37888
buffer_load_dwordx4 v[132:135], v1, s[8:11], s24 offen offset:1024 sc1
s_waitcnt lgkmcnt(8)
v_mfma_f32_16x16x32_bf16 v[100:103], v[140:143], a[72:75], v[100:103]
ds_read_b128 a[104:107], v2 offset:21504
v_mov_b32 v53, 0
v_mfma_f32_16x16x32_bf16 v[100:103], v[136:139], a[52:55], v[100:103]
ds_read_b128 a[84:87], v2 offset:20480
v_mov_b32 v54, 0
s_waitcnt lgkmcnt(8)
v_mfma_f32_16x16x32_bf16 v[104:107], v[136:139], a[56:59], v[104:107]
ds_read_b128 a[80:83], v2 offset:4096
v_mfma_f32_16x16x32_bf16 v[104:107], v[140:143], a[76:79], v[104:107]
ds_read_b128 a[100:103], v2 offset:5120
v_mov_b32 v55, 0
s_waitcnt lgkmcnt(8)
v_mfma_f32_16x16x32_bf16 v[104:107], v[144:147], a[96:99], v[104:107]
ds_read_b128 a[120:123], v2 offset:6144
buffer_load_dwordx4 v[136:139], v1, s[8:11], s24 offen offset:2048 sc1
v_mfma_f32_16x16x32_bf16 v[104:107], v[148:151], a[116:119], v[104:107]
ds_read_b128 a[140:143], v2 offset:7168
v_mov_b32 v56, 0
s_waitcnt lgkmcnt(8)
v_mfma_f32_16x16x32_bf16 v[100:103], v[148:151], a[112:115], v[100:103]
ds_read_b128 a[144:147], v2 offset:23552
v_mov_b32 v57, 0
v_mfma_f32_16x16x32_bf16 v[100:103], v[144:147], a[92:95], v[100:103]
ds_read_b128 a[124:127], v2 offset:22528
v_mov_b32 v58, 0
s_waitcnt lgkmcnt(8)
v_mfma_f32_16x16x32_bf16 v[96:99], v[144:147], a[88:91], v[96:99]
ds_read_b128 a[128:131], v2 offset:38912
v_mov_b32 v59, 0
v_mfma_f32_16x16x32_bf16 v[96:99], v[148:151], a[108:111], v[96:99]
ds_read_b128 a[148:151], v2 offset:39936
buffer_load_dwordx4 v[140:143], v1, s[8:11], s24 offen offset:3072 sc1
s_waitcnt lgkmcnt(8)
v_mfma_f32_16x16x32_bf16 v[92:95], v[148:151], a[104:107], v[92:95]
ds_read_b128 a[152:155], v2 offset:56320
s_add_u32 s24, s24, 4096
v_mfma_f32_16x16x32_bf16 v[92:95], v[144:147], a[84:87], v[92:95]
ds_read_b128 a[132:135], v2 offset:55296
v_mov_b32 v60, 0
s_waitcnt lgkmcnt(8)
v_mfma_f32_16x16x32_bf16 v[88:91], v[144:147], a[80:83], v[88:91]
ds_read_b128 a[136:139], v3 offset:6144
v_mfma_f32_16x16x32_bf16 v[88:91], v[148:151], a[100:103], v[88:91]
ds_read_b128 a[156:159], v3 offset:7168
v_mov_b32 v61, 0
s_waitcnt lgkmcnt(8)
v_mfma_f32_16x16x32_bf16 v[88:91], v[152:155], a[120:123], v[88:91]
ds_read_b128 a[176:179], v3 offset:8192
buffer_load_dwordx4 v[144:147], v1, s[8:11], s24 offen offset:0 sc1
v_mfma_f32_16x16x32_bf16 v[88:91], v[156:159], a[140:143], v[88:91]
ds_read_b128 a[196:199], v3 offset:9216
v_mov_b32 v62, 0
s_waitcnt lgkmcnt(8)
v_mfma_f32_16x16x32_bf16 v[92:95], v[156:159], a[144:147], v[92:95]
ds_read_b128 a[192:195], v2 offset:58368
v_mov_b32 v63, 0
v_mfma_f32_16x16x32_bf16 v[92:95], v[152:155], a[124:127], v[92:95]
ds_read_b128 a[172:175], v2 offset:57344
v_mov_b32 v64, 0
s_waitcnt lgkmcnt(8)
v_mfma_f32_16x16x32_bf16 v[96:99], v[152:155], a[128:131], v[96:99]
ds_read_b128 a[168:171], v2 offset:40960
v_mov_b32 v65, 0
v_mfma_f32_16x16x32_bf16 v[96:99], v[156:159], a[148:151], v[96:99]
ds_read_b128 a[188:191], v2 offset:41984
buffer_load_dwordx4 v[148:151], v1, s[8:11], s24 offen offset:1024 sc1
s_waitcnt lgkmcnt(8)
v_mfma_f32_16x16x32_bf16 v[100:103], v[156:159], a[152:155], v[100:103]
ds_read_b128 a[184:187], v2 offset:25600
v_mov_b32 v66, 0
v_mfma_f32_16x16x32_bf16 v[100:103], v[152:155], a[132:135], v[100:103]
ds_read_b128 a[164:167], v2 offset:24576
v_mov_b32 v67, 0
s_waitcnt lgkmcnt(8)
v_mfma_f32_16x16x32_bf16 v[104:107], v[152:155], a[136:139], v[104:107]
ds_read_b128 a[160:163], v2 offset:8192
s_waitcnt vmcnt(17)
v_mfma_f32_16x16x32_bf16 v[104:107], v[156:159], a[156:159], v[104:107]
ds_read_b128 a[180:183], v2 offset:9216
v_mov_b32 v68, 0
s_waitcnt lgkmcnt(8)
v_mfma_f32_16x16x32_bf16 v[104:107], v[160:163], a[176:179], v[104:107]
ds_read_b128 a[200:203], v2 offset:10240
buffer_load_dwordx4 v[152:155], v1, s[8:11], s24 offen offset:2048 sc1
v_mfma_f32_16x16x32_bf16 v[104:107], v[164:167], a[196:199], v[104:107]
ds_read_b128 a[220:223], v2 offset:11264
v_mov_b32 v69, 0
s_waitcnt lgkmcnt(8)
v_mfma_f32_16x16x32_bf16 v[100:103], v[164:167], a[192:195], v[100:103]
ds_read_b128 a[224:227], v2 offset:27648
v_mov_b32 v70, 0
v_mfma_f32_16x16x32_bf16 v[100:103], v[160:163], a[172:175], v[100:103]
ds_read_b128 a[204:207], v2 offset:26624
v_mov_b32 v71, 0
s_waitcnt lgkmcnt(8)
v_mfma_f32_16x16x32_bf16 v[96:99], v[160:163], a[168:171], v[96:99]
ds_read_b128 a[208:211], v2 offset:43008
v_mov_b32 v72, 0
v_mfma_f32_16x16x32_bf16 v[96:99], v[164:167], a[188:191], v[96:99]
ds_read_b128 a[228:231], v2 offset:44032
buffer_load_dwordx4 v[156:159], v1, s[8:11], s24 offen offset:3072 sc1
s_waitcnt lgkmcnt(8)
v_mfma_f32_16x16x32_bf16 v[92:95], v[164:167], a[184:187], v[92:95]
ds_read_b128 a[232:235], v2 offset:60416
s_add_u32 s24, s24, 4096
v_mfma_f32_16x16x32_bf16 v[92:95], v[160:163], a[164:167], v[92:95]
ds_read_b128 a[212:215], v2 offset:59392
v_mov_b32 v73, 0
s_waitcnt lgkmcnt(8)
v_mfma_f32_16x16x32_bf16 v[88:91], v[160:163], a[160:163], v[88:91]
ds_read_b128 a[216:219], v3 offset:10240
s_waitcnt vmcnt(17)
v_mfma_f32_16x16x32_bf16 v[88:91], v[164:167], a[180:183], v[88:91]
ds_read_b128 a[236:239], v3 offset:11264
v_mov_b32 v74, 0
s_waitcnt lgkmcnt(8)
v_mfma_f32_16x16x32_bf16 v[88:91], v[168:171], a[200:203], v[88:91]
ds_read_b128 v[192:195], v3 offset:12288
buffer_load_dwordx4 v[160:163], v1, s[8:11], s24 offen offset:0 sc1
v_mfma_f32_16x16x32_bf16 v[88:91], v[172:175], a[220:223], v[88:91]
ds_read_b128 v[212:215], v3 offset:13312
v_mov_b32 v75, 0
s_waitcnt lgkmcnt(8)
v_mfma_f32_16x16x32_bf16 v[92:95], v[172:175], a[224:227], v[92:95]
ds_read_b128 v[208:211], v2 offset:62464
v_mov_b32 v76, 0
v_mfma_f32_16x16x32_bf16 v[92:95], v[168:171], a[204:207], v[92:95]
ds_read_b128 a[252:255], v2 offset:61440
v_mov_b32 v77, 0
s_waitcnt lgkmcnt(8)
v_mfma_f32_16x16x32_bf16 v[96:99], v[168:171], a[208:211], v[96:99]
ds_read_b128 a[248:251], v2 offset:45056
v_mov_b32 v78, 0
v_mfma_f32_16x16x32_bf16 v[96:99], v[172:175], a[228:231], v[96:99]
ds_read_b128 v[204:207], v2 offset:46080
buffer_load_dwordx4 v[164:167], v1, s[8:11], s24 offen offset:1024 sc1
s_waitcnt lgkmcnt(8)
v_mfma_f32_16x16x32_bf16 v[100:103], v[172:175], a[232:235], v[100:103]
ds_read_b128 v[200:203], v2 offset:29696
v_mov_b32 v79, 0
v_mfma_f32_16x16x32_bf16 v[100:103], v[168:171], a[212:215], v[100:103]
ds_read_b128 a[244:247], v2 offset:28672
v_mov_b32 v80, 0
s_waitcnt lgkmcnt(8)
v_mfma_f32_16x16x32_bf16 v[104:107], v[168:171], a[216:219], v[104:107]
ds_read_b128 a[240:243], v2 offset:12288
s_waitcnt vmcnt(17)
v_mfma_f32_16x16x32_bf16 v[104:107], v[172:175], a[236:239], v[104:107]
ds_read_b128 v[196:199], v2 offset:13312
v_mov_b32 v81, 0
s_waitcnt lgkmcnt(8)
v_mfma_f32_16x16x32_bf16 v[104:107], v[176:179], v[192:195], v[104:107]
ds_read_b128 v[216:219], v2 offset:14336
buffer_load_dwordx4 v[168:171], v1, s[8:11], s24 offen offset:2048 sc1
v_mfma_f32_16x16x32_bf16 v[104:107], v[180:183], v[212:215], v[104:107]
ds_read_b128 v[236:239], v2 offset:15360
v_mov_b32 v82, 0
s_waitcnt lgkmcnt(8)
v_mfma_f32_16x16x32_bf16 v[100:103], v[180:183], v[208:211], v[100:103]
ds_read_b128 v[240:243], v2 offset:31744
v_mov_b32 v83, 0
v_mfma_f32_16x16x32_bf16 v[100:103], v[176:179], a[252:255], v[100:103]
ds_read_b128 v[220:223], v2 offset:30720
v_mov_b32 v84, 0
s_waitcnt lgkmcnt(8)
v_mfma_f32_16x16x32_bf16 v[96:99], v[176:179], a[248:251], v[96:99]
ds_read_b128 v[224:227], v2 offset:47104
v_mov_b32 v85, 0
v_mfma_f32_16x16x32_bf16 v[96:99], v[180:183], v[204:207], v[96:99]
ds_read_b128 v[244:247], v2 offset:48128
buffer_load_dwordx4 v[172:175], v1, s[8:11], s24 offen offset:3072 sc1
s_waitcnt lgkmcnt(8)
v_mfma_f32_16x16x32_bf16 v[92:95], v[180:183], v[200:203], v[92:95]
ds_read_b128 v[248:251], v2 offset:64512
s_add_u32 s24, s24, 4096
v_mfma_f32_16x16x32_bf16 v[92:95], v[176:179], a[244:247], v[92:95]
ds_read_b128 v[228:231], v2 offset:63488
v_mov_b32 v86, 0
s_waitcnt lgkmcnt(8)
v_mfma_f32_16x16x32_bf16 v[88:91], v[176:179], a[240:243], v[88:91]
ds_read_b128 v[232:235], v3 offset:14336
s_waitcnt vmcnt(12)
v_mfma_f32_16x16x32_bf16 v[88:91], v[180:183], v[196:199], v[88:91]
ds_read_b128 v[252:255], v3 offset:15360
v_mov_b32 v87, 0
s_waitcnt lgkmcnt(8)
v_mfma_f32_16x16x32_bf16 v[88:91], v[184:187], v[216:219], v[88:91]
buffer_load_dwordx4 v[176:179], v1, s[8:11], s24 offen offset:0 sc1
v_mfma_f32_16x16x32_bf16 v[88:91], v[188:191], v[236:239], v[88:91]
s_waitcnt lgkmcnt(6)
v_mfma_f32_16x16x32_bf16 v[92:95], v[188:191], v[240:243], v[92:95]
v_mfma_f32_16x16x32_bf16 v[92:95], v[184:187], v[220:223], v[92:95]
s_waitcnt lgkmcnt(4)
v_mfma_f32_16x16x32_bf16 v[96:99], v[184:187], v[224:227], v[96:99]
v_mfma_f32_16x16x32_bf16 v[96:99], v[188:191], v[244:247], v[96:99]
buffer_load_dwordx4 v[180:183], v1, s[8:11], s24 offen offset:1024 sc1
s_waitcnt lgkmcnt(2)
v_mfma_f32_16x16x32_bf16 v[100:103], v[188:191], v[248:251], v[100:103]
v_mfma_f32_16x16x32_bf16 v[100:103], v[184:187], v[228:231], v[100:103]
s_waitcnt lgkmcnt(0)
v_mfma_f32_16x16x32_bf16 v[104:107], v[184:187], v[232:235], v[104:107]
s_waitcnt vmcnt(12)
v_mfma_f32_16x16x32_bf16 v[104:107], v[188:191], v[252:255], v[104:107]
s_barrier
v_or_b32 v26, s20, v0
v_min_u32 v26, 1, v26
v_lshlrev_b32 v26, 30, v26
v_mov_b32 v27, s7
buffer_store_dword v27, v26, s[8:11], s44 offen sc1
L_c_g:
v_mfma_f32_16x16x32_bf16 v[124:127], v[128:131], a[16:19], 0
buffer_load_dwordx4 v[184:187], v1, s[8:11], s24 offen offset:2048 sc1
v_mfma_f32_16x16x32_bf16 v[124:127], v[132:135], a[36:39], v[124:127]
v_mfma_f32_16x16x32_bf16 v[120:123], v[132:135], a[32:35], 0
v_pk_mul_f32 v[18:19], v[88:89], v[88:89]
v_pk_mul_f32 v[20:21], v[90:91], v[90:91]
v_pk_mul_f32 v[22:23], v[92:93], v[92:93]
v_pk_mul_f32 v[24:25], v[94:95], v[94:95]
v_pk_fma_f32 v[18:19], v[18:19], s[46:47], s[46:47] op_sel:[0,0,1] op_sel_hi:[1,0,1]
v_pk_fma_f32 v[20:21], v[20:21], s[46:47], s[46:47] op_sel:[0,0,1] op_sel_hi:[1,0,1]
v_pk_fma_f32 v[22:23], v[22:23], s[46:47], s[46:47] op_sel:[0,0,1] op_sel_hi:[1,0,1]
v_pk_fma_f32 v[24:25], v[24:25], s[46:47], s[46:47] op_sel:[0,0,1] op_sel_hi:[1,0,1]
v_pk_mul_f32 v[18:19], v[18:19], v[88:89]
v_pk_mul_f32 v[20:21], v[20:21], v[90:91]
v_pk_mul_f32 v[22:23], v[22:23], v[92:93]
v_pk_mul_f32 v[24:25], v[24:25], v[94:95]
v_mfma_f32_16x16x32_bf16 v[120:123], v[128:131], a[12:15], v[120:123]
v_exp_f32 v18, v18
v_mfma_f32_16x16x32_bf16 v[116:119], v[128:131], a[8:11], 0
v_exp_f32 v19, v19
v_mfma_f32_16x16x32_bf16 v[116:119], v[132:135], a[28:31], v[116:119]
buffer_load_dwordx4 v[188:191], v1, s[8:11], s24 offen offset:3072 sc1
v_mfma_f32_16x16x32_bf16 v[112:115], v[132:135], a[24:27], 0
s_add_u32 s24, s24, 4096
s_cmp_eq_u32 s25, 3
s_cselect_b32 s24, s33, s24
v_mfma_f32_16x16x32_bf16 v[112:115], v[128:131], a[4:7], v[112:115]
v_exp_f32 v20, v20
v_mfma_f32_16x16x32_bf16 v[108:111], v[128:131], a[0:3], 0
s_waitcnt vmcnt(12)
v_exp_f32 v21, v21
v_mfma_f32_16x16x32_bf16 v[108:111], v[132:135], a[20:23], v[108:111]
v_exp_f32 v22, v22
v_mfma_f32_16x16x32_bf16 v[108:111], v[136:139], a[40:43], v[108:111]
buffer_load_dwordx4 v[128:131], v1, s[8:11], s24 offen offset:0 sc1
v_mfma_f32_16x16x32_bf16 v[108:111], v[140:143], a[60:63], v[108:111]
v_exp_f32 v23, v23
v_mfma_f32_16x16x32_bf16 v[112:115], v[140:143], a[64:67], v[112:115]
v_exp_f32 v24, v24
v_mfma_f32_16x16x32_bf16 v[112:115], v[136:139], a[44:47], v[112:115]
v_exp_f32 v25, v25
v_mfma_f32_16x16x32_bf16 v[116:119], v[136:139], a[48:51], v[116:119]
v_add_f32 v18, 1.0, v18
v_add_f32 v19, 1.0, v19
v_mfma_f32_16x16x32_bf16 v[116:119], v[140:143], a[68:71], v[116:119]
buffer_load_dwordx4 v[132:135], v1, s[8:11], s24 offen offset:1024 sc1
v_mfma_f32_16x16x32_bf16 v[120:123], v[140:143], a[72:75], v[120:123]
v_add_f32 v20, 1.0, v20
v_add_f32 v21, 1.0, v21
v_mfma_f32_16x16x32_bf16 v[120:123], v[136:139], a[52:55], v[120:123]
v_add_f32 v22, 1.0, v22
v_add_f32 v23, 1.0, v23
v_mfma_f32_16x16x32_bf16 v[124:127], v[136:139], a[56:59], v[124:127]
s_waitcnt vmcnt(12)
v_add_f32 v24, 1.0, v24
v_add_f32 v25, 1.0, v25
v_mfma_f32_16x16x32_bf16 v[124:127], v[140:143], a[76:79], v[124:127]
v_rcp_f32 v18, v18
v_mfma_f32_16x16x32_bf16 v[124:127], v[144:147], a[96:99], v[124:127]
buffer_load_dwordx4 v[136:139], v1, s[8:11], s24 offen offset:2048 sc1
v_mfma_f32_16x16x32_bf16 v[124:127], v[148:151], a[116:119], v[124:127]
v_rcp_f32 v19, v19
v_mfma_f32_16x16x32_bf16 v[120:123], v[148:151], a[112:115], v[120:123]
v_rcp_f32 v20, v20
v_mfma_f32_16x16x32_bf16 v[120:123], v[144:147], a[92:95], v[120:123]
v_rcp_f32 v21, v21
v_mfma_f32_16x16x32_bf16 v[116:119], v[144:147], a[88:91], v[116:119]
v_rcp_f32 v22, v22
v_mfma_f32_16x16x32_bf16 v[116:119], v[148:151], a[108:111], v[116:119]
buffer_load_dwordx4 v[140:143], v1, s[8:11], s24 offen offset:3072 sc1
v_mfma_f32_16x16x32_bf16 v[112:115], v[148:151], a[104:107], v[112:115]
s_add_u32 s24, s24, 4096
v_rcp_f32 v23, v23
v_mfma_f32_16x16x32_bf16 v[112:115], v[144:147], a[84:87], v[112:115]
v_rcp_f32 v24, v24
v_mfma_f32_16x16x32_bf16 v[108:111], v[144:147], a[80:83], v[108:111]
s_waitcnt vmcnt(12)
v_rcp_f32 v25, v25
v_mul_f32 v88, v88, v18
v_mfma_f32_16x16x32_bf16 v[108:111], v[148:151], a[100:103], v[108:111]
v_mul_f32 v89, v89, v19
v_mul_f32 v90, v90, v20
v_mfma_f32_16x16x32_bf16 v[108:111], v[152:155], a[120:123], v[108:111]
buffer_load_dwordx4 v[144:147], v1, s[8:11], s24 offen offset:0 sc1
v_mfma_f32_16x16x32_bf16 v[108:111], v[156:159], a[140:143], v[108:111]
v_mul_f32 v91, v91, v21
v_mul_f32 v92, v92, v22
v_mul_f32 v93, v93, v23
v_mul_f32 v94, v94, v24
v_mul_f32 v95, v95, v25
v_pk_mul_f32 v[18:19], v[96:97], v[96:97]
v_pk_mul_f32 v[20:21], v[98:99], v[98:99]
v_pk_mul_f32 v[22:23], v[100:101], v[100:101]
v_pk_mul_f32 v[24:25], v[102:103], v[102:103]
v_pk_fma_f32 v[18:19], v[18:19], s[46:47], s[46:47] op_sel:[0,0,1] op_sel_hi:[1,0,1]
v_pk_fma_f32 v[20:21], v[20:21], s[46:47], s[46:47] op_sel:[0,0,1] op_sel_hi:[1,0,1]
v_pk_fma_f32 v[22:23], v[22:23], s[46:47], s[46:47] op_sel:[0,0,1] op_sel_hi:[1,0,1]
v_pk_fma_f32 v[24:25], v[24:25], s[46:47], s[46:47] op_sel:[0,0,1] op_sel_hi:[1,0,1]
v_pk_mul_f32 v[18:19], v[18:19], v[96:97]
v_pk_mul_f32 v[20:21], v[20:21], v[98:99]
v_pk_mul_f32 v[22:23], v[22:23], v[100:101]
v_pk_mul_f32 v[24:25], v[24:25], v[102:103]
v_mfma_f32_16x16x32_bf16 v[112:115], v[156:159], a[144:147], v[112:115]
v_cvt_pk_bf16_f32 v28, v88, v89
v_cvt_pk_bf16_f32 v29, v90, v91
v_mfma_f32_16x16x32_bf16 v[112:115], v[152:155], a[124:127], v[112:115]
v_cvt_pk_bf16_f32 v32, v92, v93
v_cvt_pk_bf16_f32 v33, v94, v95
v_mfma_f32_16x16x32_bf16 v[116:119], v[152:155], a[128:131], v[116:119]
v_exp_f32 v18, v18
v_mfma_f32_16x16x32_bf16 v[116:119], v[156:159], a[148:151], v[116:119]
buffer_load_dwordx4 v[148:151], v1, s[8:11], s24 offen offset:1024 sc1
v_mfma_f32_16x16x32_bf16 v[120:123], v[156:159], a[152:155], v[120:123]
v_exp_f32 v19, v19
v_mfma_f32_16x16x32_bf16 v[120:123], v[152:155], a[132:135], v[120:123]
v_exp_f32 v20, v20
v_mfma_f32_16x16x32_bf16 v[124:127], v[152:155], a[136:139], v[124:127]
s_waitcnt vmcnt(12)
v_exp_f32 v21, v21
v_mfma_f32_16x16x32_bf16 v[124:127], v[156:159], a[156:159], v[124:127]
v_exp_f32 v22, v22
v_mfma_f32_16x16x32_bf16 v[124:127], v[160:163], a[176:179], v[124:127]
buffer_load_dwordx4 v[152:155], v1, s[8:11], s24 offen offset:2048 sc1
v_mfma_f32_16x16x32_bf16 v[124:127], v[164:167], a[196:199], v[124:127]
v_exp_f32 v23, v23
v_mfma_f32_16x16x32_bf16 v[120:123], v[164:167], a[192:195], v[120:123]
v_exp_f32 v24, v24
v_mfma_f32_16x16x32_bf16 v[120:123], v[160:163], a[172:175], v[120:123]
v_exp_f32 v25, v25
v_mfma_f32_16x16x32_bf16 v[116:119], v[160:163], a[168:171], v[116:119]
v_add_f32 v18, 1.0, v18
v_add_f32 v19, 1.0, v19
v_mfma_f32_16x16x32_bf16 v[116:119], v[164:167], a[188:191], v[116:119]
buffer_load_dwordx4 v[156:159], v1, s[8:11], s24 offen offset:3072 sc1
v_mfma_f32_16x16x32_bf16 v[112:115], v[164:167], a[184:187], v[112:115]
s_add_u32 s24, s24, 4096
v_add_f32 v20, 1.0, v20
v_add_f32 v21, 1.0, v21
v_mfma_f32_16x16x32_bf16 v[112:115], v[160:163], a[164:167], v[112:115]
v_add_f32 v22, 1.0, v22
v_add_f32 v23, 1.0, v23
v_mfma_f32_16x16x32_bf16 v[108:111], v[160:163], a[160:163], v[108:111]
s_waitcnt vmcnt(12)
v_add_f32 v24, 1.0, v24
v_add_f32 v25, 1.0, v25
v_mfma_f32_16x16x32_bf16 v[108:111], v[164:167], a[180:183], v[108:111]
v_rcp_f32 v18, v18
v_mfma_f32_16x16x32_bf16 v[108:111], v[168:171], a[200:203], v[108:111]
buffer_load_dwordx4 v[160:163], v1, s[8:11], s24 offen offset:0 sc1
v_mfma_f32_16x16x32_bf16 v[108:111], v[172:175], a[220:223], v[108:111]
v_rcp_f32 v19, v19
v_mfma_f32_16x16x32_bf16 v[112:115], v[172:175], a[224:227], v[112:115]
v_rcp_f32 v20, v20
v_mfma_f32_16x16x32_bf16 v[112:115], v[168:171], a[204:207], v[112:115]
v_rcp_f32 v21, v21
v_mfma_f32_16x16x32_bf16 v[116:119], v[168:171], a[208:211], v[116:119]
v_rcp_f32 v22, v22
v_mfma_f32_16x16x32_bf16 v[116:119], v[172:175], a[228:231], v[116:119]
buffer_load_dwordx4 v[164:167], v1, s[8:11], s24 offen offset:1024 sc1
v_mfma_f32_16x16x32_bf16 v[120:123], v[172:175], a[232:235], v[120:123]
v_rcp_f32 v23, v23
v_mfma_f32_16x16x32_bf16 v[120:123], v[168:171], a[212:215], v[120:123]
v_rcp_f32 v24, v24
v_mfma_f32_16x16x32_bf16 v[124:127], v[168:171], a[216:219], v[124:127]
s_waitcnt vmcnt(12)
v_rcp_f32 v25, v25
v_mul_f32 v96, v96, v18
v_mfma_f32_16x16x32_bf16 v[124:127], v[172:175], a[236:239], v[124:127]
v_mul_f32 v97, v97, v19
v_mul_f32 v98, v98, v20
v_mfma_f32_16x16x32_bf16 v[124:127], v[176:179], v[192:195], v[124:127]
buffer_load_dwordx4 v[168:171], v1, s[8:11], s24 offen offset:2048 sc1
v_mfma_f32_16x16x32_bf16 v[124:127], v[180:183], v[212:215], v[124:127]
v_mul_f32 v99, v99, v21
v_mul_f32 v100, v100, v22
v_mul_f32 v101, v101, v23
v_mul_f32 v102, v102, v24
v_mul_f32 v103, v103, v25
v_pk_mul_f32 v[18:19], v[104:105], v[104:105]
v_pk_mul_f32 v[20:21], v[106:107], v[106:107]
v_pk_fma_f32 v[18:19], v[18:19], s[46:47], s[46:47] op_sel:[0,0,1] op_sel_hi:[1,0,1]
v_pk_fma_f32 v[20:21], v[20:21], s[46:47], s[46:47] op_sel:[0,0,1] op_sel_hi:[1,0,1]
v_pk_mul_f32 v[18:19], v[18:19], v[104:105]
v_pk_mul_f32 v[20:21], v[20:21], v[106:107]
v_mfma_f32_16x16x32_bf16 v[120:123], v[180:183], v[208:211], v[120:123]
v_cvt_pk_bf16_f32 v36, v96, v97
v_cvt_pk_bf16_f32 v37, v98, v99
v_mfma_f32_16x16x32_bf16 v[120:123], v[176:179], a[252:255], v[120:123]
v_cvt_pk_bf16_f32 v40, v100, v101
v_cvt_pk_bf16_f32 v41, v102, v103
v_mfma_f32_16x16x32_bf16 v[116:119], v[176:179], a[248:251], v[116:119]
v_exp_f32 v18, v18
v_mfma_f32_16x16x32_bf16 v[116:119], v[180:183], v[204:207], v[116:119]
buffer_load_dwordx4 v[172:175], v1, s[8:11], s24 offen offset:3072 sc1
v_mfma_f32_16x16x32_bf16 v[112:115], v[180:183], v[200:203], v[112:115]
s_add_u32 s24, s24, 4096
v_exp_f32 v19, v19
v_mfma_f32_16x16x32_bf16 v[112:115], v[176:179], a[244:247], v[112:115]
v_exp_f32 v20, v20
v_mfma_f32_16x16x32_bf16 v[108:111], v[176:179], a[240:243], v[108:111]
s_waitcnt vmcnt(12)
v_exp_f32 v21, v21
v_mfma_f32_16x16x32_bf16 v[108:111], v[180:183], v[196:199], v[108:111]
v_add_f32 v18, 1.0, v18
v_add_f32 v19, 1.0, v19
v_mfma_f32_16x16x32_bf16 v[108:111], v[184:187], v[216:219], v[108:111]
buffer_load_dwordx4 v[176:179], v1, s[8:11], s24 offen offset:0 sc1
v_mfma_f32_16x16x32_bf16 v[108:111], v[188:191], v[236:239], v[108:111]
v_add_f32 v20, 1.0, v20
v_add_f32 v21, 1.0, v21
v_mfma_f32_16x16x32_bf16 v[112:115], v[188:191], v[240:243], v[112:115]
v_rcp_f32 v18, v18
v_mfma_f32_16x16x32_bf16 v[112:115], v[184:187], v[220:223], v[112:115]
v_rcp_f32 v19, v19
v_mfma_f32_16x16x32_bf16 v[116:119], v[184:187], v[224:227], v[116:119]
v_rcp_f32 v20, v20
v_mfma_f32_16x16x32_bf16 v[116:119], v[188:191], v[244:247], v[116:119]
buffer_load_dwordx4 v[180:183], v1, s[8:11], s24 offen offset:1024 sc1
v_mfma_f32_16x16x32_bf16 v[120:123], v[188:191], v[248:251], v[120:123]
v_rcp_f32 v21, v21
v_mfma_f32_16x16x32_bf16 v[120:123], v[184:187], v[228:231], v[120:123]
v_mul_f32 v104, v104, v18
v_mul_f32 v105, v105, v19
v_mfma_f32_16x16x32_bf16 v[124:127], v[184:187], v[232:235], v[124:127]
s_waitcnt vmcnt(12)
v_mul_f32 v106, v106, v20
v_mul_f32 v107, v107, v21
v_mfma_f32_16x16x32_bf16 v[124:127], v[188:191], v[252:255], v[124:127]
v_cvt_pk_bf16_f32 v44, v104, v105
v_cvt_pk_bf16_f32 v45, v106, v107
v_mfma_f32_16x16x32_bf16 v[104:107], v[128:131], a[16:19], 0
buffer_load_dwordx4 v[184:187], v1, s[8:11], s24 offen offset:2048 sc1
v_mfma_f32_16x16x32_bf16 v[104:107], v[132:135], a[36:39], v[104:107]
v_mfma_f32_16x16x32_bf16 v[100:103], v[132:135], a[32:35], 0
v_pk_mul_f32 v[18:19], v[108:109], v[108:109]
v_pk_mul_f32 v[20:21], v[110:111], v[110:111]
v_pk_mul_f32 v[22:23], v[112:113], v[112:113]
v_pk_mul_f32 v[24:25], v[114:115], v[114:115]
v_pk_fma_f32 v[18:19], v[18:19], s[46:47], s[46:47] op_sel:[0,0,1] op_sel_hi:[1,0,1]
v_pk_fma_f32 v[20:21], v[20:21], s[46:47], s[46:47] op_sel:[0,0,1] op_sel_hi:[1,0,1]
v_pk_fma_f32 v[22:23], v[22:23], s[46:47], s[46:47] op_sel:[0,0,1] op_sel_hi:[1,0,1]
v_pk_fma_f32 v[24:25], v[24:25], s[46:47], s[46:47] op_sel:[0,0,1] op_sel_hi:[1,0,1]
v_pk_mul_f32 v[18:19], v[18:19], v[108:109]
v_pk_mul_f32 v[20:21], v[20:21], v[110:111]
v_pk_mul_f32 v[22:23], v[22:23], v[112:113]
v_pk_mul_f32 v[24:25], v[24:25], v[114:115]
v_mfma_f32_16x16x32_bf16 v[100:103], v[128:131], a[12:15], v[100:103]
v_exp_f32 v18, v18
v_mfma_f32_16x16x32_bf16 v[96:99], v[128:131], a[8:11], 0
v_exp_f32 v19, v19
v_mfma_f32_16x16x32_bf16 v[96:99], v[132:135], a[28:31], v[96:99]
buffer_load_dwordx4 v[188:191], v1, s[8:11], s24 offen offset:3072 sc1
v_mfma_f32_16x16x32_bf16 v[92:95], v[132:135], a[24:27], 0
s_add_u32 s24, s24, 4096
v_exp_f32 v20, v20
v_mfma_f32_16x16x32_bf16 v[92:95], v[128:131], a[4:7], v[92:95]
v_exp_f32 v21, v21
v_mfma_f32_16x16x32_bf16 v[88:91], v[128:131], a[0:3], 0
s_waitcnt vmcnt(12)
v_exp_f32 v22, v22
v_mfma_f32_16x16x32_bf16 v[88:91], v[132:135], a[20:23], v[88:91]
v_exp_f32 v23, v23
v_mfma_f32_16x16x32_bf16 v[88:91], v[136:139], a[40:43], v[88:91]
buffer_load_dwordx4 v[128:131], v1, s[8:11], s24 offen offset:0 sc1
v_mfma_f32_16x16x32_bf16 v[88:91], v[140:143], a[60:63], v[88:91]
v_exp_f32 v24, v24
v_mfma_f32_16x16x32_bf16 v[92:95], v[140:143], a[64:67], v[92:95]
v_exp_f32 v25, v25
v_mfma_f32_16x16x32_bf16 v[92:95], v[136:139], a[44:47], v[92:95]
v_add_f32 v18, 1.0, v18
v_add_f32 v19, 1.0, v19
v_mfma_f32_16x16x32_bf16 v[96:99], v[136:139], a[48:51], v[96:99]
v_add_f32 v20, 1.0, v20
v_add_f32 v21, 1.0, v21
v_mfma_f32_16x16x32_bf16 v[96:99], v[140:143], a[68:71], v[96:99]
buffer_load_dwordx4 v[132:135], v1, s[8:11], s24 offen offset:1024 sc1
v_mfma_f32_16x16x32_bf16 v[100:103], v[140:143], a[72:75], v[100:103]
v_add_f32 v22, 1.0, v22
v_add_f32 v23, 1.0, v23
v_mfma_f32_16x16x32_bf16 v[100:103], v[136:139], a[52:55], v[100:103]
v_add_f32 v24, 1.0, v24
v_add_f32 v25, 1.0, v25
v_mfma_f32_16x16x32_bf16 v[104:107], v[136:139], a[56:59], v[104:107]
s_waitcnt vmcnt(12)
v_rcp_f32 v18, v18
v_mfma_f32_16x16x32_bf16 v[104:107], v[140:143], a[76:79], v[104:107]
v_rcp_f32 v19, v19
v_mfma_f32_16x16x32_bf16 v[104:107], v[144:147], a[96:99], v[104:107]
buffer_load_dwordx4 v[136:139], v1, s[8:11], s24 offen offset:2048 sc1
v_mfma_f32_16x16x32_bf16 v[104:107], v[148:151], a[116:119], v[104:107]
v_rcp_f32 v20, v20
v_mfma_f32_16x16x32_bf16 v[100:103], v[148:151], a[112:115], v[100:103]
v_rcp_f32 v21, v21
v_mfma_f32_16x16x32_bf16 v[100:103], v[144:147], a[92:95], v[100:103]
v_rcp_f32 v22, v22
v_mfma_f32_16x16x32_bf16 v[96:99], v[144:147], a[88:91], v[96:99]
v_rcp_f32 v23, v23
v_mfma_f32_16x16x32_bf16 v[96:99], v[148:151], a[108:111], v[96:99]
buffer_load_dwordx4 v[140:143], v1, s[8:11], s24 offen offset:3072 sc1
v_mfma_f32_16x16x32_bf16 v[92:95], v[148:151], a[104:107], v[92:95]
s_add_u32 s24, s24, 4096
v_rcp_f32 v24, v24
v_mfma_f32_16x16x32_bf16 v[92:95], v[144:147], a[84:87], v[92:95]
v_rcp_f32 v25, v25
v_mul_f32 v108, v108, v18
v_mfma_f32_16x16x32_bf16 v[88:91], v[144:147], a[80:83], v[88:91]
s_waitcnt vmcnt(12)
v_mul_f32 v109, v109, v19
v_mul_f32 v110, v110, v20
v_mfma_f32_16x16x32_bf16 v[88:91], v[148:151], a[100:103], v[88:91]
v_mul_f32 v111, v111, v21
v_mul_f32 v112, v112, v22
v_mul_f32 v113, v113, v23
v_mul_f32 v114, v114, v24
v_mul_f32 v115, v115, v25
v_pk_mul_f32 v[18:19], v[116:117], v[116:117]
v_pk_mul_f32 v[20:21], v[118:119], v[118:119]
v_pk_mul_f32 v[22:23], v[120:121], v[120:121]
v_pk_mul_f32 v[24:25], v[122:123], v[122:123]
v_pk_fma_f32 v[18:19], v[18:19], s[46:47], s[46:47] op_sel:[0,0,1] op_sel_hi:[1,0,1]
v_pk_fma_f32 v[20:21], v[20:21], s[46:47], s[46:47] op_sel:[0,0,1] op_sel_hi:[1,0,1]
v_pk_fma_f32 v[22:23], v[22:23], s[46:47], s[46:47] op_sel:[0,0,1] op_sel_hi:[1,0,1]
v_pk_fma_f32 v[24:25], v[24:25], s[46:47], s[46:47] op_sel:[0,0,1] op_sel_hi:[1,0,1]
v_pk_mul_f32 v[18:19], v[18:19], v[116:117]
v_pk_mul_f32 v[20:21], v[20:21], v[118:119]
v_pk_mul_f32 v[22:23], v[22:23], v[120:121]
v_pk_mul_f32 v[24:25], v[24:25], v[122:123]
v_mfma_f32_16x16x32_bf16 v[88:91], v[152:155], a[120:123], v[88:91]
buffer_load_dwordx4 v[144:147], v1, s[8:11], s24 offen offset:0 sc1
v_mfma_f32_16x16x32_bf16 v[88:91], v[156:159], a[140:143], v[88:91]
v_cvt_pk_bf16_f32 v30, v108, v109
v_cvt_pk_bf16_f32 v31, v110, v111
v_mfma_f32_16x16x32_bf16 v[92:95], v[156:159], a[144:147], v[92:95]
ds_write_b128 v6, v[28:31]
v_add_u32 v6, 1024, v6
v_mfma_f32_16x16x32_bf16 v[48:51], v[12:15], v[28:31], v[48:51]
v_mfma_f32_16x16x32_bf16 v[68:71], v[28:31], v[28:31], v[68:71]
v_cvt_pk_bf16_f32 v34, v112, v113
v_cvt_pk_bf16_f32 v35, v114, v115
v_mfma_f32_16x16x32_bf16 v[92:95], v[152:155], a[124:127], v[92:95]
ds_write_b128 v7, v[32:35]
v_add_u32 v7, 1024, v7
v_mfma_f32_16x16x32_bf16 v[52:55], v[12:15], v[32:35], v[52:55]
v_mfma_f32_16x16x32_bf16 v[72:75], v[32:35], v[32:35], v[72:75]
v_exp_f32 v18, v18
v_mfma_f32_16x16x32_bf16 v[96:99], v[152:155], a[128:131], v[96:99]
v_exp_f32 v19, v19
v_mfma_f32_16x16x32_bf16 v[96:99], v[156:159], a[148:151], v[96:99]
buffer_load_dwordx4 v[148:151], v1, s[8:11], s24 offen offset:1024 sc1
v_mfma_f32_16x16x32_bf16 v[100:103], v[156:159], a[152:155], v[100:103]
v_exp_f32 v20, v20
v_mfma_f32_16x16x32_bf16 v[100:103], v[152:155], a[132:135], v[100:103]
v_exp_f32 v21, v21
v_mfma_f32_16x16x32_bf16 v[104:107], v[152:155], a[136:139], v[104:107]
s_waitcnt vmcnt(12)
v_exp_f32 v22, v22
v_mfma_f32_16x16x32_bf16 v[104:107], v[156:159], a[156:159], v[104:107]
v_exp_f32 v23, v23
v_mfma_f32_16x16x32_bf16 v[104:107], v[160:163], a[176:179], v[104:107]
buffer_load_dwordx4 v[152:155], v1, s[8:11], s24 offen offset:2048 sc1
v_mfma_f32_16x16x32_bf16 v[104:107], v[164:167], a[196:199], v[104:107]
v_exp_f32 v24, v24
v_mfma_f32_16x16x32_bf16 v[100:103], v[164:167], a[192:195], v[100:103]
v_exp_f32 v25, v25
v_mfma_f32_16x16x32_bf16 v[100:103], v[160:163], a[172:175], v[100:103]
v_add_f32 v18, 1.0, v18
v_add_f32 v19, 1.0, v19
v_mfma_f32_16x16x32_bf16 v[96:99], v[160:163], a[168:171], v[96:99]
v_add_f32 v20, 1.0, v20
v_add_f32 v21, 1.0, v21
v_mfma_f32_16x16x32_bf16 v[96:99], v[164:167], a[188:191], v[96:99]
buffer_load_dwordx4 v[156:159], v1, s[8:11], s24 offen offset:3072 sc1
v_mfma_f32_16x16x32_bf16 v[92:95], v[164:167], a[184:187], v[92:95]
s_add_u32 s24, s24, 4096
v_add_f32 v22, 1.0, v22
v_add_f32 v23, 1.0, v23
v_mfma_f32_16x16x32_bf16 v[92:95], v[160:163], a[164:167], v[92:95]
v_add_f32 v24, 1.0, v24
v_add_f32 v25, 1.0, v25
v_mfma_f32_16x16x32_bf16 v[88:91], v[160:163], a[160:163], v[88:91]
s_waitcnt vmcnt(12)
v_rcp_f32 v18, v18
v_mfma_f32_16x16x32_bf16 v[88:91], v[164:167], a[180:183], v[88:91]
v_rcp_f32 v19, v19
v_mfma_f32_16x16x32_bf16 v[88:91], v[168:171], a[200:203], v[88:91]
buffer_load_dwordx4 v[160:163], v1, s[8:11], s24 offen offset:0 sc1
v_mfma_f32_16x16x32_bf16 v[88:91], v[172:175], a[220:223], v[88:91]
v_rcp_f32 v20, v20
v_mfma_f32_16x16x32_bf16 v[92:95], v[172:175], a[224:227], v[92:95]
v_rcp_f32 v21, v21
v_mfma_f32_16x16x32_bf16 v[92:95], v[168:171], a[204:207], v[92:95]
v_rcp_f32 v22, v22
v_mfma_f32_16x16x32_bf16 v[96:99], v[168:171], a[208:211], v[96:99]
v_rcp_f32 v23, v23
v_mfma_f32_16x16x32_bf16 v[96:99], v[172:175], a[228:231], v[96:99]
buffer_load_dwordx4 v[164:167], v1, s[8:11], s24 offen offset:1024 sc1
v_mfma_f32_16x16x32_bf16 v[100:103], v[172:175], a[232:235], v[100:103]
v_rcp_f32 v24, v24
v_mfma_f32_16x16x32_bf16 v[100:103], v[168:171], a[212:215], v[100:103]
v_rcp_f32 v25, v25
v_mul_f32 v116, v116, v18
v_mfma_f32_16x16x32_bf16 v[104:107], v[168:171], a[216:219], v[104:107]
s_waitcnt vmcnt(12)
v_mul_f32 v117, v117, v19
v_mul_f32 v118, v118, v20
v_mfma_f32_16x16x32_bf16 v[104:107], v[172:175], a[236:239], v[104:107]
v_mul_f32 v119, v119, v21
v_mul_f32 v120, v120, v22
v_mul_f32 v121, v121, v23
v_mul_f32 v122, v122, v24
v_mul_f32 v123, v123, v25
v_pk_mul_f32 v[18:19], v[124:125], v[124:125]
v_pk_mul_f32 v[20:21], v[126:127], v[126:127]
v_pk_fma_f32 v[18:19], v[18:19], s[46:47], s[46:47] op_sel:[0,0,1] op_sel_hi:[1,0,1]
v_pk_fma_f32 v[20:21], v[20:21], s[46:47], s[46:47] op_sel:[0,0,1] op_sel_hi:[1,0,1]
v_pk_mul_f32 v[18:19], v[18:19], v[124:125]
v_pk_mul_f32 v[20:21], v[20:21], v[126:127]
v_mfma_f32_16x16x32_bf16 v[104:107], v[176:179], v[192:195], v[104:107]
buffer_load_dwordx4 v[168:171], v1, s[8:11], s24 offen offset:2048 sc1
v_mfma_f32_16x16x32_bf16 v[104:107], v[180:183], v[212:215], v[104:107]
v_cvt_pk_bf16_f32 v38, v116, v117
v_cvt_pk_bf16_f32 v39, v118, v119
v_mfma_f32_16x16x32_bf16 v[100:103], v[180:183], v[208:211], v[100:103]
ds_write_b128 v8, v[36:39]
v_add_u32 v8, 1024, v8
v_mfma_f32_16x16x32_bf16 v[56:59], v[12:15], v[36:39], v[56:59]
v_mfma_f32_16x16x32_bf16 v[76:79], v[36:39], v[36:39], v[76:79]
v_cvt_pk_bf16_f32 v42, v120, v121
v_cvt_pk_bf16_f32 v43, v122, v123
v_mfma_f32_16x16x32_bf16 v[100:103], v[176:179], a[252:255], v[100:103]
ds_write_b128 v9, v[40:43]
v_add_u32 v9, 1024, v9
v_mfma_f32_16x16x32_bf16 v[60:63], v[12:15], v[40:43], v[60:63]
v_mfma_f32_16x16x32_bf16 v[80:83], v[40:43], v[40:43], v[80:83]
v_exp_f32 v18, v18
v_mfma_f32_16x16x32_bf16 v[96:99], v[176:179], a[248:251], v[96:99]
v_exp_f32 v19, v19
v_mfma_f32_16x16x32_bf16 v[96:99], v[180:183], v[204:207], v[96:99]
buffer_load_dwordx4 v[172:175], v1, s[8:11], s24 offen offset:3072 sc1
v_mfma_f32_16x16x32_bf16 v[92:95], v[180:183], v[200:203], v[92:95]
s_add_u32 s24, s24, 4096
v_exp_f32 v20, v20
v_mfma_f32_16x16x32_bf16 v[92:95], v[176:179], a[244:247], v[92:95]
v_exp_f32 v21, v21
v_mfma_f32_16x16x32_bf16 v[88:91], v[176:179], a[240:243], v[88:91]
s_waitcnt vmcnt(12)
v_add_f32 v18, 1.0, v18
v_add_f32 v19, 1.0, v19
v_mfma_f32_16x16x32_bf16 v[88:91], v[180:183], v[196:199], v[88:91]
v_add_f32 v20, 1.0, v20
v_add_f32 v21, 1.0, v21
v_mfma_f32_16x16x32_bf16 v[88:91], v[184:187], v[216:219], v[88:91]
buffer_load_dwordx4 v[176:179], v1, s[8:11], s24 offen offset:0 sc1
v_mfma_f32_16x16x32_bf16 v[88:91], v[188:191], v[236:239], v[88:91]
v_rcp_f32 v18, v18
v_mfma_f32_16x16x32_bf16 v[92:95], v[188:191], v[240:243], v[92:95]
v_rcp_f32 v19, v19
v_mfma_f32_16x16x32_bf16 v[92:95], v[184:187], v[220:223], v[92:95]
v_rcp_f32 v20, v20
v_mfma_f32_16x16x32_bf16 v[96:99], v[184:187], v[224:227], v[96:99]
v_rcp_f32 v21, v21
v_mfma_f32_16x16x32_bf16 v[96:99], v[188:191], v[244:247], v[96:99]
buffer_load_dwordx4 v[180:183], v1, s[8:11], s24 offen offset:1024 sc1
v_mfma_f32_16x16x32_bf16 v[100:103], v[188:191], v[248:251], v[100:103]
v_mul_f32 v124, v124, v18
v_mul_f32 v125, v125, v19
v_mfma_f32_16x16x32_bf16 v[100:103], v[184:187], v[228:231], v[100:103]
v_mul_f32 v126, v126, v20
v_mul_f32 v127, v127, v21
v_mfma_f32_16x16x32_bf16 v[104:107], v[184:187], v[232:235], v[104:107]
s_waitcnt vmcnt(12)
v_cvt_pk_bf16_f32 v46, v124, v125
v_cvt_pk_bf16_f32 v47, v126, v127
v_mfma_f32_16x16x32_bf16 v[104:107], v[188:191], v[252:255], v[104:107]
ds_write_b128 v10, v[44:47]
v_add_u32 v10, 1024, v10
v_mfma_f32_16x16x32_bf16 v[64:67], v[12:15], v[44:47], v[64:67]
v_mfma_f32_16x16x32_bf16 v[84:87], v[44:47], v[44:47], v[84:87]
s_add_u32 s25, s25, 1
s_cmp_lt_u32 s25, 4
s_cbranch_scc1 L_c_g
v_and_b32 v28, 15, v0
v_lshrrev_b32 v29, 2, v28
v_lshrrev_b32 v30, 4, v0
v_cmp_eq_u32 vcc, v29, v30
v_lshlrev_b32 v29, 5, v28
v_add_u32 v29, 92160, v29
s_lshl_b32 s26, s20, 3
v_add_u32 v30, s26, v29
v_mov_b32 v31, 96256
v_cndmask_b32 v30, v31, v30, vcc
v_cndmask_b32 v49, v68, v69, s[36:37]
v_cndmask_b32 v49, v49, v70, s[38:39]
v_cndmask_b32 v49, v49, v71, s[40:41]
ds_write_b64 v30, v[48:49] offset:0
v_cndmask_b32 v53, v72, v73, s[36:37]
v_cndmask_b32 v53, v53, v74, s[38:39]
v_cndmask_b32 v53, v53, v75, s[40:41]
ds_write_b64 v30, v[52:53] offset:512
v_cndmask_b32 v57, v76, v77, s[36:37]
v_cndmask_b32 v57, v57, v78, s[38:39]
v_cndmask_b32 v57, v57, v79, s[40:41]
ds_write_b64 v30, v[56:57] offset:1024
v_cndmask_b32 v61, v80, v81, s[36:37]
v_cndmask_b32 v61, v61, v82, s[38:39]
v_cndmask_b32 v61, v61, v83, s[40:41]
ds_write_b64 v30, v[60:61] offset:1536
v_cndmask_b32 v65, v84, v85, s[36:37]
v_cndmask_b32 v65, v65, v86, s[38:39]
v_cndmask_b32 v65, v65, v87, s[40:41]
ds_write_b64 v30, v[64:65] offset:2048
v_and_b32 v12, 3, v0
v_lshlrev_b32 v16, 7, v0
v_add_u32 v16, 0x3416400, v16
s_max_i32 s30, s22, 0
s_mul_i32 s30, s30, 52429
s_lshr_b32 s30, s30, 22
s_lshl_b32 s30, s30, 1
v_and_b32 v13, 4, v0
v_cmp_gt_u32 vcc, 48, v0
v_add_u32 v12, s30, v12
v_min_u32 v12, 0x63, v12
v_lshlrev_b32 v12, 8, v12
v_add_u32 v12, 0x3410080, v12
v_cndmask_b32 v16, v12, v16, vcc
s_waitcnt lgkmcnt(0)
s_barrier
ds_read_b128 v[48:51], v29 offset:0
ds_read_b128 v[52:55], v29 offset:16
ds_read_b128 v[56:59], v29 offset:512
ds_read_b128 v[60:63], v29 offset:528
ds_read_b128 v[64:67], v29 offset:1024
ds_read_b128 v[68:71], v29 offset:1040
ds_read_b128 v[72:75], v29 offset:1536
ds_read_b128 v[76:79], v29 offset:1552
ds_read_b128 v[80:83], v29 offset:2048
ds_read_b128 v[84:87], v29 offset:2064
v_add_u32 v6, -4096, v6
v_add_u32 v7, -4096, v7
v_add_u32 v8, -4096, v8
v_add_u32 v9, -4096, v9
v_add_u32 v10, -4096, v10
v_mul_u32_u24 v28, 5, v28
v_add_u32 v28, s22, v28
v_mov_b32 v32, 0x3b000000
s_add_u32 s42, s22, 2
s_add_u32 s42, s42, s23
s_lshl_b32 s42, s42, 10
s_lshr_b32 s30, s27, 4
s_add_u32 s42, s42, s30
s_mov_b32 s45, s43
s_waitcnt lgkmcnt(8)
v_pk_add_f32 v[48:49], v[48:49], v[50:51]
v_pk_add_f32 v[52:53], v[52:53], v[54:55]
v_add_u32 v30, 0, v28
v_pk_add_f32 v[48:49], v[48:49], v[52:53]
v_cmp_gt_u32 vcc, 0xfa0, v30
v_pk_mul_f32 v[48:49], v[48:49], v[32:33] op_sel_hi:[1,0]
v_fma_f32 v49, -v48, v48, v49
v_max_f32 v49, 0, v49
v_add_f32 v49, 0x3727c5ac, v49
v_rsq_f32 v49, v49
s_nop 0
v_cndmask_b32 v18, 0, v49, vcc
v_mul_f32 v19, -v48, v18
s_waitcnt lgkmcnt(6)
v_pk_add_f32 v[56:57], v[56:57], v[58:59]
v_pk_add_f32 v[60:61], v[60:61], v[62:63]
v_add_u32 v30, 1, v28
v_pk_add_f32 v[56:57], v[56:57], v[60:61]
v_cmp_gt_u32 vcc, 0xfa0, v30
v_pk_mul_f32 v[56:57], v[56:57], v[32:33] op_sel_hi:[1,0]
v_fma_f32 v57, -v56, v56, v57
v_max_f32 v57, 0, v57
v_add_f32 v57, 0x3727c5ac, v57
v_rsq_f32 v57, v57
s_nop 0
v_cndmask_b32 v20, 0, v57, vcc
v_mul_f32 v21, -v56, v20
s_waitcnt lgkmcnt(4)
v_pk_add_f32 v[64:65], v[64:65], v[66:67]
v_pk_add_f32 v[68:69], v[68:69], v[70:71]
v_add_u32 v30, 2, v28
v_pk_add_f32 v[64:65], v[64:65], v[68:69]
v_cmp_gt_u32 vcc, 0xfa0, v30
v_pk_mul_f32 v[64:65], v[64:65], v[32:33] op_sel_hi:[1,0]
v_fma_f32 v65, -v64, v64, v65
v_max_f32 v65, 0, v65
v_add_f32 v65, 0x3727c5ac, v65
v_rsq_f32 v65, v65
s_nop 0
v_cndmask_b32 v22, 0, v65, vcc
v_mul_f32 v23, -v64, v22
s_waitcnt lgkmcnt(2)
v_pk_add_f32 v[72:73], v[72:73], v[74:75]
v_pk_add_f32 v[76:77], v[76:77], v[78:79]
v_add_u32 v30, 3, v28
v_pk_add_f32 v[72:73], v[72:73], v[76:77]
v_cmp_gt_u32 vcc, 0xfa0, v30
v_pk_mul_f32 v[72:73], v[72:73], v[32:33] op_sel_hi:[1,0]
v_fma_f32 v73, -v72, v72, v73
v_max_f32 v73, 0, v73
v_add_f32 v73, 0x3727c5ac, v73
v_rsq_f32 v73, v73
s_nop 0
v_cndmask_b32 v24, 0, v73, vcc
v_mul_f32 v25, -v72, v24
s_waitcnt lgkmcnt(0)
v_pk_add_f32 v[80:81], v[80:81], v[82:83]
v_pk_add_f32 v[84:85], v[84:85], v[86:87]
v_add_u32 v30, 4, v28
v_pk_add_f32 v[80:81], v[80:81], v[84:85]
v_cmp_gt_u32 vcc, 0xfa0, v30
v_pk_mul_f32 v[80:81], v[80:81], v[32:33] op_sel_hi:[1,0]
v_fma_f32 v81, -v80, v80, v81
v_max_f32 v81, 0, v81
v_add_f32 v81, 0x3727c5ac, v81
v_rsq_f32 v81, v81
s_nop 0
v_cndmask_b32 v26, 0, v81, vcc
v_mul_f32 v27, -v80, v26
s_mov_b32 s25, 0
L_c_u:
v_mfma_f32_16x16x32_bf16 v[124:127], v[128:131], a[16:19], 0
buffer_load_dwordx4 v[184:187], v1, s[8:11], s24 offen offset:2048 sc1
v_mfma_f32_16x16x32_bf16 v[124:127], v[132:135], a[36:39], v[124:127]
ds_read_b64 v[76:77], v6 offset:0
ds_read_b64 v[78:79], v7 offset:0
v_mfma_f32_16x16x32_bf16 v[120:123], v[132:135], a[32:35], 0
ds_read_b64 v[80:81], v8 offset:0
ds_read_b64 v[82:83], v9 offset:0
ds_read_b64 v[84:85], v10 offset:0
v_pk_mul_f32 v[68:69], v[88:89], v[88:89]
v_pk_mul_f32 v[70:71], v[90:91], v[90:91]
v_pk_mul_f32 v[72:73], v[92:93], v[92:93]
v_pk_mul_f32 v[74:75], v[94:95], v[94:95]
v_pk_fma_f32 v[68:69], v[68:69], s[46:47], s[46:47] op_sel:[0,0,1] op_sel_hi:[1,0,1]
v_pk_fma_f32 v[70:71], v[70:71], s[46:47], s[46:47] op_sel:[0,0,1] op_sel_hi:[1,0,1]
v_pk_fma_f32 v[72:73], v[72:73], s[46:47], s[46:47] op_sel:[0,0,1] op_sel_hi:[1,0,1]
v_pk_fma_f32 v[74:75], v[74:75], s[46:47], s[46:47] op_sel:[0,0,1] op_sel_hi:[1,0,1]
v_pk_mul_f32 v[68:69], v[68:69], v[88:89]
v_pk_mul_f32 v[70:71], v[70:71], v[90:91]
v_pk_mul_f32 v[72:73], v[72:73], v[92:93]
v_pk_mul_f32 v[74:75], v[74:75], v[94:95]
v_exp_f32 v68, v68
v_exp_f32 v69, v69
v_exp_f32 v70, v70
v_exp_f32 v71, v71
v_mfma_f32_16x16x32_bf16 v[120:123], v[128:131], a[12:15], v[120:123]
v_exp_f32 v72, v72
v_mfma_f32_16x16x32_bf16 v[116:119], v[128:131], a[8:11], 0
v_exp_f32 v73, v73
v_mfma_f32_16x16x32_bf16 v[116:119], v[132:135], a[28:31], v[116:119]
buffer_load_dwordx4 v[188:191], v1, s[8:11], s24 offen offset:3072 sc1
v_mfma_f32_16x16x32_bf16 v[112:115], v[132:135], a[24:27], 0
s_add_u32 s24, s24, 4096
s_cmp_eq_u32 s25, 3
s_cselect_b32 s24, s34, s24
v_mfma_f32_16x16x32_bf16 v[112:115], v[128:131], a[4:7], v[112:115]
v_exp_f32 v74, v74
v_mfma_f32_16x16x32_bf16 v[108:111], v[128:131], a[0:3], 0
s_waitcnt vmcnt(12)
v_exp_f32 v75, v75
v_mfma_f32_16x16x32_bf16 v[108:111], v[132:135], a[20:23], v[108:111]
ds_read_b128 v[48:51], v11 offset:0
s_waitcnt lgkmcnt(1)
v_lshlrev_b32 v28, 16, v76
v_mfma_f32_16x16x32_bf16 v[108:111], v[136:139], a[40:43], v[108:111]
buffer_load_dwordx4 v[128:131], v1, s[8:11], s24 offen offset:0 sc1
v_mfma_f32_16x16x32_bf16 v[108:111], v[140:143], a[60:63], v[108:111]
ds_read_b128 v[52:55], v11 offset:2048
v_and_b32 v29, s28, v76
v_mfma_f32_16x16x32_bf16 v[112:115], v[140:143], a[64:67], v[112:115]
ds_read_b128 v[56:59], v11 offset:4096
v_lshlrev_b32 v30, 16, v77
v_mfma_f32_16x16x32_bf16 v[112:115], v[136:139], a[44:47], v[112:115]
ds_read_b128 v[60:63], v11 offset:6144
v_and_b32 v31, s28, v77
v_mfma_f32_16x16x32_bf16 v[116:119], v[136:139], a[48:51], v[116:119]
ds_read_b128 v[64:67], v11 offset:8192
v_lshlrev_b32 v32, 16, v78
v_and_b32 v33, s28, v78
v_lshlrev_b32 v34, 16, v79
v_and_b32 v35, s28, v79
v_lshlrev_b32 v36, 16, v80
v_and_b32 v37, s28, v80
v_lshlrev_b32 v38, 16, v81
v_and_b32 v39, s28, v81
v_lshlrev_b32 v40, 16, v82
v_and_b32 v41, s28, v82
v_lshlrev_b32 v42, 16, v83
v_and_b32 v43, s28, v83
v_lshlrev_b32 v44, 16, v84
v_mfma_f32_16x16x32_bf16 v[116:119], v[140:143], a[68:71], v[116:119]
buffer_load_dwordx4 v[132:135], v1, s[8:11], s24 offen offset:1024 sc1
v_and_b32 v45, s28, v84
v_lshlrev_b32 v46, 16, v85
v_and_b32 v47, s28, v85
v_pk_add_f32 v[68:69], v[68:69], s[48:49]
v_pk_add_f32 v[70:71], v[70:71], s[48:49]
v_pk_add_f32 v[72:73], v[72:73], s[48:49]
v_pk_add_f32 v[74:75], v[74:75], s[48:49]
v_pk_fma_f32 v[28:29], v[28:29], v[18:19], v[18:19] op_sel:[0,0,1] op_sel_hi:[1,0,1]
v_pk_fma_f32 v[30:31], v[30:31], v[18:19], v[18:19] op_sel:[0,0,1] op_sel_hi:[1,0,1]
v_pk_fma_f32 v[32:33], v[32:33], v[20:21], v[20:21] op_sel:[0,0,1] op_sel_hi:[1,0,1]
v_pk_fma_f32 v[34:35], v[34:35], v[20:21], v[20:21] op_sel:[0,0,1] op_sel_hi:[1,0,1]
v_pk_fma_f32 v[36:37], v[36:37], v[22:23], v[22:23] op_sel:[0,0,1] op_sel_hi:[1,0,1]
v_pk_fma_f32 v[38:39], v[38:39], v[22:23], v[22:23] op_sel:[0,0,1] op_sel_hi:[1,0,1]
v_pk_fma_f32 v[40:41], v[40:41], v[24:25], v[24:25] op_sel:[0,0,1] op_sel_hi:[1,0,1]
v_pk_fma_f32 v[42:43], v[42:43], v[24:25], v[24:25] op_sel:[0,0,1] op_sel_hi:[1,0,1]
v_pk_fma_f32 v[44:45], v[44:45], v[26:27], v[26:27] op_sel:[0,0,1] op_sel_hi:[1,0,1]
v_pk_fma_f32 v[46:47], v[46:47], v[26:27], v[26:27] op_sel:[0,0,1] op_sel_hi:[1,0,1]
v_pk_mul_f32 v[76:77], v[96:97], v[96:97]
v_pk_mul_f32 v[78:79], v[98:99], v[98:99]
v_pk_mul_f32 v[80:81], v[100:101], v[100:101]
v_pk_mul_f32 v[82:83], v[102:103], v[102:103]
v_pk_fma_f32 v[76:77], v[76:77], s[46:47], s[46:47] op_sel:[0,0,1] op_sel_hi:[1,0,1]
v_pk_fma_f32 v[78:79], v[78:79], s[46:47], s[46:47] op_sel:[0,0,1] op_sel_hi:[1,0,1]
v_pk_fma_f32 v[80:81], v[80:81], s[46:47], s[46:47] op_sel:[0,0,1] op_sel_hi:[1,0,1]
v_pk_fma_f32 v[82:83], v[82:83], s[46:47], s[46:47] op_sel:[0,0,1] op_sel_hi:[1,0,1]
v_pk_mul_f32 v[76:77], v[76:77], v[96:97]
v_pk_mul_f32 v[78:79], v[78:79], v[98:99]
v_pk_mul_f32 v[80:81], v[80:81], v[100:101]
v_pk_mul_f32 v[82:83], v[82:83], v[102:103]
s_waitcnt lgkmcnt(0)
v_pk_mul_f32 v[84:85], v[28:29], v[56:57]
v_pk_mul_f32 v[86:87], v[30:31], v[58:59]
v_pk_fma_f32 v[84:85], v[32:33], v[60:61], v[84:85]
v_pk_fma_f32 v[86:87], v[34:35], v[62:63], v[86:87]
v_pk_fma_f32 v[84:85], v[36:37], v[64:65], v[84:85]
v_pk_fma_f32 v[86:87], v[38:39], v[66:67], v[86:87]
v_mfma_f32_16x16x32_bf16 v[120:123], v[140:143], a[72:75], v[120:123]
v_rcp_f32 v68, v68
v_mfma_f32_16x16x32_bf16 v[120:123], v[136:139], a[52:55], v[120:123]
v_rcp_f32 v69, v69
v_mfma_f32_16x16x32_bf16 v[124:127], v[136:139], a[56:59], v[124:127]
s_waitcnt vmcnt(12)
v_rcp_f32 v70, v70
v_mfma_f32_16x16x32_bf16 v[124:127], v[140:143], a[76:79], v[124:127]
v_rcp_f32 v71, v71
v_mfma_f32_16x16x32_bf16 v[124:127], v[144:147], a[96:99], v[124:127]
buffer_load_dwordx4 v[136:139], v1, s[8:11], s24 offen offset:2048 sc1
v_mfma_f32_16x16x32_bf16 v[124:127], v[148:151], a[116:119], v[124:127]
v_rcp_f32 v72, v72
v_mfma_f32_16x16x32_bf16 v[120:123], v[148:151], a[112:115], v[120:123]
v_rcp_f32 v73, v73
v_mfma_f32_16x16x32_bf16 v[120:123], v[144:147], a[92:95], v[120:123]
v_rcp_f32 v74, v74
v_mfma_f32_16x16x32_bf16 v[116:119], v[144:147], a[88:91], v[116:119]
v_rcp_f32 v75, v75
v_mfma_f32_16x16x32_bf16 v[116:119], v[148:151], a[108:111], v[116:119]
buffer_load_dwordx4 v[140:143], v1, s[8:11], s24 offen offset:3072 sc1
v_mfma_f32_16x16x32_bf16 v[112:115], v[148:151], a[104:107], v[112:115]
s_add_u32 s24, s24, 4096
v_exp_f32 v76, v76
v_mfma_f32_16x16x32_bf16 v[112:115], v[144:147], a[84:87], v[112:115]
v_exp_f32 v77, v77
v_mfma_f32_16x16x32_bf16 v[108:111], v[144:147], a[80:83], v[108:111]
s_waitcnt vmcnt(12)
v_exp_f32 v78, v78
v_mfma_f32_16x16x32_bf16 v[108:111], v[148:151], a[100:103], v[108:111]
v_exp_f32 v79, v79
v_mfma_f32_16x16x32_bf16 v[108:111], v[152:155], a[120:123], v[108:111]
buffer_load_dwordx4 v[144:147], v1, s[8:11], s24 offen offset:0 sc1
v_mfma_f32_16x16x32_bf16 v[108:111], v[156:159], a[140:143], v[108:111]
v_exp_f32 v80, v80
v_mfma_f32_16x16x32_bf16 v[112:115], v[156:159], a[144:147], v[112:115]
v_exp_f32 v81, v81
v_mfma_f32_16x16x32_bf16 v[112:115], v[152:155], a[124:127], v[112:115]
v_exp_f32 v82, v82
v_mfma_f32_16x16x32_bf16 v[116:119], v[152:155], a[128:131], v[116:119]
v_exp_f32 v83, v83
v_fmac_f32_dpp v84, v44, v52 row_shr:1 row_mask:0xf bank_mask:0xf bound_ctrl:0
v_mfma_f32_16x16x32_bf16 v[116:119], v[156:159], a[148:151], v[116:119]
buffer_load_dwordx4 v[148:151], v1, s[8:11], s24 offen offset:1024 sc1
v_mfma_f32_16x16x32_bf16 v[120:123], v[156:159], a[152:155], v[120:123]
v_fmac_f32_dpp v85, v45, v53 row_shr:1 row_mask:0xf bank_mask:0xf bound_ctrl:0
v_fmac_f32_dpp v86, v46, v54 row_shr:1 row_mask:0xf bank_mask:0xf bound_ctrl:0
v_mfma_f32_16x16x32_bf16 v[120:123], v[152:155], a[132:135], v[120:123]
v_fmac_f32_dpp v87, v47, v55 row_shr:1 row_mask:0xf bank_mask:0xf bound_ctrl:0
v_fmac_f32_dpp v84, v40, v48 row_shr:1 row_mask:0xf bank_mask:0xf bound_ctrl:0
v_fmac_f32_dpp v85, v41, v49 row_shr:1 row_mask:0xf bank_mask:0xf bound_ctrl:0
v_fmac_f32_dpp v86, v42, v50 row_shr:1 row_mask:0xf bank_mask:0xf bound_ctrl:0
v_fmac_f32_dpp v87, v43, v51 row_shr:1 row_mask:0xf bank_mask:0xf bound_ctrl:0
v_pk_mul_f32 v[88:89], v[88:89], v[84:85]
v_pk_mul_f32 v[90:91], v[90:91], v[86:87]
v_pk_add_f32 v[76:77], v[76:77], s[48:49]
v_pk_add_f32 v[78:79], v[78:79], s[48:49]
v_pk_add_f32 v[80:81], v[80:81], s[48:49]
v_pk_add_f32 v[82:83], v[82:83], s[48:49]
v_pk_mul_f32 v[88:89], v[88:89], v[68:69]
v_pk_mul_f32 v[90:91], v[90:91], v[70:71]
v_pk_mul_f32 v[84:85], v[32:33], v[56:57]
v_pk_mul_f32 v[86:87], v[34:35], v[58:59]
v_pk_fma_f32 v[84:85], v[36:37], v[60:61], v[84:85]
v_pk_fma_f32 v[86:87], v[38:39], v[62:63], v[86:87]
v_pk_fma_f32 v[84:85], v[40:41], v[64:65], v[84:85]
v_pk_fma_f32 v[86:87], v[42:43], v[66:67], v[86:87]
v_pk_fma_f32 v[84:85], v[28:29], v[52:53], v[84:85]
v_pk_fma_f32 v[86:87], v[30:31], v[54:55], v[86:87]
v_mfma_f32_16x16x32_bf16 v[124:127], v[152:155], a[136:139], v[124:127]
s_waitcnt vmcnt(12)
v_rcp_f32 v76, v76
v_mfma_f32_16x16x32_bf16 v[124:127], v[156:159], a[156:159], v[124:127]
v_rcp_f32 v77, v77
v_mfma_f32_16x16x32_bf16 v[124:127], v[160:163], a[176:179], v[124:127]
buffer_load_dwordx4 v[152:155], v1, s[8:11], s24 offen offset:2048 sc1
v_mfma_f32_16x16x32_bf16 v[124:127], v[164:167], a[196:199], v[124:127]
v_rcp_f32 v78, v78
v_mfma_f32_16x16x32_bf16 v[120:123], v[164:167], a[192:195], v[120:123]
v_rcp_f32 v79, v79
v_mfma_f32_16x16x32_bf16 v[120:123], v[160:163], a[172:175], v[120:123]
v_rcp_f32 v80, v80
v_mfma_f32_16x16x32_bf16 v[116:119], v[160:163], a[168:171], v[116:119]
v_rcp_f32 v81, v81
v_mfma_f32_16x16x32_bf16 v[116:119], v[164:167], a[188:191], v[116:119]
buffer_load_dwordx4 v[156:159], v1, s[8:11], s24 offen offset:3072 sc1
v_mfma_f32_16x16x32_bf16 v[112:115], v[164:167], a[184:187], v[112:115]
s_add_u32 s24, s24, 4096
v_rcp_f32 v82, v82
v_mfma_f32_16x16x32_bf16 v[112:115], v[160:163], a[164:167], v[112:115]
v_rcp_f32 v83, v83
v_mfma_f32_16x16x32_bf16 v[108:111], v[160:163], a[160:163], v[108:111]
s_waitcnt vmcnt(12)
v_cvt_pk_bf16_f32 v88, v88, v89
v_cvt_pk_bf16_f32 v89, v90, v91
v_mfma_f32_16x16x32_bf16 v[108:111], v[164:167], a[180:183], v[108:111]
ds_write_b64 v6, v[88:89] offset:0
v_fmac_f32_dpp v84, v44, v48 row_shr:1 row_mask:0xf bank_mask:0xf bound_ctrl:0
v_fmac_f32_dpp v85, v45, v49 row_shr:1 row_mask:0xf bank_mask:0xf bound_ctrl:0
v_fmac_f32_dpp v86, v46, v50 row_shr:1 row_mask:0xf bank_mask:0xf bound_ctrl:0
v_fmac_f32_dpp v87, v47, v51 row_shr:1 row_mask:0xf bank_mask:0xf bound_ctrl:0
v_pk_mul_f32 v[92:93], v[92:93], v[84:85]
v_pk_mul_f32 v[94:95], v[94:95], v[86:87]
v_pk_mul_f32 v[96:97], v[96:97], v[76:77]
v_pk_mul_f32 v[98:99], v[98:99], v[78:79]
v_pk_mul_f32 v[92:93], v[92:93], v[72:73]
v_pk_mul_f32 v[94:95], v[94:95], v[74:75]
v_pk_mul_f32 v[68:69], v[104:105], v[104:105]
v_pk_mul_f32 v[70:71], v[106:107], v[106:107]
v_pk_fma_f32 v[68:69], v[68:69], s[46:47], s[46:47] op_sel:[0,0,1] op_sel_hi:[1,0,1]
v_pk_fma_f32 v[70:71], v[70:71], s[46:47], s[46:47] op_sel:[0,0,1] op_sel_hi:[1,0,1]
v_pk_mul_f32 v[68:69], v[68:69], v[104:105]
v_pk_mul_f32 v[70:71], v[70:71], v[106:107]
v_pk_mul_f32 v[84:85], v[36:37], v[56:57]
v_pk_mul_f32 v[86:87], v[38:39], v[58:59]
v_pk_fma_f32 v[84:85], v[40:41], v[60:61], v[84:85]
v_pk_fma_f32 v[86:87], v[42:43], v[62:63], v[86:87]
v_pk_fma_f32 v[84:85], v[44:45], v[64:65], v[84:85]
v_pk_fma_f32 v[86:87], v[46:47], v[66:67], v[86:87]
v_pk_fma_f32 v[84:85], v[32:33], v[52:53], v[84:85]
v_pk_fma_f32 v[86:87], v[34:35], v[54:55], v[86:87]
v_pk_fma_f32 v[84:85], v[28:29], v[48:49], v[84:85]
v_pk_fma_f32 v[86:87], v[30:31], v[50:51], v[86:87]
v_pk_mul_f32 v[100:101], v[100:101], v[80:81]
v_pk_mul_f32 v[102:103], v[102:103], v[82:83]
v_pk_mul_f32 v[96:97], v[96:97], v[84:85]
v_pk_mul_f32 v[98:99], v[98:99], v[86:87]
v_pk_mul_f32 v[84:85], v[40:41], v[56:57]
v_pk_mul_f32 v[86:87], v[42:43], v[58:59]
v_pk_fma_f32 v[84:85], v[44:45], v[60:61], v[84:85]
v_pk_fma_f32 v[86:87], v[46:47], v[62:63], v[86:87]
v_pk_fma_f32 v[84:85], v[36:37], v[52:53], v[84:85]
v_pk_fma_f32 v[86:87], v[38:39], v[54:55], v[86:87]
v_pk_fma_f32 v[84:85], v[32:33], v[48:49], v[84:85]
v_pk_fma_f32 v[86:87], v[34:35], v[50:51], v[86:87]
v_mfma_f32_16x16x32_bf16 v[108:111], v[168:171], a[200:203], v[108:111]
buffer_load_dwordx4 v[160:163], v1, s[8:11], s24 offen offset:0 sc1
v_mfma_f32_16x16x32_bf16 v[108:111], v[172:175], a[220:223], v[108:111]
v_exp_f32 v68, v68
v_mfma_f32_16x16x32_bf16 v[112:115], v[172:175], a[224:227], v[112:115]
v_exp_f32 v69, v69
v_mfma_f32_16x16x32_bf16 v[112:115], v[168:171], a[204:207], v[112:115]
v_exp_f32 v70, v70
v_mfma_f32_16x16x32_bf16 v[116:119], v[168:171], a[208:211], v[116:119]
v_exp_f32 v71, v71
v_mfma_f32_16x16x32_bf16 v[116:119], v[172:175], a[228:231], v[116:119]
buffer_load_dwordx4 v[164:167], v1, s[8:11], s24 offen offset:1024 sc1
v_mfma_f32_16x16x32_bf16 v[120:123], v[172:175], a[232:235], v[120:123]
v_cvt_pk_bf16_f32 v92, v92, v93
v_cvt_pk_bf16_f32 v93, v94, v95
v_mfma_f32_16x16x32_bf16 v[120:123], v[168:171], a[212:215], v[120:123]
ds_write_b64 v7, v[92:93] offset:0
v_mfma_f32_16x16x32_bf16 v[124:127], v[168:171], a[216:219], v[124:127]
s_waitcnt vmcnt(12)
v_cvt_pk_bf16_f32 v96, v96, v97
v_cvt_pk_bf16_f32 v97, v98, v99
v_mfma_f32_16x16x32_bf16 v[124:127], v[172:175], a[236:239], v[124:127]
ds_write_b64 v8, v[96:97] offset:0
v_fmac_f32_dpp v84, v28, v64 row_shl:1 row_mask:0xf bank_mask:0xf bound_ctrl:0
v_fmac_f32_dpp v85, v29, v65 row_shl:1 row_mask:0xf bank_mask:0xf bound_ctrl:0
v_fmac_f32_dpp v86, v30, v66 row_shl:1 row_mask:0xf bank_mask:0xf bound_ctrl:0
v_fmac_f32_dpp v87, v31, v67 row_shl:1 row_mask:0xf bank_mask:0xf bound_ctrl:0
v_pk_add_f32 v[68:69], v[68:69], s[48:49]
v_pk_add_f32 v[70:71], v[70:71], s[48:49]
v_pk_mul_f32 v[100:101], v[100:101], v[84:85]
v_pk_mul_f32 v[102:103], v[102:103], v[86:87]
v_pk_mul_f32 v[84:85], v[44:45], v[56:57]
v_pk_mul_f32 v[86:87], v[46:47], v[58:59]
v_pk_fma_f32 v[84:85], v[40:41], v[52:53], v[84:85]
v_pk_fma_f32 v[86:87], v[42:43], v[54:55], v[86:87]
v_pk_fma_f32 v[84:85], v[36:37], v[48:49], v[84:85]
v_pk_fma_f32 v[86:87], v[38:39], v[50:51], v[86:87]
v_mfma_f32_16x16x32_bf16 v[124:127], v[176:179], v[192:195], v[124:127]
buffer_load_dwordx4 v[168:171], v1, s[8:11], s24 offen offset:2048 sc1
v_mfma_f32_16x16x32_bf16 v[124:127], v[180:183], v[212:215], v[124:127]
v_rcp_f32 v68, v68
v_mfma_f32_16x16x32_bf16 v[120:123], v[180:183], v[208:211], v[120:123]
v_rcp_f32 v69, v69
v_mfma_f32_16x16x32_bf16 v[120:123], v[176:179], a[252:255], v[120:123]
v_rcp_f32 v70, v70
v_mfma_f32_16x16x32_bf16 v[116:119], v[176:179], a[248:251], v[116:119]
v_rcp_f32 v71, v71
v_mfma_f32_16x16x32_bf16 v[116:119], v[180:183], v[204:207], v[116:119]
buffer_load_dwordx4 v[172:175], v1, s[8:11], s24 offen offset:3072 sc1
v_mfma_f32_16x16x32_bf16 v[112:115], v[180:183], v[200:203], v[112:115]
s_add_u32 s24, s24, 4096
v_cvt_pk_bf16_f32 v100, v100, v101
v_cvt_pk_bf16_f32 v101, v102, v103
v_mfma_f32_16x16x32_bf16 v[112:115], v[176:179], a[244:247], v[112:115]
ds_write_b64 v9, v[100:101] offset:0
v_mfma_f32_16x16x32_bf16 v[108:111], v[176:179], a[240:243], v[108:111]
s_waitcnt vmcnt(12)
v_fmac_f32_dpp v84, v28, v60 row_shl:1 row_mask:0xf bank_mask:0xf bound_ctrl:0
v_fmac_f32_dpp v85, v29, v61 row_shl:1 row_mask:0xf bank_mask:0xf bound_ctrl:0
v_mfma_f32_16x16x32_bf16 v[108:111], v[180:183], v[196:199], v[108:111]
v_fmac_f32_dpp v86, v30, v62 row_shl:1 row_mask:0xf bank_mask:0xf bound_ctrl:0
v_fmac_f32_dpp v87, v31, v63 row_shl:1 row_mask:0xf bank_mask:0xf bound_ctrl:0
v_mfma_f32_16x16x32_bf16 v[108:111], v[184:187], v[216:219], v[108:111]
buffer_load_dwordx4 v[176:179], v1, s[8:11], s24 offen offset:0 sc1
v_mfma_f32_16x16x32_bf16 v[108:111], v[188:191], v[236:239], v[108:111]
v_fmac_f32_dpp v84, v32, v64 row_shl:1 row_mask:0xf bank_mask:0xf bound_ctrl:0
v_fmac_f32_dpp v85, v33, v65 row_shl:1 row_mask:0xf bank_mask:0xf bound_ctrl:0
v_mfma_f32_16x16x32_bf16 v[112:115], v[188:191], v[240:243], v[112:115]
v_fmac_f32_dpp v86, v34, v66 row_shl:1 row_mask:0xf bank_mask:0xf bound_ctrl:0
v_fmac_f32_dpp v87, v35, v67 row_shl:1 row_mask:0xf bank_mask:0xf bound_ctrl:0
v_mfma_f32_16x16x32_bf16 v[112:115], v[184:187], v[220:223], v[112:115]
v_mul_f32 v104, v104, v68
v_mul_f32 v105, v105, v69
v_mfma_f32_16x16x32_bf16 v[116:119], v[184:187], v[224:227], v[116:119]
v_mul_f32 v106, v106, v70
v_mul_f32 v107, v107, v71
v_mfma_f32_16x16x32_bf16 v[116:119], v[188:191], v[244:247], v[116:119]
buffer_load_dwordx4 v[180:183], v1, s[8:11], s24 offen offset:1024 sc1
v_mfma_f32_16x16x32_bf16 v[120:123], v[188:191], v[248:251], v[120:123]
v_mul_f32 v104, v104, v84
v_mul_f32 v105, v105, v85
v_mfma_f32_16x16x32_bf16 v[120:123], v[184:187], v[228:231], v[120:123]
v_mul_f32 v106, v106, v86
v_mul_f32 v107, v107, v87
v_mfma_f32_16x16x32_bf16 v[124:127], v[184:187], v[232:235], v[124:127]
s_waitcnt vmcnt(12)
v_cvt_pk_bf16_f32 v104, v104, v105
v_cvt_pk_bf16_f32 v105, v106, v107
v_mfma_f32_16x16x32_bf16 v[124:127], v[188:191], v[252:255], v[124:127]
ds_write_b64 v10, v[104:105] offset:0
s_cmp_eq_u32 s25, 3
s_cbranch_scc1 L_c_u3
v_mfma_f32_16x16x32_bf16 v[104:107], v[128:131], a[16:19], 0
buffer_load_dwordx4 v[184:187], v1, s[8:11], s24 offen offset:2048 sc1
v_mfma_f32_16x16x32_bf16 v[104:107], v[132:135], a[36:39], v[104:107]
ds_read_b64 v[76:77], v6 offset:8
ds_read_b64 v[78:79], v7 offset:8
v_mfma_f32_16x16x32_bf16 v[100:103], v[132:135], a[32:35], 0
ds_read_b64 v[80:81], v8 offset:8
ds_read_b64 v[82:83], v9 offset:8
ds_read_b64 v[84:85], v10 offset:8
v_pk_mul_f32 v[68:69], v[108:109], v[108:109]
v_pk_mul_f32 v[70:71], v[110:111], v[110:111]
v_pk_mul_f32 v[72:73], v[112:113], v[112:113]
v_pk_mul_f32 v[74:75], v[114:115], v[114:115]
v_pk_fma_f32 v[68:69], v[68:69], s[46:47], s[46:47] op_sel:[0,0,1] op_sel_hi:[1,0,1]
v_pk_fma_f32 v[70:71], v[70:71], s[46:47], s[46:47] op_sel:[0,0,1] op_sel_hi:[1,0,1]
v_pk_fma_f32 v[72:73], v[72:73], s[46:47], s[46:47] op_sel:[0,0,1] op_sel_hi:[1,0,1]
v_pk_fma_f32 v[74:75], v[74:75], s[46:47], s[46:47] op_sel:[0,0,1] op_sel_hi:[1,0,1]
v_pk_mul_f32 v[68:69], v[68:69], v[108:109]
v_pk_mul_f32 v[70:71], v[70:71], v[110:111]
v_pk_mul_f32 v[72:73], v[72:73], v[112:113]
v_pk_mul_f32 v[74:75], v[74:75], v[114:115]
v_exp_f32 v68, v68
v_exp_f32 v69, v69
v_exp_f32 v70, v70
v_exp_f32 v71, v71
v_mfma_f32_16x16x32_bf16 v[100:103], v[128:131], a[12:15], v[100:103]
buffer_load_dword v13, v16, s[8:11], 0 offen sc1
v_mfma_f32_16x16x32_bf16 v[96:99], v[128:131], a[8:11], 0
v_exp_f32 v72, v72
v_mfma_f32_16x16x32_bf16 v[96:99], v[132:135], a[28:31], v[96:99]
buffer_load_dwordx4 v[188:191], v1, s[8:11], s24 offen offset:3072 sc1
v_mfma_f32_16x16x32_bf16 v[92:95], v[132:135], a[24:27], 0
s_add_u32 s24, s24, 4096
v_exp_f32 v73, v73
v_mfma_f32_16x16x32_bf16 v[92:95], v[128:131], a[4:7], v[92:95]
v_exp_f32 v74, v74
v_mfma_f32_16x16x32_bf16 v[88:91], v[128:131], a[0:3], 0
s_waitcnt vmcnt(13)
v_exp_f32 v75, v75
v_mfma_f32_16x16x32_bf16 v[88:91], v[132:135], a[20:23], v[88:91]
ds_read_b128 v[48:51], v11 offset:16
s_waitcnt lgkmcnt(1)
v_lshlrev_b32 v28, 16, v76
v_mfma_f32_16x16x32_bf16 v[88:91], v[136:139], a[40:43], v[88:91]
buffer_load_dwordx4 v[128:131], v1, s[8:11], s24 offen offset:0 sc1
v_mfma_f32_16x16x32_bf16 v[88:91], v[140:143], a[60:63], v[88:91]
ds_read_b128 v[52:55], v11 offset:2064
v_and_b32 v29, s28, v76
v_mfma_f32_16x16x32_bf16 v[92:95], v[140:143], a[64:67], v[92:95]
s_add_u32 m0, s45, 0
s_add_u32 s35, s42, 0
ds_read_b128 v[56:59], v11 offset:4112
v_lshlrev_b32 v30, 16, v77
v_mfma_f32_16x16x32_bf16 v[92:95], v[136:139], a[44:47], v[92:95]
buffer_load_dwordx4 v5, s[16:19], s35 offen lds
v_mfma_f32_16x16x32_bf16 v[96:99], v[136:139], a[48:51], v[96:99]
ds_read_b128 v[60:63], v11 offset:6160
v_and_b32 v31, s28, v77
v_mfma_f32_16x16x32_bf16 v[96:99], v[140:143], a[68:71], v[96:99]
buffer_load_dwordx4 v[132:135], v1, s[8:11], s24 offen offset:1024 sc1
v_mfma_f32_16x16x32_bf16 v[100:103], v[140:143], a[72:75], v[100:103]
ds_read_b128 v[64:67], v11 offset:8208
v_lshlrev_b32 v32, 16, v78
v_and_b32 v33, s28, v78
v_lshlrev_b32 v34, 16, v79
v_and_b32 v35, s28, v79
v_lshlrev_b32 v36, 16, v80
v_and_b32 v37, s28, v80
v_lshlrev_b32 v38, 16, v81
v_and_b32 v39, s28, v81
v_lshlrev_b32 v40, 16, v82
v_and_b32 v41, s28, v82
v_lshlrev_b32 v42, 16, v83
v_mfma_f32_16x16x32_bf16 v[100:103], v[136:139], a[52:55], v[100:103]
v_and_b32 v43, s28, v83
v_lshlrev_b32 v44, 16, v84
v_and_b32 v45, s28, v84
v_lshlrev_b32 v46, 16, v85
v_and_b32 v47, s28, v85
v_pk_add_f32 v[68:69], v[68:69], s[48:49]
v_pk_add_f32 v[70:71], v[70:71], s[48:49]
v_pk_add_f32 v[72:73], v[72:73], s[48:49]
v_pk_add_f32 v[74:75], v[74:75], s[48:49]
v_pk_fma_f32 v[28:29], v[28:29], v[18:19], v[18:19] op_sel:[0,0,1] op_sel_hi:[1,0,1]
v_pk_fma_f32 v[30:31], v[30:31], v[18:19], v[18:19] op_sel:[0,0,1] op_sel_hi:[1,0,1]
v_pk_fma_f32 v[32:33], v[32:33], v[20:21], v[20:21] op_sel:[0,0,1] op_sel_hi:[1,0,1]
v_pk_fma_f32 v[34:35], v[34:35], v[20:21], v[20:21] op_sel:[0,0,1] op_sel_hi:[1,0,1]
v_pk_fma_f32 v[36:37], v[36:37], v[22:23], v[22:23] op_sel:[0,0,1] op_sel_hi:[1,0,1]
v_pk_fma_f32 v[38:39], v[38:39], v[22:23], v[22:23] op_sel:[0,0,1] op_sel_hi:[1,0,1]
v_pk_fma_f32 v[40:41], v[40:41], v[24:25], v[24:25] op_sel:[0,0,1] op_sel_hi:[1,0,1]
v_pk_fma_f32 v[42:43], v[42:43], v[24:25], v[24:25] op_sel:[0,0,1] op_sel_hi:[1,0,1]
v_pk_fma_f32 v[44:45], v[44:45], v[26:27], v[26:27] op_sel:[0,0,1] op_sel_hi:[1,0,1]
v_pk_fma_f32 v[46:47], v[46:47], v[26:27], v[26:27] op_sel:[0,0,1] op_sel_hi:[1,0,1]
v_pk_mul_f32 v[76:77], v[116:117], v[116:117]
v_pk_mul_f32 v[78:79], v[118:119], v[118:119]
v_pk_mul_f32 v[80:81], v[120:121], v[120:121]
v_pk_mul_f32 v[82:83], v[122:123], v[122:123]
v_pk_fma_f32 v[76:77], v[76:77], s[46:47], s[46:47] op_sel:[0,0,1] op_sel_hi:[1,0,1]
v_pk_fma_f32 v[78:79], v[78:79], s[46:47], s[46:47] op_sel:[0,0,1] op_sel_hi:[1,0,1]
v_pk_fma_f32 v[80:81], v[80:81], s[46:47], s[46:47] op_sel:[0,0,1] op_sel_hi:[1,0,1]
v_pk_fma_f32 v[82:83], v[82:83], s[46:47], s[46:47] op_sel:[0,0,1] op_sel_hi:[1,0,1]
v_pk_mul_f32 v[76:77], v[76:77], v[116:117]
v_pk_mul_f32 v[78:79], v[78:79], v[118:119]
v_pk_mul_f32 v[80:81], v[80:81], v[120:121]
v_pk_mul_f32 v[82:83], v[82:83], v[122:123]
s_waitcnt lgkmcnt(0)
v_pk_mul_f32 v[84:85], v[28:29], v[56:57]
v_pk_mul_f32 v[86:87], v[30:31], v[58:59]
v_pk_fma_f32 v[84:85], v[32:33], v[60:61], v[84:85]
v_pk_fma_f32 v[86:87], v[34:35], v[62:63], v[86:87]
v_pk_fma_f32 v[84:85], v[36:37], v[64:65], v[84:85]
v_pk_fma_f32 v[86:87], v[38:39], v[66:67], v[86:87]
v_rcp_f32 v68, v68
v_rcp_f32 v69, v69
v_rcp_f32 v70, v70
v_rcp_f32 v71, v71
v_rcp_f32 v72, v72
v_rcp_f32 v73, v73
v_rcp_f32 v74, v74
v_rcp_f32 v75, v75
v_mfma_f32_16x16x32_bf16 v[104:107], v[136:139], a[56:59], v[104:107]
s_waitcnt vmcnt(14)
v_exp_f32 v76, v76
v_mfma_f32_16x16x32_bf16 v[104:107], v[140:143], a[76:79], v[104:107]
v_exp_f32 v77, v77
v_mfma_f32_16x16x32_bf16 v[104:107], v[144:147], a[96:99], v[104:107]
buffer_load_dwordx4 v[136:139], v1, s[8:11], s24 offen offset:2048 sc1
v_mfma_f32_16x16x32_bf16 v[104:107], v[148:151], a[116:119], v[104:107]
v_exp_f32 v78, v78
v_mfma_f32_16x16x32_bf16 v[100:103], v[148:151], a[112:115], v[100:103]
s_add_u32 m0, s45, 1024
s_add_u32 s35, s42, 16384
v_exp_f32 v79, v79
v_mfma_f32_16x16x32_bf16 v[100:103], v[144:147], a[92:95], v[100:103]
buffer_load_dwordx4 v5, s[16:19], s35 offen lds
v_mfma_f32_16x16x32_bf16 v[96:99], v[144:147], a[88:91], v[96:99]
v_exp_f32 v80, v80
v_mfma_f32_16x16x32_bf16 v[96:99], v[148:151], a[108:111], v[96:99]
buffer_load_dwordx4 v[140:143], v1, s[8:11], s24 offen offset:3072 sc1
v_mfma_f32_16x16x32_bf16 v[92:95], v[148:151], a[104:107], v[92:95]
s_add_u32 s24, s24, 4096
v_exp_f32 v81, v81
v_mfma_f32_16x16x32_bf16 v[92:95], v[144:147], a[84:87], v[92:95]
v_exp_f32 v82, v82
v_mfma_f32_16x16x32_bf16 v[88:91], v[144:147], a[80:83], v[88:91]
s_waitcnt vmcnt(15)
v_exp_f32 v83, v83
v_mfma_f32_16x16x32_bf16 v[88:91], v[148:151], a[100:103], v[88:91]
v_fmac_f32_dpp v84, v44, v52 row_shr:1 row_mask:0xf bank_mask:0xf bound_ctrl:0
v_fmac_f32_dpp v85, v45, v53 row_shr:1 row_mask:0xf bank_mask:0xf bound_ctrl:0
v_mfma_f32_16x16x32_bf16 v[88:91], v[152:155], a[120:123], v[88:91]
buffer_load_dwordx4 v[144:147], v1, s[8:11], s24 offen offset:0 sc1
v_mfma_f32_16x16x32_bf16 v[88:91], v[156:159], a[140:143], v[88:91]
v_fmac_f32_dpp v86, v46, v54 row_shr:1 row_mask:0xf bank_mask:0xf bound_ctrl:0
v_fmac_f32_dpp v87, v47, v55 row_shr:1 row_mask:0xf bank_mask:0xf bound_ctrl:0
v_mfma_f32_16x16x32_bf16 v[92:95], v[156:159], a[144:147], v[92:95]
s_add_u32 m0, s45, 2048
s_add_u32 s35, s42, 32768
v_fmac_f32_dpp v84, v40, v48 row_shr:1 row_mask:0xf bank_mask:0xf bound_ctrl:0
v_fmac_f32_dpp v85, v41, v49 row_shr:1 row_mask:0xf bank_mask:0xf bound_ctrl:0
v_fmac_f32_dpp v86, v42, v50 row_shr:1 row_mask:0xf bank_mask:0xf bound_ctrl:0
v_fmac_f32_dpp v87, v43, v51 row_shr:1 row_mask:0xf bank_mask:0xf bound_ctrl:0
v_pk_mul_f32 v[108:109], v[108:109], v[84:85]
v_pk_mul_f32 v[110:111], v[110:111], v[86:87]
v_pk_add_f32 v[76:77], v[76:77], s[48:49]
v_pk_add_f32 v[78:79], v[78:79], s[48:49]
v_pk_add_f32 v[80:81], v[80:81], s[48:49]
v_pk_add_f32 v[82:83], v[82:83], s[48:49]
v_pk_mul_f32 v[108:109], v[108:109], v[68:69]
v_pk_mul_f32 v[110:111], v[110:111], v[70:71]
v_pk_mul_f32 v[84:85], v[32:33], v[56:57]
v_pk_mul_f32 v[86:87], v[34:35], v[58:59]
v_pk_fma_f32 v[84:85], v[36:37], v[60:61], v[84:85]
v_pk_fma_f32 v[86:87], v[38:39], v[62:63], v[86:87]
v_pk_fma_f32 v[84:85], v[40:41], v[64:65], v[84:85]
v_pk_fma_f32 v[86:87], v[42:43], v[66:67], v[86:87]
v_pk_fma_f32 v[84:85], v[28:29], v[52:53], v[84:85]
v_pk_fma_f32 v[86:87], v[30:31], v[54:55], v[86:87]
v_mfma_f32_16x16x32_bf16 v[92:95], v[152:155], a[124:127], v[92:95]
buffer_load_dwordx4 v5, s[16:19], s35 offen lds
v_mfma_f32_16x16x32_bf16 v[96:99], v[152:155], a[128:131], v[96:99]
v_rcp_f32 v76, v76
v_mfma_f32_16x16x32_bf16 v[96:99], v[156:159], a[148:151], v[96:99]
buffer_load_dwordx4 v[148:151], v1, s[8:11], s24 offen offset:1024 sc1
v_mfma_f32_16x16x32_bf16 v[100:103], v[156:159], a[152:155], v[100:103]
v_rcp_f32 v77, v77
v_mfma_f32_16x16x32_bf16 v[100:103], v[152:155], a[132:135], v[100:103]
v_rcp_f32 v78, v78
v_mfma_f32_16x16x32_bf16 v[104:107], v[152:155], a[136:139], v[104:107]
s_waitcnt vmcnt(16)
v_rcp_f32 v79, v79
v_mfma_f32_16x16x32_bf16 v[104:107], v[156:159], a[156:159], v[104:107]
v_rcp_f32 v80, v80
v_mfma_f32_16x16x32_bf16 v[104:107], v[160:163], a[176:179], v[104:107]
buffer_load_dwordx4 v[152:155], v1, s[8:11], s24 offen offset:2048 sc1
v_mfma_f32_16x16x32_bf16 v[104:107], v[164:167], a[196:199], v[104:107]
v_rcp_f32 v81, v81
v_mfma_f32_16x16x32_bf16 v[100:103], v[164:167], a[192:195], v[100:103]
s_add_u32 m0, s45, 3072
s_add_u32 s35, s42, 49152
v_rcp_f32 v82, v82
v_mfma_f32_16x16x32_bf16 v[100:103], v[160:163], a[172:175], v[100:103]
buffer_load_dwordx4 v5, s[16:19], s35 offen lds
v_mfma_f32_16x16x32_bf16 v[96:99], v[160:163], a[168:171], v[96:99]
v_rcp_f32 v83, v83
v_mfma_f32_16x16x32_bf16 v[96:99], v[164:167], a[188:191], v[96:99]
buffer_load_dwordx4 v[156:159], v1, s[8:11], s24 offen offset:3072 sc1
v_mfma_f32_16x16x32_bf16 v[92:95], v[164:167], a[184:187], v[92:95]
s_add_u32 s24, s24, 4096
v_cvt_pk_bf16_f32 v108, v108, v109
v_cvt_pk_bf16_f32 v109, v110, v111
v_mfma_f32_16x16x32_bf16 v[92:95], v[160:163], a[164:167], v[92:95]
ds_write_b64 v6, v[108:109] offset:8
v_mfma_f32_16x16x32_bf16 v[88:91], v[160:163], a[160:163], v[88:91]
s_waitcnt vmcnt(17)
v_add_u32 v6, 1024, v6
v_fmac_f32_dpp v84, v44, v48 row_shr:1 row_mask:0xf bank_mask:0xf bound_ctrl:0
v_fmac_f32_dpp v85, v45, v49 row_shr:1 row_mask:0xf bank_mask:0xf bound_ctrl:0
v_fmac_f32_dpp v86, v46, v50 row_shr:1 row_mask:0xf bank_mask:0xf bound_ctrl:0
v_fmac_f32_dpp v87, v47, v51 row_shr:1 row_mask:0xf bank_mask:0xf bound_ctrl:0
v_pk_mul_f32 v[112:113], v[112:113], v[84:85]
v_pk_mul_f32 v[114:115], v[114:115], v[86:87]
v_pk_mul_f32 v[116:117], v[116:117], v[76:77]
v_pk_mul_f32 v[118:119], v[118:119], v[78:79]
v_pk_mul_f32 v[112:113], v[112:113], v[72:73]
v_pk_mul_f32 v[114:115], v[114:115], v[74:75]
v_pk_mul_f32 v[68:69], v[124:125], v[124:125]
v_pk_mul_f32 v[70:71], v[126:127], v[126:127]
v_pk_fma_f32 v[68:69], v[68:69], s[46:47], s[46:47] op_sel:[0,0,1] op_sel_hi:[1,0,1]
v_pk_fma_f32 v[70:71], v[70:71], s[46:47], s[46:47] op_sel:[0,0,1] op_sel_hi:[1,0,1]
v_pk_mul_f32 v[68:69], v[68:69], v[124:125]
v_pk_mul_f32 v[70:71], v[70:71], v[126:127]
v_pk_mul_f32 v[84:85], v[36:37], v[56:57]
v_pk_mul_f32 v[86:87], v[38:39], v[58:59]
v_pk_fma_f32 v[84:85], v[40:41], v[60:61], v[84:85]
v_pk_fma_f32 v[86:87], v[42:43], v[62:63], v[86:87]
v_pk_fma_f32 v[84:85], v[44:45], v[64:65], v[84:85]
v_pk_fma_f32 v[86:87], v[46:47], v[66:67], v[86:87]
v_pk_fma_f32 v[84:85], v[32:33], v[52:53], v[84:85]
v_pk_fma_f32 v[86:87], v[34:35], v[54:55], v[86:87]
v_pk_fma_f32 v[84:85], v[28:29], v[48:49], v[84:85]
v_pk_fma_f32 v[86:87], v[30:31], v[50:51], v[86:87]
v_pk_mul_f32 v[120:121], v[120:121], v[80:81]
v_pk_mul_f32 v[122:123], v[122:123], v[82:83]
v_pk_mul_f32 v[116:117], v[116:117], v[84:85]
v_pk_mul_f32 v[118:119], v[118:119], v[86:87]
v_pk_mul_f32 v[84:85], v[40:41], v[56:57]
v_pk_mul_f32 v[86:87], v[42:43], v[58:59]
v_pk_fma_f32 v[84:85], v[44:45], v[60:61], v[84:85]
v_pk_fma_f32 v[86:87], v[46:47], v[62:63], v[86:87]
v_pk_fma_f32 v[84:85], v[36:37], v[52:53], v[84:85]
v_pk_fma_f32 v[86:87], v[38:39], v[54:55], v[86:87]
v_pk_fma_f32 v[84:85], v[32:33], v[48:49], v[84:85]
v_pk_fma_f32 v[86:87], v[34:35], v[50:51], v[86:87]
v_mfma_f32_16x16x32_bf16 v[88:91], v[164:167], a[180:183], v[88:91]
v_exp_f32 v68, v68
v_mfma_f32_16x16x32_bf16 v[88:91], v[168:171], a[200:203], v[88:91]
buffer_load_dwordx4 v[160:163], v1, s[8:11], s24 offen offset:0 sc1
v_mfma_f32_16x16x32_bf16 v[88:91], v[172:175], a[220:223], v[88:91]
v_exp_f32 v69, v69
v_mfma_f32_16x16x32_bf16 v[92:95], v[172:175], a[224:227], v[92:95]
s_add_u32 m0, s45, 4096
s_add_u32 s35, s42, 65536
v_exp_f32 v70, v70
v_mfma_f32_16x16x32_bf16 v[92:95], v[168:171], a[204:207], v[92:95]
buffer_load_dwordx4 v5, s[16:19], s35 offen lds
v_mfma_f32_16x16x32_bf16 v[96:99], v[168:171], a[208:211], v[96:99]
s_add_u32 s42, s42, 64
s_add_u32 s45, s45, 5120
v_exp_f32 v71, v71
v_mfma_f32_16x16x32_bf16 v[96:99], v[172:175], a[228:231], v[96:99]
buffer_load_dwordx4 v[164:167], v1, s[8:11], s24 offen offset:1024 sc1
v_mfma_f32_16x16x32_bf16 v[100:103], v[172:175], a[232:235], v[100:103]
v_cvt_pk_bf16_f32 v112, v112, v113
v_cvt_pk_bf16_f32 v113, v114, v115
v_mfma_f32_16x16x32_bf16 v[100:103], v[168:171], a[212:215], v[100:103]
ds_write_b64 v7, v[112:113] offset:8
v_add_u32 v7, 1024, v7
v_mfma_f32_16x16x32_bf16 v[104:107], v[168:171], a[216:219], v[104:107]
s_waitcnt vmcnt(18)
v_cvt_pk_bf16_f32 v116, v116, v117
v_cvt_pk_bf16_f32 v117, v118, v119
v_mfma_f32_16x16x32_bf16 v[104:107], v[172:175], a[236:239], v[104:107]
ds_write_b64 v8, v[116:117] offset:8
v_add_u32 v8, 1024, v8
v_fmac_f32_dpp v84, v28, v64 row_shl:1 row_mask:0xf bank_mask:0xf bound_ctrl:0
v_fmac_f32_dpp v85, v29, v65 row_shl:1 row_mask:0xf bank_mask:0xf bound_ctrl:0
v_fmac_f32_dpp v86, v30, v66 row_shl:1 row_mask:0xf bank_mask:0xf bound_ctrl:0
v_fmac_f32_dpp v87, v31, v67 row_shl:1 row_mask:0xf bank_mask:0xf bound_ctrl:0
v_pk_add_f32 v[68:69], v[68:69], s[48:49]
v_pk_add_f32 v[70:71], v[70:71], s[48:49]
v_pk_mul_f32 v[120:121], v[120:121], v[84:85]
v_pk_mul_f32 v[122:123], v[122:123], v[86:87]
v_pk_mul_f32 v[84:85], v[44:45], v[56:57]
v_pk_mul_f32 v[86:87], v[46:47], v[58:59]
v_pk_fma_f32 v[84:85], v[40:41], v[52:53], v[84:85]
v_pk_fma_f32 v[86:87], v[42:43], v[54:55], v[86:87]
v_pk_fma_f32 v[84:85], v[36:37], v[48:49], v[84:85]
v_pk_fma_f32 v[86:87], v[38:39], v[50:51], v[86:87]
v_mfma_f32_16x16x32_bf16 v[104:107], v[176:179], v[192:195], v[104:107]
buffer_load_dwordx4 v[168:171], v1, s[8:11], s24 offen offset:2048 sc1
v_mfma_f32_16x16x32_bf16 v[104:107], v[180:183], v[212:215], v[104:107]
v_rcp_f32 v68, v68
v_mfma_f32_16x16x32_bf16 v[100:103], v[180:183], v[208:211], v[100:103]
v_rcp_f32 v69, v69
v_mfma_f32_16x16x32_bf16 v[100:103], v[176:179], a[252:255], v[100:103]
v_rcp_f32 v70, v70
v_mfma_f32_16x16x32_bf16 v[96:99], v[176:179], a[248:251], v[96:99]
v_rcp_f32 v71, v71
v_mfma_f32_16x16x32_bf16 v[96:99], v[180:183], v[204:207], v[96:99]
buffer_load_dwordx4 v[172:175], v1, s[8:11], s24 offen offset:3072 sc1
v_mfma_f32_16x16x32_bf16 v[92:95], v[180:183], v[200:203], v[92:95]
s_add_u32 s24, s24, 4096
v_cvt_pk_bf16_f32 v120, v120, v121
v_cvt_pk_bf16_f32 v121, v122, v123
v_mfma_f32_16x16x32_bf16 v[92:95], v[176:179], a[244:247], v[92:95]
ds_write_b64 v9, v[120:121] offset:8
v_add_u32 v9, 1024, v9
v_mfma_f32_16x16x32_bf16 v[88:91], v[176:179], a[240:243], v[88:91]
s_waitcnt vmcnt(17)
v_fmac_f32_dpp v84, v28, v60 row_shl:1 row_mask:0xf bank_mask:0xf bound_ctrl:0
v_fmac_f32_dpp v85, v29, v61 row_shl:1 row_mask:0xf bank_mask:0xf bound_ctrl:0
v_mfma_f32_16x16x32_bf16 v[88:91], v[180:183], v[196:199], v[88:91]
v_fmac_f32_dpp v86, v30, v62 row_shl:1 row_mask:0xf bank_mask:0xf bound_ctrl:0
v_fmac_f32_dpp v87, v31, v63 row_shl:1 row_mask:0xf bank_mask:0xf bound_ctrl:0
v_mfma_f32_16x16x32_bf16 v[88:91], v[184:187], v[216:219], v[88:91]
buffer_load_dwordx4 v[176:179], v1, s[8:11], s24 offen offset:0 sc1
v_mfma_f32_16x16x32_bf16 v[88:91], v[188:191], v[236:239], v[88:91]
v_fmac_f32_dpp v84, v32, v64 row_shl:1 row_mask:0xf bank_mask:0xf bound_ctrl:0
v_fmac_f32_dpp v85, v33, v65 row_shl:1 row_mask:0xf bank_mask:0xf bound_ctrl:0
v_mfma_f32_16x16x32_bf16 v[92:95], v[188:191], v[240:243], v[92:95]
v_fmac_f32_dpp v86, v34, v66 row_shl:1 row_mask:0xf bank_mask:0xf bound_ctrl:0
v_fmac_f32_dpp v87, v35, v67 row_shl:1 row_mask:0xf bank_mask:0xf bound_ctrl:0
v_mfma_f32_16x16x32_bf16 v[92:95], v[184:187], v[220:223], v[92:95]
v_mul_f32 v124, v124, v68
v_mul_f32 v125, v125, v69
v_mfma_f32_16x16x32_bf16 v[96:99], v[184:187], v[224:227], v[96:99]
v_mul_f32 v126, v126, v70
v_mul_f32 v127, v127, v71
v_mfma_f32_16x16x32_bf16 v[96:99], v[188:191], v[244:247], v[96:99]
buffer_load_dwordx4 v[180:183], v1, s[8:11], s24 offen offset:1024 sc1
v_mfma_f32_16x16x32_bf16 v[100:103], v[188:191], v[248:251], v[100:103]
v_mul_f32 v124, v124, v84
v_mul_f32 v125, v125, v85
v_mfma_f32_16x16x32_bf16 v[100:103], v[184:187], v[228:231], v[100:103]
v_mul_f32 v126, v126, v86
v_mul_f32 v127, v127, v87
v_mfma_f32_16x16x32_bf16 v[104:107], v[184:187], v[232:235], v[104:107]
s_waitcnt vmcnt(16)
v_cvt_pk_bf16_f32 v124, v124, v125
v_cvt_pk_bf16_f32 v125, v126, v127
v_mfma_f32_16x16x32_bf16 v[104:107], v[188:191], v[252:255], v[104:107]
ds_write_b64 v10, v[124:125] offset:8
v_add_u32 v10, 1024, v10
v_add_u32 v11, 128, v11
v_cmp_ne_u32 vcc, s7, v13
s_add_u32 s25, s25, 1
s_cmp_eq_u32 s25, 3
s_cselect_b64 vcc, vcc, 0
s_cbranch_vccnz L_c_spin
s_branch L_c_u
L_c_u3:
s_cmp_eq_u32 s31, 0
s_cbranch_scc1 L_c_nopf
s_lshr_b32 s60, s2, 3
s_and_b32 s60, s60, 3
s_lshl_b32 s60, s60, 2
s_add_u32 s60, s60, s20
s_lshl_b32 s61, s60, 15
s_add_u32 s61, s61, 0x3180000
v_lshlrev_b32 v12, 7, v0
buffer_load_dword v15, v12, s[8:11], s61 offen
s_add_u32 s61, s61, 8192
buffer_load_dword v15, v12, s[8:11], s61 offen
s_add_u32 s61, s61, 8192
buffer_load_dword v15, v12, s[8:11], s61 offen
s_add_u32 s61, s61, 8192
buffer_load_dword v15, v12, s[8:11], s61 offen
s_add_u32 s61, s61, 8192
s_getpc_b64 s[64:65]
L_pc1:
s_sub_u32 s64, s64, L_pc1-L_qfin1
s_subb_u32 s65, s65, 0
s_lshl_b32 s60, s60, 11
v_lshl_add_u32 v12, v0, 5, s60
v_min_u32 v12, L_prec0-L_qfin1, v12
v_mov_b32 v13, s65
v_add_co_u32 v12, vcc, s64, v12
s_nop 1
v_addc_co_u32 v13, vcc, 0, v13, vcc
global_load_dword v15, v[12:13], off
L_c_nopf:
ds_read_b64 v[76:77], v6 offset:8
ds_read_b64 v[78:79], v7 offset:8
ds_read_b64 v[80:81], v8 offset:8
ds_read_b64 v[82:83], v9 offset:8
ds_read_b64 v[84:85], v10 offset:8
v_pk_mul_f32 v[68:69], v[108:109], v[108:109]
v_pk_mul_f32 v[70:71], v[110:111], v[110:111]
v_pk_mul_f32 v[72:73], v[112:113], v[112:113]
v_pk_mul_f32 v[74:75], v[114:115], v[114:115]
v_pk_fma_f32 v[68:69], v[68:69], s[46:47], s[46:47] op_sel:[0,0,1] op_sel_hi:[1,0,1]
v_pk_fma_f32 v[70:71], v[70:71], s[46:47], s[46:47] op_sel:[0,0,1] op_sel_hi:[1,0,1]
v_pk_fma_f32 v[72:73], v[72:73], s[46:47], s[46:47] op_sel:[0,0,1] op_sel_hi:[1,0,1]
v_pk_fma_f32 v[74:75], v[74:75], s[46:47], s[46:47] op_sel:[0,0,1] op_sel_hi:[1,0,1]
v_pk_mul_f32 v[68:69], v[68:69], v[108:109]
v_pk_mul_f32 v[70:71], v[70:71], v[110:111]
v_pk_mul_f32 v[72:73], v[72:73], v[112:113]
v_pk_mul_f32 v[74:75], v[74:75], v[114:115]
v_exp_f32 v68, v68
v_exp_f32 v69, v69
v_exp_f32 v70, v70
v_exp_f32 v71, v71
v_exp_f32 v72, v72
v_exp_f32 v73, v73
v_exp_f32 v74, v74
v_exp_f32 v75, v75
ds_read_b128 v[48:51], v11 offset:16
s_waitcnt lgkmcnt(1)
v_lshlrev_b32 v28, 16, v76
ds_read_b128 v[52:55], v11 offset:2064
v_and_b32 v29, s28, v76
ds_read_b128 v[56:59], v11 offset:4112
v_lshlrev_b32 v30, 16, v77
ds_read_b128 v[60:63], v11 offset:6160
v_and_b32 v31, s28, v77
ds_read_b128 v[64:67], v11 offset:8208
v_lshlrev_b32 v32, 16, v78
v_and_b32 v33, s28, v78
v_lshlrev_b32 v34, 16, v79
v_and_b32 v35, s28, v79
v_lshlrev_b32 v36, 16, v80
v_and_b32 v37, s28, v80
v_lshlrev_b32 v38, 16, v81
v_and_b32 v39, s28, v81
v_lshlrev_b32 v40, 16, v82
v_and_b32 v41, s28, v82
v_lshlrev_b32 v42, 16, v83
v_and_b32 v43, s28, v83
v_lshlrev_b32 v44, 16, v84
v_and_b32 v45, s28, v84
v_lshlrev_b32 v46, 16, v85
v_and_b32 v47, s28, v85
v_pk_add_f32 v[68:69], v[68:69], s[48:49]
v_pk_add_f32 v[70:71], v[70:71], s[48:49]
v_pk_add_f32 v[72:73], v[72:73], s[48:49]
v_pk_add_f32 v[74:75], v[74:75], s[48:49]
v_pk_fma_f32 v[28:29], v[28:29], v[18:19], v[18:19] op_sel:[0,0,1] op_sel_hi:[1,0,1]
v_pk_fma_f32 v[30:31], v[30:31], v[18:19], v[18:19] op_sel:[0,0,1] op_sel_hi:[1,0,1]
v_pk_fma_f32 v[32:33], v[32:33], v[20:21], v[20:21] op_sel:[0,0,1] op_sel_hi:[1,0,1]
v_pk_fma_f32 v[34:35], v[34:35], v[20:21], v[20:21] op_sel:[0,0,1] op_sel_hi:[1,0,1]
v_pk_fma_f32 v[36:37], v[36:37], v[22:23], v[22:23] op_sel:[0,0,1] op_sel_hi:[1,0,1]
v_pk_fma_f32 v[38:39], v[38:39], v[22:23], v[22:23] op_sel:[0,0,1] op_sel_hi:[1,0,1]
v_pk_fma_f32 v[40:41], v[40:41], v[24:25], v[24:25] op_sel:[0,0,1] op_sel_hi:[1,0,1]
v_pk_fma_f32 v[42:43], v[42:43], v[24:25], v[24:25] op_sel:[0,0,1] op_sel_hi:[1,0,1]
v_pk_fma_f32 v[44:45], v[44:45], v[26:27], v[26:27] op_sel:[0,0,1] op_sel_hi:[1,0,1]
v_pk_fma_f32 v[46:47], v[46:47], v[26:27], v[26:27] op_sel:[0,0,1] op_sel_hi:[1,0,1]
v_pk_mul_f32 v[76:77], v[116:117], v[116:117]
v_pk_mul_f32 v[78:79], v[118:119], v[118:119]
v_pk_mul_f32 v[80:81], v[120:121], v[120:121]
v_pk_mul_f32 v[82:83], v[122:123], v[122:123]
v_pk_fma_f32 v[76:77], v[76:77], s[46:47], s[46:47] op_sel:[0,0,1] op_sel_hi:[1,0,1]
v_pk_fma_f32 v[78:79], v[78:79], s[46:47], s[46:47] op_sel:[0,0,1] op_sel_hi:[1,0,1]
v_pk_fma_f32 v[80:81], v[80:81], s[46:47], s[46:47] op_sel:[0,0,1] op_sel_hi:[1,0,1]
v_pk_fma_f32 v[82:83], v[82:83], s[46:47], s[46:47] op_sel:[0,0,1] op_sel_hi:[1,0,1]
v_pk_mul_f32 v[76:77], v[76:77], v[116:117]
v_pk_mul_f32 v[78:79], v[78:79], v[118:119]
v_pk_mul_f32 v[80:81], v[80:81], v[120:121]
v_pk_mul_f32 v[82:83], v[82:83], v[122:123]
s_waitcnt lgkmcnt(0)
v_pk_mul_f32 v[84:85], v[28:29], v[56:57]
v_pk_mul_f32 v[86:87], v[30:31], v[58:59]
v_pk_fma_f32 v[84:85], v[32:33], v[60:61], v[84:85]
v_pk_fma_f32 v[86:87], v[34:35], v[62:63], v[86:87]
v_pk_fma_f32 v[84:85], v[36:37], v[64:65], v[84:85]
v_pk_fma_f32 v[86:87], v[38:39], v[66:67], v[86:87]
v_rcp_f32 v68, v68
v_rcp_f32 v69, v69
v_rcp_f32 v70, v70
v_rcp_f32 v71, v71
v_rcp_f32 v72, v72
v_rcp_f32 v73, v73
v_rcp_f32 v74, v74
v_rcp_f32 v75, v75
v_exp_f32 v76, v76
v_exp_f32 v77, v77
v_exp_f32 v78, v78
v_exp_f32 v79, v79
v_exp_f32 v80, v80
v_exp_f32 v81, v81
v_exp_f32 v82, v82
v_exp_f32 v83, v83
v_fmac_f32_dpp v84, v44, v52 row_shr:1 row_mask:0xf bank_mask:0xf bound_ctrl:0
v_fmac_f32_dpp v85, v45, v53 row_shr:1 row_mask:0xf bank_mask:0xf bound_ctrl:0
v_fmac_f32_dpp v86, v46, v54 row_shr:1 row_mask:0xf bank_mask:0xf bound_ctrl:0
v_fmac_f32_dpp v87, v47, v55 row_shr:1 row_mask:0xf bank_mask:0xf bound_ctrl:0
v_fmac_f32_dpp v84, v40, v48 row_shr:1 row_mask:0xf bank_mask:0xf bound_ctrl:0
v_fmac_f32_dpp v85, v41, v49 row_shr:1 row_mask:0xf bank_mask:0xf bound_ctrl:0
v_fmac_f32_dpp v86, v42, v50 row_shr:1 row_mask:0xf bank_mask:0xf bound_ctrl:0
v_fmac_f32_dpp v87, v43, v51 row_shr:1 row_mask:0xf bank_mask:0xf bound_ctrl:0
v_pk_mul_f32 v[108:109], v[108:109], v[84:85]
v_pk_mul_f32 v[110:111], v[110:111], v[86:87]
v_pk_add_f32 v[76:77], v[76:77], s[48:49]
v_pk_add_f32 v[78:79], v[78:79], s[48:49]
v_pk_add_f32 v[80:81], v[80:81], s[48:49]
v_pk_add_f32 v[82:83], v[82:83], s[48:49]
v_pk_mul_f32 v[108:109], v[108:109], v[68:69]
v_pk_mul_f32 v[110:111], v[110:111], v[70:71]
v_pk_mul_f32 v[84:85], v[32:33], v[56:57]
v_pk_mul_f32 v[86:87], v[34:35], v[58:59]
v_pk_fma_f32 v[84:85], v[36:37], v[60:61], v[84:85]
v_pk_fma_f32 v[86:87], v[38:39], v[62:63], v[86:87]
v_pk_fma_f32 v[84:85], v[40:41], v[64:65], v[84:85]
v_pk_fma_f32 v[86:87], v[42:43], v[66:67], v[86:87]
v_pk_fma_f32 v[84:85], v[28:29], v[52:53], v[84:85]
v_pk_fma_f32 v[86:87], v[30:31], v[54:55], v[86:87]
v_rcp_f32 v76, v76
v_rcp_f32 v77, v77
v_rcp_f32 v78, v78
v_rcp_f32 v79, v79
v_rcp_f32 v80, v80
v_rcp_f32 v81, v81
v_rcp_f32 v82, v82
v_rcp_f32 v83, v83
v_cvt_pk_bf16_f32 v108, v108, v109
v_cvt_pk_bf16_f32 v109, v110, v111
ds_write_b64 v6, v[108:109] offset:8
v_add_u32 v6, 1024, v6
v_fmac_f32_dpp v84, v44, v48 row_shr:1 row_mask:0xf bank_mask:0xf bound_ctrl:0
v_fmac_f32_dpp v85, v45, v49 row_shr:1 row_mask:0xf bank_mask:0xf bound_ctrl:0
v_fmac_f32_dpp v86, v46, v50 row_shr:1 row_mask:0xf bank_mask:0xf bound_ctrl:0
v_fmac_f32_dpp v87, v47, v51 row_shr:1 row_mask:0xf bank_mask:0xf bound_ctrl:0
v_pk_mul_f32 v[112:113], v[112:113], v[84:85]
v_pk_mul_f32 v[114:115], v[114:115], v[86:87]
v_pk_mul_f32 v[116:117], v[116:117], v[76:77]
v_pk_mul_f32 v[118:119], v[118:119], v[78:79]
v_pk_mul_f32 v[112:113], v[112:113], v[72:73]
v_pk_mul_f32 v[114:115], v[114:115], v[74:75]
v_pk_mul_f32 v[68:69], v[124:125], v[124:125]
v_pk_mul_f32 v[70:71], v[126:127], v[126:127]
v_pk_fma_f32 v[68:69], v[68:69], s[46:47], s[46:47] op_sel:[0,0,1] op_sel_hi:[1,0,1]
v_pk_fma_f32 v[70:71], v[70:71], s[46:47], s[46:47] op_sel:[0,0,1] op_sel_hi:[1,0,1]
v_pk_mul_f32 v[68:69], v[68:69], v[124:125]
v_pk_mul_f32 v[70:71], v[70:71], v[126:127]
v_pk_mul_f32 v[84:85], v[36:37], v[56:57]
v_pk_mul_f32 v[86:87], v[38:39], v[58:59]
v_pk_fma_f32 v[84:85], v[40:41], v[60:61], v[84:85]
v_pk_fma_f32 v[86:87], v[42:43], v[62:63], v[86:87]
v_pk_fma_f32 v[84:85], v[44:45], v[64:65], v[84:85]
v_pk_fma_f32 v[86:87], v[46:47], v[66:67], v[86:87]
v_pk_fma_f32 v[84:85], v[32:33], v[52:53], v[84:85]
v_pk_fma_f32 v[86:87], v[34:35], v[54:55], v[86:87]
v_pk_fma_f32 v[84:85], v[28:29], v[48:49], v[84:85]
v_pk_fma_f32 v[86:87], v[30:31], v[50:51], v[86:87]
v_pk_mul_f32 v[120:121], v[120:121], v[80:81]
v_pk_mul_f32 v[122:123], v[122:123], v[82:83]
v_pk_mul_f32 v[116:117], v[116:117], v[84:85]
v_pk_mul_f32 v[118:119], v[118:119], v[86:87]
v_pk_mul_f32 v[84:85], v[40:41], v[56:57]
v_pk_mul_f32 v[86:87], v[42:43], v[58:59]
v_pk_fma_f32 v[84:85], v[44:45], v[60:61], v[84:85]
v_pk_fma_f32 v[86:87], v[46:47], v[62:63], v[86:87]
v_pk_fma_f32 v[84:85], v[36:37], v[52:53], v[84:85]
v_pk_fma_f32 v[86:87], v[38:39], v[54:55], v[86:87]
v_pk_fma_f32 v[84:85], v[32:33], v[48:49], v[84:85]
v_pk_fma_f32 v[86:87], v[34:35], v[50:51], v[86:87]
v_exp_f32 v68, v68
v_exp_f32 v69, v69
v_exp_f32 v70, v70
v_exp_f32 v71, v71
v_cvt_pk_bf16_f32 v112, v112, v113
v_cvt_pk_bf16_f32 v113, v114, v115
ds_write_b64 v7, v[112:113] offset:8
v_add_u32 v7, 1024, v7
v_cvt_pk_bf16_f32 v116, v116, v117
v_cvt_pk_bf16_f32 v117, v118, v119
ds_write_b64 v8, v[116:117] offset:8
v_add_u32 v8, 1024, v8
v_fmac_f32_dpp v84, v28, v64 row_shl:1 row_mask:0xf bank_mask:0xf bound_ctrl:0
v_fmac_f32_dpp v85, v29, v65 row_shl:1 row_mask:0xf bank_mask:0xf bound_ctrl:0
v_fmac_f32_dpp v86, v30, v66 row_shl:1 row_mask:0xf bank_mask:0xf bound_ctrl:0
v_fmac_f32_dpp v87, v31, v67 row_shl:1 row_mask:0xf bank_mask:0xf bound_ctrl:0
v_pk_add_f32 v[68:69], v[68:69], s[48:49]
v_pk_add_f32 v[70:71], v[70:71], s[48:49]
v_pk_mul_f32 v[120:121], v[120:121], v[84:85]
v_pk_mul_f32 v[122:123], v[122:123], v[86:87]
v_pk_mul_f32 v[84:85], v[44:45], v[56:57]
v_pk_mul_f32 v[86:87], v[46:47], v[58:59]
v_pk_fma_f32 v[84:85], v[40:41], v[52:53], v[84:85]
v_pk_fma_f32 v[86:87], v[42:43], v[54:55], v[86:87]
v_pk_fma_f32 v[84:85], v[36:37], v[48:49], v[84:85]
v_pk_fma_f32 v[86:87], v[38:39], v[50:51], v[86:87]
v_rcp_f32 v68, v68
v_rcp_f32 v69, v69
v_rcp_f32 v70, v70
v_rcp_f32 v71, v71
v_cvt_pk_bf16_f32 v120, v120, v121
v_cvt_pk_bf16_f32 v121, v122, v123
ds_write_b64 v9, v[120:121] offset:8
v_add_u32 v9, 1024, v9
v_fmac_f32_dpp v84, v28, v60 row_shl:1 row_mask:0xf bank_mask:0xf bound_ctrl:0
v_fmac_f32_dpp v85, v29, v61 row_shl:1 row_mask:0xf bank_mask:0xf bound_ctrl:0
v_fmac_f32_dpp v86, v30, v62 row_shl:1 row_mask:0xf bank_mask:0xf bound_ctrl:0
v_fmac_f32_dpp v87, v31, v63 row_shl:1 row_mask:0xf bank_mask:0xf bound_ctrl:0
v_fmac_f32_dpp v84, v32, v64 row_shl:1 row_mask:0xf bank_mask:0xf bound_ctrl:0
v_fmac_f32_dpp v85, v33, v65 row_shl:1 row_mask:0xf bank_mask:0xf bound_ctrl:0
v_fmac_f32_dpp v86, v34, v66 row_shl:1 row_mask:0xf bank_mask:0xf bound_ctrl:0
v_fmac_f32_dpp v87, v35, v67 row_shl:1 row_mask:0xf bank_mask:0xf bound_ctrl:0
v_mul_f32 v124, v124, v68
v_mul_f32 v125, v125, v69
v_mul_f32 v126, v126, v70
v_mul_f32 v127, v127, v71
v_mul_f32 v124, v124, v84
v_mul_f32 v125, v125, v85
v_mul_f32 v126, v126, v86
v_mul_f32 v127, v127, v87
v_cvt_pk_bf16_f32 v124, v124, v125
v_cvt_pk_bf16_f32 v125, v126, v127
ds_write_b64 v10, v[124:125] offset:8
v_add_u32 v10, 1024, v10
v_add_u32 v11, 128, v11
s_waitcnt lgkmcnt(0)
s_barrier
s_mov_b32 s25, 0
s_mul_i32 s44, s31, 53
s_add_u32 s44, s44, s21
s_mul_i32 s29, s44, 81920
s_add_u32 s29, s29, s27
s_add_u32 s29, s29, 0x3800000
s_lshl_b32 s44, s44, 7
s_add_u32 s44, s44, 0x340c800
s_mov_b32 s45, s43
s_cmp_eq_u32 s31, 0
s_cselect_b32 s26, s27, 0x10000000
ds_read_b128 a[16:19], v4 offset:0
ds_read_b128 a[36:39], v4 offset:1024
ds_read_b128 a[32:35], v1 offset:50176
ds_read_b128 a[12:15], v1 offset:49152
ds_read_b128 a[8:11], v1 offset:32768
ds_read_b128 a[28:31], v1 offset:33792
ds_read_b128 a[24:27], v1 offset:17408
ds_read_b128 a[4:7], v1 offset:16384
ds_read_b128 a[0:3], v1 offset:0
ds_read_b128 a[20:23], v1 offset:1024
s_waitcnt lgkmcnt(8)
v_mfma_f32_16x16x32_bf16 v[104:107], v[128:131], a[16:19], 0
ds_read_b128 a[40:43], v1 offset:2048
buffer_load_dwordx4 v[184:187], v1, s[8:11], s24 offen offset:2048 sc1
v_mfma_f32_16x16x32_bf16 v[104:107], v[132:135], a[36:39], v[104:107]
ds_read_b128 a[60:63], v1 offset:3072
s_waitcnt lgkmcnt(8)
v_mfma_f32_16x16x32_bf16 v[100:103], v[132:135], a[32:35], 0
ds_read_b128 a[64:67], v1 offset:19456
v_add_u32 v6, -4096, v6
v_mfma_f32_16x16x32_bf16 v[100:103], v[128:131], a[12:15], v[100:103]
ds_read_b128 a[44:47], v1 offset:18432
v_add_u32 v7, -4096, v7
s_waitcnt lgkmcnt(8)
v_mfma_f32_16x16x32_bf16 v[96:99], v[128:131], a[8:11], 0
ds_read_b128 a[48:51], v1 offset:34816
v_add_u32 v8, -4096, v8
v_mfma_f32_16x16x32_bf16 v[96:99], v[132:135], a[28:31], v[96:99]
ds_read_b128 a[68:71], v1 offset:35840
buffer_load_dwordx4 v[188:191], v1, s[8:11], s24 offen offset:3072 sc1
s_waitcnt lgkmcnt(8)
v_mfma_f32_16x16x32_bf16 v[92:95], v[132:135], a[24:27], 0
ds_read_b128 a[72:75], v1 offset:52224
s_add_u32 s24, s24, 4096
v_mfma_f32_16x16x32_bf16 v[92:95], v[128:131], a[4:7], v[92:95]
ds_read_b128 a[52:55], v1 offset:51200
v_add_u32 v9, -4096, v9
s_waitcnt lgkmcnt(8)
v_mfma_f32_16x16x32_bf16 v[88:91], v[128:131], a[0:3], 0
ds_read_b128 a[56:59], v4 offset:2048
s_waitcnt vmcnt(12)
v_mfma_f32_16x16x32_bf16 v[88:91], v[132:135], a[20:23], v[88:91]
ds_read_b128 a[76:79], v4 offset:3072
v_add_u32 v10, -4096, v10
s_waitcnt lgkmcnt(8)
v_mfma_f32_16x16x32_bf16 v[88:91], v[136:139], a[40:43], v[88:91]
ds_read_b128 a[96:99], v4 offset:4096
buffer_load_dwordx4 v[128:131], v1, s[8:11], s24 offen offset:0 sc1
v_mfma_f32_16x16x32_bf16 v[88:91], v[140:143], a[60:63], v[88:91]
ds_read_b128 a[116:119], v4 offset:5120
v_add_u32 v11, -512, v11
s_waitcnt lgkmcnt(8)
v_mfma_f32_16x16x32_bf16 v[92:95], v[140:143], a[64:67], v[92:95]
ds_read_b128 a[112:115], v1 offset:54272
v_add_u32 v17, s43, v2
v_mfma_f32_16x16x32_bf16 v[92:95], v[136:139], a[44:47], v[92:95]
ds_read_b128 a[92:95], v1 offset:53248
v_lshlrev_b32 v48, 2, v0
s_waitcnt lgkmcnt(8)
v_mfma_f32_16x16x32_bf16 v[96:99], v[136:139], a[48:51], v[96:99]
ds_read_b128 a[88:91], v1 offset:36864
v_add_u32 v48, 94720, v48
v_mfma_f32_16x16x32_bf16 v[96:99], v[140:143], a[68:71], v[96:99]
ds_read_b128 a[108:111], v1 offset:37888
buffer_load_dwordx4 v[132:135], v1, s[8:11], s24 offen offset:1024 sc1
s_waitcnt lgkmcnt(8)
v_mfma_f32_16x16x32_bf16 v[100:103], v[140:143], a[72:75], v[100:103]
ds_read_b128 a[104:107], v1 offset:21504
v_mfma_f32_16x16x32_bf16 v[100:103], v[136:139], a[52:55], v[100:103]
ds_read_b128 a[84:87], v1 offset:20480
s_waitcnt lgkmcnt(8)
v_mfma_f32_16x16x32_bf16 v[104:107], v[136:139], a[56:59], v[104:107]
ds_read_b128 a[80:83], v1 offset:4096
s_waitcnt vmcnt(12)
v_mfma_f32_16x16x32_bf16 v[104:107], v[140:143], a[76:79], v[104:107]
ds_read_b128 a[100:103], v1 offset:5120
s_waitcnt lgkmcnt(8)
v_mfma_f32_16x16x32_bf16 v[104:107], v[144:147], a[96:99], v[104:107]
ds_read_b128 a[120:123], v1 offset:6144
buffer_load_dwordx4 v[136:139], v1, s[8:11], s24 offen offset:2048 sc1
v_mfma_f32_16x16x32_bf16 v[104:107], v[148:151], a[116:119], v[104:107]
ds_read_b128 a[140:143], v1 offset:7168
s_waitcnt lgkmcnt(8)
v_mfma_f32_16x16x32_bf16 v[100:103], v[148:151], a[112:115], v[100:103]
ds_read_b128 a[144:147], v1 offset:23552
v_mfma_f32_16x16x32_bf16 v[100:103], v[144:147], a[92:95], v[100:103]
ds_read_b128 a[124:127], v1 offset:22528
s_waitcnt lgkmcnt(8)
v_mfma_f32_16x16x32_bf16 v[96:99], v[144:147], a[88:91], v[96:99]
ds_read_b128 a[128:131], v1 offset:38912
v_mfma_f32_16x16x32_bf16 v[96:99], v[148:151], a[108:111], v[96:99]
ds_read_b128 a[148:151], v1 offset:39936
buffer_load_dwordx4 v[140:143], v1, s[8:11], s24 offen offset:3072 sc1
s_waitcnt lgkmcnt(8)
v_mfma_f32_16x16x32_bf16 v[92:95], v[148:151], a[104:107], v[92:95]
ds_read_b128 a[152:155], v1 offset:56320
s_add_u32 s24, s24, 4096
v_mfma_f32_16x16x32_bf16 v[92:95], v[144:147], a[84:87], v[92:95]
ds_read_b128 a[132:135], v1 offset:55296
s_waitcnt lgkmcnt(8)
v_mfma_f32_16x16x32_bf16 v[88:91], v[144:147], a[80:83], v[88:91]
ds_read_b128 a[136:139], v4 offset:6144
s_waitcnt vmcnt(12)
v_mfma_f32_16x16x32_bf16 v[88:91], v[148:151], a[100:103], v[88:91]
ds_read_b128 a[156:159], v4 offset:7168
s_waitcnt lgkmcnt(8)
v_mfma_f32_16x16x32_bf16 v[88:91], v[152:155], a[120:123], v[88:91]
ds_read_b128 a[176:179], v4 offset:8192
buffer_load_dwordx4 v[144:147], v1, s[8:11], s24 offen offset:0 sc1
v_mfma_f32_16x16x32_bf16 v[88:91], v[156:159], a[140:143], v[88:91]
ds_read_b128 a[196:199], v4 offset:9216
s_waitcnt lgkmcnt(8)
v_mfma_f32_16x16x32_bf16 v[92:95], v[156:159], a[144:147], v[92:95]
ds_read_b128 a[192:195], v1 offset:58368
v_mfma_f32_16x16x32_bf16 v[92:95], v[152:155], a[124:127], v[92:95]
ds_read_b128 a[172:175], v1 offset:57344
s_waitcnt lgkmcnt(8)
v_mfma_f32_16x16x32_bf16 v[96:99], v[152:155], a[128:131], v[96:99]
ds_read_b128 a[168:171], v1 offset:40960
v_mfma_f32_16x16x32_bf16 v[96:99], v[156:159], a[148:151], v[96:99]
ds_read_b128 a[188:191], v1 offset:41984
buffer_load_dwordx4 v[148:151], v1, s[8:11], s24 offen offset:1024 sc1
s_waitcnt lgkmcnt(8)
v_mfma_f32_16x16x32_bf16 v[100:103], v[156:159], a[152:155], v[100:103]
ds_read_b128 a[184:187], v1 offset:25600
v_mfma_f32_16x16x32_bf16 v[100:103], v[152:155], a[132:135], v[100:103]
ds_read_b128 a[164:167], v1 offset:24576
s_waitcnt lgkmcnt(8)
v_mfma_f32_16x16x32_bf16 v[104:107], v[152:155], a[136:139], v[104:107]
ds_read_b128 a[160:163], v1 offset:8192
s_waitcnt vmcnt(12)
v_mfma_f32_16x16x32_bf16 v[104:107], v[156:159], a[156:159], v[104:107]
ds_read_b128 a[180:183], v1 offset:9216
s_waitcnt lgkmcnt(8)
v_mfma_f32_16x16x32_bf16 v[104:107], v[160:163], a[176:179], v[104:107]
ds_read_b128 a[200:203], v1 offset:10240
buffer_load_dwordx4 v[152:155], v1, s[8:11], s24 offen offset:2048 sc1
v_mfma_f32_16x16x32_bf16 v[104:107], v[164:167], a[196:199], v[104:107]
ds_read_b128 a[220:223], v1 offset:11264
s_waitcnt lgkmcnt(8)
v_mfma_f32_16x16x32_bf16 v[100:103], v[164:167], a[192:195], v[100:103]
ds_read_b128 a[224:227], v1 offset:27648
v_mfma_f32_16x16x32_bf16 v[100:103], v[160:163], a[172:175], v[100:103]
ds_read_b128 a[204:207], v1 offset:26624
s_waitcnt lgkmcnt(8)
v_mfma_f32_16x16x32_bf16 v[96:99], v[160:163], a[168:171], v[96:99]
ds_read_b128 a[208:211], v1 offset:43008
v_mfma_f32_16x16x32_bf16 v[96:99], v[164:167], a[188:191], v[96:99]
ds_read_b128 a[228:231], v1 offset:44032
buffer_load_dwordx4 v[156:159], v1, s[8:11], s24 offen offset:3072 sc1
s_waitcnt lgkmcnt(8)
v_mfma_f32_16x16x32_bf16 v[92:95], v[164:167], a[184:187], v[92:95]
ds_read_b128 a[232:235], v1 offset:60416
s_add_u32 s24, s24, 4096
v_mfma_f32_16x16x32_bf16 v[92:95], v[160:163], a[164:167], v[92:95]
ds_read_b128 a[212:215], v1 offset:59392
s_waitcnt lgkmcnt(8)
v_mfma_f32_16x16x32_bf16 v[88:91], v[160:163], a[160:163], v[88:91]
ds_read_b128 a[216:219], v4 offset:10240
s_waitcnt vmcnt(12)
v_mfma_f32_16x16x32_bf16 v[88:91], v[164:167], a[180:183], v[88:91]
ds_read_b128 a[236:239], v4 offset:11264
s_waitcnt lgkmcnt(8)
v_mfma_f32_16x16x32_bf16 v[88:91], v[168:171], a[200:203], v[88:91]
ds_read_b128 v[192:195], v4 offset:12288
buffer_load_dwordx4 v[160:163], v1, s[8:11], s24 offen offset:0 sc1
v_mfma_f32_16x16x32_bf16 v[88:91], v[172:175], a[220:223], v[88:91]
ds_read_b128 v[212:215], v4 offset:13312
s_waitcnt lgkmcnt(8)
v_mfma_f32_16x16x32_bf16 v[92:95], v[172:175], a[224:227], v[92:95]
ds_read_b128 v[208:211], v1 offset:62464
v_mfma_f32_16x16x32_bf16 v[92:95], v[168:171], a[204:207], v[92:95]
ds_read_b128 a[252:255], v1 offset:61440
s_waitcnt lgkmcnt(8)
v_mfma_f32_16x16x32_bf16 v[96:99], v[168:171], a[208:211], v[96:99]
ds_read_b128 a[248:251], v1 offset:45056
v_mfma_f32_16x16x32_bf16 v[96:99], v[172:175], a[228:231], v[96:99]
ds_read_b128 v[204:207], v1 offset:46080
buffer_load_dwordx4 v[164:167], v1, s[8:11], s24 offen offset:1024 sc1
s_waitcnt lgkmcnt(8)
v_mfma_f32_16x16x32_bf16 v[100:103], v[172:175], a[232:235], v[100:103]
ds_read_b128 v[200:203], v1 offset:29696
v_mfma_f32_16x16x32_bf16 v[100:103], v[168:171], a[212:215], v[100:103]
ds_read_b128 a[244:247], v1 offset:28672
s_waitcnt lgkmcnt(8)
v_mfma_f32_16x16x32_bf16 v[104:107], v[168:171], a[216:219], v[104:107]
ds_read_b128 a[240:243], v1 offset:12288
s_waitcnt vmcnt(12)
v_mfma_f32_16x16x32_bf16 v[104:107], v[172:175], a[236:239], v[104:107]
ds_read_b128 v[196:199], v1 offset:13312
s_waitcnt lgkmcnt(8)
v_mfma_f32_16x16x32_bf16 v[104:107], v[176:179], v[192:195], v[104:107]
ds_read_b128 v[216:219], v1 offset:14336
buffer_load_dwordx4 v[168:171], v1, s[8:11], s24 offen offset:2048 sc1
v_mfma_f32_16x16x32_bf16 v[104:107], v[180:183], v[212:215], v[104:107]
ds_read_b128 v[236:239], v1 offset:15360
s_waitcnt lgkmcnt(8)
v_mfma_f32_16x16x32_bf16 v[100:103], v[180:183], v[208:211], v[100:103]
ds_read_b128 v[240:243], v1 offset:31744
v_mfma_f32_16x16x32_bf16 v[100:103], v[176:179], a[252:255], v[100:103]
ds_read_b128 v[220:223], v1 offset:30720
s_waitcnt lgkmcnt(8)
v_mfma_f32_16x16x32_bf16 v[96:99], v[176:179], a[248:251], v[96:99]
ds_read_b128 v[224:227], v1 offset:47104
v_mfma_f32_16x16x32_bf16 v[96:99], v[180:183], v[204:207], v[96:99]
ds_read_b128 v[244:247], v1 offset:48128
buffer_load_dwordx4 v[172:175], v1, s[8:11], s24 offen offset:3072 sc1
s_waitcnt lgkmcnt(8)
v_mfma_f32_16x16x32_bf16 v[92:95], v[180:183], v[200:203], v[92:95]
ds_read_b128 v[248:251], v1 offset:64512
s_add_u32 s24, s24, 4096
v_mfma_f32_16x16x32_bf16 v[92:95], v[176:179], a[244:247], v[92:95]
ds_read_b128 v[228:231], v1 offset:63488
s_waitcnt lgkmcnt(8)
v_mfma_f32_16x16x32_bf16 v[88:91], v[176:179], a[240:243], v[88:91]
ds_read_b128 v[232:235], v4 offset:14336
s_waitcnt vmcnt(12)
v_mfma_f32_16x16x32_bf16 v[88:91], v[180:183], v[196:199], v[88:91]
ds_read_b128 v[252:255], v4 offset:15360
s_waitcnt lgkmcnt(8)
v_mfma_f32_16x16x32_bf16 v[88:91], v[184:187], v[216:219], v[88:91]
buffer_load_dwordx4 v[176:179], v1, s[8:11], s24 offen offset:0 sc1
v_mfma_f32_16x16x32_bf16 v[88:91], v[188:191], v[236:239], v[88:91]
ds_read_b32 v12, v48 offset:0
s_waitcnt lgkmcnt(7)
v_mfma_f32_16x16x32_bf16 v[92:95], v[188:191], v[240:243], v[92:95]
ds_read_b32 v13, v48 offset:256
v_mfma_f32_16x16x32_bf16 v[92:95], v[184:187], v[220:223], v[92:95]
ds_read_b32 v14, v48 offset:512
s_waitcnt lgkmcnt(7)
v_mfma_f32_16x16x32_bf16 v[96:99], v[184:187], v[224:227], v[96:99]
ds_read_b32 v15, v48 offset:768
v_mfma_f32_16x16x32_bf16 v[96:99], v[188:191], v[244:247], v[96:99]
buffer_load_dwordx4 v[180:183], v1, s[8:11], s24 offen offset:1024 sc1
s_waitcnt lgkmcnt(6)
v_mfma_f32_16x16x32_bf16 v[100:103], v[188:191], v[248:251], v[100:103]
ds_read_b32 v16, v48 offset:1024
v_mfma_f32_16x16x32_bf16 v[100:103], v[184:187], v[228:231], v[100:103]
s_waitcnt lgkmcnt(5)
v_mfma_f32_16x16x32_bf16 v[104:107], v[184:187], v[232:235], v[104:107]
s_waitcnt vmcnt(12)
v_mfma_f32_16x16x32_bf16 v[104:107], v[188:191], v[252:255], v[104:107]
s_mov_b32 s30, s27
s_barrier
v_mfma_f32_16x16x32_bf16 v[124:127], v[128:131], a[16:19], 0
buffer_load_dwordx4 v[184:187], v1, s[8:11], s24 offen offset:2048 sc1
v_mfma_f32_16x16x32_bf16 v[124:127], v[132:135], a[36:39], v[124:127]
v_mfma_f32_16x16x32_bf16 v[120:123], v[132:135], a[32:35], 0
ds_read_b128 v[68:71], v17 offset:0
v_mfma_f32_16x16x32_bf16 v[120:123], v[128:131], a[12:15], v[120:123]
ds_read_b128 v[72:75], v17 offset:1024
v_mfma_f32_16x16x32_bf16 v[116:119], v[128:131], a[8:11], 0
ds_read_b128 v[76:79], v17 offset:2048
v_mfma_f32_16x16x32_bf16 v[116:119], v[132:135], a[28:31], v[116:119]
buffer_load_dwordx4 v[188:191], v1, s[8:11], s24 offen offset:3072 sc1
v_mfma_f32_16x16x32_bf16 v[112:115], v[132:135], a[24:27], 0
s_add_u32 s24, s24, 4096
ds_read_b128 v[80:83], v17 offset:3072
v_mfma_f32_16x16x32_bf16 v[112:115], v[128:131], a[4:7], v[112:115]
ds_read_b128 v[84:87], v17 offset:4096
v_mfma_f32_16x16x32_bf16 v[108:111], v[128:131], a[0:3], 0
s_waitcnt vmcnt(12)
s_waitcnt lgkmcnt(4)
v_lshlrev_b32 v48, 16, v68
v_mfma_f32_16x16x32_bf16 v[108:111], v[132:135], a[20:23], v[108:111]
v_and_b32 v49, s28, v68
v_lshlrev_b32 v50, 16, v69
v_mfma_f32_16x16x32_bf16 v[108:111], v[136:139], a[40:43], v[108:111]
buffer_load_dwordx4 v[128:131], v1, s[8:11], s24 offen offset:0 sc1
v_mfma_f32_16x16x32_bf16 v[108:111], v[140:143], a[60:63], v[108:111]
v_and_b32 v51, s28, v69
v_add_f32 v88, v88, v48
v_mfma_f32_16x16x32_bf16 v[112:115], v[140:143], a[64:67], v[112:115]
s_add_u32 m0, s30, 0
v_add_f32 v89, v89, v49
v_add_f32 v90, v90, v50
v_mfma_f32_16x16x32_bf16 v[112:115], v[136:139], a[44:47], v[112:115]
buffer_load_dwordx4 v12, s[8:11], s26 offen sc1 lds
v_mfma_f32_16x16x32_bf16 v[116:119], v[136:139], a[48:51], v[116:119]
v_add_f32 v91, v91, v51
v_cvt_pk_bf16_f32 v28, v88, v89
v_mfma_f32_16x16x32_bf16 v[116:119], v[140:143], a[68:71], v[116:119]
buffer_load_dwordx4 v[132:135], v1, s[8:11], s24 offen offset:1024 sc1
v_mfma_f32_16x16x32_bf16 v[120:123], v[140:143], a[72:75], v[120:123]
v_cvt_pk_bf16_f32 v29, v90, v91
v_mfma_f32_16x16x32_bf16 v[120:123], v[136:139], a[52:55], v[120:123]
s_waitcnt lgkmcnt(3)
v_lshlrev_b32 v48, 16, v72
v_and_b32 v49, s28, v72
v_mfma_f32_16x16x32_bf16 v[124:127], v[136:139], a[56:59], v[124:127]
s_waitcnt vmcnt(13)
v_lshlrev_b32 v50, 16, v73
v_and_b32 v51, s28, v73
v_mfma_f32_16x16x32_bf16 v[124:127], v[140:143], a[76:79], v[124:127]
v_add_f32 v92, v92, v48
v_add_f32 v93, v93, v49
v_mfma_f32_16x16x32_bf16 v[124:127], v[144:147], a[96:99], v[124:127]
buffer_load_dwordx4 v[136:139], v1, s[8:11], s24 offen offset:2048 sc1
v_mfma_f32_16x16x32_bf16 v[124:127], v[148:151], a[116:119], v[124:127]
v_add_f32 v94, v94, v50
v_add_f32 v95, v95, v51
v_mfma_f32_16x16x32_bf16 v[120:123], v[148:151], a[112:115], v[120:123]
s_add_u32 m0, s30, 16384
v_cvt_pk_bf16_f32 v32, v92, v93
v_cvt_pk_bf16_f32 v33, v94, v95
v_mfma_f32_16x16x32_bf16 v[120:123], v[144:147], a[92:95], v[120:123]
buffer_load_dwordx4 v13, s[8:11], s26 offen sc1 lds
v_mfma_f32_16x16x32_bf16 v[116:119], v[144:147], a[88:91], v[116:119]
s_waitcnt lgkmcnt(2)
v_lshlrev_b32 v48, 16, v76
v_and_b32 v49, s28, v76
v_mfma_f32_16x16x32_bf16 v[116:119], v[148:151], a[108:111], v[116:119]
buffer_load_dwordx4 v[140:143], v1, s[8:11], s24 offen offset:3072 sc1
v_mfma_f32_16x16x32_bf16 v[112:115], v[148:151], a[104:107], v[112:115]
s_add_u32 s24, s24, 4096
v_lshlrev_b32 v50, 16, v77
v_and_b32 v51, s28, v77
v_mfma_f32_16x16x32_bf16 v[112:115], v[144:147], a[84:87], v[112:115]
v_add_f32 v96, v96, v48
v_add_f32 v97, v97, v49
v_mfma_f32_16x16x32_bf16 v[108:111], v[144:147], a[80:83], v[108:111]
s_waitcnt vmcnt(14)
v_add_f32 v98, v98, v50
v_add_f32 v99, v99, v51
v_mfma_f32_16x16x32_bf16 v[108:111], v[148:151], a[100:103], v[108:111]
v_cvt_pk_bf16_f32 v36, v96, v97
v_cvt_pk_bf16_f32 v37, v98, v99
v_mfma_f32_16x16x32_bf16 v[108:111], v[152:155], a[120:123], v[108:111]
buffer_load_dwordx4 v[144:147], v1, s[8:11], s24 offen offset:0 sc1
v_mfma_f32_16x16x32_bf16 v[108:111], v[156:159], a[140:143], v[108:111]
s_waitcnt lgkmcnt(1)
v_lshlrev_b32 v48, 16, v80
v_and_b32 v49, s28, v80
v_mfma_f32_16x16x32_bf16 v[112:115], v[156:159], a[144:147], v[112:115]
s_add_u32 m0, s30, 32768
v_lshlrev_b32 v50, 16, v81
v_and_b32 v51, s28, v81
v_mfma_f32_16x16x32_bf16 v[112:115], v[152:155], a[124:127], v[112:115]
buffer_load_dwordx4 v14, s[8:11], s26 offen sc1 lds
v_mfma_f32_16x16x32_bf16 v[116:119], v[152:155], a[128:131], v[116:119]
v_add_f32 v100, v100, v48
v_add_f32 v101, v101, v49
v_mfma_f32_16x16x32_bf16 v[116:119], v[156:159], a[148:151], v[116:119]
buffer_load_dwordx4 v[148:151], v1, s[8:11], s24 offen offset:1024 sc1
v_mfma_f32_16x16x32_bf16 v[120:123], v[156:159], a[152:155], v[120:123]
v_add_f32 v102, v102, v50
v_add_f32 v103, v103, v51
v_mfma_f32_16x16x32_bf16 v[120:123], v[152:155], a[132:135], v[120:123]
v_cvt_pk_bf16_f32 v40, v100, v101
v_cvt_pk_bf16_f32 v41, v102, v103
v_mfma_f32_16x16x32_bf16 v[124:127], v[152:155], a[136:139], v[124:127]
s_waitcnt vmcnt(15)
s_waitcnt lgkmcnt(0)
v_lshlrev_b32 v48, 16, v84
v_mfma_f32_16x16x32_bf16 v[124:127], v[156:159], a[156:159], v[124:127]
v_and_b32 v49, s28, v84
v_lshlrev_b32 v50, 16, v85
v_mfma_f32_16x16x32_bf16 v[124:127], v[160:163], a[176:179], v[124:127]
buffer_load_dwordx4 v[152:155], v1, s[8:11], s24 offen offset:2048 sc1
v_mfma_f32_16x16x32_bf16 v[124:127], v[164:167], a[196:199], v[124:127]
v_and_b32 v51, s28, v85
v_add_f32 v104, v104, v48
v_mfma_f32_16x16x32_bf16 v[120:123], v[164:167], a[192:195], v[120:123]
s_add_u32 m0, s30, 49152
v_add_f32 v105, v105, v49
v_add_f32 v106, v106, v50
v_mfma_f32_16x16x32_bf16 v[120:123], v[160:163], a[172:175], v[120:123]
buffer_load_dwordx4 v15, s[8:11], s26 offen sc1 lds
v_mfma_f32_16x16x32_bf16 v[116:119], v[160:163], a[168:171], v[116:119]
v_add_f32 v107, v107, v51
v_cvt_pk_bf16_f32 v44, v104, v105
v_mfma_f32_16x16x32_bf16 v[116:119], v[164:167], a[188:191], v[116:119]
buffer_load_dwordx4 v[156:159], v1, s[8:11], s24 offen offset:3072 sc1
v_mfma_f32_16x16x32_bf16 v[112:115], v[164:167], a[184:187], v[112:115]
s_add_u32 s24, s24, 4096
v_cvt_pk_bf16_f32 v45, v106, v107
v_mfma_f32_16x16x32_bf16 v[112:115], v[160:163], a[164:167], v[112:115]
v_mfma_f32_16x16x32_bf16 v[108:111], v[160:163], a[160:163], v[108:111]
s_waitcnt vmcnt(16)
v_mfma_f32_16x16x32_bf16 v[108:111], v[164:167], a[180:183], v[108:111]
v_mfma_f32_16x16x32_bf16 v[108:111], v[168:171], a[200:203], v[108:111]
buffer_load_dwordx4 v[160:163], v1, s[8:11], s24 offen offset:0 sc1
v_mfma_f32_16x16x32_bf16 v[108:111], v[172:175], a[220:223], v[108:111]
v_mfma_f32_16x16x32_bf16 v[112:115], v[172:175], a[224:227], v[112:115]
s_add_u32 m0, s30, 65536
v_mfma_f32_16x16x32_bf16 v[112:115], v[168:171], a[204:207], v[112:115]
buffer_load_dwordx4 v16, s[8:11], s26 offen sc1 lds
v_mfma_f32_16x16x32_bf16 v[116:119], v[168:171], a[208:211], v[116:119]
s_add_u32 s26, s26, 1024
s_add_u32 s30, s30, 1024
v_mfma_f32_16x16x32_bf16 v[116:119], v[172:175], a[228:231], v[116:119]
buffer_load_dwordx4 v[164:167], v1, s[8:11], s24 offen offset:1024 sc1
v_mfma_f32_16x16x32_bf16 v[120:123], v[172:175], a[232:235], v[120:123]
s_add_u32 m0, s45, 0
s_add_u32 s35, s42, 0
v_mfma_f32_16x16x32_bf16 v[120:123], v[168:171], a[212:215], v[120:123]
buffer_load_dwordx4 v5, s[16:19], s35 offen lds
v_mfma_f32_16x16x32_bf16 v[124:127], v[168:171], a[216:219], v[124:127]
s_waitcnt vmcnt(18)
v_mfma_f32_16x16x32_bf16 v[124:127], v[172:175], a[236:239], v[124:127]
v_mfma_f32_16x16x32_bf16 v[124:127], v[176:179], v[192:195], v[124:127]
buffer_load_dwordx4 v[168:171], v1, s[8:11], s24 offen offset:2048 sc1
v_mfma_f32_16x16x32_bf16 v[124:127], v[180:183], v[212:215], v[124:127]
v_mfma_f32_16x16x32_bf16 v[120:123], v[180:183], v[208:211], v[120:123]
s_add_u32 m0, s45, 1024
s_add_u32 s35, s42, 16384
v_mfma_f32_16x16x32_bf16 v[120:123], v[176:179], a[252:255], v[120:123]
buffer_load_dwordx4 v5, s[16:19], s35 offen lds
v_mfma_f32_16x16x32_bf16 v[116:119], v[176:179], a[248:251], v[116:119]
v_mfma_f32_16x16x32_bf16 v[116:119], v[180:183], v[204:207], v[116:119]
buffer_load_dwordx4 v[172:175], v1, s[8:11], s24 offen offset:3072 sc1
v_mfma_f32_16x16x32_bf16 v[112:115], v[180:183], v[200:203], v[112:115]
s_add_u32 s24, s24, 4096
s_add_u32 m0, s45, 2048
s_add_u32 s35, s42, 32768
v_mfma_f32_16x16x32_bf16 v[112:115], v[176:179], a[244:247], v[112:115]
buffer_load_dwordx4 v5, s[16:19], s35 offen lds
v_mfma_f32_16x16x32_bf16 v[108:111], v[176:179], a[240:243], v[108:111]
s_waitcnt vmcnt(20)
v_mfma_f32_16x16x32_bf16 v[108:111], v[180:183], v[196:199], v[108:111]
v_mfma_f32_16x16x32_bf16 v[108:111], v[184:187], v[216:219], v[108:111]
buffer_load_dwordx4 v[176:179], v1, s[8:11], s24 offen offset:0 sc1
v_mfma_f32_16x16x32_bf16 v[108:111], v[188:191], v[236:239], v[108:111]
v_mfma_f32_16x16x32_bf16 v[112:115], v[188:191], v[240:243], v[112:115]
s_add_u32 m0, s45, 3072
s_add_u32 s35, s42, 49152
v_mfma_f32_16x16x32_bf16 v[112:115], v[184:187], v[220:223], v[112:115]
buffer_load_dwordx4 v5, s[16:19], s35 offen lds
v_mfma_f32_16x16x32_bf16 v[116:119], v[184:187], v[224:227], v[116:119]
v_mfma_f32_16x16x32_bf16 v[116:119], v[188:191], v[244:247], v[116:119]
buffer_load_dwordx4 v[180:183], v1, s[8:11], s24 offen offset:1024 sc1
v_mfma_f32_16x16x32_bf16 v[120:123], v[188:191], v[248:251], v[120:123]
s_add_u32 m0, s45, 4096
s_add_u32 s35, s42, 65536
v_mfma_f32_16x16x32_bf16 v[120:123], v[184:187], v[228:231], v[120:123]
buffer_load_dwordx4 v5, s[16:19], s35 offen lds
v_mfma_f32_16x16x32_bf16 v[124:127], v[184:187], v[232:235], v[124:127]
s_waitcnt vmcnt(21)
v_mfma_f32_16x16x32_bf16 v[124:127], v[188:191], v[252:255], v[124:127]
L_c_z:
v_mfma_f32_16x16x32_bf16 v[104:107], v[128:131], a[16:19], 0
buffer_load_dwordx4 v[184:187], v1, s[8:11], s24 offen offset:2048 sc1
v_mfma_f32_16x16x32_bf16 v[104:107], v[132:135], a[36:39], v[104:107]
v_mfma_f32_16x16x32_bf16 v[100:103], v[132:135], a[32:35], 0
v_lshlrev_b32 v48, 16, v70
v_and_b32 v49, s28, v70
v_mfma_f32_16x16x32_bf16 v[100:103], v[128:131], a[12:15], v[100:103]
v_lshlrev_b32 v50, 16, v71
v_and_b32 v51, s28, v71
v_mfma_f32_16x16x32_bf16 v[96:99], v[128:131], a[8:11], 0
v_add_f32 v108, v108, v48
v_add_f32 v109, v109, v49
v_mfma_f32_16x16x32_bf16 v[96:99], v[132:135], a[28:31], v[96:99]
buffer_load_dwordx4 v[188:191], v1, s[8:11], s24 offen offset:3072 sc1
v_mfma_f32_16x16x32_bf16 v[92:95], v[132:135], a[24:27], 0
s_add_u32 s24, s24, 4096
v_add_f32 v110, v110, v50
v_add_f32 v111, v111, v51
v_mfma_f32_16x16x32_bf16 v[92:95], v[128:131], a[4:7], v[92:95]
v_cvt_pk_bf16_f32 v30, v108, v109
v_cvt_pk_bf16_f32 v31, v110, v111
v_mfma_f32_16x16x32_bf16 v[88:91], v[128:131], a[0:3], 0
s_waitcnt vmcnt(15)
s_add_u32 s35, s29, 0
v_mfma_f32_16x16x32_bf16 v[88:91], v[132:135], a[20:23], v[88:91]
buffer_store_dwordx4 v[28:31], v1, s[8:11], s35 offen sc1
v_mfma_f32_16x16x32_bf16 v[88:91], v[136:139], a[40:43], v[88:91]
buffer_load_dwordx4 v[128:131], v1, s[8:11], s24 offen offset:0 sc1
v_mfma_f32_16x16x32_bf16 v[88:91], v[140:143], a[60:63], v[88:91]
v_lshlrev_b32 v48, 16, v74
v_and_b32 v49, s28, v74
v_mfma_f32_16x16x32_bf16 v[92:95], v[140:143], a[64:67], v[92:95]
v_lshlrev_b32 v50, 16, v75
v_and_b32 v51, s28, v75
v_mfma_f32_16x16x32_bf16 v[92:95], v[136:139], a[44:47], v[92:95]
v_add_f32 v112, v112, v48
v_add_f32 v113, v113, v49
v_mfma_f32_16x16x32_bf16 v[96:99], v[136:139], a[48:51], v[96:99]
v_add_f32 v114, v114, v50
v_add_f32 v115, v115, v51
v_mfma_f32_16x16x32_bf16 v[96:99], v[140:143], a[68:71], v[96:99]
buffer_load_dwordx4 v[132:135], v1, s[8:11], s24 offen offset:1024 sc1
v_mfma_f32_16x16x32_bf16 v[100:103], v[140:143], a[72:75], v[100:103]
v_cvt_pk_bf16_f32 v34, v112, v113
v_cvt_pk_bf16_f32 v35, v114, v115
v_mfma_f32_16x16x32_bf16 v[100:103], v[136:139], a[52:55], v[100:103]
s_add_u32 s35, s29, 16384
v_mfma_f32_16x16x32_bf16 v[104:107], v[136:139], a[56:59], v[104:107]
s_waitcnt vmcnt(15)
v_mfma_f32_16x16x32_bf16 v[104:107], v[140:143], a[76:79], v[104:107]
buffer_store_dwordx4 v[32:35], v1, s[8:11], s35 offen sc1
v_mfma_f32_16x16x32_bf16 v[104:107], v[144:147], a[96:99], v[104:107]
buffer_load_dwordx4 v[136:139], v1, s[8:11], s24 offen offset:2048 sc1
v_mfma_f32_16x16x32_bf16 v[104:107], v[148:151], a[116:119], v[104:107]
v_lshlrev_b32 v48, 16, v78
v_and_b32 v49, s28, v78
v_mfma_f32_16x16x32_bf16 v[100:103], v[148:151], a[112:115], v[100:103]
v_lshlrev_b32 v50, 16, v79
v_and_b32 v51, s28, v79
v_mfma_f32_16x16x32_bf16 v[100:103], v[144:147], a[92:95], v[100:103]
v_add_f32 v116, v116, v48
v_add_f32 v117, v117, v49
v_mfma_f32_16x16x32_bf16 v[96:99], v[144:147], a[88:91], v[96:99]
v_add_f32 v118, v118, v50
v_add_f32 v119, v119, v51
v_mfma_f32_16x16x32_bf16 v[96:99], v[148:151], a[108:111], v[96:99]
buffer_load_dwordx4 v[140:143], v1, s[8:11], s24 offen offset:3072 sc1
v_mfma_f32_16x16x32_bf16 v[92:95], v[148:151], a[104:107], v[92:95]
s_add_u32 s24, s24, 4096
v_cvt_pk_bf16_f32 v38, v116, v117
v_cvt_pk_bf16_f32 v39, v118, v119
v_mfma_f32_16x16x32_bf16 v[92:95], v[144:147], a[84:87], v[92:95]
s_add_u32 s35, s29, 32768
v_mfma_f32_16x16x32_bf16 v[88:91], v[144:147], a[80:83], v[88:91]
s_waitcnt vmcnt(15)
v_mfma_f32_16x16x32_bf16 v[88:91], v[148:151], a[100:103], v[88:91]
buffer_store_dwordx4 v[36:39], v1, s[8:11], s35 offen sc1
v_mfma_f32_16x16x32_bf16 v[88:91], v[152:155], a[120:123], v[88:91]
buffer_load_dwordx4 v[144:147], v1, s[8:11], s24 offen offset:0 sc1
v_mfma_f32_16x16x32_bf16 v[88:91], v[156:159], a[140:143], v[88:91]
v_lshlrev_b32 v48, 16, v82
v_and_b32 v49, s28, v82
v_mfma_f32_16x16x32_bf16 v[92:95], v[156:159], a[144:147], v[92:95]
v_lshlrev_b32 v50, 16, v83
v_and_b32 v51, s28, v83
v_mfma_f32_16x16x32_bf16 v[92:95], v[152:155], a[124:127], v[92:95]
v_add_f32 v120, v120, v48
v_add_f32 v121, v121, v49
v_mfma_f32_16x16x32_bf16 v[96:99], v[152:155], a[128:131], v[96:99]
v_add_f32 v122, v122, v50
v_add_f32 v123, v123, v51
v_mfma_f32_16x16x32_bf16 v[96:99], v[156:159], a[148:151], v[96:99]
buffer_load_dwordx4 v[148:151], v1, s[8:11], s24 offen offset:1024 sc1
v_mfma_f32_16x16x32_bf16 v[100:103], v[156:159], a[152:155], v[100:103]
v_cvt_pk_bf16_f32 v42, v120, v121
v_cvt_pk_bf16_f32 v43, v122, v123
v_mfma_f32_16x16x32_bf16 v[100:103], v[152:155], a[132:135], v[100:103]
s_add_u32 s35, s29, 49152
v_mfma_f32_16x16x32_bf16 v[104:107], v[152:155], a[136:139], v[104:107]
s_waitcnt vmcnt(15)
v_mfma_f32_16x16x32_bf16 v[104:107], v[156:159], a[156:159], v[104:107]
buffer_store_dwordx4 v[40:43], v1, s[8:11], s35 offen sc1
v_mfma_f32_16x16x32_bf16 v[104:107], v[160:163], a[176:179], v[104:107]
buffer_load_dwordx4 v[152:155], v1, s[8:11], s24 offen offset:2048 sc1
v_mfma_f32_16x16x32_bf16 v[104:107], v[164:167], a[196:199], v[104:107]
v_lshlrev_b32 v48, 16, v86
v_and_b32 v49, s28, v86
v_mfma_f32_16x16x32_bf16 v[100:103], v[164:167], a[192:195], v[100:103]
v_lshlrev_b32 v50, 16, v87
v_and_b32 v51, s28, v87
v_mfma_f32_16x16x32_bf16 v[100:103], v[160:163], a[172:175], v[100:103]
v_add_f32 v124, v124, v48
v_add_f32 v125, v125, v49
v_mfma_f32_16x16x32_bf16 v[96:99], v[160:163], a[168:171], v[96:99]
v_add_f32 v126, v126, v50
v_add_f32 v127, v127, v51
v_mfma_f32_16x16x32_bf16 v[96:99], v[164:167], a[188:191], v[96:99]
buffer_load_dwordx4 v[156:159], v1, s[8:11], s24 offen offset:3072 sc1
v_mfma_f32_16x16x32_bf16 v[92:95], v[164:167], a[184:187], v[92:95]
s_add_u32 s24, s24, 4096
v_cvt_pk_bf16_f32 v46, v124, v125
v_cvt_pk_bf16_f32 v47, v126, v127
v_mfma_f32_16x16x32_bf16 v[92:95], v[160:163], a[164:167], v[92:95]
s_add_u32 s35, s29, 65536
v_mfma_f32_16x16x32_bf16 v[88:91], v[160:163], a[160:163], v[88:91]
s_waitcnt vmcnt(16)
v_mfma_f32_16x16x32_bf16 v[88:91], v[164:167], a[180:183], v[88:91]
buffer_store_dwordx4 v[44:47], v1, s[8:11], s35 offen sc1
v_mfma_f32_16x16x32_bf16 v[88:91], v[168:171], a[200:203], v[88:91]
buffer_load_dwordx4 v[160:163], v1, s[8:11], s24 offen offset:0 sc1
v_mfma_f32_16x16x32_bf16 v[88:91], v[172:175], a[220:223], v[88:91]
s_add_u32 s29, s29, 1024
v_mfma_f32_16x16x32_bf16 v[92:95], v[172:175], a[224:227], v[92:95]
v_mfma_f32_16x16x32_bf16 v[92:95], v[168:171], a[204:207], v[92:95]
v_mfma_f32_16x16x32_bf16 v[96:99], v[168:171], a[208:211], v[96:99]
v_mfma_f32_16x16x32_bf16 v[96:99], v[172:175], a[228:231], v[96:99]
buffer_load_dwordx4 v[164:167], v1, s[8:11], s24 offen offset:1024 sc1
v_mfma_f32_16x16x32_bf16 v[100:103], v[172:175], a[232:235], v[100:103]
v_mfma_f32_16x16x32_bf16 v[100:103], v[168:171], a[212:215], v[100:103]
v_mfma_f32_16x16x32_bf16 v[104:107], v[168:171], a[216:219], v[104:107]
s_waitcnt vmcnt(17)
v_mfma_f32_16x16x32_bf16 v[104:107], v[172:175], a[236:239], v[104:107]
v_mfma_f32_16x16x32_bf16 v[104:107], v[176:179], v[192:195], v[104:107]
buffer_load_dwordx4 v[168:171], v1, s[8:11], s24 offen offset:2048 sc1
v_mfma_f32_16x16x32_bf16 v[104:107], v[180:183], v[212:215], v[104:107]
v_mfma_f32_16x16x32_bf16 v[100:103], v[180:183], v[208:211], v[100:103]
v_mfma_f32_16x16x32_bf16 v[100:103], v[176:179], a[252:255], v[100:103]
v_mfma_f32_16x16x32_bf16 v[96:99], v[176:179], a[248:251], v[96:99]
v_mfma_f32_16x16x32_bf16 v[96:99], v[180:183], v[204:207], v[96:99]
buffer_load_dwordx4 v[172:175], v1, s[8:11], s24 offen offset:3072 sc1
v_mfma_f32_16x16x32_bf16 v[92:95], v[180:183], v[200:203], v[92:95]
s_add_u32 s24, s24, 4096
v_mfma_f32_16x16x32_bf16 v[92:95], v[176:179], a[244:247], v[92:95]
v_mfma_f32_16x16x32_bf16 v[88:91], v[176:179], a[240:243], v[88:91]
s_waitcnt vmcnt(17)
v_mfma_f32_16x16x32_bf16 v[88:91], v[180:183], v[196:199], v[88:91]
v_mfma_f32_16x16x32_bf16 v[88:91], v[184:187], v[216:219], v[88:91]
buffer_load_dwordx4 v[176:179], v1, s[8:11], s24 offen offset:0 sc1
v_mfma_f32_16x16x32_bf16 v[88:91], v[188:191], v[236:239], v[88:91]
v_mfma_f32_16x16x32_bf16 v[92:95], v[188:191], v[240:243], v[92:95]
v_mfma_f32_16x16x32_bf16 v[92:95], v[184:187], v[220:223], v[92:95]
v_mfma_f32_16x16x32_bf16 v[96:99], v[184:187], v[224:227], v[96:99]
v_mfma_f32_16x16x32_bf16 v[96:99], v[188:191], v[244:247], v[96:99]
buffer_load_dwordx4 v[180:183], v1, s[8:11], s24 offen offset:1024 sc1
v_mfma_f32_16x16x32_bf16 v[100:103], v[188:191], v[248:251], v[100:103]
v_mfma_f32_16x16x32_bf16 v[100:103], v[184:187], v[228:231], v[100:103]
v_mfma_f32_16x16x32_bf16 v[104:107], v[184:187], v[232:235], v[104:107]
s_waitcnt vmcnt(16)
v_mfma_f32_16x16x32_bf16 v[104:107], v[188:191], v[252:255], v[104:107]
s_add_u32 s25, s25, 1
s_cmp_eq_u32 s25, 3
s_movk_i32 s35, 5120
s_cselect_b32 s35, -10240, s35
v_add_u32 v17, s35, v17
v_mfma_f32_16x16x32_bf16 v[124:127], v[128:131], a[16:19], 0
buffer_load_dwordx4 v[184:187], v1, s[8:11], s24 offen offset:2048 sc1
v_mfma_f32_16x16x32_bf16 v[124:127], v[132:135], a[36:39], v[124:127]
v_mfma_f32_16x16x32_bf16 v[120:123], v[132:135], a[32:35], 0
ds_read_b128 v[68:71], v17 offset:0
v_mfma_f32_16x16x32_bf16 v[120:123], v[128:131], a[12:15], v[120:123]
ds_read_b128 v[72:75], v17 offset:1024
v_mfma_f32_16x16x32_bf16 v[116:119], v[128:131], a[8:11], 0
ds_read_b128 v[76:79], v17 offset:2048
v_mfma_f32_16x16x32_bf16 v[116:119], v[132:135], a[28:31], v[116:119]
buffer_load_dwordx4 v[188:191], v1, s[8:11], s24 offen offset:3072 sc1
v_mfma_f32_16x16x32_bf16 v[112:115], v[132:135], a[24:27], 0
s_add_u32 s24, s24, 4096
s_cmp_eq_u32 s25, 3
s_cselect_b32 s24, s32, s24
v_mfma_f32_16x16x32_bf16 v[112:115], v[128:131], a[4:7], v[112:115]
ds_read_b128 v[80:83], v17 offset:3072
v_mfma_f32_16x16x32_bf16 v[108:111], v[128:131], a[0:3], 0
s_waitcnt vmcnt(15)
ds_read_b128 v[84:87], v17 offset:4096
v_mfma_f32_16x16x32_bf16 v[108:111], v[132:135], a[20:23], v[108:111]
s_waitcnt lgkmcnt(4)
v_lshlrev_b32 v48, 16, v68
v_and_b32 v49, s28, v68
v_mfma_f32_16x16x32_bf16 v[108:111], v[136:139], a[40:43], v[108:111]
buffer_load_dwordx4 v[128:131], v1, s[8:11], s24 offen offset:0 sc1
v_mfma_f32_16x16x32_bf16 v[108:111], v[140:143], a[60:63], v[108:111]
v_lshlrev_b32 v50, 16, v69
v_and_b32 v51, s28, v69
v_mfma_f32_16x16x32_bf16 v[112:115], v[140:143], a[64:67], v[112:115]
s_add_u32 m0, s30, 0
v_add_f32 v88, v88, v48
v_add_f32 v89, v89, v49
v_mfma_f32_16x16x32_bf16 v[112:115], v[136:139], a[44:47], v[112:115]
buffer_load_dwordx4 v12, s[8:11], s26 offen sc1 lds
v_mfma_f32_16x16x32_bf16 v[116:119], v[136:139], a[48:51], v[116:119]
v_add_f32 v90, v90, v50
v_add_f32 v91, v91, v51
v_mfma_f32_16x16x32_bf16 v[116:119], v[140:143], a[68:71], v[116:119]
buffer_load_dwordx4 v[132:135], v1, s[8:11], s24 offen offset:1024 sc1
v_mfma_f32_16x16x32_bf16 v[120:123], v[140:143], a[72:75], v[120:123]
v_cvt_pk_bf16_f32 v28, v88, v89
v_cvt_pk_bf16_f32 v29, v90, v91
v_mfma_f32_16x16x32_bf16 v[120:123], v[136:139], a[52:55], v[120:123]
s_waitcnt lgkmcnt(3)
v_lshlrev_b32 v48, 16, v72
v_and_b32 v49, s28, v72
v_mfma_f32_16x16x32_bf16 v[124:127], v[136:139], a[56:59], v[124:127]
s_waitcnt vmcnt(15)
v_lshlrev_b32 v50, 16, v73
v_and_b32 v51, s28, v73
v_mfma_f32_16x16x32_bf16 v[124:127], v[140:143], a[76:79], v[124:127]
v_add_f32 v92, v92, v48
v_add_f32 v93, v93, v49
v_mfma_f32_16x16x32_bf16 v[124:127], v[144:147], a[96:99], v[124:127]
buffer_load_dwordx4 v[136:139], v1, s[8:11], s24 offen offset:2048 sc1
v_mfma_f32_16x16x32_bf16 v[124:127], v[148:151], a[116:119], v[124:127]
v_add_f32 v94, v94, v50
v_add_f32 v95, v95, v51
v_mfma_f32_16x16x32_bf16 v[120:123], v[148:151], a[112:115], v[120:123]
s_add_u32 m0, s30, 16384
v_cvt_pk_bf16_f32 v32, v92, v93
v_cvt_pk_bf16_f32 v33, v94, v95
v_mfma_f32_16x16x32_bf16 v[120:123], v[144:147], a[92:95], v[120:123]
buffer_load_dwordx4 v13, s[8:11], s26 offen sc1 lds
v_mfma_f32_16x16x32_bf16 v[116:119], v[144:147], a[88:91], v[116:119]
s_waitcnt lgkmcnt(2)
v_lshlrev_b32 v48, 16, v76
v_and_b32 v49, s28, v76
v_mfma_f32_16x16x32_bf16 v[116:119], v[148:151], a[108:111], v[116:119]
buffer_load_dwordx4 v[140:143], v1, s[8:11], s24 offen offset:3072 sc1
v_mfma_f32_16x16x32_bf16 v[112:115], v[148:151], a[104:107], v[112:115]
s_add_u32 s24, s24, 4096
v_lshlrev_b32 v50, 16, v77
v_and_b32 v51, s28, v77
v_mfma_f32_16x16x32_bf16 v[112:115], v[144:147], a[84:87], v[112:115]
v_add_f32 v96, v96, v48
v_add_f32 v97, v97, v49
v_mfma_f32_16x16x32_bf16 v[108:111], v[144:147], a[80:83], v[108:111]
s_waitcnt vmcnt(15)
v_add_f32 v98, v98, v50
v_add_f32 v99, v99, v51
v_mfma_f32_16x16x32_bf16 v[108:111], v[148:151], a[100:103], v[108:111]
v_cvt_pk_bf16_f32 v36, v96, v97
v_cvt_pk_bf16_f32 v37, v98, v99
v_mfma_f32_16x16x32_bf16 v[108:111], v[152:155], a[120:123], v[108:111]
buffer_load_dwordx4 v[144:147], v1, s[8:11], s24 offen offset:0 sc1
v_mfma_f32_16x16x32_bf16 v[108:111], v[156:159], a[140:143], v[108:111]
s_waitcnt lgkmcnt(1)
v_lshlrev_b32 v48, 16, v80
v_and_b32 v49, s28, v80
v_mfma_f32_16x16x32_bf16 v[112:115], v[156:159], a[144:147], v[112:115]
s_add_u32 m0, s30, 32768
v_lshlrev_b32 v50, 16, v81
v_and_b32 v51, s28, v81
v_mfma_f32_16x16x32_bf16 v[112:115], v[152:155], a[124:127], v[112:115]
buffer_load_dwordx4 v14, s[8:11], s26 offen sc1 lds
v_mfma_f32_16x16x32_bf16 v[116:119], v[152:155], a[128:131], v[116:119]
v_add_f32 v100, v100, v48
v_add_f32 v101, v101, v49
v_mfma_f32_16x16x32_bf16 v[116:119], v[156:159], a[148:151], v[116:119]
buffer_load_dwordx4 v[148:151], v1, s[8:11], s24 offen offset:1024 sc1
v_mfma_f32_16x16x32_bf16 v[120:123], v[156:159], a[152:155], v[120:123]
v_add_f32 v102, v102, v50
v_add_f32 v103, v103, v51
v_mfma_f32_16x16x32_bf16 v[120:123], v[152:155], a[132:135], v[120:123]
v_cvt_pk_bf16_f32 v40, v100, v101
v_cvt_pk_bf16_f32 v41, v102, v103
v_mfma_f32_16x16x32_bf16 v[124:127], v[152:155], a[136:139], v[124:127]
s_waitcnt vmcnt(15)
s_waitcnt lgkmcnt(0)
v_lshlrev_b32 v48, 16, v84
v_mfma_f32_16x16x32_bf16 v[124:127], v[156:159], a[156:159], v[124:127]
v_and_b32 v49, s28, v84
v_lshlrev_b32 v50, 16, v85
v_mfma_f32_16x16x32_bf16 v[124:127], v[160:163], a[176:179], v[124:127]
buffer_load_dwordx4 v[152:155], v1, s[8:11], s24 offen offset:2048 sc1
v_mfma_f32_16x16x32_bf16 v[124:127], v[164:167], a[196:199], v[124:127]
v_and_b32 v51, s28, v85
v_add_f32 v104, v104, v48
v_mfma_f32_16x16x32_bf16 v[120:123], v[164:167], a[192:195], v[120:123]
s_add_u32 m0, s30, 49152
v_add_f32 v105, v105, v49
v_add_f32 v106, v106, v50
v_mfma_f32_16x16x32_bf16 v[120:123], v[160:163], a[172:175], v[120:123]
buffer_load_dwordx4 v15, s[8:11], s26 offen sc1 lds
v_mfma_f32_16x16x32_bf16 v[116:119], v[160:163], a[168:171], v[116:119]
v_add_f32 v107, v107, v51
v_cvt_pk_bf16_f32 v44, v104, v105
v_mfma_f32_16x16x32_bf16 v[116:119], v[164:167], a[188:191], v[116:119]
buffer_load_dwordx4 v[156:159], v1, s[8:11], s24 offen offset:3072 sc1
v_mfma_f32_16x16x32_bf16 v[112:115], v[164:167], a[184:187], v[112:115]
s_add_u32 s24, s24, 4096
v_cvt_pk_bf16_f32 v45, v106, v107
v_mfma_f32_16x16x32_bf16 v[112:115], v[160:163], a[164:167], v[112:115]
v_mfma_f32_16x16x32_bf16 v[108:111], v[160:163], a[160:163], v[108:111]
s_waitcnt vmcnt(16)
v_mfma_f32_16x16x32_bf16 v[108:111], v[164:167], a[180:183], v[108:111]
v_mfma_f32_16x16x32_bf16 v[108:111], v[168:171], a[200:203], v[108:111]
buffer_load_dwordx4 v[160:163], v1, s[8:11], s24 offen offset:0 sc1
v_mfma_f32_16x16x32_bf16 v[108:111], v[172:175], a[220:223], v[108:111]
v_mfma_f32_16x16x32_bf16 v[112:115], v[172:175], a[224:227], v[112:115]
s_add_u32 m0, s30, 65536
v_mfma_f32_16x16x32_bf16 v[112:115], v[168:171], a[204:207], v[112:115]
buffer_load_dwordx4 v16, s[8:11], s26 offen sc1 lds
v_mfma_f32_16x16x32_bf16 v[116:119], v[168:171], a[208:211], v[116:119]
s_add_u32 s26, s26, 1024
s_add_u32 s30, s30, 1024
v_mfma_f32_16x16x32_bf16 v[116:119], v[172:175], a[228:231], v[116:119]
buffer_load_dwordx4 v[164:167], v1, s[8:11], s24 offen offset:1024 sc1
v_mfma_f32_16x16x32_bf16 v[120:123], v[172:175], a[232:235], v[120:123]
v_mfma_f32_16x16x32_bf16 v[120:123], v[168:171], a[212:215], v[120:123]
v_mfma_f32_16x16x32_bf16 v[124:127], v[168:171], a[216:219], v[124:127]
s_waitcnt vmcnt(17)
v_mfma_f32_16x16x32_bf16 v[124:127], v[172:175], a[236:239], v[124:127]
v_mfma_f32_16x16x32_bf16 v[124:127], v[176:179], v[192:195], v[124:127]
buffer_load_dwordx4 v[168:171], v1, s[8:11], s24 offen offset:2048 sc1
v_mfma_f32_16x16x32_bf16 v[124:127], v[180:183], v[212:215], v[124:127]
v_mfma_f32_16x16x32_bf16 v[120:123], v[180:183], v[208:211], v[120:123]
v_mfma_f32_16x16x32_bf16 v[120:123], v[176:179], a[252:255], v[120:123]
v_mfma_f32_16x16x32_bf16 v[116:119], v[176:179], a[248:251], v[116:119]
v_mfma_f32_16x16x32_bf16 v[116:119], v[180:183], v[204:207], v[116:119]
buffer_load_dwordx4 v[172:175], v1, s[8:11], s24 offen offset:3072 sc1
v_mfma_f32_16x16x32_bf16 v[112:115], v[180:183], v[200:203], v[112:115]
s_add_u32 s24, s24, 4096
v_mfma_f32_16x16x32_bf16 v[112:115], v[176:179], a[244:247], v[112:115]
v_mfma_f32_16x16x32_bf16 v[108:111], v[176:179], a[240:243], v[108:111]
s_waitcnt vmcnt(17)
v_mfma_f32_16x16x32_bf16 v[108:111], v[180:183], v[196:199], v[108:111]
v_mfma_f32_16x16x32_bf16 v[108:111], v[184:187], v[216:219], v[108:111]
buffer_load_dwordx4 v[176:179], v1, s[8:11], s24 offen offset:0 sc1
v_mfma_f32_16x16x32_bf16 v[108:111], v[188:191], v[236:239], v[108:111]
v_mfma_f32_16x16x32_bf16 v[112:115], v[188:191], v[240:243], v[112:115]
v_mfma_f32_16x16x32_bf16 v[112:115], v[184:187], v[220:223], v[112:115]
v_mfma_f32_16x16x32_bf16 v[116:119], v[184:187], v[224:227], v[116:119]
v_mfma_f32_16x16x32_bf16 v[116:119], v[188:191], v[244:247], v[116:119]
buffer_load_dwordx4 v[180:183], v1, s[8:11], s24 offen offset:1024 sc1
v_mfma_f32_16x16x32_bf16 v[120:123], v[188:191], v[248:251], v[120:123]
v_mfma_f32_16x16x32_bf16 v[120:123], v[184:187], v[228:231], v[120:123]
v_mfma_f32_16x16x32_bf16 v[124:127], v[184:187], v[232:235], v[124:127]
s_waitcnt vmcnt(16)
v_mfma_f32_16x16x32_bf16 v[124:127], v[188:191], v[252:255], v[124:127]
s_cmp_lt_u32 s25, 3
s_cbranch_scc1 L_c_z
s_nop 1
v_lshlrev_b32 v48, 16, v70
v_and_b32 v49, s28, v70
v_lshlrev_b32 v50, 16, v71
v_and_b32 v51, s28, v71
v_add_f32 v108, v108, v48
v_add_f32 v109, v109, v49
v_add_f32 v110, v110, v50
v_add_f32 v111, v111, v51
v_cvt_pk_bf16_f32 v30, v108, v109
v_cvt_pk_bf16_f32 v31, v110, v111
s_add_u32 s35, s29, 0
buffer_store_dwordx4 v[28:31], v1, s[8:11], s35 offen sc1
v_lshlrev_b32 v48, 16, v74
v_and_b32 v49, s28, v74
v_lshlrev_b32 v50, 16, v75
v_and_b32 v51, s28, v75
v_add_f32 v112, v112, v48
v_add_f32 v113, v113, v49
v_add_f32 v114, v114, v50
v_add_f32 v115, v115, v51
v_cvt_pk_bf16_f32 v34, v112, v113
v_cvt_pk_bf16_f32 v35, v114, v115
s_add_u32 s35, s29, 16384
buffer_store_dwordx4 v[32:35], v1, s[8:11], s35 offen sc1
v_lshlrev_b32 v48, 16, v78
v_and_b32 v49, s28, v78
v_lshlrev_b32 v50, 16, v79
v_and_b32 v51, s28, v79
v_add_f32 v116, v116, v48
v_add_f32 v117, v117, v49
v_add_f32 v118, v118, v50
v_add_f32 v119, v119, v51
v_cvt_pk_bf16_f32 v38, v116, v117
v_cvt_pk_bf16_f32 v39, v118, v119
s_add_u32 s35, s29, 32768
buffer_store_dwordx4 v[36:39], v1, s[8:11], s35 offen sc1
v_lshlrev_b32 v48, 16, v82
v_and_b32 v49, s28, v82
v_lshlrev_b32 v50, 16, v83
v_and_b32 v51, s28, v83
v_add_f32 v120, v120, v48
v_add_f32 v121, v121, v49
v_add_f32 v122, v122, v50
v_add_f32 v123, v123, v51
v_cvt_pk_bf16_f32 v42, v120, v121
v_cvt_pk_bf16_f32 v43, v122, v123
s_add_u32 s35, s29, 49152
buffer_store_dwordx4 v[40:43], v1, s[8:11], s35 offen sc1
v_lshlrev_b32 v48, 16, v86
v_and_b32 v49, s28, v86
v_lshlrev_b32 v50, 16, v87
v_and_b32 v51, s28, v87
v_add_f32 v124, v124, v48
v_add_f32 v125, v125, v49
v_add_f32 v126, v126, v50
v_add_f32 v127, v127, v51
v_cvt_pk_bf16_f32 v46, v124, v125
v_cvt_pk_bf16_f32 v47, v126, v127
s_add_u32 s35, s29, 65536
buffer_store_dwordx4 v[44:47], v1, s[8:11], s35 offen sc1
s_add_u32 s29, s29, 1024
s_mov_b32 s23, 4000
s_add_u32 s31, s31, 1
s_cmp_lt_u32 s31, 2
s_cbranch_scc1 L_c_tile
s_waitcnt vmcnt(0)
s_barrier
v_or_b32 v26, s20, v0
v_min_u32 v26, 1, v26
v_lshlrev_b32 v26, 30, v26
v_mov_b32 v27, s7
buffer_store_dword v27, v26, s[8:11], s44 offen sc1
s_branch L_k2_fin
L_c_spin:
s_mov_b32 s30, 0
L_c_spin_l:
buffer_load_dword v13, v16, s[8:11], 0 offen sc1
s_waitcnt vmcnt(0)
v_cmp_ne_u32 vcc, s7, v13
s_cbranch_vccz L_c_u
s_add_u32 s30, s30, 1
s_cmp_lt_u32 s30, 0x40000
s_cbranch_scc1 L_c_spin_l
s_branch L_c_u
L_k2_spare:
s_waitcnt vmcnt(0) lgkmcnt(0)
s_barrier
buffer_store_dword v21, v20, s[8:11], s30 offen sc1
s_mov_b32 s60, s50
s_and_b32 s61, s51, 0xffff
s_mov_b32 s62, 0x80000
s_mov_b32 s63, 0x20000
s_mov_b32 s64, s44
s_and_b32 s65, s45, 0xffff
s_mov_b32 s66, 0x80000
s_mov_b32 s67, 0x20000
s_mov_b32 s68, s42
s_and_b32 s69, s43, 0xffff
s_mov_b32 s70, 0x80000
s_mov_b32 s71, 0x20000
L_spin1:
s_mov_b32 s21, 0
L_spin1_l:
buffer_load_dword v19, v18, s[8:11], 0 offen sc1
s_waitcnt vmcnt(0)
v_cmp_ne_u32 vcc, s7, v19
s_cbranch_vccz L_ok1
s_add_u32 s21, s21, 1
s_cmp_lt_u32 s21, 0x40000
s_cbranch_scc1 L_spin1_l
s_branch L_ok1
L_ok1:
s_barrier
s_mov_b32 s21, 0x10000000
s_cmp_eq_u32 s3, 253
s_cselect_b32 s21, 0x3420000, s21
buffer_store_dword v21, v20, s[8:11], s21 offen sc1
v_lshrrev_b32 v2, 4, v0
v_sub_u32 v3, 0, v2
v_xor_b32 v3, v3, v0
v_and_b32 v3, 3, v3
v_lshlrev_b32 v3, 4, v3
v_lshl_add_u32 v4, v2, 13, v3
v_bfe_u32 v5, v0, 2, 2
v_lshl_add_u32 v4, v5, 10, v4
v_lshrrev_b32 v5, 2, v0
v_lshl_add_u32 v5, v5, 10, v3
v_bfe_u32 v3, v0, 2, 2
v_sub_u32 v3, 0, v3
v_lshrrev_b32 v7, 4, v0
v_xor_b32 v3, v3, v7
v_and_b32 v3, 3, v3
v_and_b32 v7, 15, v0
v_lshl_add_u32 v7, v7, 2, v3
v_lshlrev_b32 v7, 4, v7
s_sub_u32 s33, s3, 253
s_lshl_b32 s32, s33, 2
s_add_u32 s32, s32, s20
s_mul_i32 s32, s32, 3
s_lshl_b32 s33, s33, 7
s_mov_b32 s21, 1
v_or_b32 v8, s20, v0
v_min_u32 v8, 1, v8
v_lshlrev_b32 v8, 30, v8
v_mov_b32 v9, s7
L_sp_prod:
s_cmp_eq_u32 s21, 0
s_cbranch_scc0 L_sp_p1
s_mov_b32 s12, s60
s_mov_b32 s72, s64
s_mov_b32 s13, s61
s_mov_b32 s73, s65
s_mov_b32 s14, s62
s_mov_b32 s74, s66
s_mov_b32 s15, s63
s_mov_b32 s75, s67
s_mov_b32 s34, 0x3380000
s_mov_b32 s31, 0x3080000
s_mov_b32 s25, 4096
v_mov_b32 v6, v4
s_mov_b32 s44, 1024
s_mov_b32 s45, s44
s_mov_b32 s46, 0
s_branch L_sp_go
L_sp_p1:
s_cmp_eq_u32 s21, 1
s_cbranch_scc0 L_sp_p2
s_mov_b32 s12, s64
s_mov_b32 s72, s68
s_mov_b32 s13, s65
s_mov_b32 s73, s69
s_mov_b32 s14, s66
s_mov_b32 s74, s70
s_mov_b32 s15, s67
s_mov_b32 s75, s71
s_mov_b32 s34, 0x3300000
s_mov_b32 s31, 0x3100000
s_mov_b32 s25, 4096
v_mov_b32 v6, v4
s_mov_b32 s44, 1024
s_mov_b32 s45, s44
s_mov_b32 s46, 0
s_branch L_sp_go
L_sp_p2:
s_mov_b32 s12, s68
s_mov_b32 s72, s68
s_mov_b32 s13, s69
s_mov_b32 s73, s69
s_mov_b32 s14, s70
s_mov_b32 s74, s70
s_mov_b32 s15, s71
s_mov_b32 s75, s71
s_mov_b32 s34, 0x3100000
s_mov_b32 s31, 0x3180000
s_mov_b32 s25, 16384
v_mov_b32 v6, v5
s_mov_b32 s44, 4096
s_mov_b32 s45, s44
s_mov_b32 s46, 16384
L_sp_go:
s_lshl_b32 s23, s20, 8
s_add_u32 s24, s23, s25
s_lshl_b32 s30, s20, 12
v_mov_b32 v2, v7
s_mov_b32 s22, 0
s_add_u32 m0, s30, 0
s_nop 0
buffer_load_dwordx4 v6, s[12:15], s23 offen offset:0 lds
s_add_u32 m0, s30, 960
s_nop 0
buffer_load_dwordx4 v6, s[12:15], s23 offen offset:64 lds
s_add_u32 m0, s30, 1920
s_nop 0
buffer_load_dwordx4 v6, s[12:15], s23 offen offset:128 lds
s_add_u32 m0, s30, 2880
s_nop 0
buffer_load_dwordx4 v6, s[12:15], s23 offen offset:192 lds
s_add_u32 m0, s30, 16384
s_nop 0
buffer_load_dwordx4 v6, s[12:15], s24 offen offset:0 lds
s_add_u32 m0, s30, 17344
s_nop 0
buffer_load_dwordx4 v6, s[12:15], s24 offen offset:64 lds
s_add_u32 m0, s30, 18304
s_nop 0
buffer_load_dwordx4 v6, s[12:15], s24 offen offset:128 lds
s_add_u32 m0, s30, 19264
s_nop 0
buffer_load_dwordx4 v6, s[12:15], s24 offen offset:192 lds
s_add_u32 s23, s23, 32768
s_add_u32 s24, s24, 32768
s_add_u32 s30, s30, 32768
s_and_b32 s30, s30, 0x1ffff
s_add_u32 s36, s32, 0
s_min_u32 s37, s36, 31
s_lshl_b32 s37, s37, 14
s_add_u32 s40, s37, s34
s_lshr_b32 s38, s36, 3
s_lshl_b32 s38, s38, 17
s_bfe_u32 s39, s36, 0x10002
s_lshl_b32 s39, s39, 14
s_add_u32 s38, s38, s39
s_and_b32 s39, s36, 3
s_lshl_b32 s39, s39, 10
s_add_u32 s38, s38, s39
s_cmp_eq_u32 s46, 0
s_cselect_b32 s38, s37, s38
s_add_u32 s38, s38, s31
s_cmp_lt_u32 s36, 32
s_cselect_b32 s26, s38, 0x10000000
s_add_u32 s36, s32, 1
s_min_u32 s37, s36, 31
s_lshl_b32 s37, s37, 14
s_add_u32 s41, s37, s34
s_lshr_b32 s38, s36, 3
s_lshl_b32 s38, s38, 17
s_bfe_u32 s39, s36, 0x10002
s_lshl_b32 s39, s39, 14
s_add_u32 s38, s38, s39
s_and_b32 s39, s36, 3
s_lshl_b32 s39, s39, 10
s_add_u32 s38, s38, s39
s_cmp_eq_u32 s46, 0
s_cselect_b32 s38, s37, s38
s_add_u32 s38, s38, s31
s_cmp_lt_u32 s36, 32
s_cselect_b32 s27, s38, 0x10000000
s_add_u32 s36, s32, 2
s_min_u32 s37, s36, 31
s_lshl_b32 s37, s37, 14
s_add_u32 s42, s37, s34
s_lshr_b32 s38, s36, 3
s_lshl_b32 s38, s38, 17
s_bfe_u32 s39, s36, 0x10002
s_lshl_b32 s39, s39, 14
s_add_u32 s38, s38, s39
s_and_b32 s39, s36, 3
s_lshl_b32 s39, s39, 10
s_add_u32 s38, s38, s39
s_cmp_eq_u32 s46, 0
s_cselect_b32 s38, s37, s38
s_add_u32 s38, s38, s31
s_cmp_lt_u32 s36, 32
s_cselect_b32 s28, s38, 0x10000000
buffer_load_dwordx4 a[0:3], v1, s[8:11], s40 offen offset:0 sc1
buffer_load_dwordx4 a[64:67], v1, s[8:11], s41 offen offset:0 sc1
buffer_load_dwordx4 a[128:131], v1, s[8:11], s42 offen offset:0 sc1
buffer_load_dwordx4 a[4:7], v1, s[8:11], s40 offen offset:1024 sc1
buffer_load_dwordx4 a[68:71], v1, s[8:11], s41 offen offset:1024 sc1
buffer_load_dwordx4 a[132:135], v1, s[8:11], s42 offen offset:1024 sc1
buffer_load_dwordx4 a[8:11], v1, s[8:11], s40 offen offset:2048 sc1
buffer_load_dwordx4 a[72:75], v1, s[8:11], s41 offen offset:2048 sc1
buffer_load_dwordx4 a[136:139], v1, s[8:11], s42 offen offset:2048 sc1
buffer_load_dwordx4 a[12:15], v1, s[8:11], s40 offen offset:3072 sc1
buffer_load_dwordx4 a[76:79], v1, s[8:11], s41 offen offset:3072 sc1
buffer_load_dwordx4 a[140:143], v1, s[8:11], s42 offen offset:3072 sc1
s_add_u32 s40, s40, 4096
s_add_u32 s41, s41, 4096
s_add_u32 s42, s42, 4096
buffer_load_dwordx4 a[16:19], v1, s[8:11], s40 offen offset:0 sc1
buffer_load_dwordx4 a[80:83], v1, s[8:11], s41 offen offset:0 sc1
buffer_load_dwordx4 a[144:147], v1, s[8:11], s42 offen offset:0 sc1
buffer_load_dwordx4 a[20:23], v1, s[8:11], s40 offen offset:1024 sc1
buffer_load_dwordx4 a[84:87], v1, s[8:11], s41 offen offset:1024 sc1
buffer_load_dwordx4 a[148:151], v1, s[8:11], s42 offen offset:1024 sc1
buffer_load_dwordx4 a[24:27], v1, s[8:11], s40 offen offset:2048 sc1
buffer_load_dwordx4 a[88:91], v1, s[8:11], s41 offen offset:2048 sc1
buffer_load_dwordx4 a[152:155], v1, s[8:11], s42 offen offset:2048 sc1
buffer_load_dwordx4 a[28:31], v1, s[8:11], s40 offen offset:3072 sc1
buffer_load_dwordx4 a[92:95], v1, s[8:11], s41 offen offset:3072 sc1
buffer_load_dwordx4 a[156:159], v1, s[8:11], s42 offen offset:3072 sc1
s_add_u32 s40, s40, 4096
s_add_u32 s41, s41, 4096
s_add_u32 s42, s42, 4096
s_waitcnt vmcnt(24)
s_barrier
ds_read_b128 v[64:67], v2 offset:0
ds_read_b128 v[68:71], v2 offset:1024
ds_read_b128 v[72:75], v2 offset:16384
ds_read_b128 v[76:79], v2 offset:17408
ds_read_b128 v[80:83], v2 offset:2048
ds_read_b128 v[84:87], v2 offset:3072
s_waitcnt vmcnt(18) lgkmcnt(4)
v_mfma_f32_16x16x32_bf16 v[16:19], v[64:67], a[0:3], 0
ds_read_b128 v[88:91], v2 offset:18432
v_mfma_f32_16x16x32_bf16 v[16:19], v[68:71], a[4:7], v[16:19]
buffer_load_dwordx4 a[32:35], v1, s[8:11], s40 offen offset:0 sc1
v_mfma_f32_16x16x32_bf16 v[24:27], v[64:67], a[64:67], 0
buffer_load_dwordx4 a[96:99], v1, s[8:11], s41 offen offset:0 sc1
v_mfma_f32_16x16x32_bf16 v[24:27], v[68:71], a[68:71], v[24:27]
ds_read_b128 v[92:95], v2 offset:19456
v_mfma_f32_16x16x32_bf16 v[32:35], v[64:67], a[128:131], 0
s_waitcnt lgkmcnt(4)
buffer_load_dwordx4 a[160:163], v1, s[8:11], s42 offen offset:0 sc1
v_mfma_f32_16x16x32_bf16 v[32:35], v[68:71], a[132:135], v[32:35]
buffer_load_dwordx4 a[36:39], v1, s[8:11], s40 offen offset:1024 sc1
v_mfma_f32_16x16x32_bf16 v[20:23], v[72:75], a[0:3], 0
ds_read_b128 v[64:67], v2 offset:4096
v_mfma_f32_16x16x32_bf16 v[20:23], v[76:79], a[4:7], v[20:23]
buffer_load_dwordx4 a[100:103], v1, s[8:11], s41 offen offset:1024 sc1
v_mfma_f32_16x16x32_bf16 v[28:31], v[72:75], a[64:67], 0
buffer_load_dwordx4 a[164:167], v1, s[8:11], s42 offen offset:1024 sc1
v_mfma_f32_16x16x32_bf16 v[28:31], v[76:79], a[68:71], v[28:31]
ds_read_b128 v[68:71], v2 offset:5120
v_mfma_f32_16x16x32_bf16 v[36:39], v[72:75], a[128:131], 0
s_waitcnt lgkmcnt(4)
buffer_load_dwordx4 a[40:43], v1, s[8:11], s40 offen offset:2048 sc1
v_mfma_f32_16x16x32_bf16 v[36:39], v[76:79], a[132:135], v[36:39]
buffer_load_dwordx4 a[104:107], v1, s[8:11], s41 offen offset:2048 sc1
s_waitcnt vmcnt(20)
v_mfma_f32_16x16x32_bf16 v[16:19], v[80:83], a[8:11], v[16:19]
ds_read_b128 v[72:75], v2 offset:20480
v_mfma_f32_16x16x32_bf16 v[16:19], v[84:87], a[12:15], v[16:19]
buffer_load_dwordx4 a[168:171], v1, s[8:11], s42 offen offset:2048 sc1
v_mfma_f32_16x16x32_bf16 v[24:27], v[80:83], a[72:75], v[24:27]
buffer_load_dwordx4 a[44:47], v1, s[8:11], s40 offen offset:3072 sc1
v_mfma_f32_16x16x32_bf16 v[24:27], v[84:87], a[76:79], v[24:27]
ds_read_b128 v[76:79], v2 offset:21504
v_mfma_f32_16x16x32_bf16 v[32:35], v[80:83], a[136:139], v[32:35]
s_waitcnt lgkmcnt(4)
buffer_load_dwordx4 a[108:111], v1, s[8:11], s41 offen offset:3072 sc1
v_mfma_f32_16x16x32_bf16 v[32:35], v[84:87], a[140:143], v[32:35]
buffer_load_dwordx4 a[172:175], v1, s[8:11], s42 offen offset:3072 sc1
v_mfma_f32_16x16x32_bf16 v[20:23], v[88:91], a[8:11], v[20:23]
ds_read_b128 v[80:83], v2 offset:6144
v_mfma_f32_16x16x32_bf16 v[20:23], v[92:95], a[12:15], v[20:23]
s_add_u32 s40, s40, 4096
s_add_u32 s41, s41, 4096
s_add_u32 s42, s42, 4096
buffer_load_dwordx4 a[48:51], v1, s[8:11], s40 offen offset:0 sc1
v_mfma_f32_16x16x32_bf16 v[28:31], v[88:91], a[72:75], v[28:31]
buffer_load_dwordx4 a[112:115], v1, s[8:11], s41 offen offset:0 sc1
v_mfma_f32_16x16x32_bf16 v[28:31], v[92:95], a[76:79], v[28:31]
ds_read_b128 v[84:87], v2 offset:7168
v_mfma_f32_16x16x32_bf16 v[36:39], v[88:91], a[136:139], v[36:39]
s_waitcnt lgkmcnt(4)
buffer_load_dwordx4 a[176:179], v1, s[8:11], s42 offen offset:0 sc1
v_mfma_f32_16x16x32_bf16 v[36:39], v[92:95], a[140:143], v[36:39]
buffer_load_dwordx4 a[52:55], v1, s[8:11], s40 offen offset:1024 sc1
s_waitcnt vmcnt(22)
v_mfma_f32_16x16x32_bf16 v[16:19], v[64:67], a[16:19], v[16:19]
ds_read_b128 v[88:91], v2 offset:22528
v_mfma_f32_16x16x32_bf16 v[16:19], v[68:71], a[20:23], v[16:19]
buffer_load_dwordx4 a[116:119], v1, s[8:11], s41 offen offset:1024 sc1
v_mfma_f32_16x16x32_bf16 v[24:27], v[64:67], a[80:83], v[24:27]
buffer_load_dwordx4 a[180:183], v1, s[8:11], s42 offen offset:1024 sc1
v_mfma_f32_16x16x32_bf16 v[24:27], v[68:71], a[84:87], v[24:27]
ds_read_b128 v[92:95], v2 offset:23552
v_mfma_f32_16x16x32_bf16 v[32:35], v[64:67], a[144:147], v[32:35]
s_waitcnt lgkmcnt(4)
buffer_load_dwordx4 a[56:59], v1, s[8:11], s40 offen offset:2048 sc1
v_mfma_f32_16x16x32_bf16 v[32:35], v[68:71], a[148:151], v[32:35]
buffer_load_dwordx4 a[120:123], v1, s[8:11], s41 offen offset:2048 sc1
v_mfma_f32_16x16x32_bf16 v[20:23], v[72:75], a[16:19], v[20:23]
ds_read_b128 v[64:67], v2 offset:8192
v_mfma_f32_16x16x32_bf16 v[20:23], v[76:79], a[20:23], v[20:23]
buffer_load_dwordx4 a[184:187], v1, s[8:11], s42 offen offset:2048 sc1
v_mfma_f32_16x16x32_bf16 v[28:31], v[72:75], a[80:83], v[28:31]
buffer_load_dwordx4 a[60:63], v1, s[8:11], s40 offen offset:3072 sc1
v_mfma_f32_16x16x32_bf16 v[28:31], v[76:79], a[84:87], v[28:31]
ds_read_b128 v[68:71], v2 offset:9216
v_mfma_f32_16x16x32_bf16 v[36:39], v[72:75], a[144:147], v[36:39]
s_waitcnt lgkmcnt(4)
buffer_load_dwordx4 a[124:127], v1, s[8:11], s41 offen offset:3072 sc1
v_mfma_f32_16x16x32_bf16 v[36:39], v[76:79], a[148:151], v[36:39]
buffer_load_dwordx4 a[188:191], v1, s[8:11], s42 offen offset:3072 sc1
s_waitcnt vmcnt(24)
v_mfma_f32_16x16x32_bf16 v[16:19], v[80:83], a[24:27], v[16:19]
ds_read_b128 v[72:75], v2 offset:24576
v_mfma_f32_16x16x32_bf16 v[16:19], v[84:87], a[28:31], v[16:19]
s_add_u32 s40, s40, 4096
s_add_u32 s41, s41, 4096
s_add_u32 s42, s42, 4096
s_add_u32 m0, s30, 0
s_nop 0
buffer_load_dwordx4 v6, s[12:15], s23 offen offset:0 lds
v_mfma_f32_16x16x32_bf16 v[24:27], v[80:83], a[88:91], v[24:27]
s_add_u32 m0, s30, 960
s_nop 0
buffer_load_dwordx4 v6, s[12:15], s23 offen offset:64 lds
v_mfma_f32_16x16x32_bf16 v[24:27], v[84:87], a[92:95], v[24:27]
ds_read_b128 v[76:79], v2 offset:25600
v_mfma_f32_16x16x32_bf16 v[32:35], v[80:83], a[152:155], v[32:35]
s_waitcnt lgkmcnt(4)
s_add_u32 m0, s30, 1920
s_nop 0
buffer_load_dwordx4 v6, s[12:15], s23 offen offset:128 lds
v_mfma_f32_16x16x32_bf16 v[32:35], v[84:87], a[156:159], v[32:35]
s_add_u32 m0, s30, 2880
s_nop 0
buffer_load_dwordx4 v6, s[12:15], s23 offen offset:192 lds
v_mfma_f32_16x16x32_bf16 v[20:23], v[88:91], a[24:27], v[20:23]
ds_read_b128 v[80:83], v2 offset:10240
v_mfma_f32_16x16x32_bf16 v[20:23], v[92:95], a[28:31], v[20:23]
s_add_u32 m0, s30, 16384
s_nop 0
buffer_load_dwordx4 v6, s[12:15], s24 offen offset:0 lds
v_mfma_f32_16x16x32_bf16 v[28:31], v[88:91], a[88:91], v[28:31]
s_add_u32 m0, s30, 17344
s_nop 0
buffer_load_dwordx4 v6, s[12:15], s24 offen offset:64 lds
v_mfma_f32_16x16x32_bf16 v[28:31], v[92:95], a[92:95], v[28:31]
ds_read_b128 v[84:87], v2 offset:11264
v_mfma_f32_16x16x32_bf16 v[36:39], v[88:91], a[152:155], v[36:39]
s_waitcnt lgkmcnt(4)
s_add_u32 m0, s30, 18304
s_nop 0
buffer_load_dwordx4 v6, s[12:15], s24 offen offset:128 lds
v_mfma_f32_16x16x32_bf16 v[36:39], v[92:95], a[156:159], v[36:39]
s_add_u32 m0, s30, 19264
s_nop 0
buffer_load_dwordx4 v6, s[12:15], s24 offen offset:192 lds
s_waitcnt vmcnt(26)
v_mfma_f32_16x16x32_bf16 v[16:19], v[64:67], a[32:35], v[16:19]
ds_read_b128 v[88:91], v2 offset:26624
v_mfma_f32_16x16x32_bf16 v[16:19], v[68:71], a[36:39], v[16:19]
s_add_u32 s23, s23, 32768
s_add_u32 s24, s24, 32768
s_add_u32 s30, s30, 32768
s_and_b32 s30, s30, 0x1ffff
s_add_u32 m0, s30, 0
s_nop 0
buffer_load_dwordx4 v6, s[12:15], s23 offen offset:0 lds
v_mfma_f32_16x16x32_bf16 v[24:27], v[64:67], a[96:99], v[24:27]
s_add_u32 m0, s30, 960
s_nop 0
buffer_load_dwordx4 v6, s[12:15], s23 offen offset:64 lds
v_mfma_f32_16x16x32_bf16 v[24:27], v[68:71], a[100:103], v[24:27]
ds_read_b128 v[92:95], v2 offset:27648
v_mfma_f32_16x16x32_bf16 v[32:35], v[64:67], a[160:163], v[32:35]
s_waitcnt lgkmcnt(4)
s_add_u32 m0, s30, 1920
s_nop 0
buffer_load_dwordx4 v6, s[12:15], s23 offen offset:128 lds
v_mfma_f32_16x16x32_bf16 v[32:35], v[68:71], a[164:167], v[32:35]
s_add_u32 m0, s30, 2880
s_nop 0
buffer_load_dwordx4 v6, s[12:15], s23 offen offset:192 lds
v_mfma_f32_16x16x32_bf16 v[20:23], v[72:75], a[32:35], v[20:23]
ds_read_b128 v[64:67], v2 offset:12288
v_mfma_f32_16x16x32_bf16 v[20:23], v[76:79], a[36:39], v[20:23]
s_add_u32 m0, s30, 16384
s_nop 0
buffer_load_dwordx4 v6, s[12:15], s24 offen offset:0 lds
v_mfma_f32_16x16x32_bf16 v[28:31], v[72:75], a[96:99], v[28:31]
s_add_u32 m0, s30, 17344
s_nop 0
buffer_load_dwordx4 v6, s[12:15], s24 offen offset:64 lds
v_mfma_f32_16x16x32_bf16 v[28:31], v[76:79], a[100:103], v[28:31]
ds_read_b128 v[68:71], v2 offset:13312
v_mfma_f32_16x16x32_bf16 v[36:39], v[72:75], a[160:163], v[36:39]
s_waitcnt lgkmcnt(4)
s_add_u32 m0, s30, 18304
s_nop 0
buffer_load_dwordx4 v6, s[12:15], s24 offen offset:128 lds
v_mfma_f32_16x16x32_bf16 v[36:39], v[76:79], a[164:167], v[36:39]
s_add_u32 m0, s30, 19264
s_nop 0
buffer_load_dwordx4 v6, s[12:15], s24 offen offset:192 lds
s_waitcnt vmcnt(28)
v_mfma_f32_16x16x32_bf16 v[16:19], v[80:83], a[40:43], v[16:19]
ds_read_b128 v[72:75], v2 offset:28672
v_mfma_f32_16x16x32_bf16 v[16:19], v[84:87], a[44:47], v[16:19]
s_add_u32 s23, s23, 32768
s_add_u32 s24, s24, 32768
s_add_u32 s30, s30, 32768
s_and_b32 s30, s30, 0x1ffff
v_mfma_f32_16x16x32_bf16 v[24:27], v[80:83], a[104:107], v[24:27]
v_mfma_f32_16x16x32_bf16 v[24:27], v[84:87], a[108:111], v[24:27]
ds_read_b128 v[76:79], v2 offset:29696
v_mfma_f32_16x16x32_bf16 v[32:35], v[80:83], a[168:171], v[32:35]
s_waitcnt lgkmcnt(4)
v_mfma_f32_16x16x32_bf16 v[32:35], v[84:87], a[172:175], v[32:35]
v_mfma_f32_16x16x32_bf16 v[20:23], v[88:91], a[40:43], v[20:23]
ds_read_b128 v[80:83], v2 offset:14336
v_mfma_f32_16x16x32_bf16 v[20:23], v[92:95], a[44:47], v[20:23]
v_mfma_f32_16x16x32_bf16 v[28:31], v[88:91], a[104:107], v[28:31]
v_mfma_f32_16x16x32_bf16 v[28:31], v[92:95], a[108:111], v[28:31]
ds_read_b128 v[84:87], v2 offset:15360
v_mfma_f32_16x16x32_bf16 v[36:39], v[88:91], a[168:171], v[36:39]
ds_read_b128 v[88:91], v2 offset:30720
s_waitcnt lgkmcnt(5)
v_mfma_f32_16x16x32_bf16 v[36:39], v[92:95], a[172:175], v[36:39]
ds_read_b128 v[92:95], v2 offset:31744
s_waitcnt vmcnt(22)
v_mfma_f32_16x16x32_bf16 v[16:19], v[64:67], a[48:51], v[16:19]
v_mfma_f32_16x16x32_bf16 v[16:19], v[68:71], a[52:55], v[16:19]
v_mfma_f32_16x16x32_bf16 v[24:27], v[64:67], a[112:115], v[24:27]
v_mfma_f32_16x16x32_bf16 v[24:27], v[68:71], a[116:119], v[24:27]
v_mfma_f32_16x16x32_bf16 v[32:35], v[64:67], a[176:179], v[32:35]
s_waitcnt lgkmcnt(4)
v_mfma_f32_16x16x32_bf16 v[32:35], v[68:71], a[180:183], v[32:35]
s_waitcnt vmcnt(8)
s_barrier
v_mfma_f32_16x16x32_bf16 v[20:23], v[72:75], a[48:51], v[20:23]
ds_read_b128 v[64:67], v2 offset:32768
v_mfma_f32_16x16x32_bf16 v[20:23], v[76:79], a[52:55], v[20:23]
v_mfma_f32_16x16x32_bf16 v[28:31], v[72:75], a[112:115], v[28:31]
v_mfma_f32_16x16x32_bf16 v[28:31], v[76:79], a[116:119], v[28:31]
ds_read_b128 v[68:71], v2 offset:33792
v_mfma_f32_16x16x32_bf16 v[36:39], v[72:75], a[176:179], v[36:39]
s_waitcnt lgkmcnt(4)
v_mfma_f32_16x16x32_bf16 v[36:39], v[76:79], a[180:183], v[36:39]
v_mfma_f32_16x16x32_bf16 v[16:19], v[80:83], a[56:59], v[16:19]
ds_read_b128 v[72:75], v2 offset:49152
v_mfma_f32_16x16x32_bf16 v[16:19], v[84:87], a[60:63], v[16:19]
v_mfma_f32_16x16x32_bf16 v[24:27], v[80:83], a[120:123], v[24:27]
v_mfma_f32_16x16x32_bf16 v[24:27], v[84:87], a[124:127], v[24:27]
ds_read_b128 v[76:79], v2 offset:50176
v_mfma_f32_16x16x32_bf16 v[32:35], v[80:83], a[184:187], v[32:35]
s_waitcnt lgkmcnt(4)
v_mfma_f32_16x16x32_bf16 v[32:35], v[84:87], a[188:191], v[32:35]
v_mfma_f32_16x16x32_bf16 v[20:23], v[88:91], a[56:59], v[20:23]
ds_read_b128 v[80:83], v2 offset:34816
v_mfma_f32_16x16x32_bf16 v[20:23], v[92:95], a[60:63], v[20:23]
v_mfma_f32_16x16x32_bf16 v[28:31], v[88:91], a[120:123], v[28:31]
v_mfma_f32_16x16x32_bf16 v[28:31], v[92:95], a[124:127], v[28:31]
ds_read_b128 v[84:87], v2 offset:35840
v_mfma_f32_16x16x32_bf16 v[36:39], v[88:91], a[184:187], v[36:39]
s_waitcnt lgkmcnt(4)
v_mfma_f32_16x16x32_bf16 v[36:39], v[92:95], a[188:191], v[36:39]
L_sp_l:
v_mfma_f32_16x16x32_bf16 v[40:43], v[64:67], a[0:3], 0
ds_read_b128 v[88:91], v2 offset:51200
v_mfma_f32_16x16x32_bf16 v[40:43], v[68:71], a[4:7], v[40:43]
s_add_u32 m0, s30, 0
v_mfma_f32_16x16x32_bf16 v[48:51], v[64:67], a[64:67], 0
buffer_load_dwordx4 v6, s[12:15], s23 offen offset:0 lds
v_mfma_f32_16x16x32_bf16 v[48:51], v[68:71], a[68:71], v[48:51]
ds_read_b128 v[92:95], v2 offset:52224
v_mfma_f32_16x16x32_bf16 v[56:59], v[64:67], a[128:131], 0
s_waitcnt lgkmcnt(4)
v_mfma_f32_16x16x32_bf16 v[56:59], v[68:71], a[132:135], v[56:59]
v_mfma_f32_16x16x32_bf16 v[44:47], v[72:75], a[0:3], 0
ds_read_b128 v[64:67], v2 offset:36864
v_mfma_f32_16x16x32_bf16 v[44:47], v[76:79], a[4:7], v[44:47]
v_mfma_f32_16x16x32_bf16 v[52:55], v[72:75], a[64:67], 0
v_mfma_f32_16x16x32_bf16 v[52:55], v[76:79], a[68:71], v[52:55]
ds_read_b128 v[68:71], v2 offset:37888
v_mfma_f32_16x16x32_bf16 v[60:63], v[72:75], a[128:131], 0
s_waitcnt lgkmcnt(4)
s_add_u32 m0, s30, 960
v_mfma_f32_16x16x32_bf16 v[60:63], v[76:79], a[132:135], v[60:63]
buffer_load_dwordx4 v6, s[12:15], s23 offen offset:64 lds
v_mfma_f32_16x16x32_bf16 v[40:43], v[80:83], a[8:11], v[40:43]
ds_read_b128 v[72:75], v2 offset:53248
v_mfma_f32_16x16x32_bf16 v[40:43], v[84:87], a[12:15], v[40:43]
v_cvt_pk_bf16_f32 v96, v16, v17
v_cvt_pk_bf16_f32 v97, v18, v19
v_mfma_f32_16x16x32_bf16 v[48:51], v[80:83], a[72:75], v[48:51]
v_cvt_pk_bf16_f32 v98, v20, v21
v_cvt_pk_bf16_f32 v99, v22, v23
v_mfma_f32_16x16x32_bf16 v[48:51], v[84:87], a[76:79], v[48:51]
ds_read_b128 v[76:79], v2 offset:54272
v_mfma_f32_16x16x32_bf16 v[56:59], v[80:83], a[136:139], v[56:59]
s_waitcnt lgkmcnt(4)
v_mfma_f32_16x16x32_bf16 v[56:59], v[84:87], a[140:143], v[56:59]
buffer_store_dwordx4 v[96:99], v1, s[8:11], s26 offen sc1
v_mfma_f32_16x16x32_bf16 v[44:47], v[88:91], a[8:11], v[44:47]
ds_read_b128 v[80:83], v2 offset:38912
s_add_u32 s26, s26, s44
v_mfma_f32_16x16x32_bf16 v[44:47], v[92:95], a[12:15], v[44:47]
s_add_u32 m0, s30, 1920
v_mfma_f32_16x16x32_bf16 v[52:55], v[88:91], a[72:75], v[52:55]
buffer_load_dwordx4 v6, s[12:15], s23 offen offset:128 lds
v_mfma_f32_16x16x32_bf16 v[52:55], v[92:95], a[76:79], v[52:55]
ds_read_b128 v[84:87], v2 offset:39936
v_mfma_f32_16x16x32_bf16 v[60:63], v[88:91], a[136:139], v[60:63]
s_waitcnt lgkmcnt(4)
v_mfma_f32_16x16x32_bf16 v[60:63], v[92:95], a[140:143], v[60:63]
v_mfma_f32_16x16x32_bf16 v[40:43], v[64:67], a[16:19], v[40:43]
ds_read_b128 v[88:91], v2 offset:55296
v_mfma_f32_16x16x32_bf16 v[40:43], v[68:71], a[20:23], v[40:43]
v_mfma_f32_16x16x32_bf16 v[48:51], v[64:67], a[80:83], v[48:51]
v_mfma_f32_16x16x32_bf16 v[48:51], v[68:71], a[84:87], v[48:51]
ds_read_b128 v[92:95], v2 offset:56320
v_mfma_f32_16x16x32_bf16 v[56:59], v[64:67], a[144:147], v[56:59]
s_waitcnt lgkmcnt(4)
s_add_u32 m0, s30, 2880
v_mfma_f32_16x16x32_bf16 v[56:59], v[68:71], a[148:151], v[56:59]
buffer_load_dwordx4 v6, s[12:15], s23 offen offset:192 lds
v_mfma_f32_16x16x32_bf16 v[44:47], v[72:75], a[16:19], v[44:47]
ds_read_b128 v[64:67], v2 offset:40960
v_mfma_f32_16x16x32_bf16 v[44:47], v[76:79], a[20:23], v[44:47]
v_cvt_pk_bf16_f32 v100, v24, v25
v_cvt_pk_bf16_f32 v101, v26, v27
v_mfma_f32_16x16x32_bf16 v[52:55], v[72:75], a[80:83], v[52:55]
v_cvt_pk_bf16_f32 v102, v28, v29
v_cvt_pk_bf16_f32 v103, v30, v31
v_mfma_f32_16x16x32_bf16 v[52:55], v[76:79], a[84:87], v[52:55]
ds_read_b128 v[68:71], v2 offset:41984
v_mfma_f32_16x16x32_bf16 v[60:63], v[72:75], a[144:147], v[60:63]
s_waitcnt lgkmcnt(4)
v_mfma_f32_16x16x32_bf16 v[60:63], v[76:79], a[148:151], v[60:63]
buffer_store_dwordx4 v[100:103], v1, s[8:11], s27 offen sc1
v_mfma_f32_16x16x32_bf16 v[40:43], v[80:83], a[24:27], v[40:43]
ds_read_b128 v[72:75], v2 offset:57344
s_add_u32 s27, s27, s44
v_mfma_f32_16x16x32_bf16 v[40:43], v[84:87], a[28:31], v[40:43]
s_add_u32 m0, s30, 16384
v_mfma_f32_16x16x32_bf16 v[48:51], v[80:83], a[88:91], v[48:51]
buffer_load_dwordx4 v6, s[12:15], s24 offen offset:0 lds
v_mfma_f32_16x16x32_bf16 v[48:51], v[84:87], a[92:95], v[48:51]
ds_read_b128 v[76:79], v2 offset:58368
v_mfma_f32_16x16x32_bf16 v[56:59], v[80:83], a[152:155], v[56:59]
s_waitcnt lgkmcnt(4)
v_mfma_f32_16x16x32_bf16 v[56:59], v[84:87], a[156:159], v[56:59]
v_mfma_f32_16x16x32_bf16 v[44:47], v[88:91], a[24:27], v[44:47]
ds_read_b128 v[80:83], v2 offset:43008
v_mfma_f32_16x16x32_bf16 v[44:47], v[92:95], a[28:31], v[44:47]
v_mfma_f32_16x16x32_bf16 v[52:55], v[88:91], a[88:91], v[52:55]
v_mfma_f32_16x16x32_bf16 v[52:55], v[92:95], a[92:95], v[52:55]
ds_read_b128 v[84:87], v2 offset:44032
v_mfma_f32_16x16x32_bf16 v[60:63], v[88:91], a[152:155], v[60:63]
s_waitcnt lgkmcnt(4)
s_add_u32 m0, s30, 17344
v_mfma_f32_16x16x32_bf16 v[60:63], v[92:95], a[156:159], v[60:63]
buffer_load_dwordx4 v6, s[12:15], s24 offen offset:64 lds
v_mfma_f32_16x16x32_bf16 v[40:43], v[64:67], a[32:35], v[40:43]
ds_read_b128 v[88:91], v2 offset:59392
v_mfma_f32_16x16x32_bf16 v[40:43], v[68:71], a[36:39], v[40:43]
v_cvt_pk_bf16_f32 v104, v32, v33
v_cvt_pk_bf16_f32 v105, v34, v35
v_mfma_f32_16x16x32_bf16 v[48:51], v[64:67], a[96:99], v[48:51]
v_cvt_pk_bf16_f32 v106, v36, v37
v_cvt_pk_bf16_f32 v107, v38, v39
v_mfma_f32_16x16x32_bf16 v[48:51], v[68:71], a[100:103], v[48:51]
ds_read_b128 v[92:95], v2 offset:60416
v_mfma_f32_16x16x32_bf16 v[56:59], v[64:67], a[160:163], v[56:59]
s_waitcnt lgkmcnt(4)
v_mfma_f32_16x16x32_bf16 v[56:59], v[68:71], a[164:167], v[56:59]
buffer_store_dwordx4 v[104:107], v1, s[8:11], s28 offen sc1
v_mfma_f32_16x16x32_bf16 v[44:47], v[72:75], a[32:35], v[44:47]
ds_read_b128 v[64:67], v2 offset:45056
s_add_u32 s28, s28, s44
v_mfma_f32_16x16x32_bf16 v[44:47], v[76:79], a[36:39], v[44:47]
s_add_u32 m0, s30, 18304
v_mfma_f32_16x16x32_bf16 v[52:55], v[72:75], a[96:99], v[52:55]
buffer_load_dwordx4 v6, s[12:15], s24 offen offset:128 lds
v_mfma_f32_16x16x32_bf16 v[52:55], v[76:79], a[100:103], v[52:55]
ds_read_b128 v[68:71], v2 offset:46080
v_mfma_f32_16x16x32_bf16 v[60:63], v[72:75], a[160:163], v[60:63]
s_waitcnt lgkmcnt(4)
v_mfma_f32_16x16x32_bf16 v[60:63], v[76:79], a[164:167], v[60:63]
v_mfma_f32_16x16x32_bf16 v[40:43], v[80:83], a[40:43], v[40:43]
ds_read_b128 v[72:75], v2 offset:61440
v_mfma_f32_16x16x32_bf16 v[40:43], v[84:87], a[44:47], v[40:43]
v_mfma_f32_16x16x32_bf16 v[48:51], v[80:83], a[104:107], v[48:51]
v_mfma_f32_16x16x32_bf16 v[48:51], v[84:87], a[108:111], v[48:51]
ds_read_b128 v[76:79], v2 offset:62464
v_mfma_f32_16x16x32_bf16 v[56:59], v[80:83], a[168:171], v[56:59]
s_waitcnt lgkmcnt(4)
s_add_u32 m0, s30, 19264
v_mfma_f32_16x16x32_bf16 v[56:59], v[84:87], a[172:175], v[56:59]
buffer_load_dwordx4 v6, s[12:15], s24 offen offset:192 lds
v_mfma_f32_16x16x32_bf16 v[44:47], v[88:91], a[40:43], v[44:47]
ds_read_b128 v[80:83], v2 offset:47104
v_mfma_f32_16x16x32_bf16 v[44:47], v[92:95], a[44:47], v[44:47]
s_add_u32 s23, s23, 32768
s_add_u32 s24, s24, 32768
v_mfma_f32_16x16x32_bf16 v[52:55], v[88:91], a[104:107], v[52:55]
s_add_u32 s30, s30, 32768
s_and_b32 s30, s30, 0x1ffff
v_mfma_f32_16x16x32_bf16 v[52:55], v[92:95], a[108:111], v[52:55]
ds_read_b128 v[84:87], v2 offset:48128
v_mfma_f32_16x16x32_bf16 v[60:63], v[88:91], a[168:171], v[60:63]
ds_read_b128 v[88:91], v2 offset:63488
s_waitcnt lgkmcnt(5)
v_mfma_f32_16x16x32_bf16 v[60:63], v[92:95], a[172:175], v[60:63]
ds_read_b128 v[92:95], v2 offset:64512
v_mfma_f32_16x16x32_bf16 v[40:43], v[64:67], a[48:51], v[40:43]
v_mfma_f32_16x16x32_bf16 v[40:43], v[68:71], a[52:55], v[40:43]
v_mfma_f32_16x16x32_bf16 v[48:51], v[64:67], a[112:115], v[48:51]
v_mfma_f32_16x16x32_bf16 v[48:51], v[68:71], a[116:119], v[48:51]
v_mfma_f32_16x16x32_bf16 v[56:59], v[64:67], a[176:179], v[56:59]
v_xor_b32 v2, 0x10000, v2
s_waitcnt lgkmcnt(4)
v_mfma_f32_16x16x32_bf16 v[56:59], v[68:71], a[180:183], v[56:59]
s_waitcnt vmcnt(11)
s_barrier
v_mfma_f32_16x16x32_bf16 v[44:47], v[72:75], a[48:51], v[44:47]
ds_read_b128 v[64:67], v2 offset:0
v_mfma_f32_16x16x32_bf16 v[44:47], v[76:79], a[52:55], v[44:47]
v_mfma_f32_16x16x32_bf16 v[52:55], v[72:75], a[112:115], v[52:55]
v_mfma_f32_16x16x32_bf16 v[52:55], v[76:79], a[116:119], v[52:55]
ds_read_b128 v[68:71], v2 offset:1024
v_mfma_f32_16x16x32_bf16 v[60:63], v[72:75], a[176:179], v[60:63]
s_waitcnt lgkmcnt(4)
v_mfma_f32_16x16x32_bf16 v[60:63], v[76:79], a[180:183], v[60:63]
v_mfma_f32_16x16x32_bf16 v[40:43], v[80:83], a[56:59], v[40:43]
ds_read_b128 v[72:75], v2 offset:16384
v_mfma_f32_16x16x32_bf16 v[40:43], v[84:87], a[60:63], v[40:43]
v_mfma_f32_16x16x32_bf16 v[48:51], v[80:83], a[120:123], v[48:51]
v_mfma_f32_16x16x32_bf16 v[48:51], v[84:87], a[124:127], v[48:51]
ds_read_b128 v[76:79], v2 offset:17408
v_mfma_f32_16x16x32_bf16 v[56:59], v[80:83], a[184:187], v[56:59]
s_waitcnt lgkmcnt(4)
v_mfma_f32_16x16x32_bf16 v[56:59], v[84:87], a[188:191], v[56:59]
v_mfma_f32_16x16x32_bf16 v[44:47], v[88:91], a[56:59], v[44:47]
ds_read_b128 v[80:83], v2 offset:2048
v_mfma_f32_16x16x32_bf16 v[44:47], v[92:95], a[60:63], v[44:47]
v_mfma_f32_16x16x32_bf16 v[52:55], v[88:91], a[120:123], v[52:55]
v_mfma_f32_16x16x32_bf16 v[52:55], v[92:95], a[124:127], v[52:55]
ds_read_b128 v[84:87], v2 offset:3072
v_mfma_f32_16x16x32_bf16 v[60:63], v[88:91], a[184:187], v[60:63]
s_waitcnt lgkmcnt(4)
v_mfma_f32_16x16x32_bf16 v[60:63], v[92:95], a[188:191], v[60:63]
s_add_u32 s22, s22, 1
s_cmp_eq_u32 s22, 8
s_cbranch_scc1 L_sp_f
v_mfma_f32_16x16x32_bf16 v[16:19], v[64:67], a[0:3], 0
ds_read_b128 v[88:91], v2 offset:18432
v_mfma_f32_16x16x32_bf16 v[16:19], v[68:71], a[4:7], v[16:19]
s_add_u32 m0, s30, 0
v_mfma_f32_16x16x32_bf16 v[24:27], v[64:67], a[64:67], 0
buffer_load_dwordx4 v6, s[12:15], s23 offen offset:0 lds
v_mfma_f32_16x16x32_bf16 v[24:27], v[68:71], a[68:71], v[24:27]
ds_read_b128 v[92:95], v2 offset:19456
v_mfma_f32_16x16x32_bf16 v[32:35], v[64:67], a[128:131], 0
s_waitcnt lgkmcnt(4)
v_mfma_f32_16x16x32_bf16 v[32:35], v[68:71], a[132:135], v[32:35]
v_mfma_f32_16x16x32_bf16 v[20:23], v[72:75], a[0:3], 0
ds_read_b128 v[64:67], v2 offset:4096
v_mfma_f32_16x16x32_bf16 v[20:23], v[76:79], a[4:7], v[20:23]
v_mfma_f32_16x16x32_bf16 v[28:31], v[72:75], a[64:67], 0
v_mfma_f32_16x16x32_bf16 v[28:31], v[76:79], a[68:71], v[28:31]
ds_read_b128 v[68:71], v2 offset:5120
v_mfma_f32_16x16x32_bf16 v[36:39], v[72:75], a[128:131], 0
s_waitcnt lgkmcnt(4)
s_add_u32 m0, s30, 960
v_mfma_f32_16x16x32_bf16 v[36:39], v[76:79], a[132:135], v[36:39]
buffer_load_dwordx4 v6, s[12:15], s23 offen offset:64 lds
v_mfma_f32_16x16x32_bf16 v[16:19], v[80:83], a[8:11], v[16:19]
ds_read_b128 v[72:75], v2 offset:20480
v_mfma_f32_16x16x32_bf16 v[16:19], v[84:87], a[12:15], v[16:19]
v_cvt_pk_bf16_f32 v96, v40, v41
v_cvt_pk_bf16_f32 v97, v42, v43
v_mfma_f32_16x16x32_bf16 v[24:27], v[80:83], a[72:75], v[24:27]
v_cvt_pk_bf16_f32 v98, v44, v45
v_cvt_pk_bf16_f32 v99, v46, v47
v_mfma_f32_16x16x32_bf16 v[24:27], v[84:87], a[76:79], v[24:27]
ds_read_b128 v[76:79], v2 offset:21504
v_mfma_f32_16x16x32_bf16 v[32:35], v[80:83], a[136:139], v[32:35]
s_waitcnt lgkmcnt(4)
v_mfma_f32_16x16x32_bf16 v[32:35], v[84:87], a[140:143], v[32:35]
buffer_store_dwordx4 v[96:99], v1, s[8:11], s26 offen sc1
v_mfma_f32_16x16x32_bf16 v[20:23], v[88:91], a[8:11], v[20:23]
ds_read_b128 v[80:83], v2 offset:6144
s_add_u32 s26, s26, s45
v_mfma_f32_16x16x32_bf16 v[20:23], v[92:95], a[12:15], v[20:23]
s_add_u32 m0, s30, 1920
v_mfma_f32_16x16x32_bf16 v[28:31], v[88:91], a[72:75], v[28:31]
buffer_load_dwordx4 v6, s[12:15], s23 offen offset:128 lds
v_mfma_f32_16x16x32_bf16 v[28:31], v[92:95], a[76:79], v[28:31]
ds_read_b128 v[84:87], v2 offset:7168
v_mfma_f32_16x16x32_bf16 v[36:39], v[88:91], a[136:139], v[36:39]
s_waitcnt lgkmcnt(4)
v_mfma_f32_16x16x32_bf16 v[36:39], v[92:95], a[140:143], v[36:39]
v_mfma_f32_16x16x32_bf16 v[16:19], v[64:67], a[16:19], v[16:19]
ds_read_b128 v[88:91], v2 offset:22528
v_mfma_f32_16x16x32_bf16 v[16:19], v[68:71], a[20:23], v[16:19]
v_mfma_f32_16x16x32_bf16 v[24:27], v[64:67], a[80:83], v[24:27]
v_mfma_f32_16x16x32_bf16 v[24:27], v[68:71], a[84:87], v[24:27]
ds_read_b128 v[92:95], v2 offset:23552
v_mfma_f32_16x16x32_bf16 v[32:35], v[64:67], a[144:147], v[32:35]
s_waitcnt lgkmcnt(4)
s_add_u32 m0, s30, 2880
v_mfma_f32_16x16x32_bf16 v[32:35], v[68:71], a[148:151], v[32:35]
buffer_load_dwordx4 v6, s[12:15], s23 offen offset:192 lds
v_mfma_f32_16x16x32_bf16 v[20:23], v[72:75], a[16:19], v[20:23]
ds_read_b128 v[64:67], v2 offset:8192
v_mfma_f32_16x16x32_bf16 v[20:23], v[76:79], a[20:23], v[20:23]
v_cvt_pk_bf16_f32 v100, v48, v49
v_cvt_pk_bf16_f32 v101, v50, v51
v_mfma_f32_16x16x32_bf16 v[28:31], v[72:75], a[80:83], v[28:31]
v_cvt_pk_bf16_f32 v102, v52, v53
v_cvt_pk_bf16_f32 v103, v54, v55
v_mfma_f32_16x16x32_bf16 v[28:31], v[76:79], a[84:87], v[28:31]
ds_read_b128 v[68:71], v2 offset:9216
v_mfma_f32_16x16x32_bf16 v[36:39], v[72:75], a[144:147], v[36:39]
s_waitcnt lgkmcnt(4)
v_mfma_f32_16x16x32_bf16 v[36:39], v[76:79], a[148:151], v[36:39]
buffer_store_dwordx4 v[100:103], v1, s[8:11], s27 offen sc1
v_mfma_f32_16x16x32_bf16 v[16:19], v[80:83], a[24:27], v[16:19]
ds_read_b128 v[72:75], v2 offset:24576
s_add_u32 s27, s27, s45
v_mfma_f32_16x16x32_bf16 v[16:19], v[84:87], a[28:31], v[16:19]
s_add_u32 m0, s30, 16384
v_mfma_f32_16x16x32_bf16 v[24:27], v[80:83], a[88:91], v[24:27]
buffer_load_dwordx4 v6, s[12:15], s24 offen offset:0 lds
v_mfma_f32_16x16x32_bf16 v[24:27], v[84:87], a[92:95], v[24:27]
ds_read_b128 v[76:79], v2 offset:25600
v_mfma_f32_16x16x32_bf16 v[32:35], v[80:83], a[152:155], v[32:35]
s_waitcnt lgkmcnt(4)
v_mfma_f32_16x16x32_bf16 v[32:35], v[84:87], a[156:159], v[32:35]
v_mfma_f32_16x16x32_bf16 v[20:23], v[88:91], a[24:27], v[20:23]
ds_read_b128 v[80:83], v2 offset:10240
v_mfma_f32_16x16x32_bf16 v[20:23], v[92:95], a[28:31], v[20:23]
v_mfma_f32_16x16x32_bf16 v[28:31], v[88:91], a[88:91], v[28:31]
v_mfma_f32_16x16x32_bf16 v[28:31], v[92:95], a[92:95], v[28:31]
ds_read_b128 v[84:87], v2 offset:11264
v_mfma_f32_16x16x32_bf16 v[36:39], v[88:91], a[152:155], v[36:39]
s_waitcnt lgkmcnt(4)
s_add_u32 m0, s30, 17344
v_mfma_f32_16x16x32_bf16 v[36:39], v[92:95], a[156:159], v[36:39]
buffer_load_dwordx4 v6, s[12:15], s24 offen offset:64 lds
v_mfma_f32_16x16x32_bf16 v[16:19], v[64:67], a[32:35], v[16:19]
ds_read_b128 v[88:91], v2 offset:26624
v_mfma_f32_16x16x32_bf16 v[16:19], v[68:71], a[36:39], v[16:19]
v_cvt_pk_bf16_f32 v104, v56, v57
v_cvt_pk_bf16_f32 v105, v58, v59
v_mfma_f32_16x16x32_bf16 v[24:27], v[64:67], a[96:99], v[24:27]
v_cvt_pk_bf16_f32 v106, v60, v61
v_cvt_pk_bf16_f32 v107, v62, v63
v_mfma_f32_16x16x32_bf16 v[24:27], v[68:71], a[100:103], v[24:27]
ds_read_b128 v[92:95], v2 offset:27648
v_mfma_f32_16x16x32_bf16 v[32:35], v[64:67], a[160:163], v[32:35]
s_waitcnt lgkmcnt(4)
v_mfma_f32_16x16x32_bf16 v[32:35], v[68:71], a[164:167], v[32:35]
buffer_store_dwordx4 v[104:107], v1, s[8:11], s28 offen sc1
v_mfma_f32_16x16x32_bf16 v[20:23], v[72:75], a[32:35], v[20:23]
ds_read_b128 v[64:67], v2 offset:12288
s_add_u32 s28, s28, s45
v_mfma_f32_16x16x32_bf16 v[20:23], v[76:79], a[36:39], v[20:23]
s_add_u32 m0, s30, 18304
v_mfma_f32_16x16x32_bf16 v[28:31], v[72:75], a[96:99], v[28:31]
buffer_load_dwordx4 v6, s[12:15], s24 offen offset:128 lds
v_mfma_f32_16x16x32_bf16 v[28:31], v[76:79], a[100:103], v[28:31]
ds_read_b128 v[68:71], v2 offset:13312
v_mfma_f32_16x16x32_bf16 v[36:39], v[72:75], a[160:163], v[36:39]
s_waitcnt lgkmcnt(4)
v_mfma_f32_16x16x32_bf16 v[36:39], v[76:79], a[164:167], v[36:39]
v_mfma_f32_16x16x32_bf16 v[16:19], v[80:83], a[40:43], v[16:19]
ds_read_b128 v[72:75], v2 offset:28672
v_mfma_f32_16x16x32_bf16 v[16:19], v[84:87], a[44:47], v[16:19]
v_mfma_f32_16x16x32_bf16 v[24:27], v[80:83], a[104:107], v[24:27]
v_mfma_f32_16x16x32_bf16 v[24:27], v[84:87], a[108:111], v[24:27]
ds_read_b128 v[76:79], v2 offset:29696
v_mfma_f32_16x16x32_bf16 v[32:35], v[80:83], a[168:171], v[32:35]
s_waitcnt lgkmcnt(4)
s_add_u32 m0, s30, 19264
v_mfma_f32_16x16x32_bf16 v[32:35], v[84:87], a[172:175], v[32:35]
buffer_load_dwordx4 v6, s[12:15], s24 offen offset:192 lds
v_mfma_f32_16x16x32_bf16 v[20:23], v[88:91], a[40:43], v[20:23]
ds_read_b128 v[80:83], v2 offset:14336
v_mfma_f32_16x16x32_bf16 v[20:23], v[92:95], a[44:47], v[20:23]
s_add_u32 s23, s23, 32768
s_add_u32 s24, s24, 32768
v_mfma_f32_16x16x32_bf16 v[28:31], v[88:91], a[104:107], v[28:31]
s_add_u32 s30, s30, 32768
s_and_b32 s30, s30, 0x1ffff
v_mfma_f32_16x16x32_bf16 v[28:31], v[92:95], a[108:111], v[28:31]
ds_read_b128 v[84:87], v2 offset:15360
v_mfma_f32_16x16x32_bf16 v[36:39], v[88:91], a[168:171], v[36:39]
ds_read_b128 v[88:91], v2 offset:30720
s_waitcnt lgkmcnt(5)
v_mfma_f32_16x16x32_bf16 v[36:39], v[92:95], a[172:175], v[36:39]
ds_read_b128 v[92:95], v2 offset:31744
v_mfma_f32_16x16x32_bf16 v[16:19], v[64:67], a[48:51], v[16:19]
v_mfma_f32_16x16x32_bf16 v[16:19], v[68:71], a[52:55], v[16:19]
s_xor_b32 s45, s45, s46
v_mfma_f32_16x16x32_bf16 v[24:27], v[64:67], a[112:115], v[24:27]
v_mfma_f32_16x16x32_bf16 v[24:27], v[68:71], a[116:119], v[24:27]
v_mfma_f32_16x16x32_bf16 v[32:35], v[64:67], a[176:179], v[32:35]
s_waitcnt lgkmcnt(4)
v_mfma_f32_16x16x32_bf16 v[32:35], v[68:71], a[180:183], v[32:35]
s_waitcnt vmcnt(11)
s_barrier
v_mfma_f32_16x16x32_bf16 v[20:23], v[72:75], a[48:51], v[20:23]
ds_read_b128 v[64:67], v2 offset:32768
v_mfma_f32_16x16x32_bf16 v[20:23], v[76:79], a[52:55], v[20:23]
v_mfma_f32_16x16x32_bf16 v[28:31], v[72:75], a[112:115], v[28:31]
v_mfma_f32_16x16x32_bf16 v[28:31], v[76:79], a[116:119], v[28:31]
ds_read_b128 v[68:71], v2 offset:33792
v_mfma_f32_16x16x32_bf16 v[36:39], v[72:75], a[176:179], v[36:39]
s_waitcnt lgkmcnt(4)
v_mfma_f32_16x16x32_bf16 v[36:39], v[76:79], a[180:183], v[36:39]
v_mfma_f32_16x16x32_bf16 v[16:19], v[80:83], a[56:59], v[16:19]
ds_read_b128 v[72:75], v2 offset:49152
v_mfma_f32_16x16x32_bf16 v[16:19], v[84:87], a[60:63], v[16:19]
v_mfma_f32_16x16x32_bf16 v[24:27], v[80:83], a[120:123], v[24:27]
v_mfma_f32_16x16x32_bf16 v[24:27], v[84:87], a[124:127], v[24:27]
ds_read_b128 v[76:79], v2 offset:50176
v_mfma_f32_16x16x32_bf16 v[32:35], v[80:83], a[184:187], v[32:35]
s_waitcnt lgkmcnt(4)
v_mfma_f32_16x16x32_bf16 v[32:35], v[84:87], a[188:191], v[32:35]
v_mfma_f32_16x16x32_bf16 v[20:23], v[88:91], a[56:59], v[20:23]
ds_read_b128 v[80:83], v2 offset:34816
v_mfma_f32_16x16x32_bf16 v[20:23], v[92:95], a[60:63], v[20:23]
v_mfma_f32_16x16x32_bf16 v[28:31], v[88:91], a[120:123], v[28:31]
v_mfma_f32_16x16x32_bf16 v[28:31], v[92:95], a[124:127], v[28:31]
ds_read_b128 v[84:87], v2 offset:35840
v_mfma_f32_16x16x32_bf16 v[36:39], v[88:91], a[184:187], v[36:39]
s_waitcnt lgkmcnt(4)
v_mfma_f32_16x16x32_bf16 v[36:39], v[92:95], a[188:191], v[36:39]
s_branch L_sp_l
L_sp_f:
s_nop 7
v_cvt_pk_bf16_f32 v96, v40, v41
v_cvt_pk_bf16_f32 v97, v42, v43
v_cvt_pk_bf16_f32 v98, v44, v45
v_cvt_pk_bf16_f32 v99, v46, v47
buffer_store_dwordx4 v[96:99], v1, s[8:11], s26 offen sc1
s_add_u32 s26, s26, s45
v_cvt_pk_bf16_f32 v100, v48, v49
v_cvt_pk_bf16_f32 v101, v50, v51
v_cvt_pk_bf16_f32 v102, v52, v53
v_cvt_pk_bf16_f32 v103, v54, v55
buffer_store_dwordx4 v[100:103], v1, s[8:11], s27 offen sc1
s_add_u32 s27, s27, s45
v_cvt_pk_bf16_f32 v104, v56, v57
v_cvt_pk_bf16_f32 v105, v58, v59
v_cvt_pk_bf16_f32 v106, v60, v61
v_cvt_pk_bf16_f32 v107, v62, v63
buffer_store_dwordx4 v[104:107], v1, s[8:11], s28 offen sc1
s_add_u32 s28, s28, s45
s_waitcnt vmcnt(0) lgkmcnt(0)
s_barrier
s_mov_b32 s36, 0x340fd00
s_cmp_eq_u32 s21, 0
s_cselect_b32 s36, 0x340fe80, s36
s_cmp_eq_u32 s21, 1
s_cselect_b32 s36, 0x10000000, s36
s_add_u32 s36, s36, s33
buffer_store_dword v9, v8, s[8:11], s36 offen sc1
s_add_u32 s21, s21, 1
s_cmp_lt_u32 s21, 3
s_cbranch_scc1 L_sp_prod
s_branch L_k2_fin
L_code_end:
s_endpgm
.section .rodata,"a"
.p2align 6
.amdhsa_kernel standalone__conformer_family_branchformer__speech_kernel
  .amdhsa_next_free_vgpr 512
  .amdhsa_next_free_sgpr 102
  .amdhsa_accum_offset 256
  .amdhsa_group_segment_fixed_size 0
  .amdhsa_kernarg_size 96
  .amdhsa_user_sgpr_count 2
  .amdhsa_user_sgpr_kernarg_segment_ptr 1
  .amdhsa_system_sgpr_workgroup_id_x 1
  .amdhsa_float_denorm_mode_32 3
.end_amdhsa_kernel
```
